```python
import torch

def _softmax(x, axis=-1):
    return torch.softmax(x, dim=axis)
def _gelu(x):
    return torch.nn.functional.gelu(x, approximate="tanh")
def _silu(x):
    return torch.nn.functional.silu(x)
def _sigmoid(x):
    return torch.sigmoid(x)
def _layernorm(x, axis=-1, eps=1e-5):
    m = x.mean(dim=axis, keepdim=True)
    v = x.var(dim=axis, keepdim=True, unbiased=False)
    return (x - m) / torch.sqrt(v + eps)
def _scatter_add(tgt, idx, src, axis=0):
    return tgt.clone().index_add_(axis, idx, src)
def _segment_sum(src, seg, n):
    out = torch.zeros((n,) + src.shape[1:], dtype=src.dtype)
    return out.index_add_(0, seg, src)
def _pad(x, pw):
    flat = tuple(v for pair in reversed(pw) for v in pair)
    return torch.nn.functional.pad(x, flat)

kernel_name = 'standalone__mha_softmax__near_ridge'

def setup_inputs():

    _w = (lambda a: (lambda t: t.to(torch.bfloat16) if t.is_floating_point() else t)(torch.as_tensor(a)))
    B, H, Sq, Sk, D = 16, 16, 736, 512, 256
    return {
        "q": _w((lambda *s: torch.randn(*s, dtype=torch.bfloat16) * 0.8)(B, H, Sq, D)),
        "k": _w((lambda *s: torch.randn(*s, dtype=torch.bfloat16) * 0.8)(B, H, Sk, D)),
        "v": _w((lambda *s: torch.randn(*s, dtype=torch.bfloat16) * 0.05)(B, H, Sk, D)),
    }

def reference(q, k, v):
    scale = q.shape[-1] ** -0.5
    scores = torch.einsum("bhqd,bhkd->bhqk", q, k) * scale
    p = _softmax(scores, axis=-1)
    return torch.einsum("bhqk,bhkd->bhqd", p, v)
```

```asm
; @launch grid=(256,1,1) block=(256,1,1) lds=162240
.amdgcn_target "amdgcn-amd-amdhsa--gfx950"
.text
.globl standalone__mha_softmax__near_ridge_kernel
.p2align 8
.type standalone__mha_softmax__near_ridge_kernel,@function
standalone__mha_softmax__near_ridge_kernel:
    s_cmp_ge_u32 s2, 256
    s_cbranch_scc1 L_end
    s_load_dwordx4 s[32:35], s[0:1], 0
    s_load_dwordx4 s[36:39], s[0:1], 16
    s_and_b32 s3, s2, 7
    s_lshl_b32 s3, s3, 5
    s_lshr_b32 s57, s2, 3
    s_mov_b32 s53, 16384
    v_lshrrev_b32 v245, 6, v0
    v_and_b32 v247, 63, v0
    v_readfirstlane_b32 s20, v245
    s_waitcnt lgkmcnt(0)
    s_cmp_ge_u32 s20, 2
    s_cbranch_scc1 L_proB
L_proA:
    s_mul_hi_u32 s42, s57, 0x55555556
    s_mul_i32 s43, s42, 3
    s_sub_u32 s43, s57, s43
    s_cmp_eq_u32 s43, 2
    s_cselect_b32 s85, 3, 7
    s_cmp_eq_u32 s20, s85
    s_mov_b32 s85, 0x7e967699
    s_cselect_b32 s84, 0xf149f2ca, s85
    s_add_u32 s42, s42, s3
    s_mul_i32 s44, s42, 376832
    s_lshl_b32 s43, s43, 17
    s_add_u32 s44, s44, s43
    s_lshl_b32 s45, s42, 18
    s_lshr_b32 s80, s42, 4
    s_xor_b32 s80, s80, s42
    s_and_b32 s80, s80, 15
    s_lshl_b32 s80, s80, 14
    s_add_u32 s81, s80, 0x1000
    s_sub_u32 s43, 376832, s43
    s_cmp_lt_u32 s57, 96
    s_cselect_b32 s43, s43, 0
    s_cselect_b32 s52, 262144, 0
    s_add_u32 s4, s32, s44
    s_addc_u32 s5, s33, 0
    s_and_b32 s5, s5, 0xffff
    s_mov_b32 s6, s43
    s_add_u32 s54, s38, s44
    s_addc_u32 s55, s39, 0
    s_and_b32 s55, s55, 0xffff
    s_mov_b32 s56, s43
    s_add_u32 s48, s34, s45
    s_addc_u32 s49, s35, 0
    s_and_b32 s49, s49, 0xffff
    s_add_u32 s50, s36, s45
    s_addc_u32 s51, s37, 0
    s_and_b32 s51, s51, 0xffff
    s_mov_b32 s7, 0x00020000
    s_mov_b32 s8, s48
    s_mov_b32 s9, s49
    s_mov_b32 s10, 262144
    s_mov_b32 s11, 0x00020000
    s_mov_b32 s12, s50
    s_mov_b32 s13, s51
    s_mov_b32 s14, 262144
    s_mov_b32 s15, 0x00020000
    s_mov_b32 s16, s54
    s_mov_b32 s17, s55
    s_mov_b32 s18, 0
    s_mov_b32 s19, 0x00020000
    s_mov_b32 s21, 0x3db8aa3b
    s_mov_b32 s30, 0xbdb8aa3b
    s_mov_b32 s22, 0x45800000
    s_mov_b32 s23, s80
    s_mov_b32 s24, s80
    s_mov_b32 s59, 0
    s_mul_i32 s25, s20, 4160
    s_add_u32 s25, s25, 0
    s_mul_i32 s26, s20, 4352
    s_add_u32 s26, s26, 33280
    s_mul_i32 s58, s20, 23280
    s_add_u32 s58, s58, 68096
    s_lshl_b32 s71, s20, 15
    v_lshrrev_b32 v245, 5, v247
    v_lshlrev_b32 v238, 11, v245
    v_and_b32 v248, 31, v247
    v_lshl_add_u32 v238, v248, 4, v238
    s_lshl_b32 s46, s20, 12
    v_add_u32 v238, s46, v238
    v_lshrrev_b32 v232, 3, v247
    v_bfe_u32 v233, v247, 4, 1
    v_and_b32 v234, 7, v247
    v_xor_b32 v234, v234, v233
    v_lshlrev_b32 v249, 9, v232
    v_lshl_add_u32 v249, v234, 4, v249
    s_add_u32 m0, s25, 0
    s_nop 0
    buffer_load_dwordx4 v238, s[8:11], s23 offen nt lds
    s_add_u32 m0, s25, 528
    s_nop 0
    buffer_load_dwordx4 v238, s[8:11], s23 offen offset:512 nt lds
    s_add_u32 m0, s25, 1056
    s_nop 0
    buffer_load_dwordx4 v238, s[8:11], s23 offen offset:1024 nt lds
    s_add_u32 m0, s25, 1584
    s_nop 0
    buffer_load_dwordx4 v238, s[8:11], s23 offen offset:1536 nt lds
    s_add_u32 s23, s23, 16384
    s_and_b32 s23, s23, 0x3ffff
    s_add_u32 m0, s58, 0
    s_add_u32 s40, s71, 0
    buffer_load_dwordx4 v249, s[4:7], s40 offen nt lds
    s_add_u32 m0, s58, 1056
    s_add_u32 s40, s71, 4096
    buffer_load_dwordx4 v249, s[4:7], s40 offen nt lds
    s_add_u32 m0, s58, 2112
    s_add_u32 s40, s71, 8192
    buffer_load_dwordx4 v249, s[4:7], s40 offen nt lds
    s_add_u32 m0, s58, 3168
    s_add_u32 s40, s71, 12288
    buffer_load_dwordx4 v249, s[4:7], s40 offen nt lds
    s_add_u32 m0, s58, 4656
    s_add_u32 s40, s71, 16384
    buffer_load_dwordx4 v249, s[4:7], s40 offen nt lds
    s_add_u32 m0, s58, 5712
    s_add_u32 s40, s71, 20480
    buffer_load_dwordx4 v249, s[4:7], s40 offen nt lds
    s_add_u32 m0, s58, 6768
    s_add_u32 s40, s71, 24576
    buffer_load_dwordx4 v249, s[4:7], s40 offen nt lds
    s_add_u32 m0, s58, 7824
    s_add_u32 s40, s71, 28672
    buffer_load_dwordx4 v249, s[4:7], s40 offen nt lds
    s_add_u32 m0, s58, 9312
    s_add_u32 s40, s71, 128
    buffer_load_dwordx4 v249, s[4:7], s40 offen nt lds
    s_add_u32 m0, s58, 10368
    s_add_u32 s40, s71, 4224
    buffer_load_dwordx4 v249, s[4:7], s40 offen nt lds
    s_add_u32 m0, s58, 11424
    s_add_u32 s40, s71, 8320
    buffer_load_dwordx4 v249, s[4:7], s40 offen nt lds
    s_add_u32 m0, s58, 12480
    s_add_u32 s40, s71, 12416
    buffer_load_dwordx4 v249, s[4:7], s40 offen nt lds
    s_add_u32 m0, s58, 13968
    s_add_u32 s40, s71, 16512
    buffer_load_dwordx4 v249, s[4:7], s40 offen nt lds
    s_add_u32 m0, s58, 15024
    s_add_u32 s40, s71, 20608
    buffer_load_dwordx4 v249, s[4:7], s40 offen nt lds
    s_add_u32 m0, s58, 16080
    s_add_u32 s40, s71, 24704
    buffer_load_dwordx4 v249, s[4:7], s40 offen nt lds
    s_add_u32 m0, s58, 17136
    s_add_u32 s40, s71, 28800
    buffer_load_dwordx4 v249, s[4:7], s40 offen nt lds
    s_add_u32 m0, s58, 18624
    s_add_u32 s40, s71, 256
    buffer_load_dwordx4 v249, s[4:7], s40 offen nt lds
    s_add_u32 m0, s58, 19680
    s_add_u32 s40, s71, 4352
    buffer_load_dwordx4 v249, s[4:7], s40 offen nt lds
    s_add_u32 m0, s58, 20736
    s_add_u32 s40, s71, 8448
    buffer_load_dwordx4 v249, s[4:7], s40 offen nt lds
    s_add_u32 m0, s58, 21792
    s_add_u32 s40, s71, 12544
    buffer_load_dwordx4 v249, s[4:7], s40 offen nt lds
    v_lshrrev_b32 v232, 3, v248
    s_movk_i32 s46, 1056
    v_mul_lo_u32 v250, v232, s46
    v_and_b32 v232, 7, v248
    v_lshl_add_u32 v250, v232, 7, v250
    v_bfe_u32 v232, v248, 1, 1
    v_xor_b32 v232, v232, v245
    v_lshl_add_u32 v250, v232, 4, v250
    v_add_u32 v250, s58, v250
    v_and_b32 v236, 3, v248
    v_lshrrev_b32 v232, 3, v248
    v_lshl_add_u32 v236, v232, 2, v236
    s_movk_i32 s46, 1040
    v_mul_lo_u32 v236, v236, s46
    v_bfe_u32 v232, v248, 2, 1
    v_lshl_add_u32 v236, v232, 9, v236
    v_lshl_add_u32 v236, v245, 4, v236
    v_bfe_u32 v237, v247, 2, 2
    s_movk_i32 s46, 1088
    v_mul_lo_u32 v237, v237, s46
    v_lshl_add_u32 v237, v245, 9, v237
    v_bfe_u32 v232, v247, 4, 1
    v_lshl_add_u32 v237, v232, 5, v237
    v_and_b32 v232, 1, v247
    v_lshl_add_u32 v237, v232, 4, v237
    v_bfe_u32 v232, v247, 1, 1
    v_lshl_add_u32 v237, v232, 3, v237
    v_bfe_u32 v232, v247, 3, 2
    v_lshrrev_b32 v233, 5, v247
    v_lshl_add_u32 v232, v232, 2, v233
    v_and_b32 v233, 7, v247
    v_lshlrev_b32 v246, 9, v232
    v_lshl_add_u32 v246, v233, 4, v246
    v_mul_u32_u24 v251, 0x90, v232
    v_lshl_add_u32 v251, v233, 4, v251
    v_add_u32 v251, s58, v251
    v_mul_u32_u24 v253, 0x90, v248
    v_lshrrev_b32 v232, 4, v248
    v_lshl_add_u32 v253, v232, 6, v253
    v_lshl_add_u32 v253, v245, 4, v253
    v_add_u32 v253, s58, v253
    s_waitcnt vmcnt(16)
    ds_read_b128 a[128:131], v250
    ds_read_b128 a[132:135], v250 offset:32
    ds_read_b128 a[136:139], v250 offset:64
    ds_read_b128 a[140:143], v250 offset:96
    s_waitcnt lgkmcnt(0)
    s_add_u32 m0, s58, 0
    s_add_u32 s40, s71, 16640
    buffer_load_dwordx4 v249, s[4:7], s40 offen nt lds
    s_add_u32 m0, s58, 1056
    s_add_u32 s40, s71, 20736
    buffer_load_dwordx4 v249, s[4:7], s40 offen nt lds
    s_add_u32 m0, s58, 2112
    s_add_u32 s40, s71, 24832
    buffer_load_dwordx4 v249, s[4:7], s40 offen nt lds
    s_add_u32 m0, s58, 3168
    s_add_u32 s40, s71, 28928
    buffer_load_dwordx4 v249, s[4:7], s40 offen nt lds
    s_waitcnt vmcnt(16)
    ds_read_b128 a[192:195], v250 offset:4656
    ds_read_b128 a[196:199], v250 offset:4688
    ds_read_b128 a[200:203], v250 offset:4720
    ds_read_b128 a[204:207], v250 offset:4752
    s_waitcnt lgkmcnt(0)
    s_add_u32 m0, s58, 4656
    s_add_u32 s40, s71, 384
    buffer_load_dwordx4 v249, s[4:7], s40 offen nt lds
    s_add_u32 m0, s58, 5712
    s_add_u32 s40, s71, 4480
    buffer_load_dwordx4 v249, s[4:7], s40 offen nt lds
    s_add_u32 m0, s58, 6768
    s_add_u32 s40, s71, 8576
    buffer_load_dwordx4 v249, s[4:7], s40 offen nt lds
    s_add_u32 m0, s58, 7824
    s_add_u32 s40, s71, 12672
    buffer_load_dwordx4 v249, s[4:7], s40 offen nt lds
    s_waitcnt vmcnt(16)
    ds_read_b128 a[144:147], v250 offset:9312
    ds_read_b128 a[148:151], v250 offset:9344
    ds_read_b128 a[152:155], v250 offset:9376
    ds_read_b128 a[156:159], v250 offset:9408
    s_waitcnt lgkmcnt(0)
    s_add_u32 m0, s58, 9312
    s_add_u32 s40, s71, 16768
    buffer_load_dwordx4 v249, s[4:7], s40 offen nt lds
    s_add_u32 m0, s58, 10368
    s_add_u32 s40, s71, 20864
    buffer_load_dwordx4 v249, s[4:7], s40 offen nt lds
    s_add_u32 m0, s58, 11424
    s_add_u32 s40, s71, 24960
    buffer_load_dwordx4 v249, s[4:7], s40 offen nt lds
    s_add_u32 m0, s58, 12480
    s_add_u32 s40, s71, 29056
    buffer_load_dwordx4 v249, s[4:7], s40 offen nt lds
    s_add_u32 m0, s25, 16640
    s_nop 0
    buffer_load_dwordx4 v238, s[8:11], s23 offen nt lds
    s_add_u32 m0, s25, 17168
    s_nop 0
    buffer_load_dwordx4 v238, s[8:11], s23 offen offset:512 nt lds
    s_add_u32 m0, s25, 17696
    s_nop 0
    buffer_load_dwordx4 v238, s[8:11], s23 offen offset:1024 nt lds
    s_add_u32 m0, s25, 18224
    s_nop 0
    buffer_load_dwordx4 v238, s[8:11], s23 offen offset:1536 nt lds
    s_add_u32 s23, s23, 16384
    s_and_b32 s23, s23, 0x3ffff
    s_add_u32 m0, s26, 0
    s_nop 0
    buffer_load_dwordx4 v238, s[12:15], s24 offen nt lds
    s_add_u32 m0, s26, 576
    s_nop 0
    buffer_load_dwordx4 v238, s[12:15], s24 offen offset:512 nt lds
    s_add_u32 m0, s26, 1152
    s_nop 0
    buffer_load_dwordx4 v238, s[12:15], s24 offen offset:1024 nt lds
    s_add_u32 m0, s26, 1728
    s_nop 0
    buffer_load_dwordx4 v238, s[12:15], s24 offen offset:1536 nt lds
    s_add_u32 s24, s24, 16384
    s_and_b32 s24, s24, 0x3ffff
    s_lshl_b32 s46, s20, 12
    v_add_u32 v238, s46, v238
    s_mul_i32 s25, s20, 8320
    s_add_u32 s25, s25, 0
    s_mul_i32 s26, s20, 8704
    s_add_u32 s26, s26, 33280
    s_add_u32 s68, s23, 4096
    s_add_u32 s69, s24, 4096
    s_barrier
    ds_read_b128 v[216:219], v236
    ds_read_b128 v[220:223], v236 offset:32
    ds_read_b128 v[224:227], v236 offset:64
    ds_read_b128 v[228:231], v236 offset:96
    s_waitcnt lgkmcnt(3)
    v_mfma_f32_32x32x16_bf16 v[128:143], v[216:219], a[128:131], 0
    v_mfma_f32_32x32x16_bf16 v[144:159], v[216:219], a[192:195], 0
    ds_read_b128 v[216:219], v236 offset:128
    s_waitcnt lgkmcnt(3)
    v_mfma_f32_32x32x16_bf16 v[128:143], v[220:223], a[132:135], v[128:143]
    v_mfma_f32_32x32x16_bf16 v[144:159], v[220:223], a[196:199], v[144:159]
    ds_read_b128 v[220:223], v236 offset:160
    s_waitcnt lgkmcnt(3)
    v_mfma_f32_32x32x16_bf16 v[128:143], v[224:227], a[136:139], v[128:143]
    v_mfma_f32_32x32x16_bf16 v[144:159], v[224:227], a[200:203], v[144:159]
    ds_read_b128 v[224:227], v236 offset:192
    s_waitcnt lgkmcnt(3)
    v_mfma_f32_32x32x16_bf16 v[128:143], v[228:231], a[140:143], v[128:143]
    v_mfma_f32_32x32x16_bf16 v[144:159], v[228:231], a[204:207], v[144:159]
    ds_read_b128 v[228:231], v236 offset:224
    s_waitcnt vmcnt(24)
    ds_read_b128 a[208:211], v250 offset:13968
    ds_read_b128 a[212:215], v250 offset:14000
    ds_read_b128 a[216:219], v250 offset:14032
    ds_read_b128 a[220:223], v250 offset:14064
    s_waitcnt lgkmcnt(7)
    v_mfma_f32_32x32x16_bf16 v[128:143], v[216:219], a[144:147], v[128:143]
    s_waitcnt lgkmcnt(3)
    v_mfma_f32_32x32x16_bf16 v[144:159], v[216:219], a[208:211], v[144:159]
    ds_read_b128 v[216:219], v236 offset:256
    v_mfma_f32_32x32x16_bf16 v[128:143], v[220:223], a[148:151], v[128:143]
    s_waitcnt lgkmcnt(3)
    v_mfma_f32_32x32x16_bf16 v[144:159], v[220:223], a[212:215], v[144:159]
    ds_read_b128 v[220:223], v236 offset:288
    v_mfma_f32_32x32x16_bf16 v[128:143], v[224:227], a[152:155], v[128:143]
    s_waitcnt lgkmcnt(3)
    v_mfma_f32_32x32x16_bf16 v[144:159], v[224:227], a[216:219], v[144:159]
    ds_read_b128 v[224:227], v236 offset:320
    v_mfma_f32_32x32x16_bf16 v[128:143], v[228:231], a[156:159], v[128:143]
    s_waitcnt lgkmcnt(3)
    v_mfma_f32_32x32x16_bf16 v[144:159], v[228:231], a[220:223], v[144:159]
    ds_read_b128 v[228:231], v236 offset:352
    s_waitcnt vmcnt(20)
    ds_read_b128 a[160:163], v250 offset:18624
    ds_read_b128 a[164:167], v250 offset:18656
    ds_read_b128 a[168:171], v250 offset:18688
    ds_read_b128 a[172:175], v250 offset:18720
    s_waitcnt vmcnt(16)
    ds_read_b128 a[224:227], v250
    ds_read_b128 a[228:231], v250 offset:32
    ds_read_b128 a[232:235], v250 offset:64
    ds_read_b128 a[236:239], v250 offset:96
    s_waitcnt lgkmcnt(7)
    v_mfma_f32_32x32x16_bf16 v[128:143], v[216:219], a[160:163], v[128:143]
    s_waitcnt lgkmcnt(3)
    v_mfma_f32_32x32x16_bf16 v[144:159], v[216:219], a[224:227], v[144:159]
    ds_read_b128 v[216:219], v236 offset:384
    v_mfma_f32_32x32x16_bf16 v[128:143], v[220:223], a[164:167], v[128:143]
    s_waitcnt lgkmcnt(3)
    v_mfma_f32_32x32x16_bf16 v[144:159], v[220:223], a[228:231], v[144:159]
    ds_read_b128 v[220:223], v236 offset:416
    v_mfma_f32_32x32x16_bf16 v[128:143], v[224:227], a[168:171], v[128:143]
    s_waitcnt lgkmcnt(3)
    v_mfma_f32_32x32x16_bf16 v[144:159], v[224:227], a[232:235], v[144:159]
    ds_read_b128 v[224:227], v236 offset:448
    v_mfma_f32_32x32x16_bf16 v[128:143], v[228:231], a[172:175], v[128:143]
    s_waitcnt lgkmcnt(3)
    v_mfma_f32_32x32x16_bf16 v[144:159], v[228:231], a[236:239], v[144:159]
    ds_read_b128 v[228:231], v236 offset:480
    s_waitcnt vmcnt(12)
    ds_read_b128 a[176:179], v250 offset:4656
    ds_read_b128 a[180:183], v250 offset:4688
    ds_read_b128 a[184:187], v250 offset:4720
    ds_read_b128 a[188:191], v250 offset:4752
    s_waitcnt vmcnt(8)
    ds_read_b128 a[240:243], v250 offset:9312
    ds_read_b128 a[244:247], v250 offset:9344
    ds_read_b128 a[248:251], v250 offset:9376
    ds_read_b128 a[252:255], v250 offset:9408
    s_waitcnt lgkmcnt(7)
    v_mfma_f32_32x32x16_bf16 v[128:143], v[216:219], a[176:179], v[128:143]
    s_waitcnt lgkmcnt(3)
    v_mfma_f32_32x32x16_bf16 v[144:159], v[216:219], a[240:243], v[144:159]
    v_mfma_f32_32x32x16_bf16 v[128:143], v[220:223], a[180:183], v[128:143]
    s_waitcnt lgkmcnt(2)
    v_mfma_f32_32x32x16_bf16 v[144:159], v[220:223], a[244:247], v[144:159]
    s_waitcnt vmcnt(0)
    s_waitcnt lgkmcnt(0)
    s_barrier
    ds_read_b128 v[216:219], v236 offset:16640
    ds_read_b128 v[220:223], v236 offset:16672
    v_mfma_f32_32x32x16_bf16 v[128:143], v[224:227], a[184:187], v[128:143]
    v_mfma_f32_32x32x16_bf16 v[144:159], v[224:227], a[248:251], v[144:159]
    ds_read_b128 v[224:227], v236 offset:16704
    v_mfma_f32_32x32x16_bf16 v[128:143], v[228:231], a[188:191], v[128:143]
    v_mfma_f32_32x32x16_bf16 v[144:159], v[228:231], a[252:255], v[144:159]
    ds_read_b128 v[228:231], v236 offset:16736
    s_add_u32 m0, s25, 0
    s_nop 0
    buffer_load_dwordx4 v238, s[8:11], s23 offen nt lds
    s_add_u32 m0, s25, 528
    s_nop 0
    buffer_load_dwordx4 v238, s[8:11], s23 offen offset:512 nt lds
    s_add_u32 m0, s25, 1056
    s_nop 0
    buffer_load_dwordx4 v238, s[8:11], s23 offen offset:1024 nt lds
    s_add_u32 m0, s25, 1584
    s_nop 0
    buffer_load_dwordx4 v238, s[8:11], s23 offen offset:1536 nt lds
    s_add_u32 s23, s23, 16384
    s_and_b32 s23, s23, 0x3ffff
    s_add_u32 m0, s25, 4160
    s_nop 0
    buffer_load_dwordx4 v238, s[8:11], s68 offen nt lds
    s_add_u32 m0, s25, 4688
    s_nop 0
    buffer_load_dwordx4 v238, s[8:11], s68 offen offset:512 nt lds
    buffer_store_dwordx4 v[0:3], v246, s[16:19], s47 offen nt
    buffer_store_dwordx4 v[8:11], v246, s[16:19], s47 offen nt
    s_add_u32 m0, s25, 5216
    s_nop 0
    buffer_load_dwordx4 v238, s[8:11], s68 offen offset:1024 nt lds
    buffer_store_dwordx4 v[16:19], v246, s[16:19], s47 offen nt
    buffer_store_dwordx4 v[24:27], v246, s[16:19], s47 offen nt
    s_add_u32 m0, s25, 5744
    s_nop 0
    buffer_load_dwordx4 v238, s[8:11], s68 offen offset:1536 nt lds
    s_add_u32 s68, s68, 16384
    s_and_b32 s68, s68, 0x3ffff
    s_add_u32 m0, s26, 17408
    s_nop 0
    buffer_load_dwordx4 v238, s[12:15], s24 offen nt lds
    buffer_store_dwordx4 v[4:7], v246, s[16:19], s47 offen nt
    s_add_u32 m0, s26, 17984
    s_nop 0
    buffer_load_dwordx4 v238, s[12:15], s24 offen offset:512 nt lds
    buffer_store_dwordx4 v[12:15], v246, s[16:19], s47 offen nt
    s_nop 7
    s_nop 7
    v_max3_f32 v247, v128, v129, v130
    v_max3_f32 v248, v144, v145, v146
    v_max3_f32 v247, v247, v131, v132
    v_max3_f32 v248, v248, v147, v148
    v_max3_f32 v247, v247, v133, v134
    v_max3_f32 v248, v248, v149, v150
    v_max3_f32 v247, v247, v135, v136
    v_max3_f32 v248, v248, v151, v152
    v_max3_f32 v247, v247, v137, v138
    v_max3_f32 v248, v248, v153, v154
    v_max3_f32 v247, v247, v139, v140
    v_max3_f32 v248, v248, v155, v156
    v_max3_f32 v247, v247, v141, v142
    v_max3_f32 v248, v248, v157, v158
    v_max_f32 v247, v247, v143
    v_max_f32 v248, v248, v159
    v_mov_b32 v245, v247
    v_mov_b32 v255, v248
    s_nop 1
    v_permlane32_swap_b32 v245, v247
    v_permlane32_swap_b32 v255, v248
    s_nop 0
    v_max_f32 v247, v247, v245
    v_max_f32 v248, v248, v255
    v_mul_f32 v239, s30, v247
    v_mul_f32 v240, s30, v248
    v_min_f32 v240, s84, v240
    v_fma_f32 v232, v128, s21, v239
    s_nop 0
    v_fma_f32 v233, v129, s21, v239
    v_exp_f32 v232, v232
    s_nop 0
    v_fma_f32 v234, v130, s21, v239
    v_exp_f32 v233, v233
    s_nop 0
    v_fma_f32 v235, v131, s21, v239
    v_exp_f32 v234, v234
    v_add_f32 v243, v232, v233
    v_cvt_pk_bf16_f32 v192, v232, v233
    s_nop 0
    v_fma_f32 v232, v132, s21, v239
    v_exp_f32 v235, v235
    v_add_f32 v243, v243, v234
    s_nop 0
    v_fma_f32 v233, v133, s21, v239
    v_exp_f32 v232, v232
    v_add_f32 v243, v243, v235
    v_cvt_pk_bf16_f32 v193, v234, v235
    s_nop 0
    v_fma_f32 v234, v134, s21, v239
    v_exp_f32 v233, v233
    v_add_f32 v243, v243, v232
    s_nop 0
    v_fma_f32 v235, v135, s21, v239
    v_exp_f32 v234, v234
    v_add_f32 v243, v243, v233
    v_cvt_pk_bf16_f32 v194, v232, v233
    s_nop 0
    v_fma_f32 v232, v144, s21, v240
    v_exp_f32 v235, v235
    v_add_f32 v243, v243, v234
    s_nop 0
    v_fma_f32 v233, v145, s21, v240
    v_exp_f32 v232, v232
    v_add_f32 v243, v243, v235
    v_cvt_pk_bf16_f32 v195, v234, v235
    s_nop 0
    v_fma_f32 v234, v146, s21, v240
    v_exp_f32 v233, v233
    s_nop 0
    v_fma_f32 v235, v147, s21, v240
    v_exp_f32 v234, v234
    v_add_f32 v244, v232, v233
    v_cvt_pk_bf16_f32 v196, v232, v233
    s_nop 0
    s_waitcnt lgkmcnt(0)
    v_mfma_f32_32x32x16_bf16 v[160:175], v[216:219], a[128:131], 0
    s_add_u32 m0, s26, 18560
    s_nop 0
    buffer_load_dwordx4 v238, s[12:15], s24 offen offset:1024 nt lds
    s_add_u32 s47, s71, 24576
    buffer_store_dwordx4 v[20:23], v246, s[16:19], s47 offen nt
    v_mfma_f32_32x32x16_bf16 v[176:191], v[216:219], a[192:195], 0
    ds_read_b128 v[216:219], v236 offset:16768
    v_fma_f32 v232, v148, s21, v240
    v_exp_f32 v235, v235
    v_add_f32 v244, v244, v234
    s_add_u32 s47, s71, 25600
    buffer_store_dwordx4 v[28:31], v246, s[16:19], s47 offen nt
    v_mfma_f32_32x32x16_bf16 v[160:175], v[220:223], a[132:135], v[160:175]
    v_fma_f32 v233, v149, s21, v240
    v_exp_f32 v232, v232
    v_add_f32 v244, v244, v235
    v_cvt_pk_bf16_f32 v197, v234, v235
    v_mfma_f32_32x32x16_bf16 v[176:191], v[220:223], a[196:199], v[176:191]
    ds_read_b128 v[220:223], v236 offset:16800
    s_add_u32 m0, s26, 19136
    s_nop 0
    buffer_load_dwordx4 v238, s[12:15], s24 offen offset:1536 nt lds
    s_add_u32 s24, s24, 16384
    s_and_b32 s24, s24, 0x3ffff
    v_mfma_f32_32x32x16_bf16 v[160:175], v[224:227], a[136:139], v[160:175]
    v_fma_f32 v234, v150, s21, v240
    v_exp_f32 v233, v233
    v_add_f32 v244, v244, v232
    v_mfma_f32_32x32x16_bf16 v[176:191], v[224:227], a[200:203], v[176:191]
    ds_read_b128 v[224:227], v236 offset:16832
    v_fma_f32 v235, v151, s21, v240
    v_exp_f32 v234, v234
    v_add_f32 v244, v244, v233
    v_cvt_pk_bf16_f32 v198, v232, v233
    s_add_u32 s47, s71, 0
    buffer_store_dwordx4 v[32:35], v246, s[16:19], s47 offen offset:128 nt
    s_add_u32 s47, s71, 1024
    buffer_store_dwordx4 v[40:43], v246, s[16:19], s47 offen offset:128 nt
    v_mfma_f32_32x32x16_bf16 v[160:175], v[228:231], a[140:143], v[160:175]
    s_add_u32 m0, s26, 21760
    s_nop 0
    buffer_load_dwordx4 v238, s[12:15], s69 offen nt lds
    v_mfma_f32_32x32x16_bf16 v[176:191], v[228:231], a[204:207], v[176:191]
    ds_read_b128 v[228:231], v236 offset:16864
    v_fma_f32 v232, v136, s21, v239
    v_exp_f32 v235, v235
    v_add_f32 v244, v244, v234
    s_waitcnt lgkmcnt(3)
    v_mfma_f32_32x32x16_bf16 v[160:175], v[216:219], a[144:147], v[160:175]
    v_fma_f32 v233, v137, s21, v239
    v_exp_f32 v232, v232
    v_add_f32 v244, v244, v235
    v_cvt_pk_bf16_f32 v199, v234, v235
    s_add_u32 s47, s71, 8192
    buffer_store_dwordx4 v[48:51], v246, s[16:19], s47 offen offset:128 nt
    v_mfma_f32_32x32x16_bf16 v[176:191], v[216:219], a[208:211], v[176:191]
    ds_read_b128 v[216:219], v236 offset:16896
    s_add_u32 m0, s26, 22336
    s_nop 0
    buffer_load_dwordx4 v238, s[12:15], s69 offen offset:512 nt lds
    s_add_u32 s47, s71, 9216
    buffer_store_dwordx4 v[56:59], v246, s[16:19], s47 offen offset:128 nt
    s_waitcnt lgkmcnt(3)
    v_mfma_f32_32x32x16_bf16 v[160:175], v[220:223], a[148:151], v[160:175]
    v_fma_f32 v234, v138, s21, v239
    v_exp_f32 v233, v233
    v_add_f32 v243, v243, v232
    v_mfma_f32_32x32x16_bf16 v[176:191], v[220:223], a[212:215], v[176:191]
    ds_read_b128 v[220:223], v236 offset:16928
    v_fma_f32 v235, v139, s21, v239
    v_exp_f32 v234, v234
    v_add_f32 v243, v243, v233
    v_cvt_pk_bf16_f32 v208, v232, v233
    s_waitcnt lgkmcnt(3)
    v_mfma_f32_32x32x16_bf16 v[160:175], v[224:227], a[152:155], v[160:175]
    s_add_u32 m0, s26, 22912
    s_nop 0
    buffer_load_dwordx4 v238, s[12:15], s69 offen offset:1024 nt lds
    v_mfma_f32_32x32x16_bf16 v[176:191], v[224:227], a[216:219], v[176:191]
    ds_read_b128 v[224:227], v236 offset:16960
    v_fma_f32 v232, v140, s21, v239
    v_exp_f32 v235, v235
    v_add_f32 v243, v243, v234
    s_waitcnt lgkmcnt(3)
    v_mfma_f32_32x32x16_bf16 v[160:175], v[228:231], a[156:159], v[160:175]
    v_fma_f32 v233, v141, s21, v239
    v_exp_f32 v232, v232
    v_add_f32 v243, v243, v235
    v_cvt_pk_bf16_f32 v209, v234, v235
    v_mfma_f32_32x32x16_bf16 v[176:191], v[228:231], a[220:223], v[176:191]
    ds_read_b128 v[228:231], v236 offset:16992
    s_add_u32 m0, s26, 23488
    s_nop 0
    buffer_load_dwordx4 v238, s[12:15], s69 offen offset:1536 nt lds
    s_add_u32 s69, s69, 16384
    s_and_b32 s69, s69, 0x3ffff
    s_waitcnt lgkmcnt(3)
    v_mfma_f32_32x32x16_bf16 v[160:175], v[216:219], a[160:163], v[160:175]
    v_fma_f32 v234, v142, s21, v239
    v_exp_f32 v233, v233
    v_add_f32 v243, v243, v232
    v_mfma_f32_32x32x16_bf16 v[176:191], v[216:219], a[224:227], v[176:191]
    ds_read_b128 v[216:219], v236 offset:17024
    v_fma_f32 v235, v143, s21, v239
    v_exp_f32 v234, v234
    v_add_f32 v243, v243, v233
    v_cvt_pk_bf16_f32 v210, v232, v233
    s_waitcnt lgkmcnt(3)
    v_mfma_f32_32x32x16_bf16 v[160:175], v[220:223], a[164:167], v[160:175]
    v_fma_f32 v232, v152, s21, v240
    v_exp_f32 v235, v235
    v_add_f32 v243, v243, v234
    v_mfma_f32_32x32x16_bf16 v[176:191], v[220:223], a[228:231], v[176:191]
    ds_read_b128 v[220:223], v236 offset:17056
    v_fma_f32 v233, v153, s21, v240
    v_exp_f32 v232, v232
    v_add_f32 v243, v243, v235
    v_cvt_pk_bf16_f32 v211, v234, v235
    s_waitcnt lgkmcnt(3)
    v_mfma_f32_32x32x16_bf16 v[160:175], v[224:227], a[168:171], v[160:175]
    v_fma_f32 v234, v154, s21, v240
    v_exp_f32 v233, v233
    v_add_f32 v244, v244, v232
    v_mfma_f32_32x32x16_bf16 v[176:191], v[224:227], a[232:235], v[176:191]
    ds_read_b128 v[224:227], v236 offset:17088
    v_fma_f32 v235, v155, s21, v240
    v_exp_f32 v234, v234
    v_add_f32 v244, v244, v233
    v_cvt_pk_bf16_f32 v212, v232, v233
    s_waitcnt lgkmcnt(3)
    v_mfma_f32_32x32x16_bf16 v[160:175], v[228:231], a[172:175], v[160:175]
    v_fma_f32 v232, v156, s21, v240
    v_exp_f32 v235, v235
    v_add_f32 v244, v244, v234
    v_mfma_f32_32x32x16_bf16 v[176:191], v[228:231], a[236:239], v[176:191]
    ds_read_b128 v[228:231], v236 offset:17120
    v_fma_f32 v233, v157, s21, v240
    v_exp_f32 v232, v232
    v_add_f32 v244, v244, v235
    v_cvt_pk_bf16_f32 v213, v234, v235
    s_waitcnt lgkmcnt(3)
    v_mfma_f32_32x32x16_bf16 v[160:175], v[216:219], a[176:179], v[160:175]
    v_fma_f32 v234, v158, s21, v240
    v_exp_f32 v233, v233
    v_add_f32 v244, v244, v232
    v_mfma_f32_32x32x16_bf16 v[176:191], v[216:219], a[240:243], v[176:191]
    v_fma_f32 v235, v159, s21, v240
    v_exp_f32 v234, v234
    v_add_f32 v244, v244, v233
    v_cvt_pk_bf16_f32 v214, v232, v233
    s_waitcnt lgkmcnt(2)
    v_mfma_f32_32x32x16_bf16 v[160:175], v[220:223], a[180:183], v[160:175]
    v_exp_f32 v235, v235
    v_add_f32 v244, v244, v234
    v_add_f32 v244, v244, v235
    v_cvt_pk_bf16_f32 v215, v234, v235
    v_mfma_f32_32x32x16_bf16 v[176:191], v[220:223], a[244:247], v[176:191]
    s_waitcnt vmcnt(28)
    s_waitcnt lgkmcnt(0)
    s_barrier
    ds_read_b64_tr_b16 v[216:217], v237 offset:33280
    ds_read_b64_tr_b16 v[218:219], v237 offset:37632
    ds_read_b64_tr_b16 v[220:221], v237 offset:41984
    ds_read_b64_tr_b16 v[222:223], v237 offset:46336
    v_mfma_f32_32x32x16_bf16 v[160:175], v[224:227], a[184:187], v[160:175]
    s_add_u32 m0, s25, 16640
    s_nop 0
    buffer_load_dwordx4 v238, s[8:11], s23 offen nt lds
    v_mfma_f32_32x32x16_bf16 v[176:191], v[224:227], a[248:251], v[176:191]
    ds_read_b64_tr_b16 v[224:225], v237 offset:33344
    ds_read_b64_tr_b16 v[226:227], v237 offset:37696
    v_mfma_f32_32x32x16_bf16 v[160:175], v[228:231], a[188:191], v[160:175]
    v_mov_b32 v241, v243
    v_mov_b32 v242, v244
    v_mfma_f32_32x32x16_bf16 v[176:191], v[228:231], a[252:255], v[176:191]
    ds_read_b64_tr_b16 v[228:229], v237 offset:42048
    ds_read_b64_tr_b16 v[230:231], v237 offset:46400
    s_waitcnt lgkmcnt(6)
    v_mfma_f32_32x32x16_bf16 v[0:15], v[216:219], v[192:195], 0
    s_add_u32 m0, s25, 17168
    s_nop 0
    buffer_load_dwordx4 v238, s[8:11], s23 offen offset:512 nt lds
    v_mfma_f32_32x32x16_bf16 a[0:15], v[216:219], v[196:199], 0
    ds_read_b64_tr_b16 v[216:217], v237 offset:33408
    ds_read_b64_tr_b16 v[218:219], v237 offset:37760
    s_waitcnt lgkmcnt(6)
    v_mfma_f32_32x32x16_bf16 v[0:15], v[220:223], v[208:211], v[0:15]
    v_mfma_f32_32x32x16_bf16 a[0:15], v[220:223], v[212:215], a[0:15]
    ds_read_b64_tr_b16 v[220:221], v237 offset:42112
    ds_read_b64_tr_b16 v[222:223], v237 offset:46464
    v_fma_f32 v232, v160, s21, v239
    v_fma_f32 v233, v161, s21, v239
    v_exp_f32 v232, v232
    s_waitcnt lgkmcnt(6)
    v_mfma_f32_32x32x16_bf16 v[16:31], v[224:227], v[192:195], 0
    s_add_u32 m0, s25, 17696
    s_nop 0
    buffer_load_dwordx4 v238, s[8:11], s23 offen offset:1024 nt lds
    v_mfma_f32_32x32x16_bf16 a[16:31], v[224:227], v[196:199], 0
    ds_read_b64_tr_b16 v[224:225], v237 offset:33472
    ds_read_b64_tr_b16 v[226:227], v237 offset:37824
    v_fma_f32 v234, v162, s21, v239
    v_exp_f32 v233, v233
    s_waitcnt lgkmcnt(6)
    v_mfma_f32_32x32x16_bf16 v[16:31], v[228:231], v[208:211], v[16:31]
    v_fma_f32 v235, v163, s21, v239
    v_exp_f32 v234, v234
    v_add_f32 v243, v232, v233
    v_cvt_pk_bf16_f32 v200, v232, v233
    v_mfma_f32_32x32x16_bf16 a[16:31], v[228:231], v[212:215], a[16:31]
    ds_read_b64_tr_b16 v[228:229], v237 offset:42176
    ds_read_b64_tr_b16 v[230:231], v237 offset:46528
    v_fma_f32 v232, v164, s21, v239
    v_exp_f32 v235, v235
    v_add_f32 v243, v243, v234
    s_waitcnt lgkmcnt(6)
    v_mfma_f32_32x32x16_bf16 v[32:47], v[216:219], v[192:195], 0
    s_add_u32 m0, s25, 18224
    s_nop 0
    buffer_load_dwordx4 v238, s[8:11], s23 offen offset:1536 nt lds
    s_add_u32 s23, s23, 16384
    s_and_b32 s23, s23, 0x3ffff
    v_mfma_f32_32x32x16_bf16 a[32:47], v[216:219], v[196:199], 0
    ds_read_b64_tr_b16 v[216:217], v237 offset:33536
    ds_read_b64_tr_b16 v[218:219], v237 offset:37888
    v_fma_f32 v233, v165, s21, v239
    v_exp_f32 v232, v232
    v_add_f32 v243, v243, v235
    v_cvt_pk_bf16_f32 v201, v234, v235
    s_waitcnt lgkmcnt(6)
    v_mfma_f32_32x32x16_bf16 v[32:47], v[220:223], v[208:211], v[32:47]
    v_fma_f32 v234, v166, s21, v239
    v_exp_f32 v233, v233
    v_add_f32 v243, v243, v232
    v_mfma_f32_32x32x16_bf16 a[32:47], v[220:223], v[212:215], a[32:47]
    ds_read_b64_tr_b16 v[220:221], v237 offset:42240
    ds_read_b64_tr_b16 v[222:223], v237 offset:46592
    v_fma_f32 v235, v167, s21, v239
    v_exp_f32 v234, v234
    v_add_f32 v243, v243, v233
    v_cvt_pk_bf16_f32 v202, v232, v233
    s_waitcnt lgkmcnt(6)
    v_mfma_f32_32x32x16_bf16 v[48:63], v[224:227], v[192:195], 0
    s_add_u32 m0, s25, 20800
    s_nop 0
    buffer_load_dwordx4 v238, s[8:11], s68 offen nt lds
    v_mfma_f32_32x32x16_bf16 a[48:63], v[224:227], v[196:199], 0
    ds_read_b64_tr_b16 v[224:225], v237 offset:33600
    ds_read_b64_tr_b16 v[226:227], v237 offset:37952
    v_fma_f32 v232, v176, s21, v240
    v_exp_f32 v235, v235
    v_add_f32 v243, v243, v234
    s_waitcnt lgkmcnt(6)
    v_mfma_f32_32x32x16_bf16 v[48:63], v[228:231], v[208:211], v[48:63]
    v_fma_f32 v233, v177, s21, v240
    v_exp_f32 v232, v232
    v_add_f32 v243, v243, v235
    v_cvt_pk_bf16_f32 v203, v234, v235
    v_mfma_f32_32x32x16_bf16 a[48:63], v[228:231], v[212:215], a[48:63]
    ds_read_b64_tr_b16 v[228:229], v237 offset:42304
    ds_read_b64_tr_b16 v[230:231], v237 offset:46656
    v_fma_f32 v234, v178, s21, v240
    v_exp_f32 v233, v233
    s_waitcnt lgkmcnt(6)
    v_mfma_f32_32x32x16_bf16 v[64:79], v[216:219], v[192:195], 0
    s_add_u32 m0, s25, 21328
    s_nop 0
    buffer_load_dwordx4 v238, s[8:11], s68 offen offset:512 nt lds
    v_mfma_f32_32x32x16_bf16 a[64:79], v[216:219], v[196:199], 0
    ds_read_b64_tr_b16 v[216:217], v237 offset:33664
    ds_read_b64_tr_b16 v[218:219], v237 offset:38016
    v_fma_f32 v235, v179, s21, v240
    v_exp_f32 v234, v234
    v_add_f32 v244, v232, v233
    v_cvt_pk_bf16_f32 v204, v232, v233
    s_waitcnt lgkmcnt(6)
    v_mfma_f32_32x32x16_bf16 v[64:79], v[220:223], v[208:211], v[64:79]
    v_fma_f32 v232, v180, s21, v240
    v_exp_f32 v235, v235
    v_add_f32 v244, v244, v234
    v_mfma_f32_32x32x16_bf16 a[64:79], v[220:223], v[212:215], a[64:79]
    ds_read_b64_tr_b16 v[220:221], v237 offset:42368
    ds_read_b64_tr_b16 v[222:223], v237 offset:46720
    v_fma_f32 v233, v181, s21, v240
    v_exp_f32 v232, v232
    v_add_f32 v244, v244, v235
    v_cvt_pk_bf16_f32 v205, v234, v235
    s_waitcnt lgkmcnt(6)
    v_mfma_f32_32x32x16_bf16 v[80:95], v[224:227], v[192:195], 0
    s_add_u32 m0, s25, 21856
    s_nop 0
    buffer_load_dwordx4 v238, s[8:11], s68 offen offset:1024 nt lds
    v_mfma_f32_32x32x16_bf16 a[80:95], v[224:227], v[196:199], 0
    ds_read_b64_tr_b16 v[224:225], v237 offset:33728
    ds_read_b64_tr_b16 v[226:227], v237 offset:38080
    v_fma_f32 v234, v182, s21, v240
    v_exp_f32 v233, v233
    v_add_f32 v244, v244, v232
    s_waitcnt lgkmcnt(6)
    v_mfma_f32_32x32x16_bf16 v[80:95], v[228:231], v[208:211], v[80:95]
    v_fma_f32 v235, v183, s21, v240
    v_exp_f32 v234, v234
    v_add_f32 v244, v244, v233
    v_cvt_pk_bf16_f32 v206, v232, v233
    v_mfma_f32_32x32x16_bf16 a[80:95], v[228:231], v[212:215], a[80:95]
    ds_read_b64_tr_b16 v[228:229], v237 offset:42432
    ds_read_b64_tr_b16 v[230:231], v237 offset:46784
    v_fma_f32 v232, v168, s21, v239
    v_exp_f32 v235, v235
    v_add_f32 v244, v244, v234
    s_waitcnt lgkmcnt(6)
    v_mfma_f32_32x32x16_bf16 v[96:111], v[216:219], v[192:195], 0
    s_add_u32 m0, s25, 22384
    s_nop 0
    buffer_load_dwordx4 v238, s[8:11], s68 offen offset:1536 nt lds
    s_add_u32 s68, s68, 16384
    s_and_b32 s68, s68, 0x3ffff
    v_mfma_f32_32x32x16_bf16 a[96:111], v[216:219], v[196:199], 0
    v_fma_f32 v233, v169, s21, v239
    v_exp_f32 v232, v232
    v_add_f32 v244, v244, v235
    v_cvt_pk_bf16_f32 v207, v234, v235
    s_waitcnt lgkmcnt(4)
    v_mfma_f32_32x32x16_bf16 v[96:111], v[220:223], v[208:211], v[96:111]
    v_fma_f32 v234, v170, s21, v239
    v_exp_f32 v233, v233
    v_add_f32 v243, v243, v232
    v_mfma_f32_32x32x16_bf16 a[96:111], v[220:223], v[212:215], a[96:111]
    s_waitcnt vmcnt(24)
    s_waitcnt lgkmcnt(0)
    s_barrier
    ds_read_b128 v[216:219], v236
    ds_read_b128 v[220:223], v236 offset:32
    v_mfma_f32_32x32x16_bf16 v[112:127], v[224:227], v[192:195], 0
    s_add_u32 m0, s26, 0
    s_nop 0
    buffer_load_dwordx4 v238, s[12:15], s24 offen nt lds
    v_mfma_f32_32x32x16_bf16 a[112:127], v[224:227], v[196:199], 0
    ds_read_b128 v[224:227], v236 offset:64
    v_mfma_f32_32x32x16_bf16 v[112:127], v[228:231], v[208:211], v[112:127]
    s_add_u32 m0, s26, 576
    s_nop 0
    buffer_load_dwordx4 v238, s[12:15], s24 offen offset:512 nt lds
    v_mfma_f32_32x32x16_bf16 a[112:127], v[228:231], v[212:215], a[112:127]
    ds_read_b128 v[228:231], v236 offset:96
    s_branch L_it0eA
L_saA:
    s_waitcnt lgkmcnt(3)
    v_mfma_f32_32x32x16_bf16 v[160:175], v[216:219], a[128:131], 0
    s_add_u32 m0, s26, 18560
    s_nop 0
    buffer_load_dwordx4 v238, s[12:15], s24 offen offset:1024 nt lds
    v_mfma_f32_32x32x16_bf16 v[176:191], v[216:219], a[192:195], 0
    ds_read_b128 v[216:219], v236 offset:16768
    v_fma_f32 v235, v139, s21, v239
    v_exp_f32 v234, v234
    v_add_f32 v243, v243, v233
    v_cvt_pk_bf16_f32 v208, v232, v233
    v_fma_f32 v232, v140, s21, v239
    v_exp_f32 v235, v235
    v_add_f32 v243, v243, v234
    s_waitcnt lgkmcnt(3)
    v_mfma_f32_32x32x16_bf16 v[160:175], v[220:223], a[132:135], v[160:175]
    ds_read_b128 a[128:131], v250
    v_fma_f32 v233, v141, s21, v239
    v_exp_f32 v232, v232
    v_add_f32 v243, v243, v235
    v_cvt_pk_bf16_f32 v209, v234, v235
    v_fma_f32 v234, v142, s21, v239
    v_exp_f32 v233, v233
    v_add_f32 v243, v243, v232
    v_mfma_f32_32x32x16_bf16 v[176:191], v[220:223], a[196:199], v[176:191]
    ds_read_b128 v[220:223], v236 offset:16800
    s_add_u32 m0, s26, 19136
    s_nop 0
    buffer_load_dwordx4 v238, s[12:15], s24 offen offset:1536 nt lds
    s_add_u32 s24, s24, 16384
    s_and_b32 s24, s24, 0x3ffff
    ds_read_b128 a[192:195], v250 offset:4656
    s_waitcnt lgkmcnt(5)
    v_mfma_f32_32x32x16_bf16 v[160:175], v[224:227], a[136:139], v[160:175]
    ds_read_b128 a[132:135], v250 offset:32
    v_fma_f32 v235, v143, s21, v239
    v_exp_f32 v234, v234
    v_add_f32 v243, v243, v233
    v_cvt_pk_bf16_f32 v210, v232, v233
    v_fma_f32 v232, v152, s21, v240
    v_exp_f32 v235, v235
    v_add_f32 v243, v243, v234
    v_mfma_f32_32x32x16_bf16 v[176:191], v[224:227], a[200:203], v[176:191]
    ds_read_b128 v[224:227], v236 offset:16832
    ds_read_b128 a[196:199], v250 offset:4688
    v_fma_f32 v233, v153, s21, v240
    v_exp_f32 v232, v232
    v_add_f32 v243, v243, v235
    v_cvt_pk_bf16_f32 v211, v234, v235
    s_waitcnt lgkmcnt(7)
    v_mfma_f32_32x32x16_bf16 v[160:175], v[228:231], a[140:143], v[160:175]
    s_add_u32 m0, s26, 21760
    s_nop 0
    buffer_load_dwordx4 v238, s[12:15], s69 offen nt lds
    ds_read_b128 a[136:139], v250 offset:64
    v_mfma_f32_32x32x16_bf16 v[176:191], v[228:231], a[204:207], v[176:191]
    ds_read_b128 v[228:231], v236 offset:16864
    ds_read_b128 a[200:203], v250 offset:4720
    v_fma_f32 v234, v154, s21, v240
    v_exp_f32 v233, v233
    v_add_f32 v244, v244, v232
    s_waitcnt lgkmcnt(9)
    v_mfma_f32_32x32x16_bf16 v[160:175], v[216:219], a[144:147], v[160:175]
    ds_read_b128 a[140:143], v250 offset:96
    v_fma_f32 v235, v155, s21, v240
    v_exp_f32 v234, v234
    v_add_f32 v244, v244, v233
    v_cvt_pk_bf16_f32 v212, v232, v233
    v_fma_f32 v232, v156, s21, v240
    v_exp_f32 v235, v235
    v_add_f32 v244, v244, v234
    v_mfma_f32_32x32x16_bf16 v[176:191], v[216:219], a[208:211], v[176:191]
    ds_read_b128 v[216:219], v236 offset:16896
    s_add_u32 m0, s26, 22336
    s_nop 0
    buffer_load_dwordx4 v238, s[12:15], s69 offen offset:512 nt lds
    ds_read_b128 a[204:207], v250 offset:4752
    s_waitcnt lgkmcnt(10)
    v_mfma_f32_32x32x16_bf16 v[160:175], v[220:223], a[148:151], v[160:175]
    ds_read_b128 a[144:147], v250 offset:9312
    v_fma_f32 v233, v157, s21, v240
    v_exp_f32 v232, v232
    v_add_f32 v244, v244, v235
    v_cvt_pk_bf16_f32 v213, v234, v235
    v_fma_f32 v234, v158, s21, v240
    v_exp_f32 v233, v233
    v_add_f32 v244, v244, v232
    v_mfma_f32_32x32x16_bf16 v[176:191], v[220:223], a[212:215], v[176:191]
    ds_read_b128 v[220:223], v236 offset:16928
    ds_read_b128 a[208:211], v250 offset:13968
    s_waitcnt lgkmcnt(5)
    s_add_u32 m0, s58, 0
    s_add_u32 s40, s71, 16640
    buffer_load_dwordx4 v249, s[4:7], s40 offen nt lds
    v_mfma_f32_32x32x16_bf16 v[160:175], v[224:227], a[152:155], v[160:175]
    s_add_u32 m0, s26, 22912
    s_nop 0
    buffer_load_dwordx4 v238, s[12:15], s69 offen offset:1024 nt lds
    ds_read_b128 a[148:151], v250 offset:9344
    s_waitcnt lgkmcnt(4)
    s_add_u32 m0, s58, 4656
    s_add_u32 s40, s71, 384
    buffer_load_dwordx4 v249, s[4:7], s40 offen nt lds
    v_mfma_f32_32x32x16_bf16 v[176:191], v[224:227], a[216:219], v[176:191]
    ds_read_b128 v[224:227], v236 offset:16960
    ds_read_b128 a[212:215], v250 offset:14000
    s_add_u32 m0, s58, 1056
    s_add_u32 s40, s71, 20736
    buffer_load_dwordx4 v249, s[4:7], s40 offen nt lds
    v_mfma_f32_32x32x16_bf16 v[160:175], v[228:231], a[156:159], v[160:175]
    ds_read_b128 a[152:155], v250 offset:9376
    s_add_u32 m0, s58, 5712
    s_add_u32 s40, s71, 4480
    buffer_load_dwordx4 v249, s[4:7], s40 offen nt lds
    v_mfma_f32_32x32x16_bf16 v[176:191], v[228:231], a[220:223], v[176:191]
    ds_read_b128 v[228:231], v236 offset:16992
    s_add_u32 m0, s26, 23488
    s_nop 0
    buffer_load_dwordx4 v238, s[12:15], s69 offen offset:1536 nt lds
    s_add_u32 s69, s69, 16384
    s_and_b32 s69, s69, 0x3ffff
    ds_read_b128 a[216:219], v250 offset:14032
    s_add_u32 m0, s58, 2112
    s_add_u32 s40, s71, 24832
    buffer_load_dwordx4 v249, s[4:7], s40 offen nt lds
    v_mfma_f32_32x32x16_bf16 v[160:175], v[216:219], a[160:163], v[160:175]
    ds_read_b128 a[156:159], v250 offset:9408
    s_add_u32 m0, s58, 6768
    s_add_u32 s40, s71, 8576
    buffer_load_dwordx4 v249, s[4:7], s40 offen nt lds
    v_mfma_f32_32x32x16_bf16 v[176:191], v[216:219], a[224:227], v[176:191]
    ds_read_b128 v[216:219], v236 offset:17024
    ds_read_b128 a[220:223], v250 offset:14064
    s_add_u32 m0, s58, 3168
    s_add_u32 s40, s71, 28928
    buffer_load_dwordx4 v249, s[4:7], s40 offen nt lds
    s_waitcnt lgkmcnt(10)
    v_mfma_f32_32x32x16_bf16 v[160:175], v[220:223], a[164:167], v[160:175]
    ds_read_b128 a[160:163], v250 offset:18624
    s_add_u32 m0, s58, 7824
    s_add_u32 s40, s71, 12672
    buffer_load_dwordx4 v249, s[4:7], s40 offen nt lds
    v_mfma_f32_32x32x16_bf16 v[176:191], v[220:223], a[228:231], v[176:191]
    ds_read_b128 v[220:223], v236 offset:17056
    s_waitcnt lgkmcnt(4)
    s_add_u32 m0, s58, 9312
    s_add_u32 s40, s71, 16768
    buffer_load_dwordx4 v249, s[4:7], s40 offen nt lds
    v_mfma_f32_32x32x16_bf16 v[160:175], v[224:227], a[168:171], v[160:175]
    ds_read_b128 a[164:167], v250 offset:18656
    v_fma_f32 v235, v159, s21, v240
    v_exp_f32 v234, v234
    v_add_f32 v244, v244, v233
    v_cvt_pk_bf16_f32 v214, v232, v233
    v_exp_f32 v235, v235
    v_add_f32 v244, v244, v234
    v_mfma_f32_32x32x16_bf16 v[176:191], v[224:227], a[232:235], v[176:191]
    ds_read_b128 v[224:227], v236 offset:17088
    s_add_u32 m0, s58, 10368
    s_add_u32 s40, s71, 20864
    buffer_load_dwordx4 v249, s[4:7], s40 offen nt lds
    v_add_f32 v244, v244, v235
    v_cvt_pk_bf16_f32 v215, v234, v235
    v_mfma_f32_32x32x16_bf16 v[160:175], v[228:231], a[172:175], v[160:175]
    ds_read_b128 a[168:171], v250 offset:18688
    v_mfma_f32_32x32x16_bf16 v[176:191], v[228:231], a[236:239], v[176:191]
    ds_read_b128 v[228:231], v236 offset:17120
    s_add_u32 m0, s58, 11424
    s_add_u32 s40, s71, 24960
    buffer_load_dwordx4 v249, s[4:7], s40 offen nt lds
    s_waitcnt lgkmcnt(7)
    v_mfma_f32_32x32x16_bf16 v[160:175], v[216:219], a[176:179], v[160:175]
    ds_read_b128 a[172:175], v250 offset:18720
    v_mfma_f32_32x32x16_bf16 v[176:191], v[216:219], a[240:243], v[176:191]
    s_add_u32 m0, s58, 12480
    s_add_u32 s40, s71, 29056
    buffer_load_dwordx4 v249, s[4:7], s40 offen nt lds
    s_waitcnt lgkmcnt(5)
    v_mfma_f32_32x32x16_bf16 v[160:175], v[220:223], a[180:183], v[160:175]
    v_mfma_f32_32x32x16_bf16 v[176:191], v[220:223], a[244:247], v[176:191]
    s_waitcnt vmcnt(28)
    s_waitcnt lgkmcnt(0)
    s_barrier
    ds_read_b64_tr_b16 v[216:217], v237 offset:33280
    ds_read_b64_tr_b16 v[218:219], v237 offset:37632
    ds_read_b64_tr_b16 v[220:221], v237 offset:41984
    ds_read_b64_tr_b16 v[222:223], v237 offset:46336
    v_mfma_f32_32x32x16_bf16 v[160:175], v[224:227], a[184:187], v[160:175]
    s_add_u32 m0, s25, 16640
    s_nop 0
    buffer_load_dwordx4 v238, s[8:11], s23 offen nt lds
    v_mfma_f32_32x32x16_bf16 v[176:191], v[224:227], a[248:251], v[176:191]
    ds_read_b64_tr_b16 v[224:225], v237 offset:33344
    ds_read_b64_tr_b16 v[226:227], v237 offset:37696
    v_add_f32 v245, v243, v244
    v_mfma_f32_32x32x16_bf16 v[160:175], v[228:231], a[188:191], v[160:175]
    v_cmp_nge_f32 vcc, s22, v245
    s_cbranch_vccnz L_rares14A
L_backs14A:
    v_add_f32 v241, v241, v243
    v_add_f32 v242, v242, v244
    v_mfma_f32_32x32x16_bf16 v[176:191], v[228:231], a[252:255], v[176:191]
    ds_read_b64_tr_b16 v[228:229], v237 offset:42048
    ds_read_b64_tr_b16 v[230:231], v237 offset:46400
    s_waitcnt lgkmcnt(6)
    v_mfma_f32_32x32x16_bf16 v[0:15], v[216:219], v[192:195], v[0:15]
    s_add_u32 m0, s25, 17168
    s_nop 0
    buffer_load_dwordx4 v238, s[8:11], s23 offen offset:512 nt lds
    v_mfma_f32_32x32x16_bf16 a[0:15], v[216:219], v[196:199], a[0:15]
    ds_read_b64_tr_b16 v[216:217], v237 offset:33408
    ds_read_b64_tr_b16 v[218:219], v237 offset:37760
    s_waitcnt lgkmcnt(6)
    v_mfma_f32_32x32x16_bf16 v[0:15], v[220:223], v[208:211], v[0:15]
    v_mfma_f32_32x32x16_bf16 a[0:15], v[220:223], v[212:215], a[0:15]
    ds_read_b64_tr_b16 v[220:221], v237 offset:42112
    ds_read_b64_tr_b16 v[222:223], v237 offset:46464
    v_fma_f32 v232, v160, s21, v239
    v_fma_f32 v233, v161, s21, v239
    v_exp_f32 v232, v232
    s_waitcnt lgkmcnt(6)
    v_mfma_f32_32x32x16_bf16 v[16:31], v[224:227], v[192:195], v[16:31]
    s_add_u32 m0, s25, 17696
    s_nop 0
    buffer_load_dwordx4 v238, s[8:11], s23 offen offset:1024 nt lds
    v_mfma_f32_32x32x16_bf16 a[16:31], v[224:227], v[196:199], a[16:31]
    ds_read_b64_tr_b16 v[224:225], v237 offset:33472
    ds_read_b64_tr_b16 v[226:227], v237 offset:37824
    v_fma_f32 v234, v162, s21, v239
    v_exp_f32 v233, v233
    s_waitcnt lgkmcnt(6)
    v_mfma_f32_32x32x16_bf16 v[16:31], v[228:231], v[208:211], v[16:31]
    v_fma_f32 v235, v163, s21, v239
    v_exp_f32 v234, v234
    v_add_f32 v243, v232, v233
    v_cvt_pk_bf16_f32 v200, v232, v233
    v_mfma_f32_32x32x16_bf16 a[16:31], v[228:231], v[212:215], a[16:31]
    ds_read_b64_tr_b16 v[228:229], v237 offset:42176
    ds_read_b64_tr_b16 v[230:231], v237 offset:46528
    v_fma_f32 v232, v164, s21, v239
    v_exp_f32 v235, v235
    v_add_f32 v243, v243, v234
    s_waitcnt lgkmcnt(6)
    v_mfma_f32_32x32x16_bf16 v[32:47], v[216:219], v[192:195], v[32:47]
    s_add_u32 m0, s25, 18224
    s_nop 0
    buffer_load_dwordx4 v238, s[8:11], s23 offen offset:1536 nt lds
    s_add_u32 s23, s23, 16384
    s_and_b32 s23, s23, 0x3ffff
    v_mfma_f32_32x32x16_bf16 a[32:47], v[216:219], v[196:199], a[32:47]
    ds_read_b64_tr_b16 v[216:217], v237 offset:33536
    ds_read_b64_tr_b16 v[218:219], v237 offset:37888
    v_fma_f32 v233, v165, s21, v239
    v_exp_f32 v232, v232
    v_add_f32 v243, v243, v235
    v_cvt_pk_bf16_f32 v201, v234, v235
    s_waitcnt lgkmcnt(6)
    v_mfma_f32_32x32x16_bf16 v[32:47], v[220:223], v[208:211], v[32:47]
    v_fma_f32 v234, v166, s21, v239
    v_exp_f32 v233, v233
    v_add_f32 v243, v243, v232
    v_mfma_f32_32x32x16_bf16 a[32:47], v[220:223], v[212:215], a[32:47]
    ds_read_b64_tr_b16 v[220:221], v237 offset:42240
    ds_read_b64_tr_b16 v[222:223], v237 offset:46592
    v_fma_f32 v235, v167, s21, v239
    v_exp_f32 v234, v234
    v_add_f32 v243, v243, v233
    v_cvt_pk_bf16_f32 v202, v232, v233
    s_waitcnt lgkmcnt(6)
    v_mfma_f32_32x32x16_bf16 v[48:63], v[224:227], v[192:195], v[48:63]
    s_add_u32 m0, s25, 20800
    s_nop 0
    buffer_load_dwordx4 v238, s[8:11], s68 offen nt lds
    v_mfma_f32_32x32x16_bf16 a[48:63], v[224:227], v[196:199], a[48:63]
    ds_read_b64_tr_b16 v[224:225], v237 offset:33600
    ds_read_b64_tr_b16 v[226:227], v237 offset:37952
    v_fma_f32 v232, v176, s21, v240
    v_exp_f32 v235, v235
    v_add_f32 v243, v243, v234
    s_waitcnt lgkmcnt(6)
    v_mfma_f32_32x32x16_bf16 v[48:63], v[228:231], v[208:211], v[48:63]
    v_fma_f32 v233, v177, s21, v240
    v_exp_f32 v232, v232
    v_add_f32 v243, v243, v235
    v_cvt_pk_bf16_f32 v203, v234, v235
    v_mfma_f32_32x32x16_bf16 a[48:63], v[228:231], v[212:215], a[48:63]
    ds_read_b64_tr_b16 v[228:229], v237 offset:42304
    ds_read_b64_tr_b16 v[230:231], v237 offset:46656
    v_fma_f32 v234, v178, s21, v240
    v_exp_f32 v233, v233
    s_waitcnt lgkmcnt(6)
    v_mfma_f32_32x32x16_bf16 v[64:79], v[216:219], v[192:195], v[64:79]
    s_add_u32 m0, s25, 21328
    s_nop 0
    buffer_load_dwordx4 v238, s[8:11], s68 offen offset:512 nt lds
    v_mfma_f32_32x32x16_bf16 a[64:79], v[216:219], v[196:199], a[64:79]
    ds_read_b64_tr_b16 v[216:217], v237 offset:33664
    ds_read_b64_tr_b16 v[218:219], v237 offset:38016
    v_fma_f32 v235, v179, s21, v240
    v_exp_f32 v234, v234
    v_add_f32 v244, v232, v233
    v_cvt_pk_bf16_f32 v204, v232, v233
    s_waitcnt lgkmcnt(6)
    v_mfma_f32_32x32x16_bf16 v[64:79], v[220:223], v[208:211], v[64:79]
    s_mov_b32 s12, s50
    s_mov_b32 s13, s51
    s_mov_b32 s14, s52
    s_mov_b32 s24, s80
    s_mov_b32 s69, s81
    v_mfma_f32_32x32x16_bf16 a[64:79], v[220:223], v[212:215], a[64:79]
    ds_read_b64_tr_b16 v[220:221], v237 offset:42368
    ds_read_b64_tr_b16 v[222:223], v237 offset:46720
    v_fma_f32 v232, v180, s21, v240
    v_exp_f32 v235, v235
    v_add_f32 v244, v244, v234
    s_waitcnt lgkmcnt(6)
    v_mfma_f32_32x32x16_bf16 v[80:95], v[224:227], v[192:195], v[80:95]
    s_add_u32 m0, s25, 21856
    s_nop 0
    buffer_load_dwordx4 v238, s[8:11], s68 offen offset:1024 nt lds
    v_mfma_f32_32x32x16_bf16 a[80:95], v[224:227], v[196:199], a[80:95]
    ds_read_b64_tr_b16 v[224:225], v237 offset:33728
    ds_read_b64_tr_b16 v[226:227], v237 offset:38080
    v_fma_f32 v233, v181, s21, v240
    v_exp_f32 v232, v232
    v_add_f32 v244, v244, v235
    v_cvt_pk_bf16_f32 v205, v234, v235
    s_waitcnt lgkmcnt(6)
    v_mfma_f32_32x32x16_bf16 v[80:95], v[228:231], v[208:211], v[80:95]
    v_fma_f32 v234, v182, s21, v240
    v_exp_f32 v233, v233
    v_add_f32 v244, v244, v232
    v_mfma_f32_32x32x16_bf16 a[80:95], v[228:231], v[212:215], a[80:95]
    ds_read_b64_tr_b16 v[228:229], v237 offset:42432
    ds_read_b64_tr_b16 v[230:231], v237 offset:46784
    v_fma_f32 v235, v183, s21, v240
    v_exp_f32 v234, v234
    v_add_f32 v244, v244, v233
    v_cvt_pk_bf16_f32 v206, v232, v233
    s_waitcnt lgkmcnt(6)
    v_mfma_f32_32x32x16_bf16 v[96:111], v[216:219], v[192:195], v[96:111]
    s_add_u32 m0, s25, 22384
    s_nop 0
    buffer_load_dwordx4 v238, s[8:11], s68 offen offset:1536 nt lds
    s_add_u32 s68, s68, 16384
    s_and_b32 s68, s68, 0x3ffff
    v_mfma_f32_32x32x16_bf16 a[96:111], v[216:219], v[196:199], a[96:111]
    v_fma_f32 v232, v168, s21, v239
    v_exp_f32 v235, v235
    v_add_f32 v244, v244, v234
    s_waitcnt lgkmcnt(4)
    v_mfma_f32_32x32x16_bf16 v[96:111], v[220:223], v[208:211], v[96:111]
    v_fma_f32 v233, v169, s21, v239
    v_exp_f32 v232, v232
    v_add_f32 v244, v244, v235
    v_cvt_pk_bf16_f32 v207, v234, v235
    v_mfma_f32_32x32x16_bf16 a[96:111], v[220:223], v[212:215], a[96:111]
    s_waitcnt vmcnt(28)
    s_waitcnt lgkmcnt(0)
    s_barrier
    ds_read_b128 v[216:219], v236
    ds_read_b128 v[220:223], v236 offset:32
    v_mfma_f32_32x32x16_bf16 v[112:127], v[224:227], v[192:195], v[112:127]
    s_add_u32 m0, s26, 0
    s_nop 0
    buffer_load_dwordx4 v238, s[12:15], s24 offen nt lds
    v_mfma_f32_32x32x16_bf16 a[112:127], v[224:227], v[196:199], a[112:127]
    ds_read_b128 v[224:227], v236 offset:64
    v_fma_f32 v234, v170, s21, v239
    v_exp_f32 v233, v233
    v_add_f32 v243, v243, v232
    v_mfma_f32_32x32x16_bf16 v[112:127], v[228:231], v[208:211], v[112:127]
    s_add_u32 m0, s26, 576
    s_nop 0
    buffer_load_dwordx4 v238, s[12:15], s24 offen offset:512 nt lds
    v_mfma_f32_32x32x16_bf16 a[112:127], v[228:231], v[212:215], a[112:127]
    ds_read_b128 v[228:231], v236 offset:96
    s_cmp_eq_u32 s59, 3
    s_cbranch_scc1 L_f15A
    s_waitcnt lgkmcnt(3)
    v_mfma_f32_32x32x16_bf16 v[128:143], v[216:219], a[128:131], 0
    s_add_u32 m0, s26, 1152
    s_nop 0
    buffer_load_dwordx4 v238, s[12:15], s24 offen offset:1024 nt lds
    v_mfma_f32_32x32x16_bf16 v[144:159], v[216:219], a[192:195], 0
    ds_read_b128 v[216:219], v236 offset:128
    v_fma_f32 v235, v171, s21, v239
    v_exp_f32 v234, v234
    v_add_f32 v243, v243, v233
    v_cvt_pk_bf16_f32 v208, v232, v233
    s_waitcnt lgkmcnt(3)
    v_mfma_f32_32x32x16_bf16 v[128:143], v[220:223], a[132:135], v[128:143]
    v_fma_f32 v232, v172, s21, v239
    v_exp_f32 v235, v235
    v_add_f32 v243, v243, v234
    v_mfma_f32_32x32x16_bf16 v[144:159], v[220:223], a[196:199], v[144:159]
    ds_read_b128 v[220:223], v236 offset:160
    s_add_u32 m0, s26, 1728
    s_nop 0
    buffer_load_dwordx4 v238, s[12:15], s24 offen offset:1536 nt lds
    s_add_u32 s24, s24, 16384
    s_and_b32 s24, s24, 0x3ffff
    s_waitcnt lgkmcnt(3)
    v_mfma_f32_32x32x16_bf16 v[128:143], v[224:227], a[136:139], v[128:143]
    v_fma_f32 v233, v173, s21, v239
    v_exp_f32 v232, v232
    v_add_f32 v243, v243, v235
    v_cvt_pk_bf16_f32 v209, v234, v235
    v_mfma_f32_32x32x16_bf16 v[144:159], v[224:227], a[200:203], v[144:159]
    ds_read_b128 v[224:227], v236 offset:192
    v_fma_f32 v234, v174, s21, v239
    v_exp_f32 v233, v233
    v_add_f32 v243, v243, v232
    s_waitcnt lgkmcnt(3)
    v_mfma_f32_32x32x16_bf16 v[128:143], v[228:231], a[140:143], v[128:143]
    s_add_u32 m0, s26, 4352
    s_nop 0
    buffer_load_dwordx4 v238, s[12:15], s69 offen nt lds
    v_mfma_f32_32x32x16_bf16 v[144:159], v[228:231], a[204:207], v[144:159]
    ds_read_b128 v[228:231], v236 offset:224
    v_fma_f32 v235, v175, s21, v239
    v_exp_f32 v234, v234
    v_add_f32 v243, v243, v233
    v_cvt_pk_bf16_f32 v210, v232, v233
    s_waitcnt lgkmcnt(3)
    v_mfma_f32_32x32x16_bf16 v[128:143], v[216:219], a[144:147], v[128:143]
    v_fma_f32 v232, v184, s21, v240
    v_exp_f32 v235, v235
    v_add_f32 v243, v243, v234
    v_mfma_f32_32x32x16_bf16 v[144:159], v[216:219], a[208:211], v[144:159]
    ds_read_b128 v[216:219], v236 offset:256
    s_add_u32 m0, s26, 4928
    s_nop 0
    buffer_load_dwordx4 v238, s[12:15], s69 offen offset:512 nt lds
    s_waitcnt lgkmcnt(3)
    v_mfma_f32_32x32x16_bf16 v[128:143], v[220:223], a[148:151], v[128:143]
    s_waitcnt vmcnt(19)
    ds_read_b128 a[224:227], v250
    ds_read_b128 a[228:231], v250 offset:32
    ds_read_b128 a[232:235], v250 offset:64
    ds_read_b128 a[236:239], v250 offset:96
    v_mfma_f32_32x32x16_bf16 v[144:159], v[220:223], a[212:215], v[144:159]
    ds_read_b128 v[220:223], v236 offset:288
    v_fma_f32 v233, v185, s21, v240
    v_exp_f32 v232, v232
    v_add_f32 v243, v243, v235
    v_cvt_pk_bf16_f32 v211, v234, v235
    s_waitcnt lgkmcnt(7)
    v_mfma_f32_32x32x16_bf16 v[128:143], v[224:227], a[152:155], v[128:143]
    s_add_u32 m0, s26, 5504
    s_nop 0
    buffer_load_dwordx4 v238, s[12:15], s69 offen offset:1024 nt lds
    v_mfma_f32_32x32x16_bf16 v[144:159], v[224:227], a[216:219], v[144:159]
    ds_read_b128 v[224:227], v236 offset:320
    v_fma_f32 v234, v186, s21, v240
    v_exp_f32 v233, v233
    v_add_f32 v244, v244, v232
    s_waitcnt lgkmcnt(7)
    v_mfma_f32_32x32x16_bf16 v[128:143], v[228:231], a[156:159], v[128:143]
    v_fma_f32 v235, v187, s21, v240
    v_exp_f32 v234, v234
    v_add_f32 v244, v244, v233
    v_cvt_pk_bf16_f32 v212, v232, v233
    v_mfma_f32_32x32x16_bf16 v[144:159], v[228:231], a[220:223], v[144:159]
    ds_read_b128 v[228:231], v236 offset:352
    s_add_u32 m0, s26, 6080
    s_nop 0
    buffer_load_dwordx4 v238, s[12:15], s69 offen offset:1536 nt lds
    s_add_u32 s69, s69, 16384
    s_and_b32 s69, s69, 0x3ffff
    s_waitcnt lgkmcnt(7)
    v_mfma_f32_32x32x16_bf16 v[128:143], v[216:219], a[160:163], v[128:143]
    s_waitcnt vmcnt(20)
    ds_read_b128 a[176:179], v250 offset:4656
    ds_read_b128 a[180:183], v250 offset:4688
    ds_read_b128 a[184:187], v250 offset:4720
    ds_read_b128 a[188:191], v250 offset:4752
    s_waitcnt lgkmcnt(10)
    v_mfma_f32_32x32x16_bf16 v[144:159], v[216:219], a[224:227], v[144:159]
    ds_read_b128 v[216:219], v236 offset:384
    v_fma_f32 v232, v188, s21, v240
    v_exp_f32 v235, v235
    v_add_f32 v244, v244, v234
    s_waitcnt lgkmcnt(7)
    v_mfma_f32_32x32x16_bf16 v[128:143], v[220:223], a[164:167], v[128:143]
    s_waitcnt vmcnt(16)
    ds_read_b128 a[240:243], v250 offset:9312
    ds_read_b128 a[244:247], v250 offset:9344
    ds_read_b128 a[248:251], v250 offset:9376
    ds_read_b128 a[252:255], v250 offset:9408
    v_mfma_f32_32x32x16_bf16 v[144:159], v[220:223], a[228:231], v[144:159]
    ds_read_b128 v[220:223], v236 offset:416
    v_fma_f32 v233, v189, s21, v240
    v_exp_f32 v232, v232
    v_add_f32 v244, v244, v235
    v_cvt_pk_bf16_f32 v213, v234, v235
    s_waitcnt lgkmcnt(11)
    v_mfma_f32_32x32x16_bf16 v[128:143], v[224:227], a[168:171], v[128:143]
    v_fma_f32 v234, v190, s21, v240
    v_exp_f32 v233, v233
    v_add_f32 v244, v244, v232
    v_mfma_f32_32x32x16_bf16 v[144:159], v[224:227], a[232:235], v[144:159]
    ds_read_b128 v[224:227], v236 offset:448
    v_fma_f32 v235, v191, s21, v240
    v_exp_f32 v234, v234
    v_add_f32 v244, v244, v233
    v_cvt_pk_bf16_f32 v214, v232, v233
    s_waitcnt lgkmcnt(11)
    v_mfma_f32_32x32x16_bf16 v[128:143], v[228:231], a[172:175], v[128:143]
    v_exp_f32 v235, v235
    v_add_f32 v244, v244, v234
    v_add_f32 v244, v244, v235
    v_cvt_pk_bf16_f32 v215, v234, v235
    v_mfma_f32_32x32x16_bf16 v[144:159], v[228:231], a[236:239], v[144:159]
    ds_read_b128 v[228:231], v236 offset:480
    s_waitcnt lgkmcnt(7)
    v_mfma_f32_32x32x16_bf16 v[128:143], v[216:219], a[176:179], v[128:143]
    s_waitcnt lgkmcnt(6)
    v_mfma_f32_32x32x16_bf16 v[144:159], v[216:219], a[240:243], v[144:159]
    s_waitcnt lgkmcnt(2)
    v_mfma_f32_32x32x16_bf16 v[128:143], v[220:223], a[180:183], v[128:143]
    v_mbcnt_lo_u32_b32 v253, -1, 0
    v_mbcnt_hi_u32_b32 v253, -1, v253
    v_and_b32 v247, 31, v253
    v_mul_u32_u24 v248, 0x90, v247
    v_mfma_f32_32x32x16_bf16 v[144:159], v[220:223], a[244:247], v[144:159]
    s_waitcnt lgkmcnt(0)
    s_barrier
    ds_read_b64_tr_b16 v[216:217], v237 offset:50688
    ds_read_b64_tr_b16 v[218:219], v237 offset:55040
    ds_read_b64_tr_b16 v[220:221], v237 offset:59392
    ds_read_b64_tr_b16 v[222:223], v237 offset:63744
    v_mfma_f32_32x32x16_bf16 v[128:143], v[224:227], a[184:187], v[128:143]
    s_add_u32 m0, s25, 0
    s_nop 0
    buffer_load_dwordx4 v238, s[8:11], s23 offen nt lds
    v_lshrrev_b32 v247, 4, v247
    v_lshl_add_u32 v248, v247, 6, v248
    v_lshrrev_b32 v253, 5, v253
    v_lshl_add_u32 v253, v253, 4, v248
    v_add_u32 v253, s58, v253
    v_mfma_f32_32x32x16_bf16 v[144:159], v[224:227], a[248:251], v[144:159]
    ds_read_b64_tr_b16 v[224:225], v237 offset:50752
    ds_read_b64_tr_b16 v[226:227], v237 offset:55104
    v_add_f32 v245, v243, v244
    v_mfma_f32_32x32x16_bf16 v[128:143], v[228:231], a[188:191], v[128:143]
    v_cmp_nge_f32 vcc, s22, v245
    s_cbranch_vccnz L_rares15A
L_backs15A:
    v_add_f32 v241, v241, v243
    v_add_f32 v242, v242, v244
    v_mfma_f32_32x32x16_bf16 v[144:159], v[228:231], a[252:255], v[144:159]
    ds_read_b64_tr_b16 v[228:229], v237 offset:59456
    ds_read_b64_tr_b16 v[230:231], v237 offset:63808
    s_waitcnt lgkmcnt(6)
    v_mfma_f32_32x32x16_bf16 v[0:15], v[216:219], v[200:203], v[0:15]
    s_add_u32 m0, s25, 528
    s_nop 0
    buffer_load_dwordx4 v238, s[8:11], s23 offen offset:512 nt lds
    v_mfma_f32_32x32x16_bf16 a[0:15], v[216:219], v[204:207], a[0:15]
    ds_read_b64_tr_b16 v[216:217], v237 offset:50816
    ds_read_b64_tr_b16 v[218:219], v237 offset:55168
    s_waitcnt lgkmcnt(6)
    v_mfma_f32_32x32x16_bf16 v[0:15], v[220:223], v[208:211], v[0:15]
    v_mov_b32 v245, v241
    v_mov_b32 v255, v242
    s_nop 1
    v_permlane32_swap_b32 v245, v241
    v_permlane32_swap_b32 v255, v242
    s_nop 0
    v_add_f32 v241, v241, v245
    v_add_f32 v242, v242, v255
    v_rcp_f32 v252, v241
    v_rcp_f32 v254, v242
    v_mfma_f32_32x32x16_bf16 a[0:15], v[220:223], v[212:215], a[0:15]
    ds_read_b64_tr_b16 v[220:221], v237 offset:59520
    ds_read_b64_tr_b16 v[222:223], v237 offset:63872
    v_max3_f32 v247, v128, v129, v130
    v_max3_f32 v248, v144, v145, v146
    v_max3_f32 v247, v247, v131, v132
    v_max3_f32 v248, v248, v147, v148
    s_waitcnt lgkmcnt(6)
    v_mfma_f32_32x32x16_bf16 v[16:31], v[224:227], v[200:203], v[16:31]
    s_add_u32 m0, s25, 1056
    s_nop 0
    buffer_load_dwordx4 v238, s[8:11], s23 offen offset:1024 nt lds
    v_mfma_f32_32x32x16_bf16 a[16:31], v[224:227], v[204:207], a[16:31]
    ds_read_b64_tr_b16 v[224:225], v237 offset:50880
    ds_read_b64_tr_b16 v[226:227], v237 offset:55232
    v_max3_f32 v247, v247, v133, v134
    v_max3_f32 v248, v248, v149, v150
    v_max3_f32 v247, v247, v135, v136
    v_max3_f32 v248, v248, v151, v152
    s_waitcnt lgkmcnt(6)
    v_mfma_f32_32x32x16_bf16 v[16:31], v[228:231], v[208:211], v[16:31]
    v_max3_f32 v247, v247, v137, v138
    v_max3_f32 v248, v248, v153, v154
    v_max3_f32 v247, v247, v139, v140
    v_max3_f32 v248, v248, v155, v156
    v_max3_f32 v247, v247, v141, v142
    v_max3_f32 v248, v248, v157, v158
    v_pk_mul_f32 v[0:1], v[0:1], v[252:253] op_sel_hi:[1,0]
    v_pk_mul_f32 v[2:3], v[2:3], v[252:253] op_sel_hi:[1,0]
    v_pk_mul_f32 v[4:5], v[4:5], v[252:253] op_sel_hi:[1,0]
    v_pk_mul_f32 v[6:7], v[6:7], v[252:253] op_sel_hi:[1,0]
    v_mfma_f32_32x32x16_bf16 a[16:31], v[228:231], v[212:215], a[16:31]
    ds_read_b64_tr_b16 v[228:229], v237 offset:59584
    ds_read_b64_tr_b16 v[230:231], v237 offset:63936
    v_max_f32 v247, v247, v143
    v_max_f32 v248, v248, v159
    v_cvt_pk_bf16_f32 v0, v0, v1
    v_cvt_pk_bf16_f32 v1, v2, v3
    v_cvt_pk_bf16_f32 v2, v4, v5
    v_cvt_pk_bf16_f32 v3, v6, v7
    ds_write_b128 v253, v[0:3] offset:9312
    v_pk_mul_f32 v[8:9], v[8:9], v[252:253] op_sel_hi:[1,0]
    v_pk_mul_f32 v[10:11], v[10:11], v[252:253] op_sel_hi:[1,0]
    v_pk_mul_f32 v[12:13], v[12:13], v[252:253] op_sel_hi:[1,0]
    v_pk_mul_f32 v[14:15], v[14:15], v[252:253] op_sel_hi:[1,0]
    s_waitcnt lgkmcnt(7)
    v_mfma_f32_32x32x16_bf16 v[32:47], v[216:219], v[200:203], v[32:47]
    s_add_u32 m0, s25, 1584
    s_nop 0
    buffer_load_dwordx4 v238, s[8:11], s23 offen offset:1536 nt lds
    s_add_u32 s23, s23, 16384
    s_and_b32 s23, s23, 0x3ffff
    v_cvt_pk_bf16_f32 v8, v8, v9
    v_cvt_pk_bf16_f32 v9, v10, v11
    v_cvt_pk_bf16_f32 v10, v12, v13
    v_cvt_pk_bf16_f32 v11, v14, v15
    ds_write_b128 v253, v[8:11] offset:9344
    v_mfma_f32_32x32x16_bf16 a[32:47], v[216:219], v[204:207], a[32:47]
    ds_read_b64_tr_b16 v[216:217], v237 offset:50944
    ds_read_b64_tr_b16 v[218:219], v237 offset:55296
    s_waitcnt lgkmcnt(8)
    v_mfma_f32_32x32x16_bf16 v[32:47], v[220:223], v[208:211], v[32:47]
    v_mov_b32 v245, v247
    v_mov_b32 v255, v248
    s_nop 1
    v_permlane32_swap_b32 v245, v247
    v_permlane32_swap_b32 v255, v248
    s_nop 0
    v_max_f32 v247, v247, v245
    v_max_f32 v248, v248, v255
    v_mul_f32 v239, s30, v247
    v_mul_f32 v240, s30, v248
    v_min_f32 v240, s84, v240
    v_mfma_f32_32x32x16_bf16 a[32:47], v[220:223], v[212:215], a[32:47]
    ds_read_b64_tr_b16 v[220:221], v237 offset:59648
    ds_read_b64_tr_b16 v[222:223], v237 offset:64000
    v_fma_f32 v232, v128, s21, v239
    v_fma_f32 v233, v129, s21, v239
    v_exp_f32 v232, v232
    v_pk_mul_f32 v[16:17], v[16:17], v[252:253] op_sel_hi:[1,0]
    v_pk_mul_f32 v[18:19], v[18:19], v[252:253] op_sel_hi:[1,0]
    v_pk_mul_f32 v[20:21], v[20:21], v[252:253] op_sel_hi:[1,0]
    v_pk_mul_f32 v[22:23], v[22:23], v[252:253] op_sel_hi:[1,0]
    s_waitcnt lgkmcnt(8)
    v_mfma_f32_32x32x16_bf16 v[48:63], v[224:227], v[200:203], v[48:63]
    s_add_u32 m0, s25, 4160
    s_nop 0
    buffer_load_dwordx4 v238, s[8:11], s68 offen nt lds
    v_cvt_pk_bf16_f32 v16, v16, v17
    v_cvt_pk_bf16_f32 v17, v18, v19
    v_cvt_pk_bf16_f32 v18, v20, v21
    v_cvt_pk_bf16_f32 v19, v22, v23
    ds_write_b128 v253, v[16:19] offset:9376
    v_mfma_f32_32x32x16_bf16 a[48:63], v[224:227], v[204:207], a[48:63]
    ds_read_b64_tr_b16 v[224:225], v237 offset:51008
    ds_read_b64_tr_b16 v[226:227], v237 offset:55360
    v_fma_f32 v234, v130, s21, v239
    v_exp_f32 v233, v233
    v_pk_mul_f32 v[24:25], v[24:25], v[252:253] op_sel_hi:[1,0]
    v_pk_mul_f32 v[26:27], v[26:27], v[252:253] op_sel_hi:[1,0]
    v_pk_mul_f32 v[28:29], v[28:29], v[252:253] op_sel_hi:[1,0]
    v_pk_mul_f32 v[30:31], v[30:31], v[252:253] op_sel_hi:[1,0]
    s_waitcnt lgkmcnt(9)
    v_mfma_f32_32x32x16_bf16 v[48:63], v[228:231], v[208:211], v[48:63]
    v_fma_f32 v235, v131, s21, v239
    v_exp_f32 v234, v234
    v_add_f32 v243, v232, v233
    v_cvt_pk_bf16_f32 v192, v232, v233
    v_cvt_pk_bf16_f32 v24, v24, v25
    v_cvt_pk_bf16_f32 v25, v26, v27
    v_cvt_pk_bf16_f32 v26, v28, v29
    v_cvt_pk_bf16_f32 v27, v30, v31
    ds_write_b128 v253, v[24:27] offset:9408
    v_mfma_f32_32x32x16_bf16 a[48:63], v[228:231], v[212:215], a[48:63]
    ds_read_b64_tr_b16 v[228:229], v237 offset:59712
    ds_read_b64_tr_b16 v[230:231], v237 offset:64064
    v_fma_f32 v232, v132, s21, v239
    v_exp_f32 v235, v235
    v_add_f32 v243, v243, v234
    ds_read_b128 v[0:3], v251 offset:9312
    ds_read_b128 v[8:11], v251 offset:9600
    ds_read_b128 v[16:19], v251 offset:11680
    s_waitcnt lgkmcnt(8)
    ds_read_b128 v[24:27], v251 offset:11968
    v_accvgpr_read_b32 v4, a0
    v_accvgpr_read_b32 v5, a1
    v_accvgpr_read_b32 v6, a2
    v_accvgpr_read_b32 v7, a3
    v_mfma_f32_32x32x16_bf16 v[64:79], v[216:219], v[200:203], v[64:79]
    s_add_u32 m0, s25, 4688
    s_nop 0
    buffer_load_dwordx4 v238, s[8:11], s68 offen offset:512 nt lds
    v_accvgpr_read_b32 v12, a4
    v_accvgpr_read_b32 v13, a5
    v_accvgpr_read_b32 v14, a6
    v_accvgpr_read_b32 v15, a7
    v_pk_mul_f32 v[4:5], v[4:5], v[254:255] op_sel_hi:[1,0]
    v_pk_mul_f32 v[6:7], v[6:7], v[254:255] op_sel_hi:[1,0]
    v_pk_mul_f32 v[12:13], v[12:13], v[254:255] op_sel_hi:[1,0]
    v_pk_mul_f32 v[14:15], v[14:15], v[254:255] op_sel_hi:[1,0]
    v_mfma_f32_32x32x16_bf16 a[64:79], v[216:219], v[204:207], a[64:79]
    ds_read_b64_tr_b16 v[216:217], v237 offset:51072
    ds_read_b64_tr_b16 v[218:219], v237 offset:55424
    v_cvt_pk_bf16_f32 v4, v4, v5
    v_cvt_pk_bf16_f32 v5, v6, v7
    v_cvt_pk_bf16_f32 v6, v12, v13
    v_cvt_pk_bf16_f32 v7, v14, v15
    ds_write_b128 v253, v[4:7] offset:13968
    s_add_u32 s47, s71, 0
    s_waitcnt lgkmcnt(6)
    buffer_store_dwordx4 v[0:3], v246, s[16:19], s47 offen nt
    s_add_u32 s47, s71, 1024
    s_waitcnt lgkmcnt(5)
    buffer_store_dwordx4 v[8:11], v246, s[16:19], s47 offen nt
    v_mfma_f32_32x32x16_bf16 v[64:79], v[220:223], v[208:211], v[64:79]
    v_fma_f32 v233, v133, s21, v239
    v_exp_f32 v232, v232
    v_add_f32 v243, v243, v235
    v_cvt_pk_bf16_f32 v193, v234, v235
    v_accvgpr_read_b32 v20, a8
    v_accvgpr_read_b32 v21, a9
    v_accvgpr_read_b32 v22, a10
    v_accvgpr_read_b32 v23, a11
    v_accvgpr_read_b32 v28, a12
    v_accvgpr_read_b32 v29, a13
    v_accvgpr_read_b32 v30, a14
    v_accvgpr_read_b32 v31, a15
    v_mfma_f32_32x32x16_bf16 a[64:79], v[220:223], v[212:215], a[64:79]
    ds_read_b64_tr_b16 v[220:221], v237 offset:59776
    ds_read_b64_tr_b16 v[222:223], v237 offset:64128
    v_fma_f32 v234, v134, s21, v239
    v_exp_f32 v233, v233
    v_add_f32 v243, v243, v232
    v_pk_mul_f32 v[20:21], v[20:21], v[254:255] op_sel_hi:[1,0]
    v_pk_mul_f32 v[22:23], v[22:23], v[254:255] op_sel_hi:[1,0]
    v_pk_mul_f32 v[28:29], v[28:29], v[254:255] op_sel_hi:[1,0]
    v_pk_mul_f32 v[30:31], v[30:31], v[254:255] op_sel_hi:[1,0]
    v_mfma_f32_32x32x16_bf16 v[80:95], v[224:227], v[200:203], v[80:95]
    s_add_u32 m0, s25, 5216
    s_nop 0
    buffer_load_dwordx4 v238, s[8:11], s68 offen offset:1024 nt lds
    v_cvt_pk_bf16_f32 v20, v20, v21
    v_cvt_pk_bf16_f32 v21, v22, v23
    v_cvt_pk_bf16_f32 v22, v28, v29
    v_cvt_pk_bf16_f32 v23, v30, v31
    ds_write_b128 v253, v[20:23] offset:14000
    v_mfma_f32_32x32x16_bf16 a[80:95], v[224:227], v[204:207], a[80:95]
    ds_read_b64_tr_b16 v[224:225], v237 offset:51136
    ds_read_b64_tr_b16 v[226:227], v237 offset:55488
    s_add_u32 s47, s71, 8192
    s_waitcnt lgkmcnt(9)
    buffer_store_dwordx4 v[16:19], v246, s[16:19], s47 offen nt
    s_add_u32 s47, s71, 9216
    s_waitcnt lgkmcnt(8)
    buffer_store_dwordx4 v[24:27], v246, s[16:19], s47 offen nt
    v_accvgpr_read_b32 v4, a16
    v_accvgpr_read_b32 v5, a17
    v_accvgpr_read_b32 v6, a18
    v_accvgpr_read_b32 v7, a19
    v_mfma_f32_32x32x16_bf16 v[80:95], v[228:231], v[208:211], v[80:95]
    v_fma_f32 v235, v135, s21, v239
    v_exp_f32 v234, v234
    v_add_f32 v243, v243, v233
    v_cvt_pk_bf16_f32 v194, v232, v233
    v_accvgpr_read_b32 v12, a20
    v_accvgpr_read_b32 v13, a21
    v_accvgpr_read_b32 v14, a22
    v_accvgpr_read_b32 v15, a23
    v_pk_mul_f32 v[4:5], v[4:5], v[254:255] op_sel_hi:[1,0]
    v_pk_mul_f32 v[6:7], v[6:7], v[254:255] op_sel_hi:[1,0]
    v_pk_mul_f32 v[12:13], v[12:13], v[254:255] op_sel_hi:[1,0]
    v_pk_mul_f32 v[14:15], v[14:15], v[254:255] op_sel_hi:[1,0]
    v_mfma_f32_32x32x16_bf16 a[80:95], v[228:231], v[212:215], a[80:95]
    ds_read_b64_tr_b16 v[228:229], v237 offset:59840
    ds_read_b64_tr_b16 v[230:231], v237 offset:64192
    v_fma_f32 v232, v144, s21, v240
    v_exp_f32 v235, v235
    v_add_f32 v243, v243, v234
    v_cvt_pk_bf16_f32 v4, v4, v5
    v_cvt_pk_bf16_f32 v5, v6, v7
    v_cvt_pk_bf16_f32 v6, v12, v13
    v_cvt_pk_bf16_f32 v7, v14, v15
    ds_write_b128 v253, v[4:7] offset:14032
    s_waitcnt lgkmcnt(9)
    v_mfma_f32_32x32x16_bf16 v[96:111], v[216:219], v[200:203], v[96:111]
    s_add_u32 m0, s25, 5744
    s_nop 0
    buffer_load_dwordx4 v238, s[8:11], s68 offen offset:1536 nt lds
    s_add_u32 s68, s68, 16384
    s_and_b32 s68, s68, 0x3ffff
    v_accvgpr_read_b32 v20, a24
    v_accvgpr_read_b32 v21, a25
    v_accvgpr_read_b32 v22, a26
    v_accvgpr_read_b32 v23, a27
    v_mfma_f32_32x32x16_bf16 a[96:111], v[216:219], v[204:207], a[96:111]
    v_fma_f32 v233, v145, s21, v240
    v_exp_f32 v232, v232
    v_add_f32 v243, v243, v235
    v_cvt_pk_bf16_f32 v195, v234, v235
    v_accvgpr_read_b32 v28, a28
    v_accvgpr_read_b32 v29, a29
    v_accvgpr_read_b32 v30, a30
    v_accvgpr_read_b32 v31, a31
    v_pk_mul_f32 v[20:21], v[20:21], v[254:255] op_sel_hi:[1,0]
    v_pk_mul_f32 v[22:23], v[22:23], v[254:255] op_sel_hi:[1,0]
    v_pk_mul_f32 v[28:29], v[28:29], v[254:255] op_sel_hi:[1,0]
    v_pk_mul_f32 v[30:31], v[30:31], v[254:255] op_sel_hi:[1,0]
    s_waitcnt lgkmcnt(6)
    v_mfma_f32_32x32x16_bf16 v[96:111], v[220:223], v[208:211], v[96:111]
    v_fma_f32 v234, v146, s21, v240
    v_exp_f32 v233, v233
    v_cvt_pk_bf16_f32 v20, v20, v21
    v_cvt_pk_bf16_f32 v21, v22, v23
    v_cvt_pk_bf16_f32 v22, v28, v29
    v_cvt_pk_bf16_f32 v23, v30, v31
    ds_write_b128 v253, v[20:23] offset:14064
    ds_read_b128 v[4:7], v251 offset:13968
    ds_read_b128 v[12:15], v251 offset:14256
    ds_read_b128 v[20:23], v251 offset:16336
    ds_read_b128 v[28:31], v251 offset:16624
    v_mfma_f32_32x32x16_bf16 a[96:111], v[220:223], v[212:215], a[96:111]
    s_waitcnt vmcnt(20)
    s_waitcnt lgkmcnt(0)
    s_barrier
    ds_read_b128 v[216:219], v236 offset:16640
    ds_read_b128 v[220:223], v236 offset:16672
    v_pk_mul_f32 v[32:33], v[32:33], v[252:253] op_sel_hi:[1,0]
    v_pk_mul_f32 v[34:35], v[34:35], v[252:253] op_sel_hi:[1,0]
    v_pk_mul_f32 v[36:37], v[36:37], v[252:253] op_sel_hi:[1,0]
    v_pk_mul_f32 v[38:39], v[38:39], v[252:253] op_sel_hi:[1,0]
    v_mfma_f32_32x32x16_bf16 v[112:127], v[224:227], v[200:203], v[112:127]
    s_add_u32 m0, s26, 17408
    s_nop 0
    buffer_load_dwordx4 v238, s[12:15], s24 offen nt lds
    v_cvt_pk_bf16_f32 v32, v32, v33
    v_cvt_pk_bf16_f32 v33, v34, v35
    v_cvt_pk_bf16_f32 v34, v36, v37
    v_cvt_pk_bf16_f32 v35, v38, v39
    ds_write_b128 v253, v[32:35] offset:18624
    v_mfma_f32_32x32x16_bf16 a[112:127], v[224:227], v[204:207], a[112:127]
    ds_read_b128 v[224:227], v236 offset:16704
    v_fma_f32 v235, v147, s21, v240
    v_exp_f32 v234, v234
    v_add_f32 v244, v232, v233
    v_cvt_pk_bf16_f32 v196, v232, v233
    s_add_u32 s47, s71, 16384
    buffer_store_dwordx4 v[4:7], v246, s[16:19], s47 offen nt
    v_pk_mul_f32 v[40:41], v[40:41], v[252:253] op_sel_hi:[1,0]
    v_pk_mul_f32 v[42:43], v[42:43], v[252:253] op_sel_hi:[1,0]
    v_pk_mul_f32 v[44:45], v[44:45], v[252:253] op_sel_hi:[1,0]
    v_pk_mul_f32 v[46:47], v[46:47], v[252:253] op_sel_hi:[1,0]
    v_mfma_f32_32x32x16_bf16 v[112:127], v[228:231], v[208:211], v[112:127]
    s_add_u32 m0, s26, 17984
    s_nop 0
    buffer_load_dwordx4 v238, s[12:15], s24 offen offset:512 nt lds
    v_cvt_pk_bf16_f32 v40, v40, v41
    v_cvt_pk_bf16_f32 v41, v42, v43
    v_cvt_pk_bf16_f32 v42, v44, v45
    v_cvt_pk_bf16_f32 v43, v46, v47
    ds_write_b128 v253, v[40:43] offset:18656
    v_mfma_f32_32x32x16_bf16 a[112:127], v[228:231], v[212:215], a[112:127]
    ds_read_b128 v[228:231], v236 offset:16736
    s_add_u32 s47, s71, 17408
    buffer_store_dwordx4 v[12:15], v246, s[16:19], s47 offen nt
    v_pk_mul_f32 v[48:49], v[48:49], v[252:253] op_sel_hi:[1,0]
    v_pk_mul_f32 v[50:51], v[50:51], v[252:253] op_sel_hi:[1,0]
    v_pk_mul_f32 v[52:53], v[52:53], v[252:253] op_sel_hi:[1,0]
    v_pk_mul_f32 v[54:55], v[54:55], v[252:253] op_sel_hi:[1,0]
    v_cvt_pk_bf16_f32 v48, v48, v49
    v_cvt_pk_bf16_f32 v49, v50, v51
    v_cvt_pk_bf16_f32 v50, v52, v53
    v_cvt_pk_bf16_f32 v51, v54, v55
    ds_write_b128 v253, v[48:51] offset:18688
L_it0A:
    s_waitcnt lgkmcnt(6)
    v_mfma_f32_32x32x16_bf16 v[160:175], v[216:219], a[128:131], 0
    s_add_u32 m0, s26, 18560
    s_nop 0
    buffer_load_dwordx4 v238, s[12:15], s24 offen offset:1024 nt lds
    s_add_u32 s47, s71, 24576
    buffer_store_dwordx4 v[20:23], v246, s[16:19], s47 offen nt
    v_pk_mul_f32 v[56:57], v[56:57], v[252:253] op_sel_hi:[1,0]
    v_pk_mul_f32 v[58:59], v[58:59], v[252:253] op_sel_hi:[1,0]
    v_pk_mul_f32 v[60:61], v[60:61], v[252:253] op_sel_hi:[1,0]
    v_pk_mul_f32 v[62:63], v[62:63], v[252:253] op_sel_hi:[1,0]
    v_mfma_f32_32x32x16_bf16 v[176:191], v[216:219], a[192:195], 0
    ds_read_b128 v[216:219], v236 offset:16768
    v_fma_f32 v232, v148, s21, v240
    v_exp_f32 v235, v235
    v_add_f32 v244, v244, v234
    v_cvt_pk_bf16_f32 v56, v56, v57
    v_cvt_pk_bf16_f32 v57, v58, v59
    v_cvt_pk_bf16_f32 v58, v60, v61
    v_cvt_pk_bf16_f32 v59, v62, v63
    ds_write_b128 v253, v[56:59] offset:18720
    s_add_u32 s47, s71, 25600
    buffer_store_dwordx4 v[28:31], v246, s[16:19], s47 offen nt
    s_waitcnt lgkmcnt(7)
    v_mfma_f32_32x32x16_bf16 v[160:175], v[220:223], a[132:135], v[160:175]
    v_fma_f32 v233, v149, s21, v240
    v_exp_f32 v232, v232
    v_add_f32 v244, v244, v235
    v_cvt_pk_bf16_f32 v197, v234, v235
    ds_read_b128 v[32:35], v251 offset:18624
    ds_read_b128 v[40:43], v251 offset:18912
    ds_read_b128 v[48:51], v251 offset:20992
    ds_read_b128 v[56:59], v251 offset:21280
    v_accvgpr_read_b32 v36, a32
    v_accvgpr_read_b32 v37, a33
    v_accvgpr_read_b32 v38, a34
    v_accvgpr_read_b32 v39, a35
    v_mfma_f32_32x32x16_bf16 v[176:191], v[220:223], a[196:199], v[176:191]
    ds_read_b128 v[220:223], v236 offset:16800
    s_add_u32 m0, s26, 19136
    s_nop 0
    buffer_load_dwordx4 v238, s[12:15], s24 offen offset:1536 nt lds
    s_add_u32 s24, s24, 16384
    s_and_b32 s24, s24, 0x3ffff
    v_accvgpr_read_b32 v44, a36
    v_accvgpr_read_b32 v45, a37
    v_accvgpr_read_b32 v46, a38
    v_accvgpr_read_b32 v47, a39
    s_waitcnt lgkmcnt(10)
    v_mfma_f32_32x32x16_bf16 v[160:175], v[224:227], a[136:139], v[160:175]
    v_fma_f32 v234, v150, s21, v240
    v_exp_f32 v233, v233
    v_add_f32 v244, v244, v232
    v_pk_mul_f32 v[36:37], v[36:37], v[254:255] op_sel_hi:[1,0]
    v_pk_mul_f32 v[38:39], v[38:39], v[254:255] op_sel_hi:[1,0]
    v_pk_mul_f32 v[44:45], v[44:45], v[254:255] op_sel_hi:[1,0]
    v_pk_mul_f32 v[46:47], v[46:47], v[254:255] op_sel_hi:[1,0]
    v_cvt_pk_bf16_f32 v36, v36, v37
    v_cvt_pk_bf16_f32 v37, v38, v39
    v_cvt_pk_bf16_f32 v38, v44, v45
    v_cvt_pk_bf16_f32 v39, v46, v47
    ds_write_b128 v253, v[36:39]
    v_mfma_f32_32x32x16_bf16 v[176:191], v[224:227], a[200:203], v[176:191]
    ds_read_b128 v[224:227], v236 offset:16832
    v_fma_f32 v235, v151, s21, v240
    v_exp_f32 v234, v234
    v_add_f32 v244, v244, v233
    v_cvt_pk_bf16_f32 v198, v232, v233
    s_add_u32 s47, s71, 0
    s_waitcnt lgkmcnt(6)
    buffer_store_dwordx4 v[32:35], v246, s[16:19], s47 offen offset:128 nt
    s_add_u32 s47, s71, 1024
    s_waitcnt lgkmcnt(5)
    buffer_store_dwordx4 v[40:43], v246, s[16:19], s47 offen offset:128 nt
    v_mfma_f32_32x32x16_bf16 v[160:175], v[228:231], a[140:143], v[160:175]
    s_add_u32 m0, s26, 21760
    s_nop 0
    buffer_load_dwordx4 v238, s[12:15], s69 offen nt lds
    v_accvgpr_read_b32 v52, a40
    v_accvgpr_read_b32 v53, a41
    v_accvgpr_read_b32 v54, a42
    v_accvgpr_read_b32 v55, a43
    v_accvgpr_read_b32 v60, a44
    v_accvgpr_read_b32 v61, a45
    v_accvgpr_read_b32 v62, a46
    v_accvgpr_read_b32 v63, a47
    v_mfma_f32_32x32x16_bf16 v[176:191], v[228:231], a[204:207], v[176:191]
    ds_read_b128 v[228:231], v236 offset:16864
    v_fma_f32 v232, v136, s21, v239
    v_exp_f32 v235, v235
    v_add_f32 v244, v244, v234
    v_pk_mul_f32 v[52:53], v[52:53], v[254:255] op_sel_hi:[1,0]
    v_pk_mul_f32 v[54:55], v[54:55], v[254:255] op_sel_hi:[1,0]
    v_pk_mul_f32 v[60:61], v[60:61], v[254:255] op_sel_hi:[1,0]
    v_pk_mul_f32 v[62:63], v[62:63], v[254:255] op_sel_hi:[1,0]
    v_mfma_f32_32x32x16_bf16 v[160:175], v[216:219], a[144:147], v[160:175]
    v_fma_f32 v233, v137, s21, v239
    v_exp_f32 v232, v232
    v_add_f32 v244, v244, v235
    v_cvt_pk_bf16_f32 v199, v234, v235
    v_cvt_pk_bf16_f32 v52, v52, v53
    v_cvt_pk_bf16_f32 v53, v54, v55
    v_cvt_pk_bf16_f32 v54, v60, v61
    v_cvt_pk_bf16_f32 v55, v62, v63
    ds_write_b128 v253, v[52:55] offset:32
    s_add_u32 s47, s71, 8192
    s_waitcnt lgkmcnt(6)
    buffer_store_dwordx4 v[48:51], v246, s[16:19], s47 offen offset:128 nt
    v_mfma_f32_32x32x16_bf16 v[176:191], v[216:219], a[208:211], v[176:191]
    ds_read_b128 v[216:219], v236 offset:16896
    s_add_u32 m0, s26, 22336
    s_nop 0
    buffer_load_dwordx4 v238, s[12:15], s69 offen offset:512 nt lds
    s_add_u32 s47, s71, 9216
    s_waitcnt lgkmcnt(6)
    buffer_store_dwordx4 v[56:59], v246, s[16:19], s47 offen offset:128 nt
    v_accvgpr_read_b32 v36, a48
    v_accvgpr_read_b32 v37, a49
    v_accvgpr_read_b32 v38, a50
    v_accvgpr_read_b32 v39, a51
    s_waitcnt lgkmcnt(5)
    v_mfma_f32_32x32x16_bf16 v[160:175], v[220:223], a[148:151], v[160:175]
    v_fma_f32 v234, v138, s21, v239
    v_exp_f32 v233, v233
    v_add_f32 v243, v243, v232
    v_accvgpr_read_b32 v44, a52
    v_accvgpr_read_b32 v45, a53
    v_accvgpr_read_b32 v46, a54
    v_accvgpr_read_b32 v47, a55
    v_pk_mul_f32 v[36:37], v[36:37], v[254:255] op_sel_hi:[1,0]
    v_pk_mul_f32 v[38:39], v[38:39], v[254:255] op_sel_hi:[1,0]
    v_pk_mul_f32 v[44:45], v[44:45], v[254:255] op_sel_hi:[1,0]
    v_pk_mul_f32 v[46:47], v[46:47], v[254:255] op_sel_hi:[1,0]
    v_mfma_f32_32x32x16_bf16 v[176:191], v[220:223], a[212:215], v[176:191]
    ds_read_b128 v[220:223], v236 offset:16928
    v_fma_f32 v235, v139, s21, v239
    v_exp_f32 v234, v234
    v_add_f32 v243, v243, v233
    v_cvt_pk_bf16_f32 v208, v232, v233
    v_cvt_pk_bf16_f32 v36, v36, v37
    v_cvt_pk_bf16_f32 v37, v38, v39
    v_cvt_pk_bf16_f32 v38, v44, v45
    v_cvt_pk_bf16_f32 v39, v46, v47
    ds_write_b128 v253, v[36:39] offset:64
    s_waitcnt lgkmcnt(5)
    v_mfma_f32_32x32x16_bf16 v[160:175], v[224:227], a[152:155], v[160:175]
    s_add_u32 m0, s26, 22912
    s_nop 0
    buffer_load_dwordx4 v238, s[12:15], s69 offen offset:1024 nt lds
    v_accvgpr_read_b32 v52, a56
    v_accvgpr_read_b32 v53, a57
    v_accvgpr_read_b32 v54, a58
    v_accvgpr_read_b32 v55, a59
    v_accvgpr_read_b32 v60, a60
    v_accvgpr_read_b32 v61, a61
    v_accvgpr_read_b32 v62, a62
    v_accvgpr_read_b32 v63, a63
    v_mfma_f32_32x32x16_bf16 v[176:191], v[224:227], a[216:219], v[176:191]
    ds_read_b128 v[224:227], v236 offset:16960
    v_fma_f32 v232, v140, s21, v239
    v_exp_f32 v235, v235
    v_add_f32 v243, v243, v234
    v_pk_mul_f32 v[52:53], v[52:53], v[254:255] op_sel_hi:[1,0]
    v_pk_mul_f32 v[54:55], v[54:55], v[254:255] op_sel_hi:[1,0]
    v_pk_mul_f32 v[60:61], v[60:61], v[254:255] op_sel_hi:[1,0]
    v_pk_mul_f32 v[62:63], v[62:63], v[254:255] op_sel_hi:[1,0]
    s_waitcnt lgkmcnt(5)
    v_mfma_f32_32x32x16_bf16 v[160:175], v[228:231], a[156:159], v[160:175]
    v_fma_f32 v233, v141, s21, v239
    v_exp_f32 v232, v232
    v_add_f32 v243, v243, v235
    v_cvt_pk_bf16_f32 v209, v234, v235
    v_cvt_pk_bf16_f32 v52, v52, v53
    v_cvt_pk_bf16_f32 v53, v54, v55
    v_cvt_pk_bf16_f32 v54, v60, v61
    v_cvt_pk_bf16_f32 v55, v62, v63
    ds_write_b128 v253, v[52:55] offset:96
    v_mfma_f32_32x32x16_bf16 v[176:191], v[228:231], a[220:223], v[176:191]
    ds_read_b128 v[228:231], v236 offset:16992
    s_add_u32 m0, s26, 23488
    s_nop 0
    buffer_load_dwordx4 v238, s[12:15], s69 offen offset:1536 nt lds
    s_add_u32 s69, s69, 16384
    s_and_b32 s69, s69, 0x3ffff
    v_pk_mul_f32 v[64:65], v[64:65], v[252:253] op_sel_hi:[1,0]
    v_pk_mul_f32 v[66:67], v[66:67], v[252:253] op_sel_hi:[1,0]
    v_pk_mul_f32 v[68:69], v[68:69], v[252:253] op_sel_hi:[1,0]
    v_pk_mul_f32 v[70:71], v[70:71], v[252:253] op_sel_hi:[1,0]
    s_waitcnt lgkmcnt(5)
    v_mfma_f32_32x32x16_bf16 v[160:175], v[216:219], a[160:163], v[160:175]
    v_fma_f32 v234, v142, s21, v239
    v_exp_f32 v233, v233
    v_add_f32 v243, v243, v232
    v_cvt_pk_bf16_f32 v64, v64, v65
    v_cvt_pk_bf16_f32 v65, v66, v67
    v_cvt_pk_bf16_f32 v66, v68, v69
    v_cvt_pk_bf16_f32 v67, v70, v71
    ds_write_b128 v253, v[64:67] offset:4656
    v_pk_mul_f32 v[72:73], v[72:73], v[252:253] op_sel_hi:[1,0]
    v_pk_mul_f32 v[74:75], v[74:75], v[252:253] op_sel_hi:[1,0]
    v_pk_mul_f32 v[76:77], v[76:77], v[252:253] op_sel_hi:[1,0]
    v_pk_mul_f32 v[78:79], v[78:79], v[252:253] op_sel_hi:[1,0]
    v_mfma_f32_32x32x16_bf16 v[176:191], v[216:219], a[224:227], v[176:191]
    ds_read_b128 v[216:219], v236 offset:17024
    v_fma_f32 v235, v143, s21, v239
    v_exp_f32 v234, v234
    v_add_f32 v243, v243, v233
    v_cvt_pk_bf16_f32 v210, v232, v233
    v_cvt_pk_bf16_f32 v72, v72, v73
    v_cvt_pk_bf16_f32 v73, v74, v75
    v_cvt_pk_bf16_f32 v74, v76, v77
    v_cvt_pk_bf16_f32 v75, v78, v79
    ds_write_b128 v253, v[72:75] offset:4688
    s_waitcnt lgkmcnt(7)
    v_mfma_f32_32x32x16_bf16 v[160:175], v[220:223], a[164:167], v[160:175]
    v_fma_f32 v232, v152, s21, v240
    v_exp_f32 v235, v235
    v_add_f32 v243, v243, v234
    v_pk_mul_f32 v[80:81], v[80:81], v[252:253] op_sel_hi:[1,0]
    v_pk_mul_f32 v[82:83], v[82:83], v[252:253] op_sel_hi:[1,0]
    v_pk_mul_f32 v[84:85], v[84:85], v[252:253] op_sel_hi:[1,0]
    v_pk_mul_f32 v[86:87], v[86:87], v[252:253] op_sel_hi:[1,0]
    v_cvt_pk_bf16_f32 v80, v80, v81
    v_cvt_pk_bf16_f32 v81, v82, v83
    v_cvt_pk_bf16_f32 v82, v84, v85
    v_cvt_pk_bf16_f32 v83, v86, v87
    ds_write_b128 v253, v[80:83] offset:4720
    v_mfma_f32_32x32x16_bf16 v[176:191], v[220:223], a[228:231], v[176:191]
    ds_read_b128 v[220:223], v236 offset:17056
    v_fma_f32 v233, v153, s21, v240
    v_exp_f32 v232, v232
    v_add_f32 v243, v243, v235
    v_cvt_pk_bf16_f32 v211, v234, v235
    v_pk_mul_f32 v[88:89], v[88:89], v[252:253] op_sel_hi:[1,0]
    v_pk_mul_f32 v[90:91], v[90:91], v[252:253] op_sel_hi:[1,0]
    v_pk_mul_f32 v[92:93], v[92:93], v[252:253] op_sel_hi:[1,0]
    v_pk_mul_f32 v[94:95], v[94:95], v[252:253] op_sel_hi:[1,0]
    s_waitcnt lgkmcnt(7)
    v_mfma_f32_32x32x16_bf16 v[160:175], v[224:227], a[168:171], v[160:175]
    v_fma_f32 v234, v154, s21, v240
    v_exp_f32 v233, v233
    v_add_f32 v244, v244, v232
    v_cvt_pk_bf16_f32 v88, v88, v89
    v_cvt_pk_bf16_f32 v89, v90, v91
    v_cvt_pk_bf16_f32 v90, v92, v93
    v_cvt_pk_bf16_f32 v91, v94, v95
    ds_write_b128 v253, v[88:91] offset:4752
    v_accvgpr_read_b32 v68, a64
    v_accvgpr_read_b32 v69, a65
    v_accvgpr_read_b32 v70, a66
    v_accvgpr_read_b32 v71, a67
    v_mfma_f32_32x32x16_bf16 v[176:191], v[224:227], a[232:235], v[176:191]
    ds_read_b128 v[224:227], v236 offset:17088
    v_fma_f32 v235, v155, s21, v240
    v_exp_f32 v234, v234
    v_add_f32 v244, v244, v233
    v_cvt_pk_bf16_f32 v212, v232, v233
    v_accvgpr_read_b32 v76, a68
    v_accvgpr_read_b32 v77, a69
    v_accvgpr_read_b32 v78, a70
    v_accvgpr_read_b32 v79, a71
    v_pk_mul_f32 v[68:69], v[68:69], v[254:255] op_sel_hi:[1,0]
    v_pk_mul_f32 v[70:71], v[70:71], v[254:255] op_sel_hi:[1,0]
    v_pk_mul_f32 v[76:77], v[76:77], v[254:255] op_sel_hi:[1,0]
    v_pk_mul_f32 v[78:79], v[78:79], v[254:255] op_sel_hi:[1,0]
    s_waitcnt lgkmcnt(7)
    v_mfma_f32_32x32x16_bf16 v[160:175], v[228:231], a[172:175], v[160:175]
    v_fma_f32 v232, v156, s21, v240
    v_exp_f32 v235, v235
    v_add_f32 v244, v244, v234
    v_cvt_pk_bf16_f32 v68, v68, v69
    v_cvt_pk_bf16_f32 v69, v70, v71
    v_cvt_pk_bf16_f32 v70, v76, v77
    v_cvt_pk_bf16_f32 v71, v78, v79
    ds_write_b128 v253, v[68:71] offset:9312
    v_accvgpr_read_b32 v84, a72
    v_accvgpr_read_b32 v85, a73
    v_accvgpr_read_b32 v86, a74
    v_accvgpr_read_b32 v87, a75
    v_mfma_f32_32x32x16_bf16 v[176:191], v[228:231], a[236:239], v[176:191]
    ds_read_b128 v[228:231], v236 offset:17120
    v_fma_f32 v233, v157, s21, v240
    v_exp_f32 v232, v232
    v_add_f32 v244, v244, v235
    v_cvt_pk_bf16_f32 v213, v234, v235
    v_accvgpr_read_b32 v92, a76
    v_accvgpr_read_b32 v93, a77
    v_accvgpr_read_b32 v94, a78
    v_accvgpr_read_b32 v95, a79
    v_pk_mul_f32 v[84:85], v[84:85], v[254:255] op_sel_hi:[1,0]
    v_pk_mul_f32 v[86:87], v[86:87], v[254:255] op_sel_hi:[1,0]
    v_pk_mul_f32 v[92:93], v[92:93], v[254:255] op_sel_hi:[1,0]
    v_pk_mul_f32 v[94:95], v[94:95], v[254:255] op_sel_hi:[1,0]
    s_waitcnt lgkmcnt(7)
    v_mfma_f32_32x32x16_bf16 v[160:175], v[216:219], a[176:179], v[160:175]
    v_fma_f32 v234, v158, s21, v240
    v_exp_f32 v233, v233
    v_add_f32 v244, v244, v232
    v_cvt_pk_bf16_f32 v84, v84, v85
    v_cvt_pk_bf16_f32 v85, v86, v87
    v_cvt_pk_bf16_f32 v86, v92, v93
    v_cvt_pk_bf16_f32 v87, v94, v95
    ds_write_b128 v253, v[84:87] offset:9344
    v_accvgpr_read_b32 v68, a80
    v_accvgpr_read_b32 v69, a81
    v_accvgpr_read_b32 v70, a82
    v_accvgpr_read_b32 v71, a83
    v_mfma_f32_32x32x16_bf16 v[176:191], v[216:219], a[240:243], v[176:191]
    v_fma_f32 v235, v159, s21, v240
    v_exp_f32 v234, v234
    v_add_f32 v244, v244, v233
    v_cvt_pk_bf16_f32 v214, v232, v233
    v_accvgpr_read_b32 v76, a84
    v_accvgpr_read_b32 v77, a85
    v_accvgpr_read_b32 v78, a86
    v_accvgpr_read_b32 v79, a87
    v_pk_mul_f32 v[68:69], v[68:69], v[254:255] op_sel_hi:[1,0]
    v_pk_mul_f32 v[70:71], v[70:71], v[254:255] op_sel_hi:[1,0]
    v_pk_mul_f32 v[76:77], v[76:77], v[254:255] op_sel_hi:[1,0]
    v_pk_mul_f32 v[78:79], v[78:79], v[254:255] op_sel_hi:[1,0]
    s_waitcnt lgkmcnt(5)
    v_mfma_f32_32x32x16_bf16 v[160:175], v[220:223], a[180:183], v[160:175]
    v_exp_f32 v235, v235
    v_add_f32 v244, v244, v234
    v_add_f32 v244, v244, v235
    v_cvt_pk_bf16_f32 v215, v234, v235
    v_cvt_pk_bf16_f32 v68, v68, v69
    v_cvt_pk_bf16_f32 v69, v70, v71
    v_cvt_pk_bf16_f32 v70, v76, v77
    v_cvt_pk_bf16_f32 v71, v78, v79
    ds_write_b128 v253, v[68:71] offset:9376
    v_mfma_f32_32x32x16_bf16 v[176:191], v[220:223], a[244:247], v[176:191]
    s_waitcnt vmcnt(28)
    s_waitcnt lgkmcnt(0)
    s_barrier
    ds_read_b64_tr_b16 v[216:217], v237 offset:33280
    ds_read_b64_tr_b16 v[218:219], v237 offset:37632
    ds_read_b64_tr_b16 v[220:221], v237 offset:41984
    ds_read_b64_tr_b16 v[222:223], v237 offset:46336
    v_accvgpr_read_b32 v84, a88
    v_accvgpr_read_b32 v85, a89
    v_accvgpr_read_b32 v86, a90
    v_accvgpr_read_b32 v87, a91
    v_mfma_f32_32x32x16_bf16 v[160:175], v[224:227], a[184:187], v[160:175]
    s_add_u32 m0, s25, 16640
    s_nop 0
    buffer_load_dwordx4 v238, s[8:11], s23 offen nt lds
    v_accvgpr_read_b32 v92, a92
    v_accvgpr_read_b32 v93, a93
    v_accvgpr_read_b32 v94, a94
    v_accvgpr_read_b32 v95, a95
    v_pk_mul_f32 v[84:85], v[84:85], v[254:255] op_sel_hi:[1,0]
    v_pk_mul_f32 v[86:87], v[86:87], v[254:255] op_sel_hi:[1,0]
    v_pk_mul_f32 v[92:93], v[92:93], v[254:255] op_sel_hi:[1,0]
    v_pk_mul_f32 v[94:95], v[94:95], v[254:255] op_sel_hi:[1,0]
    v_mfma_f32_32x32x16_bf16 v[176:191], v[224:227], a[248:251], v[176:191]
    ds_read_b64_tr_b16 v[224:225], v237 offset:33344
    ds_read_b64_tr_b16 v[226:227], v237 offset:37696
    v_cvt_pk_bf16_f32 v84, v84, v85
    v_cvt_pk_bf16_f32 v85, v86, v87
    v_cvt_pk_bf16_f32 v86, v92, v93
    v_cvt_pk_bf16_f32 v87, v94, v95
    ds_write_b128 v253, v[84:87] offset:9408
    v_pk_mul_f32 v[96:97], v[96:97], v[252:253] op_sel_hi:[1,0]
    v_pk_mul_f32 v[98:99], v[98:99], v[252:253] op_sel_hi:[1,0]
    v_pk_mul_f32 v[100:101], v[100:101], v[252:253] op_sel_hi:[1,0]
    v_pk_mul_f32 v[102:103], v[102:103], v[252:253] op_sel_hi:[1,0]
    v_mfma_f32_32x32x16_bf16 v[160:175], v[228:231], a[188:191], v[160:175]
    v_mov_b32 v241, v243
    v_mov_b32 v242, v244
    v_cvt_pk_bf16_f32 v96, v96, v97
    v_cvt_pk_bf16_f32 v97, v98, v99
    v_cvt_pk_bf16_f32 v98, v100, v101
    v_cvt_pk_bf16_f32 v99, v102, v103
    ds_write_b128 v253, v[96:99] offset:13968
    v_pk_mul_f32 v[104:105], v[104:105], v[252:253] op_sel_hi:[1,0]
    v_pk_mul_f32 v[106:107], v[106:107], v[252:253] op_sel_hi:[1,0]
    v_pk_mul_f32 v[108:109], v[108:109], v[252:253] op_sel_hi:[1,0]
    v_pk_mul_f32 v[110:111], v[110:111], v[252:253] op_sel_hi:[1,0]
    v_mfma_f32_32x32x16_bf16 v[176:191], v[228:231], a[252:255], v[176:191]
    ds_read_b64_tr_b16 v[228:229], v237 offset:42048
    ds_read_b64_tr_b16 v[230:231], v237 offset:46400
    v_cvt_pk_bf16_f32 v104, v104, v105
    v_cvt_pk_bf16_f32 v105, v106, v107
    v_cvt_pk_bf16_f32 v106, v108, v109
    v_cvt_pk_bf16_f32 v107, v110, v111
    ds_write_b128 v253, v[104:107] offset:14000
    v_pk_mul_f32 v[112:113], v[112:113], v[252:253] op_sel_hi:[1,0]
    v_pk_mul_f32 v[114:115], v[114:115], v[252:253] op_sel_hi:[1,0]
    v_pk_mul_f32 v[116:117], v[116:117], v[252:253] op_sel_hi:[1,0]
    v_pk_mul_f32 v[118:119], v[118:119], v[252:253] op_sel_hi:[1,0]
    s_waitcnt lgkmcnt(9)
    v_mfma_f32_32x32x16_bf16 v[0:15], v[216:219], v[192:195], 0
    s_add_u32 m0, s25, 17168
    s_nop 0
    buffer_load_dwordx4 v238, s[8:11], s23 offen offset:512 nt lds
    v_cvt_pk_bf16_f32 v112, v112, v113
    v_cvt_pk_bf16_f32 v113, v114, v115
    v_cvt_pk_bf16_f32 v114, v116, v117
    v_cvt_pk_bf16_f32 v115, v118, v119
    ds_write_b128 v253, v[112:115] offset:14032
    v_mfma_f32_32x32x16_bf16 a[0:15], v[216:219], v[196:199], 0
    ds_read_b64_tr_b16 v[216:217], v237 offset:33408
    ds_read_b64_tr_b16 v[218:219], v237 offset:37760
    v_pk_mul_f32 v[120:121], v[120:121], v[252:253] op_sel_hi:[1,0]
    v_pk_mul_f32 v[122:123], v[122:123], v[252:253] op_sel_hi:[1,0]
    v_pk_mul_f32 v[124:125], v[124:125], v[252:253] op_sel_hi:[1,0]
    v_pk_mul_f32 v[126:127], v[126:127], v[252:253] op_sel_hi:[1,0]
    v_cvt_pk_bf16_f32 v120, v120, v121
    v_cvt_pk_bf16_f32 v121, v122, v123
    v_cvt_pk_bf16_f32 v122, v124, v125
    v_cvt_pk_bf16_f32 v123, v126, v127
    ds_write_b128 v253, v[120:123] offset:14064
    s_waitcnt lgkmcnt(11)
    v_mfma_f32_32x32x16_bf16 v[0:15], v[220:223], v[208:211], v[0:15]
    v_accvgpr_read_b32 v100, a96
    v_accvgpr_read_b32 v101, a97
    v_accvgpr_read_b32 v102, a98
    v_accvgpr_read_b32 v103, a99
    v_accvgpr_read_b32 v108, a100
    v_accvgpr_read_b32 v109, a101
    v_accvgpr_read_b32 v110, a102
    v_accvgpr_read_b32 v111, a103
    v_pk_mul_f32 v[100:101], v[100:101], v[254:255] op_sel_hi:[1,0]
    v_pk_mul_f32 v[102:103], v[102:103], v[254:255] op_sel_hi:[1,0]
    v_pk_mul_f32 v[108:109], v[108:109], v[254:255] op_sel_hi:[1,0]
    v_pk_mul_f32 v[110:111], v[110:111], v[254:255] op_sel_hi:[1,0]
    v_mfma_f32_32x32x16_bf16 a[0:15], v[220:223], v[212:215], a[0:15]
    ds_read_b64_tr_b16 v[220:221], v237 offset:42112
    ds_read_b64_tr_b16 v[222:223], v237 offset:46464
    v_fma_f32 v232, v160, s21, v239
    v_fma_f32 v233, v161, s21, v239
    v_exp_f32 v232, v232
    v_cvt_pk_bf16_f32 v100, v100, v101
    v_cvt_pk_bf16_f32 v101, v102, v103
    v_cvt_pk_bf16_f32 v102, v108, v109
    v_cvt_pk_bf16_f32 v103, v110, v111
    ds_write_b128 v253, v[100:103] offset:18624
    s_waitcnt lgkmcnt(12)
    v_mfma_f32_32x32x16_bf16 v[16:31], v[224:227], v[192:195], 0
    s_add_u32 m0, s25, 17696
    s_nop 0
    buffer_load_dwordx4 v238, s[8:11], s23 offen offset:1024 nt lds
    v_accvgpr_read_b32 v116, a104
    v_accvgpr_read_b32 v117, a105
    v_accvgpr_read_b32 v118, a106
    v_accvgpr_read_b32 v119, a107
    v_accvgpr_read_b32 v124, a108
    v_accvgpr_read_b32 v125, a109
    v_accvgpr_read_b32 v126, a110
    v_accvgpr_read_b32 v127, a111
    v_mfma_f32_32x32x16_bf16 a[16:31], v[224:227], v[196:199], 0
    ds_read_b64_tr_b16 v[224:225], v237 offset:33472
    ds_read_b64_tr_b16 v[226:227], v237 offset:37824
    v_fma_f32 v234, v162, s21, v239
    v_exp_f32 v233, v233
    v_pk_mul_f32 v[116:117], v[116:117], v[254:255] op_sel_hi:[1,0]
    v_pk_mul_f32 v[118:119], v[118:119], v[254:255] op_sel_hi:[1,0]
    v_pk_mul_f32 v[124:125], v[124:125], v[254:255] op_sel_hi:[1,0]
    v_pk_mul_f32 v[126:127], v[126:127], v[254:255] op_sel_hi:[1,0]
    s_waitcnt lgkmcnt(10)
    v_mfma_f32_32x32x16_bf16 v[16:31], v[228:231], v[208:211], v[16:31]
    v_fma_f32 v235, v163, s21, v239
    v_exp_f32 v234, v234
    v_add_f32 v243, v232, v233
    v_cvt_pk_bf16_f32 v200, v232, v233
    v_cvt_pk_bf16_f32 v116, v116, v117
    v_cvt_pk_bf16_f32 v117, v118, v119
    v_cvt_pk_bf16_f32 v118, v124, v125
    v_cvt_pk_bf16_f32 v119, v126, v127
    ds_write_b128 v253, v[116:119] offset:18656
    v_mfma_f32_32x32x16_bf16 a[16:31], v[228:231], v[212:215], a[16:31]
    ds_read_b64_tr_b16 v[228:229], v237 offset:42176
    ds_read_b64_tr_b16 v[230:231], v237 offset:46528
    v_fma_f32 v232, v164, s21, v239
    v_exp_f32 v235, v235
    v_add_f32 v243, v243, v234
    v_accvgpr_read_b32 v100, a112
    v_accvgpr_read_b32 v101, a113
    v_accvgpr_read_b32 v102, a114
    v_accvgpr_read_b32 v103, a115
    v_accvgpr_read_b32 v108, a116
    v_accvgpr_read_b32 v109, a117
    v_accvgpr_read_b32 v110, a118
    v_accvgpr_read_b32 v111, a119
    s_waitcnt lgkmcnt(9)
    v_mfma_f32_32x32x16_bf16 v[32:47], v[216:219], v[192:195], 0
    s_add_u32 m0, s25, 18224
    s_nop 0
    buffer_load_dwordx4 v238, s[8:11], s23 offen offset:1536 nt lds
    s_add_u32 s23, s23, 16384
    s_and_b32 s23, s23, 0x3ffff
    v_pk_mul_f32 v[100:101], v[100:101], v[254:255] op_sel_hi:[1,0]
    v_pk_mul_f32 v[102:103], v[102:103], v[254:255] op_sel_hi:[1,0]
    v_pk_mul_f32 v[108:109], v[108:109], v[254:255] op_sel_hi:[1,0]
    v_pk_mul_f32 v[110:111], v[110:111], v[254:255] op_sel_hi:[1,0]
    v_mfma_f32_32x32x16_bf16 a[32:47], v[216:219], v[196:199], 0
    ds_read_b64_tr_b16 v[216:217], v237 offset:33536
    ds_read_b64_tr_b16 v[218:219], v237 offset:37888
    v_fma_f32 v233, v165, s21, v239
    v_exp_f32 v232, v232
    v_add_f32 v243, v243, v235
    v_cvt_pk_bf16_f32 v201, v234, v235
    v_cvt_pk_bf16_f32 v100, v100, v101
    v_cvt_pk_bf16_f32 v101, v102, v103
    v_cvt_pk_bf16_f32 v102, v108, v109
    v_cvt_pk_bf16_f32 v103, v110, v111
    ds_write_b128 v253, v[100:103] offset:18688
    s_waitcnt lgkmcnt(9)
    v_mfma_f32_32x32x16_bf16 v[32:47], v[220:223], v[208:211], v[32:47]
    v_fma_f32 v234, v166, s21, v239
    v_exp_f32 v233, v233
    v_add_f32 v243, v243, v232
    v_accvgpr_read_b32 v116, a120
    v_accvgpr_read_b32 v117, a121
    v_accvgpr_read_b32 v118, a122
    v_accvgpr_read_b32 v119, a123
    v_accvgpr_read_b32 v124, a124
    v_accvgpr_read_b32 v125, a125
    v_accvgpr_read_b32 v126, a126
    v_accvgpr_read_b32 v127, a127
    v_mfma_f32_32x32x16_bf16 a[32:47], v[220:223], v[212:215], a[32:47]
    ds_read_b64_tr_b16 v[220:221], v237 offset:42240
    ds_read_b64_tr_b16 v[222:223], v237 offset:46592
    v_fma_f32 v235, v167, s21, v239
    v_exp_f32 v234, v234
    v_add_f32 v243, v243, v233
    v_cvt_pk_bf16_f32 v202, v232, v233
    v_pk_mul_f32 v[116:117], v[116:117], v[254:255] op_sel_hi:[1,0]
    v_pk_mul_f32 v[118:119], v[118:119], v[254:255] op_sel_hi:[1,0]
    v_pk_mul_f32 v[124:125], v[124:125], v[254:255] op_sel_hi:[1,0]
    v_pk_mul_f32 v[126:127], v[126:127], v[254:255] op_sel_hi:[1,0]
    s_waitcnt lgkmcnt(8)
    v_mfma_f32_32x32x16_bf16 v[48:63], v[224:227], v[192:195], 0
    s_add_u32 m0, s25, 20800
    s_nop 0
    buffer_load_dwordx4 v238, s[8:11], s68 offen nt lds
    v_cvt_pk_bf16_f32 v116, v116, v117
    v_cvt_pk_bf16_f32 v117, v118, v119
    v_cvt_pk_bf16_f32 v118, v124, v125
    v_cvt_pk_bf16_f32 v119, v126, v127
    ds_write_b128 v253, v[116:119] offset:18720
    v_mfma_f32_32x32x16_bf16 a[48:63], v[224:227], v[196:199], 0
    ds_read_b64_tr_b16 v[224:225], v237 offset:33600
    ds_read_b64_tr_b16 v[226:227], v237 offset:37952
    v_fma_f32 v232, v176, s21, v240
    v_exp_f32 v235, v235
    v_add_f32 v243, v243, v234
    s_waitcnt lgkmcnt(8)
    v_mfma_f32_32x32x16_bf16 v[48:63], v[228:231], v[208:211], v[48:63]
    v_fma_f32 v233, v177, s21, v240
    v_exp_f32 v232, v232
    v_add_f32 v243, v243, v235
    v_cvt_pk_bf16_f32 v203, v234, v235
    v_mfma_f32_32x32x16_bf16 a[48:63], v[228:231], v[212:215], a[48:63]
    ds_read_b64_tr_b16 v[228:229], v237 offset:42304
    ds_read_b64_tr_b16 v[230:231], v237 offset:46656
    v_fma_f32 v234, v178, s21, v240
    v_exp_f32 v233, v233
    s_waitcnt lgkmcnt(8)
    v_mfma_f32_32x32x16_bf16 v[64:79], v[216:219], v[192:195], 0
    s_add_u32 m0, s25, 21328
    s_nop 0
    buffer_load_dwordx4 v238, s[8:11], s68 offen offset:512 nt lds
    v_mfma_f32_32x32x16_bf16 a[64:79], v[216:219], v[196:199], 0
    ds_read_b64_tr_b16 v[216:217], v237 offset:33664
    ds_read_b64_tr_b16 v[218:219], v237 offset:38016
    v_fma_f32 v235, v179, s21, v240
    v_exp_f32 v234, v234
    v_add_f32 v244, v232, v233
    v_cvt_pk_bf16_f32 v204, v232, v233
    s_waitcnt lgkmcnt(7)
    v_mfma_f32_32x32x16_bf16 v[64:79], v[220:223], v[208:211], v[64:79]
    v_fma_f32 v232, v180, s21, v240
    v_exp_f32 v235, v235
    v_add_f32 v244, v244, v234
    v_mfma_f32_32x32x16_bf16 a[64:79], v[220:223], v[212:215], a[64:79]
    ds_read_b64_tr_b16 v[220:221], v237 offset:42368
    ds_read_b64_tr_b16 v[222:223], v237 offset:46720
    v_fma_f32 v233, v181, s21, v240
    v_exp_f32 v232, v232
    v_add_f32 v244, v244, v235
    v_cvt_pk_bf16_f32 v205, v234, v235
    s_waitcnt lgkmcnt(6)
    v_mfma_f32_32x32x16_bf16 v[80:95], v[224:227], v[192:195], 0
    s_add_u32 m0, s25, 21856
    s_nop 0
    buffer_load_dwordx4 v238, s[8:11], s68 offen offset:1024 nt lds
    v_mfma_f32_32x32x16_bf16 a[80:95], v[224:227], v[196:199], 0
    ds_read_b64_tr_b16 v[224:225], v237 offset:33728
    ds_read_b64_tr_b16 v[226:227], v237 offset:38080
    v_fma_f32 v234, v182, s21, v240
    v_exp_f32 v233, v233
    v_add_f32 v244, v244, v232
    s_waitcnt lgkmcnt(6)
    v_mfma_f32_32x32x16_bf16 v[80:95], v[228:231], v[208:211], v[80:95]
    v_fma_f32 v235, v183, s21, v240
    v_exp_f32 v234, v234
    v_add_f32 v244, v244, v233
    v_cvt_pk_bf16_f32 v206, v232, v233
    v_mfma_f32_32x32x16_bf16 a[80:95], v[228:231], v[212:215], a[80:95]
    ds_read_b64_tr_b16 v[228:229], v237 offset:42432
    ds_read_b64_tr_b16 v[230:231], v237 offset:46784
    v_fma_f32 v232, v168, s21, v239
    v_exp_f32 v235, v235
    v_add_f32 v244, v244, v234
    s_waitcnt lgkmcnt(6)
    v_mfma_f32_32x32x16_bf16 v[96:111], v[216:219], v[192:195], 0
    s_add_u32 m0, s25, 22384
    s_nop 0
    buffer_load_dwordx4 v238, s[8:11], s68 offen offset:1536 nt lds
    s_add_u32 s68, s68, 16384
    s_and_b32 s68, s68, 0x3ffff
    v_mfma_f32_32x32x16_bf16 a[96:111], v[216:219], v[196:199], 0
    v_fma_f32 v233, v169, s21, v239
    v_exp_f32 v232, v232
    v_add_f32 v244, v244, v235
    v_cvt_pk_bf16_f32 v207, v234, v235
    s_waitcnt lgkmcnt(4)
    v_mfma_f32_32x32x16_bf16 v[96:111], v[220:223], v[208:211], v[96:111]
    v_fma_f32 v234, v170, s21, v239
    v_exp_f32 v233, v233
    v_add_f32 v243, v243, v232
    v_mfma_f32_32x32x16_bf16 a[96:111], v[220:223], v[212:215], a[96:111]
    s_waitcnt vmcnt(24)
    s_waitcnt lgkmcnt(0)
    s_barrier
    ds_read_b128 v[216:219], v236
    ds_read_b128 v[220:223], v236 offset:32
    v_mfma_f32_32x32x16_bf16 v[112:127], v[224:227], v[192:195], 0
    s_add_u32 m0, s26, 0
    s_nop 0
    buffer_load_dwordx4 v238, s[12:15], s24 offen nt lds
    v_mfma_f32_32x32x16_bf16 a[112:127], v[224:227], v[196:199], 0
    ds_read_b128 v[224:227], v236 offset:64
    v_mfma_f32_32x32x16_bf16 v[112:127], v[228:231], v[208:211], v[112:127]
    s_add_u32 m0, s26, 576
    s_nop 0
    buffer_load_dwordx4 v238, s[12:15], s24 offen offset:512 nt lds
    v_mfma_f32_32x32x16_bf16 a[112:127], v[228:231], v[212:215], a[112:127]
    ds_read_b128 v[228:231], v236 offset:96
L_it0eA:
    s_add_u32 s59, s59, 1
    s_waitcnt lgkmcnt(3)
    v_mfma_f32_32x32x16_bf16 v[128:143], v[216:219], a[128:131], 0
    s_add_u32 m0, s26, 1152
    s_nop 0
    buffer_load_dwordx4 v238, s[12:15], s24 offen offset:1024 nt lds
    v_mfma_f32_32x32x16_bf16 v[144:159], v[216:219], a[192:195], 0
    ds_read_b128 v[216:219], v236 offset:128
    s_waitcnt lgkmcnt(3)
    v_mfma_f32_32x32x16_bf16 v[128:143], v[220:223], a[132:135], v[128:143]
    v_fma_f32 v235, v171, s21, v239
    v_exp_f32 v234, v234
    v_add_f32 v243, v243, v233
    v_cvt_pk_bf16_f32 v208, v232, v233
    v_mfma_f32_32x32x16_bf16 v[144:159], v[220:223], a[196:199], v[144:159]
    ds_read_b128 v[220:223], v236 offset:160
    s_add_u32 m0, s26, 1728
    s_nop 0
    buffer_load_dwordx4 v238, s[12:15], s24 offen offset:1536 nt lds
    s_add_u32 s24, s24, 16384
    s_and_b32 s24, s24, 0x3ffff
    s_waitcnt lgkmcnt(3)
    v_mfma_f32_32x32x16_bf16 v[128:143], v[224:227], a[136:139], v[128:143]
    v_fma_f32 v232, v172, s21, v239
    v_exp_f32 v235, v235
    v_add_f32 v243, v243, v234
    v_mfma_f32_32x32x16_bf16 v[144:159], v[224:227], a[200:203], v[144:159]
    ds_read_b128 v[224:227], v236 offset:192
    s_mov_b32 s16, s54
    s_mov_b32 s17, s55
    s_mov_b32 s18, s56
    s_add_u32 s57, s57, 32
    s_mul_hi_u32 s42, s57, 0x55555556
    s_waitcnt lgkmcnt(3)
    v_mfma_f32_32x32x16_bf16 v[128:143], v[228:231], a[140:143], v[128:143]
    s_add_u32 m0, s26, 4352
    s_nop 0
    buffer_load_dwordx4 v238, s[12:15], s69 offen nt lds
    v_mfma_f32_32x32x16_bf16 v[144:159], v[228:231], a[204:207], v[144:159]
    ds_read_b128 v[228:231], v236 offset:224
    s_mul_i32 s43, s42, 3
    s_sub_u32 s43, s57, s43
    s_waitcnt lgkmcnt(3)
    v_mfma_f32_32x32x16_bf16 v[128:143], v[216:219], a[144:147], v[128:143]
    v_fma_f32 v233, v173, s21, v239
    v_exp_f32 v232, v232
    v_add_f32 v243, v243, v235
    v_cvt_pk_bf16_f32 v209, v234, v235
    v_mfma_f32_32x32x16_bf16 v[144:159], v[216:219], a[208:211], v[144:159]
    ds_read_b128 v[216:219], v236 offset:256
    s_add_u32 m0, s26, 4928
    s_nop 0
    buffer_load_dwordx4 v238, s[12:15], s69 offen offset:512 nt lds
    s_waitcnt lgkmcnt(3)
    v_mfma_f32_32x32x16_bf16 v[128:143], v[220:223], a[148:151], v[128:143]
    v_fma_f32 v234, v174, s21, v239
    v_exp_f32 v233, v233
    v_add_f32 v243, v243, v232
    v_mfma_f32_32x32x16_bf16 v[144:159], v[220:223], a[212:215], v[144:159]
    ds_read_b128 v[220:223], v236 offset:288
    s_cmp_eq_u32 s43, 2
    s_cselect_b32 s85, 3, 7
    s_cmp_eq_u32 s20, s85
    s_mov_b32 s85, 0x7e967699
    s_cselect_b32 s84, 0xf149f2ca, s85
    s_waitcnt lgkmcnt(3)
    v_mfma_f32_32x32x16_bf16 v[128:143], v[224:227], a[152:155], v[128:143]
    s_add_u32 m0, s26, 5504
    s_nop 0
    buffer_load_dwordx4 v238, s[12:15], s69 offen offset:1024 nt lds
    v_mfma_f32_32x32x16_bf16 v[144:159], v[224:227], a[216:219], v[144:159]
    ds_read_b128 v[224:227], v236 offset:320
    s_add_u32 s42, s42, s3
    s_mul_i32 s44, s42, 376832
    s_lshl_b32 s43, s43, 17
    s_add_u32 s44, s44, s43
    s_lshl_b32 s45, s42, 18
    s_waitcnt lgkmcnt(3)
    v_mfma_f32_32x32x16_bf16 v[128:143], v[228:231], a[156:159], v[128:143]
    v_fma_f32 v235, v175, s21, v239
    v_exp_f32 v234, v234
    v_add_f32 v243, v243, v233
    v_cvt_pk_bf16_f32 v210, v232, v233
    s_lshr_b32 s80, s42, 4
    v_mfma_f32_32x32x16_bf16 v[144:159], v[228:231], a[220:223], v[144:159]
    ds_read_b128 v[228:231], v236 offset:352
    s_add_u32 m0, s26, 6080
    s_nop 0
    buffer_load_dwordx4 v238, s[12:15], s69 offen offset:1536 nt lds
    s_add_u32 s69, s69, 16384
    s_and_b32 s69, s69, 0x3ffff
    s_waitcnt lgkmcnt(3)
    v_mfma_f32_32x32x16_bf16 v[128:143], v[216:219], a[160:163], v[128:143]
    v_fma_f32 v232, v184, s21, v240
    v_exp_f32 v235, v235
    v_add_f32 v243, v243, v234
    s_xor_b32 s80, s80, s42
    s_and_b32 s80, s80, 15
    v_mfma_f32_32x32x16_bf16 v[144:159], v[216:219], a[224:227], v[144:159]
    ds_read_b128 v[216:219], v236 offset:384
    s_lshl_b32 s80, s80, 14
    s_add_u32 s81, s80, 0x1000
    s_sub_u32 s43, 376832, s43
    s_waitcnt lgkmcnt(3)
    v_mfma_f32_32x32x16_bf16 v[128:143], v[220:223], a[164:167], v[128:143]
    v_fma_f32 v233, v185, s21, v240
    v_exp_f32 v232, v232
    v_add_f32 v243, v243, v235
    v_cvt_pk_bf16_f32 v211, v234, v235
    v_mfma_f32_32x32x16_bf16 v[144:159], v[220:223], a[228:231], v[144:159]
    ds_read_b128 v[220:223], v236 offset:416
    v_fma_f32 v234, v186, s21, v240
    v_exp_f32 v233, v233
    v_add_f32 v244, v244, v232
    s_waitcnt lgkmcnt(3)
    v_mfma_f32_32x32x16_bf16 v[128:143], v[224:227], a[168:171], v[128:143]
    v_fma_f32 v235, v187, s21, v240
    v_exp_f32 v234, v234
    v_add_f32 v244, v244, v233
    v_cvt_pk_bf16_f32 v212, v232, v233
    v_mfma_f32_32x32x16_bf16 v[144:159], v[224:227], a[232:235], v[144:159]
    ds_read_b128 v[224:227], v236 offset:448
    v_fma_f32 v232, v188, s21, v240
    v_exp_f32 v235, v235
    v_add_f32 v244, v244, v234
    s_waitcnt lgkmcnt(3)
    v_mfma_f32_32x32x16_bf16 v[128:143], v[228:231], a[172:175], v[128:143]
    v_fma_f32 v233, v189, s21, v240
    v_exp_f32 v232, v232
    v_add_f32 v244, v244, v235
    v_cvt_pk_bf16_f32 v213, v234, v235
    v_mfma_f32_32x32x16_bf16 v[144:159], v[228:231], a[236:239], v[144:159]
    ds_read_b128 v[228:231], v236 offset:480
    v_fma_f32 v234, v190, s21, v240
    v_exp_f32 v233, v233
    v_add_f32 v244, v244, v232
    s_waitcnt lgkmcnt(3)
    v_mfma_f32_32x32x16_bf16 v[128:143], v[216:219], a[176:179], v[128:143]
    v_fma_f32 v235, v191, s21, v240
    v_exp_f32 v234, v234
    v_add_f32 v244, v244, v233
    v_cvt_pk_bf16_f32 v214, v232, v233
    v_mfma_f32_32x32x16_bf16 v[144:159], v[216:219], a[240:243], v[144:159]
    v_exp_f32 v235, v235
    v_add_f32 v244, v244, v234
    v_add_f32 v244, v244, v235
    v_cvt_pk_bf16_f32 v215, v234, v235
    s_waitcnt lgkmcnt(2)
    v_mfma_f32_32x32x16_bf16 v[128:143], v[220:223], a[180:183], v[128:143]
    s_cmp_lt_u32 s57, 96
    s_cselect_b32 s43, s43, 0
    s_cselect_b32 s52, 262144, 0
    s_add_u32 s4, s32, s44
    s_addc_u32 s5, s33, 0
    s_and_b32 s5, s5, 0xffff
    v_mfma_f32_32x32x16_bf16 v[144:159], v[220:223], a[244:247], v[144:159]
    s_waitcnt vmcnt(16)
    s_waitcnt lgkmcnt(0)
    s_barrier
    ds_read_b64_tr_b16 v[216:217], v237 offset:50688
    ds_read_b64_tr_b16 v[218:219], v237 offset:55040
    ds_read_b64_tr_b16 v[220:221], v237 offset:59392
    ds_read_b64_tr_b16 v[222:223], v237 offset:63744
    v_mfma_f32_32x32x16_bf16 v[128:143], v[224:227], a[184:187], v[128:143]
    s_add_u32 m0, s25, 0
    s_nop 0
    buffer_load_dwordx4 v238, s[8:11], s23 offen nt lds
    v_mfma_f32_32x32x16_bf16 v[144:159], v[224:227], a[248:251], v[144:159]
    ds_read_b64_tr_b16 v[224:225], v237 offset:50752
    ds_read_b64_tr_b16 v[226:227], v237 offset:55104
    v_add_f32 v245, v243, v244
    s_mov_b32 s6, s43
    s_add_u32 s54, s38, s44
    s_addc_u32 s55, s39, 0
    v_mfma_f32_32x32x16_bf16 v[128:143], v[228:231], a[188:191], v[128:143]
    v_cmp_nge_f32 vcc, s22, v245
    s_cbranch_vccnz L_rares1A
L_backs1A:
    v_add_f32 v241, v241, v243
    v_add_f32 v242, v242, v244
    s_and_b32 s55, s55, 0xffff
    s_mov_b32 s56, s43
    v_mfma_f32_32x32x16_bf16 v[144:159], v[228:231], a[252:255], v[144:159]
    ds_read_b64_tr_b16 v[228:229], v237 offset:59456
    ds_read_b64_tr_b16 v[230:231], v237 offset:63808
    s_add_u32 s48, s34, s45
    s_addc_u32 s49, s35, 0
    s_and_b32 s49, s49, 0xffff
    s_waitcnt lgkmcnt(6)
    v_mfma_f32_32x32x16_bf16 v[0:15], v[216:219], v[200:203], v[0:15]
    s_add_u32 m0, s25, 528
    s_nop 0
    buffer_load_dwordx4 v238, s[8:11], s23 offen offset:512 nt lds
    v_mfma_f32_32x32x16_bf16 a[0:15], v[216:219], v[204:207], a[0:15]
    ds_read_b64_tr_b16 v[216:217], v237 offset:50816
    ds_read_b64_tr_b16 v[218:219], v237 offset:55168
    s_add_u32 s50, s36, s45
    s_addc_u32 s51, s37, 0
    s_and_b32 s51, s51, 0xffff
    s_mov_b32 s27, 0
    s_waitcnt lgkmcnt(6)
    v_mfma_f32_32x32x16_bf16 v[0:15], v[220:223], v[208:211], v[0:15]
    v_mfma_f32_32x32x16_bf16 a[0:15], v[220:223], v[212:215], a[0:15]
    ds_read_b64_tr_b16 v[220:221], v237 offset:59520
    ds_read_b64_tr_b16 v[222:223], v237 offset:63872
    v_fma_f32 v232, v128, s21, v239
    v_fma_f32 v233, v129, s21, v239
    v_exp_f32 v232, v232
    s_waitcnt lgkmcnt(6)
    v_mfma_f32_32x32x16_bf16 v[16:31], v[224:227], v[200:203], v[16:31]
    s_add_u32 m0, s25, 1056
    s_nop 0
    buffer_load_dwordx4 v238, s[8:11], s23 offen offset:1024 nt lds
    v_mfma_f32_32x32x16_bf16 a[16:31], v[224:227], v[204:207], a[16:31]
    ds_read_b64_tr_b16 v[224:225], v237 offset:50880
    ds_read_b64_tr_b16 v[226:227], v237 offset:55232
    v_fma_f32 v234, v130, s21, v239
    v_exp_f32 v233, v233
    s_waitcnt lgkmcnt(6)
    v_mfma_f32_32x32x16_bf16 v[16:31], v[228:231], v[208:211], v[16:31]
    v_fma_f32 v235, v131, s21, v239
    v_exp_f32 v234, v234
    v_add_f32 v243, v232, v233
    v_cvt_pk_bf16_f32 v192, v232, v233
    v_mfma_f32_32x32x16_bf16 a[16:31], v[228:231], v[212:215], a[16:31]
    ds_read_b64_tr_b16 v[228:229], v237 offset:59584
    ds_read_b64_tr_b16 v[230:231], v237 offset:63936
    v_fma_f32 v232, v132, s21, v239
    v_exp_f32 v235, v235
    v_add_f32 v243, v243, v234
    s_waitcnt lgkmcnt(6)
    v_mfma_f32_32x32x16_bf16 v[32:47], v[216:219], v[200:203], v[32:47]
    s_add_u32 m0, s25, 1584
    s_nop 0
    buffer_load_dwordx4 v238, s[8:11], s23 offen offset:1536 nt lds
    s_add_u32 s23, s23, 16384
    s_and_b32 s23, s23, 0x3ffff
    v_mfma_f32_32x32x16_bf16 a[32:47], v[216:219], v[204:207], a[32:47]
    ds_read_b64_tr_b16 v[216:217], v237 offset:50944
    ds_read_b64_tr_b16 v[218:219], v237 offset:55296
    v_fma_f32 v233, v133, s21, v239
    v_exp_f32 v232, v232
    v_add_f32 v243, v243, v235
    v_cvt_pk_bf16_f32 v193, v234, v235
    s_waitcnt lgkmcnt(6)
    v_mfma_f32_32x32x16_bf16 v[32:47], v[220:223], v[208:211], v[32:47]
    v_fma_f32 v234, v134, s21, v239
    v_exp_f32 v233, v233
    v_add_f32 v243, v243, v232
    v_mfma_f32_32x32x16_bf16 a[32:47], v[220:223], v[212:215], a[32:47]
    ds_read_b64_tr_b16 v[220:221], v237 offset:59648
    ds_read_b64_tr_b16 v[222:223], v237 offset:64000
    v_fma_f32 v235, v135, s21, v239
    v_exp_f32 v234, v234
    v_add_f32 v243, v243, v233
    v_cvt_pk_bf16_f32 v194, v232, v233
    s_waitcnt lgkmcnt(6)
    v_mfma_f32_32x32x16_bf16 v[48:63], v[224:227], v[200:203], v[48:63]
    s_add_u32 m0, s25, 4160
    s_nop 0
    buffer_load_dwordx4 v238, s[8:11], s68 offen nt lds
    v_mfma_f32_32x32x16_bf16 a[48:63], v[224:227], v[204:207], a[48:63]
    ds_read_b64_tr_b16 v[224:225], v237 offset:51008
    ds_read_b64_tr_b16 v[226:227], v237 offset:55360
    v_fma_f32 v232, v144, s21, v240
    v_exp_f32 v235, v235
    v_add_f32 v243, v243, v234
    s_waitcnt lgkmcnt(6)
    v_mfma_f32_32x32x16_bf16 v[48:63], v[228:231], v[208:211], v[48:63]
    v_fma_f32 v233, v145, s21, v240
    v_exp_f32 v232, v232
    v_add_f32 v243, v243, v235
    v_cvt_pk_bf16_f32 v195, v234, v235
    v_mfma_f32_32x32x16_bf16 a[48:63], v[228:231], v[212:215], a[48:63]
    ds_read_b64_tr_b16 v[228:229], v237 offset:59712
    ds_read_b64_tr_b16 v[230:231], v237 offset:64064
    v_fma_f32 v234, v146, s21, v240
    v_exp_f32 v233, v233
    s_waitcnt lgkmcnt(6)
    v_mfma_f32_32x32x16_bf16 v[64:79], v[216:219], v[200:203], v[64:79]
    s_add_u32 m0, s25, 4688
    s_nop 0
    buffer_load_dwordx4 v238, s[8:11], s68 offen offset:512 nt lds
    v_mfma_f32_32x32x16_bf16 a[64:79], v[216:219], v[204:207], a[64:79]
    ds_read_b64_tr_b16 v[216:217], v237 offset:51072
    ds_read_b64_tr_b16 v[218:219], v237 offset:55424
    v_fma_f32 v235, v147, s21, v240
    v_exp_f32 v234, v234
    v_add_f32 v244, v232, v233
    v_cvt_pk_bf16_f32 v196, v232, v233
    s_waitcnt lgkmcnt(6)
    v_mfma_f32_32x32x16_bf16 v[64:79], v[220:223], v[208:211], v[64:79]
    v_fma_f32 v232, v148, s21, v240
    v_exp_f32 v235, v235
    v_add_f32 v244, v244, v234
    v_mfma_f32_32x32x16_bf16 a[64:79], v[220:223], v[212:215], a[64:79]
    ds_read_b64_tr_b16 v[220:221], v237 offset:59776
    ds_read_b64_tr_b16 v[222:223], v237 offset:64128
    v_fma_f32 v233, v149, s21, v240
    v_exp_f32 v232, v232
    v_add_f32 v244, v244, v235
    v_cvt_pk_bf16_f32 v197, v234, v235
    s_waitcnt lgkmcnt(6)
    v_mfma_f32_32x32x16_bf16 v[80:95], v[224:227], v[200:203], v[80:95]
    s_add_u32 m0, s25, 5216
    s_nop 0
    buffer_load_dwordx4 v238, s[8:11], s68 offen offset:1024 nt lds
    v_mfma_f32_32x32x16_bf16 a[80:95], v[224:227], v[204:207], a[80:95]
    ds_read_b64_tr_b16 v[224:225], v237 offset:51136
    ds_read_b64_tr_b16 v[226:227], v237 offset:55488
    v_fma_f32 v234, v150, s21, v240
    v_exp_f32 v233, v233
    v_add_f32 v244, v244, v232
    s_waitcnt lgkmcnt(6)
    v_mfma_f32_32x32x16_bf16 v[80:95], v[228:231], v[208:211], v[80:95]
    v_fma_f32 v235, v151, s21, v240
    v_exp_f32 v234, v234
    v_add_f32 v244, v244, v233
    v_cvt_pk_bf16_f32 v198, v232, v233
    v_mfma_f32_32x32x16_bf16 a[80:95], v[228:231], v[212:215], a[80:95]
    ds_read_b64_tr_b16 v[228:229], v237 offset:59840
    ds_read_b64_tr_b16 v[230:231], v237 offset:64192
    v_fma_f32 v232, v136, s21, v239
    v_exp_f32 v235, v235
    v_add_f32 v244, v244, v234
    s_waitcnt lgkmcnt(6)
    v_mfma_f32_32x32x16_bf16 v[96:111], v[216:219], v[200:203], v[96:111]
    s_add_u32 m0, s25, 5744
    s_nop 0
    buffer_load_dwordx4 v238, s[8:11], s68 offen offset:1536 nt lds
    s_add_u32 s68, s68, 16384
    s_and_b32 s68, s68, 0x3ffff
    v_mfma_f32_32x32x16_bf16 a[96:111], v[216:219], v[204:207], a[96:111]
    v_fma_f32 v233, v137, s21, v239
    v_exp_f32 v232, v232
    v_add_f32 v244, v244, v235
    v_cvt_pk_bf16_f32 v199, v234, v235
    s_waitcnt lgkmcnt(4)
    v_mfma_f32_32x32x16_bf16 v[96:111], v[220:223], v[208:211], v[96:111]
    v_fma_f32 v234, v138, s21, v239
    v_exp_f32 v233, v233
    v_add_f32 v243, v243, v232
    v_mfma_f32_32x32x16_bf16 a[96:111], v[220:223], v[212:215], a[96:111]
    s_waitcnt vmcnt(16)
    s_waitcnt lgkmcnt(0)
    s_barrier
    ds_read_b128 v[216:219], v236 offset:16640
    ds_read_b128 v[220:223], v236 offset:16672
    v_mfma_f32_32x32x16_bf16 v[112:127], v[224:227], v[200:203], v[112:127]
    s_add_u32 m0, s26, 17408
    s_nop 0
    buffer_load_dwordx4 v238, s[12:15], s24 offen nt lds
    v_mfma_f32_32x32x16_bf16 a[112:127], v[224:227], v[204:207], a[112:127]
    ds_read_b128 v[224:227], v236 offset:16704
    v_mfma_f32_32x32x16_bf16 v[112:127], v[228:231], v[208:211], v[112:127]
    s_add_u32 m0, s26, 17984
    s_nop 0
    buffer_load_dwordx4 v238, s[12:15], s24 offen offset:512 nt lds
    v_mfma_f32_32x32x16_bf16 a[112:127], v[228:231], v[212:215], a[112:127]
    ds_read_b128 v[228:231], v236 offset:16736
L_loopA:
    s_waitcnt lgkmcnt(3)
    v_mfma_f32_32x32x16_bf16 v[160:175], v[216:219], a[128:131], 0
    s_add_u32 m0, s26, 18560
    s_nop 0
    buffer_load_dwordx4 v238, s[12:15], s24 offen offset:1024 nt lds
    v_mfma_f32_32x32x16_bf16 v[176:191], v[216:219], a[192:195], 0
    ds_read_b128 v[216:219], v236 offset:16768
    s_waitcnt lgkmcnt(3)
    v_mfma_f32_32x32x16_bf16 v[160:175], v[220:223], a[132:135], v[160:175]
    v_fma_f32 v235, v139, s21, v239
    v_exp_f32 v234, v234
    v_add_f32 v243, v243, v233
    v_cvt_pk_bf16_f32 v208, v232, v233
    v_mfma_f32_32x32x16_bf16 v[176:191], v[220:223], a[196:199], v[176:191]
    ds_read_b128 v[220:223], v236 offset:16800
    s_add_u32 m0, s26, 19136
    s_nop 0
    buffer_load_dwordx4 v238, s[12:15], s24 offen offset:1536 nt lds
    s_add_u32 s24, s24, 16384
    s_and_b32 s24, s24, 0x3ffff
    s_waitcnt lgkmcnt(3)
    v_mfma_f32_32x32x16_bf16 v[160:175], v[224:227], a[136:139], v[160:175]
    v_fma_f32 v232, v140, s21, v239
    v_exp_f32 v235, v235
    v_add_f32 v243, v243, v234
    v_mfma_f32_32x32x16_bf16 v[176:191], v[224:227], a[200:203], v[176:191]
    ds_read_b128 v[224:227], v236 offset:16832
    s_waitcnt lgkmcnt(3)
    v_mfma_f32_32x32x16_bf16 v[160:175], v[228:231], a[140:143], v[160:175]
    s_add_u32 m0, s26, 21760
    s_nop 0
    buffer_load_dwordx4 v238, s[12:15], s69 offen nt lds
    v_mfma_f32_32x32x16_bf16 v[176:191], v[228:231], a[204:207], v[176:191]
    ds_read_b128 v[228:231], v236 offset:16864
    s_waitcnt lgkmcnt(3)
    v_mfma_f32_32x32x16_bf16 v[160:175], v[216:219], a[144:147], v[160:175]
    v_fma_f32 v233, v141, s21, v239
    v_exp_f32 v232, v232
    v_add_f32 v243, v243, v235
    v_cvt_pk_bf16_f32 v209, v234, v235
    v_mfma_f32_32x32x16_bf16 v[176:191], v[216:219], a[208:211], v[176:191]
    ds_read_b128 v[216:219], v236 offset:16896
    s_add_u32 m0, s26, 22336
    s_nop 0
    buffer_load_dwordx4 v238, s[12:15], s69 offen offset:512 nt lds
    s_waitcnt lgkmcnt(3)
    v_mfma_f32_32x32x16_bf16 v[160:175], v[220:223], a[148:151], v[160:175]
    v_fma_f32 v234, v142, s21, v239
    v_exp_f32 v233, v233
    v_add_f32 v243, v243, v232
    v_mfma_f32_32x32x16_bf16 v[176:191], v[220:223], a[212:215], v[176:191]
    ds_read_b128 v[220:223], v236 offset:16928
    s_waitcnt lgkmcnt(3)
    v_mfma_f32_32x32x16_bf16 v[160:175], v[224:227], a[152:155], v[160:175]
    s_add_u32 m0, s26, 22912
    s_nop 0
    buffer_load_dwordx4 v238, s[12:15], s69 offen offset:1024 nt lds
    v_mfma_f32_32x32x16_bf16 v[176:191], v[224:227], a[216:219], v[176:191]
    ds_read_b128 v[224:227], v236 offset:16960
    s_waitcnt lgkmcnt(3)
    v_mfma_f32_32x32x16_bf16 v[160:175], v[228:231], a[156:159], v[160:175]
    v_fma_f32 v235, v143, s21, v239
    v_exp_f32 v234, v234
    v_add_f32 v243, v243, v233
    v_cvt_pk_bf16_f32 v210, v232, v233
    v_mfma_f32_32x32x16_bf16 v[176:191], v[228:231], a[220:223], v[176:191]
    ds_read_b128 v[228:231], v236 offset:16992
    s_add_u32 m0, s26, 23488
    s_nop 0
    buffer_load_dwordx4 v238, s[12:15], s69 offen offset:1536 nt lds
    s_add_u32 s69, s69, 16384
    s_and_b32 s69, s69, 0x3ffff
    s_waitcnt lgkmcnt(3)
    v_mfma_f32_32x32x16_bf16 v[160:175], v[216:219], a[160:163], v[160:175]
    v_fma_f32 v232, v152, s21, v240
    v_exp_f32 v235, v235
    v_add_f32 v243, v243, v234
    v_mfma_f32_32x32x16_bf16 v[176:191], v[216:219], a[224:227], v[176:191]
    ds_read_b128 v[216:219], v236 offset:17024
    s_waitcnt lgkmcnt(3)
    v_mfma_f32_32x32x16_bf16 v[160:175], v[220:223], a[164:167], v[160:175]
    v_fma_f32 v233, v153, s21, v240
    v_exp_f32 v232, v232
    v_add_f32 v243, v243, v235
    v_cvt_pk_bf16_f32 v211, v234, v235
    v_mfma_f32_32x32x16_bf16 v[176:191], v[220:223], a[228:231], v[176:191]
    ds_read_b128 v[220:223], v236 offset:17056
    v_fma_f32 v234, v154, s21, v240
    v_exp_f32 v233, v233
    v_add_f32 v244, v244, v232
    s_waitcnt lgkmcnt(3)
    v_mfma_f32_32x32x16_bf16 v[160:175], v[224:227], a[168:171], v[160:175]
    v_fma_f32 v235, v155, s21, v240
    v_exp_f32 v234, v234
    v_add_f32 v244, v244, v233
    v_cvt_pk_bf16_f32 v212, v232, v233
    v_mfma_f32_32x32x16_bf16 v[176:191], v[224:227], a[232:235], v[176:191]
    ds_read_b128 v[224:227], v236 offset:17088
    v_fma_f32 v232, v156, s21, v240
    v_exp_f32 v235, v235
    v_add_f32 v244, v244, v234
    s_waitcnt lgkmcnt(3)
    v_mfma_f32_32x32x16_bf16 v[160:175], v[228:231], a[172:175], v[160:175]
    v_fma_f32 v233, v157, s21, v240
    v_exp_f32 v232, v232
    v_add_f32 v244, v244, v235
    v_cvt_pk_bf16_f32 v213, v234, v235
    v_mfma_f32_32x32x16_bf16 v[176:191], v[228:231], a[236:239], v[176:191]
    ds_read_b128 v[228:231], v236 offset:17120
    v_fma_f32 v234, v158, s21, v240
    v_exp_f32 v233, v233
    v_add_f32 v244, v244, v232
    s_waitcnt lgkmcnt(3)
    v_mfma_f32_32x32x16_bf16 v[160:175], v[216:219], a[176:179], v[160:175]
    v_fma_f32 v235, v159, s21, v240
    v_exp_f32 v234, v234
    v_add_f32 v244, v244, v233
    v_cvt_pk_bf16_f32 v214, v232, v233
    v_mfma_f32_32x32x16_bf16 v[176:191], v[216:219], a[240:243], v[176:191]
    v_exp_f32 v235, v235
    v_add_f32 v244, v244, v234
    v_add_f32 v244, v244, v235
    v_cvt_pk_bf16_f32 v215, v234, v235
    s_waitcnt lgkmcnt(2)
    v_mfma_f32_32x32x16_bf16 v[160:175], v[220:223], a[180:183], v[160:175]
    v_mfma_f32_32x32x16_bf16 v[176:191], v[220:223], a[244:247], v[176:191]
    s_waitcnt vmcnt(16)
    s_waitcnt lgkmcnt(0)
    s_barrier
    ds_read_b64_tr_b16 v[216:217], v237 offset:33280
    ds_read_b64_tr_b16 v[218:219], v237 offset:37632
    ds_read_b64_tr_b16 v[220:221], v237 offset:41984
    ds_read_b64_tr_b16 v[222:223], v237 offset:46336
    v_mfma_f32_32x32x16_bf16 v[160:175], v[224:227], a[184:187], v[160:175]
    s_add_u32 m0, s25, 16640
    s_nop 0
    buffer_load_dwordx4 v238, s[8:11], s23 offen nt lds
    v_mfma_f32_32x32x16_bf16 v[176:191], v[224:227], a[248:251], v[176:191]
    ds_read_b64_tr_b16 v[224:225], v237 offset:33344
    ds_read_b64_tr_b16 v[226:227], v237 offset:37696
    v_add_f32 v245, v243, v244
    v_mfma_f32_32x32x16_bf16 v[160:175], v[228:231], a[188:191], v[160:175]
    v_cmp_nge_f32 vcc, s22, v245
    s_cbranch_vccnz L_rarel0A
L_backl0A:
    v_add_f32 v241, v241, v243
    v_add_f32 v242, v242, v244
    v_mfma_f32_32x32x16_bf16 v[176:191], v[228:231], a[252:255], v[176:191]
    ds_read_b64_tr_b16 v[228:229], v237 offset:42048
    ds_read_b64_tr_b16 v[230:231], v237 offset:46400
    s_waitcnt lgkmcnt(6)
    v_mfma_f32_32x32x16_bf16 v[0:15], v[216:219], v[192:195], v[0:15]
    s_add_u32 m0, s25, 17168
    s_nop 0
    buffer_load_dwordx4 v238, s[8:11], s23 offen offset:512 nt lds
    v_mfma_f32_32x32x16_bf16 a[0:15], v[216:219], v[196:199], a[0:15]
    ds_read_b64_tr_b16 v[216:217], v237 offset:33408
    ds_read_b64_tr_b16 v[218:219], v237 offset:37760
    s_waitcnt lgkmcnt(6)
    v_mfma_f32_32x32x16_bf16 v[0:15], v[220:223], v[208:211], v[0:15]
    v_mfma_f32_32x32x16_bf16 a[0:15], v[220:223], v[212:215], a[0:15]
    ds_read_b64_tr_b16 v[220:221], v237 offset:42112
    ds_read_b64_tr_b16 v[222:223], v237 offset:46464
    v_fma_f32 v232, v160, s21, v239
    v_fma_f32 v233, v161, s21, v239
    v_exp_f32 v232, v232
    s_waitcnt lgkmcnt(6)
    v_mfma_f32_32x32x16_bf16 v[16:31], v[224:227], v[192:195], v[16:31]
    s_add_u32 m0, s25, 17696
    s_nop 0
    buffer_load_dwordx4 v238, s[8:11], s23 offen offset:1024 nt lds
    v_mfma_f32_32x32x16_bf16 a[16:31], v[224:227], v[196:199], a[16:31]
    ds_read_b64_tr_b16 v[224:225], v237 offset:33472
    ds_read_b64_tr_b16 v[226:227], v237 offset:37824
    v_fma_f32 v234, v162, s21, v239
    v_exp_f32 v233, v233
    s_waitcnt lgkmcnt(6)
    v_mfma_f32_32x32x16_bf16 v[16:31], v[228:231], v[208:211], v[16:31]
    v_fma_f32 v235, v163, s21, v239
    v_exp_f32 v234, v234
    v_add_f32 v243, v232, v233
    v_cvt_pk_bf16_f32 v200, v232, v233
    v_mfma_f32_32x32x16_bf16 a[16:31], v[228:231], v[212:215], a[16:31]
    ds_read_b64_tr_b16 v[228:229], v237 offset:42176
    ds_read_b64_tr_b16 v[230:231], v237 offset:46528
    v_fma_f32 v232, v164, s21, v239
    v_exp_f32 v235, v235
    v_add_f32 v243, v243, v234
    s_waitcnt lgkmcnt(6)
    v_mfma_f32_32x32x16_bf16 v[32:47], v[216:219], v[192:195], v[32:47]
    s_add_u32 m0, s25, 18224
    s_nop 0
    buffer_load_dwordx4 v238, s[8:11], s23 offen offset:1536 nt lds
    s_add_u32 s23, s23, 16384
    s_and_b32 s23, s23, 0x3ffff
    v_mfma_f32_32x32x16_bf16 a[32:47], v[216:219], v[196:199], a[32:47]
    ds_read_b64_tr_b16 v[216:217], v237 offset:33536
    ds_read_b64_tr_b16 v[218:219], v237 offset:37888
    v_fma_f32 v233, v165, s21, v239
    v_exp_f32 v232, v232
    v_add_f32 v243, v243, v235
    v_cvt_pk_bf16_f32 v201, v234, v235
    s_waitcnt lgkmcnt(6)
    v_mfma_f32_32x32x16_bf16 v[32:47], v[220:223], v[208:211], v[32:47]
    v_fma_f32 v234, v166, s21, v239
    v_exp_f32 v233, v233
    v_add_f32 v243, v243, v232
    v_mfma_f32_32x32x16_bf16 a[32:47], v[220:223], v[212:215], a[32:47]
    ds_read_b64_tr_b16 v[220:221], v237 offset:42240
    ds_read_b64_tr_b16 v[222:223], v237 offset:46592
    v_fma_f32 v235, v167, s21, v239
    v_exp_f32 v234, v234
    v_add_f32 v243, v243, v233
    v_cvt_pk_bf16_f32 v202, v232, v233
    s_waitcnt lgkmcnt(6)
    v_mfma_f32_32x32x16_bf16 v[48:63], v[224:227], v[192:195], v[48:63]
    s_add_u32 m0, s25, 20800
    s_nop 0
    buffer_load_dwordx4 v238, s[8:11], s68 offen nt lds
    v_mfma_f32_32x32x16_bf16 a[48:63], v[224:227], v[196:199], a[48:63]
    ds_read_b64_tr_b16 v[224:225], v237 offset:33600
    ds_read_b64_tr_b16 v[226:227], v237 offset:37952
    v_fma_f32 v232, v176, s21, v240
    v_exp_f32 v235, v235
    v_add_f32 v243, v243, v234
    s_waitcnt lgkmcnt(6)
    v_mfma_f32_32x32x16_bf16 v[48:63], v[228:231], v[208:211], v[48:63]
    v_fma_f32 v233, v177, s21, v240
    v_exp_f32 v232, v232
    v_add_f32 v243, v243, v235
    v_cvt_pk_bf16_f32 v203, v234, v235
    v_mfma_f32_32x32x16_bf16 a[48:63], v[228:231], v[212:215], a[48:63]
    ds_read_b64_tr_b16 v[228:229], v237 offset:42304
    ds_read_b64_tr_b16 v[230:231], v237 offset:46656
    v_fma_f32 v234, v178, s21, v240
    v_exp_f32 v233, v233
    s_waitcnt lgkmcnt(6)
    v_mfma_f32_32x32x16_bf16 v[64:79], v[216:219], v[192:195], v[64:79]
    s_add_u32 m0, s25, 21328
    s_nop 0
    buffer_load_dwordx4 v238, s[8:11], s68 offen offset:512 nt lds
    v_mfma_f32_32x32x16_bf16 a[64:79], v[216:219], v[196:199], a[64:79]
    ds_read_b64_tr_b16 v[216:217], v237 offset:33664
    ds_read_b64_tr_b16 v[218:219], v237 offset:38016
    v_fma_f32 v235, v179, s21, v240
    v_exp_f32 v234, v234
    v_add_f32 v244, v232, v233
    v_cvt_pk_bf16_f32 v204, v232, v233
    s_waitcnt lgkmcnt(6)
    v_mfma_f32_32x32x16_bf16 v[64:79], v[220:223], v[208:211], v[64:79]
    v_fma_f32 v232, v180, s21, v240
    v_exp_f32 v235, v235
    v_add_f32 v244, v244, v234
    v_mfma_f32_32x32x16_bf16 a[64:79], v[220:223], v[212:215], a[64:79]
    ds_read_b64_tr_b16 v[220:221], v237 offset:42368
    ds_read_b64_tr_b16 v[222:223], v237 offset:46720
    v_fma_f32 v233, v181, s21, v240
    v_exp_f32 v232, v232
    v_add_f32 v244, v244, v235
    v_cvt_pk_bf16_f32 v205, v234, v235
    s_waitcnt lgkmcnt(6)
    v_mfma_f32_32x32x16_bf16 v[80:95], v[224:227], v[192:195], v[80:95]
    s_add_u32 m0, s25, 21856
    s_nop 0
    buffer_load_dwordx4 v238, s[8:11], s68 offen offset:1024 nt lds
    v_mfma_f32_32x32x16_bf16 a[80:95], v[224:227], v[196:199], a[80:95]
    ds_read_b64_tr_b16 v[224:225], v237 offset:33728
    ds_read_b64_tr_b16 v[226:227], v237 offset:38080
    v_fma_f32 v234, v182, s21, v240
    v_exp_f32 v233, v233
    v_add_f32 v244, v244, v232
    s_waitcnt lgkmcnt(6)
    v_mfma_f32_32x32x16_bf16 v[80:95], v[228:231], v[208:211], v[80:95]
    v_fma_f32 v235, v183, s21, v240
    v_exp_f32 v234, v234
    v_add_f32 v244, v244, v233
    v_cvt_pk_bf16_f32 v206, v232, v233
    v_mfma_f32_32x32x16_bf16 a[80:95], v[228:231], v[212:215], a[80:95]
    ds_read_b64_tr_b16 v[228:229], v237 offset:42432
    ds_read_b64_tr_b16 v[230:231], v237 offset:46784
    v_fma_f32 v232, v168, s21, v239
    v_exp_f32 v235, v235
    v_add_f32 v244, v244, v234
    s_waitcnt lgkmcnt(6)
    v_mfma_f32_32x32x16_bf16 v[96:111], v[216:219], v[192:195], v[96:111]
    s_add_u32 m0, s25, 22384
    s_nop 0
    buffer_load_dwordx4 v238, s[8:11], s68 offen offset:1536 nt lds
    s_add_u32 s68, s68, 16384
    s_and_b32 s68, s68, 0x3ffff
    v_mfma_f32_32x32x16_bf16 a[96:111], v[216:219], v[196:199], a[96:111]
    v_fma_f32 v233, v169, s21, v239
    v_exp_f32 v232, v232
    v_add_f32 v244, v244, v235
    v_cvt_pk_bf16_f32 v207, v234, v235
    s_waitcnt lgkmcnt(4)
    v_mfma_f32_32x32x16_bf16 v[96:111], v[220:223], v[208:211], v[96:111]
    v_fma_f32 v234, v170, s21, v239
    v_exp_f32 v233, v233
    v_add_f32 v243, v243, v232
    v_mfma_f32_32x32x16_bf16 a[96:111], v[220:223], v[212:215], a[96:111]
    s_waitcnt vmcnt(16)
    s_waitcnt lgkmcnt(0)
    s_barrier
    ds_read_b128 v[216:219], v236
    ds_read_b128 v[220:223], v236 offset:32
    v_mfma_f32_32x32x16_bf16 v[112:127], v[224:227], v[192:195], v[112:127]
    s_add_u32 m0, s26, 0
    s_nop 0
    buffer_load_dwordx4 v238, s[12:15], s24 offen nt lds
    v_mfma_f32_32x32x16_bf16 a[112:127], v[224:227], v[196:199], a[112:127]
    ds_read_b128 v[224:227], v236 offset:64
    v_mfma_f32_32x32x16_bf16 v[112:127], v[228:231], v[208:211], v[112:127]
    s_add_u32 m0, s26, 576
    s_nop 0
    buffer_load_dwordx4 v238, s[12:15], s24 offen offset:512 nt lds
    v_mfma_f32_32x32x16_bf16 a[112:127], v[228:231], v[212:215], a[112:127]
    ds_read_b128 v[228:231], v236 offset:96
    s_waitcnt lgkmcnt(3)
    v_mfma_f32_32x32x16_bf16 v[128:143], v[216:219], a[128:131], 0
    s_add_u32 m0, s26, 1152
    s_nop 0
    buffer_load_dwordx4 v238, s[12:15], s24 offen offset:1024 nt lds
    v_mfma_f32_32x32x16_bf16 v[144:159], v[216:219], a[192:195], 0
    ds_read_b128 v[216:219], v236 offset:128
    s_waitcnt lgkmcnt(3)
    v_mfma_f32_32x32x16_bf16 v[128:143], v[220:223], a[132:135], v[128:143]
    v_fma_f32 v235, v171, s21, v239
    v_exp_f32 v234, v234
    v_add_f32 v243, v243, v233
    v_cvt_pk_bf16_f32 v208, v232, v233
    v_mfma_f32_32x32x16_bf16 v[144:159], v[220:223], a[196:199], v[144:159]
    ds_read_b128 v[220:223], v236 offset:160
    s_add_u32 m0, s26, 1728
    s_nop 0
    buffer_load_dwordx4 v238, s[12:15], s24 offen offset:1536 nt lds
    s_add_u32 s24, s24, 16384
    s_and_b32 s24, s24, 0x3ffff
    s_waitcnt lgkmcnt(3)
    v_mfma_f32_32x32x16_bf16 v[128:143], v[224:227], a[136:139], v[128:143]
    s_cmp_eq_u32 s27, 5
    s_cselect_b32 s8, s48, s8
    s_cselect_b32 s9, s49, s9
    s_cselect_b32 s10, s52, s10
    s_cselect_b32 s23, s80, s23
    s_cselect_b32 s68, s81, s68
    v_mfma_f32_32x32x16_bf16 v[144:159], v[224:227], a[200:203], v[144:159]
    ds_read_b128 v[224:227], v236 offset:192
    v_fma_f32 v232, v172, s21, v239
    v_exp_f32 v235, v235
    v_add_f32 v243, v243, v234
    s_waitcnt lgkmcnt(3)
    v_mfma_f32_32x32x16_bf16 v[128:143], v[228:231], a[140:143], v[128:143]
    s_add_u32 m0, s26, 4352
    s_nop 0
    buffer_load_dwordx4 v238, s[12:15], s69 offen nt lds
    v_mfma_f32_32x32x16_bf16 v[144:159], v[228:231], a[204:207], v[144:159]
    ds_read_b128 v[228:231], v236 offset:224
    s_waitcnt lgkmcnt(3)
    v_mfma_f32_32x32x16_bf16 v[128:143], v[216:219], a[144:147], v[128:143]
    v_fma_f32 v233, v173, s21, v239
    v_exp_f32 v232, v232
    v_add_f32 v243, v243, v235
    v_cvt_pk_bf16_f32 v209, v234, v235
    v_mfma_f32_32x32x16_bf16 v[144:159], v[216:219], a[208:211], v[144:159]
    ds_read_b128 v[216:219], v236 offset:256
    s_add_u32 m0, s26, 4928
    s_nop 0
    buffer_load_dwordx4 v238, s[12:15], s69 offen offset:512 nt lds
    s_waitcnt lgkmcnt(3)
    v_mfma_f32_32x32x16_bf16 v[128:143], v[220:223], a[148:151], v[128:143]
    v_fma_f32 v234, v174, s21, v239
    v_exp_f32 v233, v233
    v_add_f32 v243, v243, v232
    v_mfma_f32_32x32x16_bf16 v[144:159], v[220:223], a[212:215], v[144:159]
    ds_read_b128 v[220:223], v236 offset:288
    s_waitcnt lgkmcnt(3)
    v_mfma_f32_32x32x16_bf16 v[128:143], v[224:227], a[152:155], v[128:143]
    s_add_u32 m0, s26, 5504
    s_nop 0
    buffer_load_dwordx4 v238, s[12:15], s69 offen offset:1024 nt lds
    v_mfma_f32_32x32x16_bf16 v[144:159], v[224:227], a[216:219], v[144:159]
    ds_read_b128 v[224:227], v236 offset:320
    s_waitcnt lgkmcnt(3)
    v_mfma_f32_32x32x16_bf16 v[128:143], v[228:231], a[156:159], v[128:143]
    v_fma_f32 v235, v175, s21, v239
    v_exp_f32 v234, v234
    v_add_f32 v243, v243, v233
    v_cvt_pk_bf16_f32 v210, v232, v233
    v_mfma_f32_32x32x16_bf16 v[144:159], v[228:231], a[220:223], v[144:159]
    ds_read_b128 v[228:231], v236 offset:352
    s_add_u32 m0, s26, 6080
    s_nop 0
    buffer_load_dwordx4 v238, s[12:15], s69 offen offset:1536 nt lds
    s_add_u32 s69, s69, 16384
    s_and_b32 s69, s69, 0x3ffff
    s_waitcnt lgkmcnt(3)
    v_mfma_f32_32x32x16_bf16 v[128:143], v[216:219], a[160:163], v[128:143]
    v_fma_f32 v232, v184, s21, v240
    v_exp_f32 v235, v235
    v_add_f32 v243, v243, v234
    v_mfma_f32_32x32x16_bf16 v[144:159], v[216:219], a[224:227], v[144:159]
    ds_read_b128 v[216:219], v236 offset:384
    s_waitcnt lgkmcnt(3)
    v_mfma_f32_32x32x16_bf16 v[128:143], v[220:223], a[164:167], v[128:143]
    v_fma_f32 v233, v185, s21, v240
    v_exp_f32 v232, v232
    v_add_f32 v243, v243, v235
    v_cvt_pk_bf16_f32 v211, v234, v235
    v_mfma_f32_32x32x16_bf16 v[144:159], v[220:223], a[228:231], v[144:159]
    ds_read_b128 v[220:223], v236 offset:416
    v_fma_f32 v234, v186, s21, v240
    v_exp_f32 v233, v233
    v_add_f32 v244, v244, v232
    s_waitcnt lgkmcnt(3)
    v_mfma_f32_32x32x16_bf16 v[128:143], v[224:227], a[168:171], v[128:143]
    v_fma_f32 v235, v187, s21, v240
    v_exp_f32 v234, v234
    v_add_f32 v244, v244, v233
    v_cvt_pk_bf16_f32 v212, v232, v233
    v_mfma_f32_32x32x16_bf16 v[144:159], v[224:227], a[232:235], v[144:159]
    ds_read_b128 v[224:227], v236 offset:448
    v_fma_f32 v232, v188, s21, v240
    v_exp_f32 v235, v235
    v_add_f32 v244, v244, v234
    s_waitcnt lgkmcnt(3)
    v_mfma_f32_32x32x16_bf16 v[128:143], v[228:231], a[172:175], v[128:143]
    v_fma_f32 v233, v189, s21, v240
    v_exp_f32 v232, v232
    v_add_f32 v244, v244, v235
    v_cvt_pk_bf16_f32 v213, v234, v235
    v_mfma_f32_32x32x16_bf16 v[144:159], v[228:231], a[236:239], v[144:159]
    ds_read_b128 v[228:231], v236 offset:480
    v_fma_f32 v234, v190, s21, v240
    v_exp_f32 v233, v233
    v_add_f32 v244, v244, v232
    s_waitcnt lgkmcnt(3)
    v_mfma_f32_32x32x16_bf16 v[128:143], v[216:219], a[176:179], v[128:143]
    v_fma_f32 v235, v191, s21, v240
    v_exp_f32 v234, v234
    v_add_f32 v244, v244, v233
    v_cvt_pk_bf16_f32 v214, v232, v233
    v_mfma_f32_32x32x16_bf16 v[144:159], v[216:219], a[240:243], v[144:159]
    v_exp_f32 v235, v235
    v_add_f32 v244, v244, v234
    v_add_f32 v244, v244, v235
    v_cvt_pk_bf16_f32 v215, v234, v235
    s_waitcnt lgkmcnt(2)
    v_mfma_f32_32x32x16_bf16 v[128:143], v[220:223], a[180:183], v[128:143]
    v_mfma_f32_32x32x16_bf16 v[144:159], v[220:223], a[244:247], v[144:159]
    s_waitcnt vmcnt(16)
    s_waitcnt lgkmcnt(0)
    s_barrier
    ds_read_b64_tr_b16 v[216:217], v237 offset:50688
    ds_read_b64_tr_b16 v[218:219], v237 offset:55040
    ds_read_b64_tr_b16 v[220:221], v237 offset:59392
    ds_read_b64_tr_b16 v[222:223], v237 offset:63744
    v_mfma_f32_32x32x16_bf16 v[128:143], v[224:227], a[184:187], v[128:143]
    s_add_u32 m0, s25, 0
    s_nop 0
    buffer_load_dwordx4 v238, s[8:11], s23 offen nt lds
    v_mfma_f32_32x32x16_bf16 v[144:159], v[224:227], a[248:251], v[144:159]
    ds_read_b64_tr_b16 v[224:225], v237 offset:50752
    ds_read_b64_tr_b16 v[226:227], v237 offset:55104
    v_add_f32 v245, v243, v244
    v_mfma_f32_32x32x16_bf16 v[128:143], v[228:231], a[188:191], v[128:143]
    v_cmp_nge_f32 vcc, s22, v245
    s_cbranch_vccnz L_rarel1A
L_backl1A:
    v_add_f32 v241, v241, v243
    v_add_f32 v242, v242, v244
    v_mfma_f32_32x32x16_bf16 v[144:159], v[228:231], a[252:255], v[144:159]
    ds_read_b64_tr_b16 v[228:229], v237 offset:59456
    ds_read_b64_tr_b16 v[230:231], v237 offset:63808
    s_waitcnt lgkmcnt(6)
    v_mfma_f32_32x32x16_bf16 v[0:15], v[216:219], v[200:203], v[0:15]
    s_add_u32 m0, s25, 528
    s_nop 0
    buffer_load_dwordx4 v238, s[8:11], s23 offen offset:512 nt lds
    v_mfma_f32_32x32x16_bf16 a[0:15], v[216:219], v[204:207], a[0:15]
    ds_read_b64_tr_b16 v[216:217], v237 offset:50816
    ds_read_b64_tr_b16 v[218:219], v237 offset:55168
    s_waitcnt lgkmcnt(6)
    v_mfma_f32_32x32x16_bf16 v[0:15], v[220:223], v[208:211], v[0:15]
    v_mfma_f32_32x32x16_bf16 a[0:15], v[220:223], v[212:215], a[0:15]
    ds_read_b64_tr_b16 v[220:221], v237 offset:59520
    ds_read_b64_tr_b16 v[222:223], v237 offset:63872
    v_fma_f32 v232, v128, s21, v239
    v_fma_f32 v233, v129, s21, v239
    v_exp_f32 v232, v232
    s_waitcnt lgkmcnt(6)
    v_mfma_f32_32x32x16_bf16 v[16:31], v[224:227], v[200:203], v[16:31]
    s_add_u32 m0, s25, 1056
    s_nop 0
    buffer_load_dwordx4 v238, s[8:11], s23 offen offset:1024 nt lds
    v_mfma_f32_32x32x16_bf16 a[16:31], v[224:227], v[204:207], a[16:31]
    ds_read_b64_tr_b16 v[224:225], v237 offset:50880
    ds_read_b64_tr_b16 v[226:227], v237 offset:55232
    v_fma_f32 v234, v130, s21, v239
    v_exp_f32 v233, v233
    s_waitcnt lgkmcnt(6)
    v_mfma_f32_32x32x16_bf16 v[16:31], v[228:231], v[208:211], v[16:31]
    v_fma_f32 v235, v131, s21, v239
    v_exp_f32 v234, v234
    v_add_f32 v243, v232, v233
    v_cvt_pk_bf16_f32 v192, v232, v233
    v_mfma_f32_32x32x16_bf16 a[16:31], v[228:231], v[212:215], a[16:31]
    ds_read_b64_tr_b16 v[228:229], v237 offset:59584
    ds_read_b64_tr_b16 v[230:231], v237 offset:63936
    v_fma_f32 v232, v132, s21, v239
    v_exp_f32 v235, v235
    v_add_f32 v243, v243, v234
    s_waitcnt lgkmcnt(6)
    v_mfma_f32_32x32x16_bf16 v[32:47], v[216:219], v[200:203], v[32:47]
    s_add_u32 m0, s25, 1584
    s_nop 0
    buffer_load_dwordx4 v238, s[8:11], s23 offen offset:1536 nt lds
    s_add_u32 s23, s23, 16384
    s_and_b32 s23, s23, 0x3ffff
    v_mfma_f32_32x32x16_bf16 a[32:47], v[216:219], v[204:207], a[32:47]
    ds_read_b64_tr_b16 v[216:217], v237 offset:50944
    ds_read_b64_tr_b16 v[218:219], v237 offset:55296
    v_fma_f32 v233, v133, s21, v239
    v_exp_f32 v232, v232
    v_add_f32 v243, v243, v235
    v_cvt_pk_bf16_f32 v193, v234, v235
    s_waitcnt lgkmcnt(6)
    v_mfma_f32_32x32x16_bf16 v[32:47], v[220:223], v[208:211], v[32:47]
    v_fma_f32 v234, v134, s21, v239
    v_exp_f32 v233, v233
    v_add_f32 v243, v243, v232
    v_mfma_f32_32x32x16_bf16 a[32:47], v[220:223], v[212:215], a[32:47]
    ds_read_b64_tr_b16 v[220:221], v237 offset:59648
    ds_read_b64_tr_b16 v[222:223], v237 offset:64000
    v_fma_f32 v235, v135, s21, v239
    v_exp_f32 v234, v234
    v_add_f32 v243, v243, v233
    v_cvt_pk_bf16_f32 v194, v232, v233
    s_waitcnt lgkmcnt(6)
    v_mfma_f32_32x32x16_bf16 v[48:63], v[224:227], v[200:203], v[48:63]
    s_add_u32 m0, s25, 4160
    s_nop 0
    buffer_load_dwordx4 v238, s[8:11], s68 offen nt lds
    v_mfma_f32_32x32x16_bf16 a[48:63], v[224:227], v[204:207], a[48:63]
    ds_read_b64_tr_b16 v[224:225], v237 offset:51008
    ds_read_b64_tr_b16 v[226:227], v237 offset:55360
    v_fma_f32 v232, v144, s21, v240
    v_exp_f32 v235, v235
    v_add_f32 v243, v243, v234
    s_waitcnt lgkmcnt(6)
    v_mfma_f32_32x32x16_bf16 v[48:63], v[228:231], v[208:211], v[48:63]
    v_fma_f32 v233, v145, s21, v240
    v_exp_f32 v232, v232
    v_add_f32 v243, v243, v235
    v_cvt_pk_bf16_f32 v195, v234, v235
    v_mfma_f32_32x32x16_bf16 a[48:63], v[228:231], v[212:215], a[48:63]
    ds_read_b64_tr_b16 v[228:229], v237 offset:59712
    ds_read_b64_tr_b16 v[230:231], v237 offset:64064
    v_fma_f32 v234, v146, s21, v240
    v_exp_f32 v233, v233
    s_waitcnt lgkmcnt(6)
    v_mfma_f32_32x32x16_bf16 v[64:79], v[216:219], v[200:203], v[64:79]
    s_add_u32 m0, s25, 4688
    s_nop 0
    buffer_load_dwordx4 v238, s[8:11], s68 offen offset:512 nt lds
    v_mfma_f32_32x32x16_bf16 a[64:79], v[216:219], v[204:207], a[64:79]
    ds_read_b64_tr_b16 v[216:217], v237 offset:51072
    ds_read_b64_tr_b16 v[218:219], v237 offset:55424
    v_fma_f32 v235, v147, s21, v240
    v_exp_f32 v234, v234
    v_add_f32 v244, v232, v233
    v_cvt_pk_bf16_f32 v196, v232, v233
    s_waitcnt lgkmcnt(6)
    v_mfma_f32_32x32x16_bf16 v[64:79], v[220:223], v[208:211], v[64:79]
    v_fma_f32 v232, v148, s21, v240
    v_exp_f32 v235, v235
    v_add_f32 v244, v244, v234
    v_mfma_f32_32x32x16_bf16 a[64:79], v[220:223], v[212:215], a[64:79]
    ds_read_b64_tr_b16 v[220:221], v237 offset:59776
    ds_read_b64_tr_b16 v[222:223], v237 offset:64128
    v_fma_f32 v233, v149, s21, v240
    v_exp_f32 v232, v232
    v_add_f32 v244, v244, v235
    v_cvt_pk_bf16_f32 v197, v234, v235
    s_waitcnt lgkmcnt(6)
    v_mfma_f32_32x32x16_bf16 v[80:95], v[224:227], v[200:203], v[80:95]
    s_add_u32 m0, s25, 5216
    s_nop 0
    buffer_load_dwordx4 v238, s[8:11], s68 offen offset:1024 nt lds
    v_mfma_f32_32x32x16_bf16 a[80:95], v[224:227], v[204:207], a[80:95]
    ds_read_b64_tr_b16 v[224:225], v237 offset:51136
    ds_read_b64_tr_b16 v[226:227], v237 offset:55488
    v_fma_f32 v234, v150, s21, v240
    v_exp_f32 v233, v233
    v_add_f32 v244, v244, v232
    s_waitcnt lgkmcnt(6)
    v_mfma_f32_32x32x16_bf16 v[80:95], v[228:231], v[208:211], v[80:95]
    v_fma_f32 v235, v151, s21, v240
    v_exp_f32 v234, v234
    v_add_f32 v244, v244, v233
    v_cvt_pk_bf16_f32 v198, v232, v233
    v_mfma_f32_32x32x16_bf16 a[80:95], v[228:231], v[212:215], a[80:95]
    ds_read_b64_tr_b16 v[228:229], v237 offset:59840
    ds_read_b64_tr_b16 v[230:231], v237 offset:64192
    v_fma_f32 v232, v136, s21, v239
    v_exp_f32 v235, v235
    v_add_f32 v244, v244, v234
    s_waitcnt lgkmcnt(6)
    v_mfma_f32_32x32x16_bf16 v[96:111], v[216:219], v[200:203], v[96:111]
    s_add_u32 m0, s25, 5744
    s_nop 0
    buffer_load_dwordx4 v238, s[8:11], s68 offen offset:1536 nt lds
    s_add_u32 s68, s68, 16384
    s_and_b32 s68, s68, 0x3ffff
    v_mfma_f32_32x32x16_bf16 a[96:111], v[216:219], v[204:207], a[96:111]
    v_fma_f32 v233, v137, s21, v239
    v_exp_f32 v232, v232
    v_add_f32 v244, v244, v235
    v_cvt_pk_bf16_f32 v199, v234, v235
    s_waitcnt lgkmcnt(4)
    v_mfma_f32_32x32x16_bf16 v[96:111], v[220:223], v[208:211], v[96:111]
    v_fma_f32 v234, v138, s21, v239
    v_exp_f32 v233, v233
    v_add_f32 v243, v243, v232
    v_mfma_f32_32x32x16_bf16 a[96:111], v[220:223], v[212:215], a[96:111]
    s_waitcnt vmcnt(16)
    s_waitcnt lgkmcnt(0)
    s_barrier
    ds_read_b128 v[216:219], v236 offset:16640
    ds_read_b128 v[220:223], v236 offset:16672
    v_mfma_f32_32x32x16_bf16 v[112:127], v[224:227], v[200:203], v[112:127]
    s_add_u32 m0, s26, 17408
    s_nop 0
    buffer_load_dwordx4 v238, s[12:15], s24 offen nt lds
    v_mfma_f32_32x32x16_bf16 a[112:127], v[224:227], v[204:207], a[112:127]
    ds_read_b128 v[224:227], v236 offset:16704
    v_mfma_f32_32x32x16_bf16 v[112:127], v[228:231], v[208:211], v[112:127]
    s_add_u32 m0, s26, 17984
    s_nop 0
    buffer_load_dwordx4 v238, s[12:15], s24 offen offset:512 nt lds
    v_mfma_f32_32x32x16_bf16 a[112:127], v[228:231], v[212:215], a[112:127]
    ds_read_b128 v[228:231], v236 offset:16736
    s_add_u32 s27, s27, 1
    s_cmp_lt_u32 s27, 6
    s_cbranch_scc1 L_loopA
    s_branch L_saA
L_f15A:
    v_fma_f32 v235, v171, s21, v239
    v_exp_f32 v234, v234
    v_add_f32 v243, v243, v233
    v_cvt_pk_bf16_f32 v208, v232, v233
    s_nop 0
    v_fma_f32 v232, v172, s21, v239
    v_exp_f32 v235, v235
    v_add_f32 v243, v243, v234
    s_nop 0
    v_fma_f32 v233, v173, s21, v239
    v_exp_f32 v232, v232
    v_add_f32 v243, v243, v235
    v_cvt_pk_bf16_f32 v209, v234, v235
    s_nop 0
    v_fma_f32 v234, v174, s21, v239
    v_exp_f32 v233, v233
    v_add_f32 v243, v243, v232
    s_nop 0
    v_fma_f32 v235, v175, s21, v239
    v_exp_f32 v234, v234
    v_add_f32 v243, v243, v233
    v_cvt_pk_bf16_f32 v210, v232, v233
    s_nop 0
    v_fma_f32 v232, v184, s21, v240
    v_exp_f32 v235, v235
    v_add_f32 v243, v243, v234
    s_nop 0
    v_fma_f32 v233, v185, s21, v240
    v_exp_f32 v232, v232
    v_add_f32 v243, v243, v235
    v_cvt_pk_bf16_f32 v211, v234, v235
    s_nop 0
    v_fma_f32 v234, v186, s21, v240
    v_exp_f32 v233, v233
    v_add_f32 v244, v244, v232
    s_nop 0
    v_fma_f32 v235, v187, s21, v240
    v_exp_f32 v234, v234
    v_add_f32 v244, v244, v233
    v_cvt_pk_bf16_f32 v212, v232, v233
    s_nop 0
    v_fma_f32 v232, v188, s21, v240
    v_exp_f32 v235, v235
    v_add_f32 v244, v244, v234
    s_nop 0
    v_fma_f32 v233, v189, s21, v240
    v_exp_f32 v232, v232
    v_add_f32 v244, v244, v235
    v_cvt_pk_bf16_f32 v213, v234, v235
    s_nop 0
    v_fma_f32 v234, v190, s21, v240
    v_exp_f32 v233, v233
    v_add_f32 v244, v244, v232
    s_nop 0
    v_fma_f32 v235, v191, s21, v240
    v_exp_f32 v234, v234
    v_add_f32 v244, v244, v233
    v_cvt_pk_bf16_f32 v214, v232, v233
    s_nop 0
    v_exp_f32 v235, v235
    v_add_f32 v244, v244, v234
    s_nop 0
    v_add_f32 v244, v244, v235
    v_cvt_pk_bf16_f32 v215, v234, v235
    s_nop 0
    v_add_f32 v245, v243, v244
    s_nop 0
    v_cmp_nge_f32 vcc, s22, v245
    s_cbranch_vccnz L_raref15A
L_backf15A:
    v_add_f32 v241, v241, v243
    v_add_f32 v242, v242, v244
    s_waitcnt vmcnt(18)
    s_waitcnt vmcnt(10)
    s_waitcnt lgkmcnt(0)
    s_barrier
    ds_read_b64_tr_b16 v[216:217], v237 offset:50688
    ds_read_b64_tr_b16 v[218:219], v237 offset:55040
    ds_read_b64_tr_b16 v[220:221], v237 offset:59392
    ds_read_b64_tr_b16 v[222:223], v237 offset:63744
    ds_read_b64_tr_b16 v[224:225], v237 offset:50752
    ds_read_b64_tr_b16 v[226:227], v237 offset:55104
    ds_read_b64_tr_b16 v[228:229], v237 offset:59456
    ds_read_b64_tr_b16 v[230:231], v237 offset:63808
    v_mov_b32 v245, v241
    v_mov_b32 v255, v242
    s_nop 1
    v_permlane32_swap_b32 v245, v241
    v_permlane32_swap_b32 v255, v242
    s_nop 0
    v_add_f32 v241, v241, v245
    v_add_f32 v242, v242, v255
    v_rcp_f32 v252, v241
    v_rcp_f32 v254, v242
    v_mbcnt_lo_u32_b32 v253, -1, 0
    v_mbcnt_hi_u32_b32 v253, -1, v253
    v_and_b32 v247, 31, v253
    v_mul_u32_u24 v248, 0x90, v247
    v_lshrrev_b32 v247, 4, v247
    v_lshl_add_u32 v248, v247, 6, v248
    v_lshrrev_b32 v253, 5, v253
    v_lshl_add_u32 v253, v253, 4, v248
    v_add_u32 v253, s58, v253
    s_nop 3
    s_waitcnt lgkmcnt(6)
    v_mfma_f32_32x32x16_bf16 v[0:15], v[216:219], v[200:203], v[0:15]
    v_mfma_f32_32x32x16_bf16 a[0:15], v[216:219], v[204:207], a[0:15]
    ds_read_b64_tr_b16 v[216:217], v237 offset:50816
    ds_read_b64_tr_b16 v[218:219], v237 offset:55168
    s_waitcnt lgkmcnt(6)
    v_mfma_f32_32x32x16_bf16 v[0:15], v[220:223], v[208:211], v[0:15]
    v_mfma_f32_32x32x16_bf16 a[0:15], v[220:223], v[212:215], a[0:15]
    ds_read_b64_tr_b16 v[220:221], v237 offset:59520
    ds_read_b64_tr_b16 v[222:223], v237 offset:63872
    s_waitcnt lgkmcnt(6)
    v_mfma_f32_32x32x16_bf16 v[16:31], v[224:227], v[200:203], v[16:31]
    v_mfma_f32_32x32x16_bf16 a[16:31], v[224:227], v[204:207], a[16:31]
    ds_read_b64_tr_b16 v[224:225], v237 offset:50880
    ds_read_b64_tr_b16 v[226:227], v237 offset:55232
    s_waitcnt lgkmcnt(6)
    v_mfma_f32_32x32x16_bf16 v[16:31], v[228:231], v[208:211], v[16:31]
    v_mfma_f32_32x32x16_bf16 a[16:31], v[228:231], v[212:215], a[16:31]
    ds_read_b64_tr_b16 v[228:229], v237 offset:59584
    ds_read_b64_tr_b16 v[230:231], v237 offset:63936
    v_pk_mul_f32 v[0:1], v[0:1], v[252:253] op_sel_hi:[1,0]
    v_pk_mul_f32 v[2:3], v[2:3], v[252:253] op_sel_hi:[1,0]
    v_pk_mul_f32 v[4:5], v[4:5], v[252:253] op_sel_hi:[1,0]
    v_pk_mul_f32 v[6:7], v[6:7], v[252:253] op_sel_hi:[1,0]
    s_waitcnt lgkmcnt(6)
    v_mfma_f32_32x32x16_bf16 v[32:47], v[216:219], v[200:203], v[32:47]
    v_cvt_pk_bf16_f32 v0, v0, v1
    v_cvt_pk_bf16_f32 v1, v2, v3
    v_cvt_pk_bf16_f32 v2, v4, v5
    v_cvt_pk_bf16_f32 v3, v6, v7
    ds_write_b128 v253, v[0:3]
    v_pk_mul_f32 v[8:9], v[8:9], v[252:253] op_sel_hi:[1,0]
    v_pk_mul_f32 v[10:11], v[10:11], v[252:253] op_sel_hi:[1,0]
    v_pk_mul_f32 v[12:13], v[12:13], v[252:253] op_sel_hi:[1,0]
    v_pk_mul_f32 v[14:15], v[14:15], v[252:253] op_sel_hi:[1,0]
    v_mfma_f32_32x32x16_bf16 a[32:47], v[216:219], v[204:207], a[32:47]
    ds_read_b64_tr_b16 v[216:217], v237 offset:50944
    ds_read_b64_tr_b16 v[218:219], v237 offset:55296
    v_cvt_pk_bf16_f32 v8, v8, v9
    v_cvt_pk_bf16_f32 v9, v10, v11
    v_cvt_pk_bf16_f32 v10, v12, v13
    v_cvt_pk_bf16_f32 v11, v14, v15
    ds_write_b128 v253, v[8:11] offset:32
    s_waitcnt lgkmcnt(8)
    v_mfma_f32_32x32x16_bf16 v[32:47], v[220:223], v[208:211], v[32:47]
    v_mfma_f32_32x32x16_bf16 a[32:47], v[220:223], v[212:215], a[32:47]
    ds_read_b64_tr_b16 v[220:221], v237 offset:59648
    ds_read_b64_tr_b16 v[222:223], v237 offset:64000
    v_pk_mul_f32 v[16:17], v[16:17], v[252:253] op_sel_hi:[1,0]
    v_pk_mul_f32 v[18:19], v[18:19], v[252:253] op_sel_hi:[1,0]
    v_pk_mul_f32 v[20:21], v[20:21], v[252:253] op_sel_hi:[1,0]
    v_pk_mul_f32 v[22:23], v[22:23], v[252:253] op_sel_hi:[1,0]
    s_waitcnt lgkmcnt(8)
    v_mfma_f32_32x32x16_bf16 v[48:63], v[224:227], v[200:203], v[48:63]
    v_cvt_pk_bf16_f32 v16, v16, v17
    v_cvt_pk_bf16_f32 v17, v18, v19
    v_cvt_pk_bf16_f32 v18, v20, v21
    v_cvt_pk_bf16_f32 v19, v22, v23
    ds_write_b128 v253, v[16:19] offset:64
    v_pk_mul_f32 v[24:25], v[24:25], v[252:253] op_sel_hi:[1,0]
    v_pk_mul_f32 v[26:27], v[26:27], v[252:253] op_sel_hi:[1,0]
    v_pk_mul_f32 v[28:29], v[28:29], v[252:253] op_sel_hi:[1,0]
    v_pk_mul_f32 v[30:31], v[30:31], v[252:253] op_sel_hi:[1,0]
    v_mfma_f32_32x32x16_bf16 a[48:63], v[224:227], v[204:207], a[48:63]
    ds_read_b64_tr_b16 v[224:225], v237 offset:51008
    ds_read_b64_tr_b16 v[226:227], v237 offset:55360
    v_cvt_pk_bf16_f32 v24, v24, v25
    v_cvt_pk_bf16_f32 v25, v26, v27
    v_cvt_pk_bf16_f32 v26, v28, v29
    v_cvt_pk_bf16_f32 v27, v30, v31
    ds_write_b128 v253, v[24:27] offset:96
    s_waitcnt lgkmcnt(10)
    v_mfma_f32_32x32x16_bf16 v[48:63], v[228:231], v[208:211], v[48:63]
    ds_read_b128 v[0:3], v251
    ds_read_b128 v[8:11], v251 offset:288
    ds_read_b128 v[16:19], v251 offset:2368
    ds_read_b128 v[24:27], v251 offset:2656
    v_accvgpr_read_b32 v4, a0
    v_accvgpr_read_b32 v5, a1
    v_accvgpr_read_b32 v6, a2
    v_accvgpr_read_b32 v7, a3
    v_mfma_f32_32x32x16_bf16 a[48:63], v[228:231], v[212:215], a[48:63]
    ds_read_b64_tr_b16 v[228:229], v237 offset:59712
    s_waitcnt lgkmcnt(8)
    ds_read_b64_tr_b16 v[230:231], v237 offset:64064
    v_accvgpr_read_b32 v12, a4
    v_accvgpr_read_b32 v13, a5
    v_accvgpr_read_b32 v14, a6
    v_accvgpr_read_b32 v15, a7
    v_pk_mul_f32 v[4:5], v[4:5], v[254:255] op_sel_hi:[1,0]
    v_pk_mul_f32 v[6:7], v[6:7], v[254:255] op_sel_hi:[1,0]
    v_pk_mul_f32 v[12:13], v[12:13], v[254:255] op_sel_hi:[1,0]
    v_pk_mul_f32 v[14:15], v[14:15], v[254:255] op_sel_hi:[1,0]
    v_mfma_f32_32x32x16_bf16 v[64:79], v[216:219], v[200:203], v[64:79]
    v_cvt_pk_bf16_f32 v4, v4, v5
    v_cvt_pk_bf16_f32 v5, v6, v7
    v_cvt_pk_bf16_f32 v6, v12, v13
    v_cvt_pk_bf16_f32 v7, v14, v15
    ds_write_b128 v253, v[4:7] offset:4656
    s_add_u32 s47, s71, 0
    s_waitcnt lgkmcnt(6)
    buffer_store_dwordx4 v[0:3], v246, s[16:19], s47 offen nt
    v_mfma_f32_32x32x16_bf16 a[64:79], v[216:219], v[204:207], a[64:79]
    ds_read_b64_tr_b16 v[216:217], v237 offset:51072
    ds_read_b64_tr_b16 v[218:219], v237 offset:55424
    s_add_u32 s47, s71, 1024
    s_waitcnt lgkmcnt(7)
    buffer_store_dwordx4 v[8:11], v246, s[16:19], s47 offen nt
    v_accvgpr_read_b32 v20, a8
    v_accvgpr_read_b32 v21, a9
    v_accvgpr_read_b32 v22, a10
    v_accvgpr_read_b32 v23, a11
    v_mfma_f32_32x32x16_bf16 v[64:79], v[220:223], v[208:211], v[64:79]
    v_accvgpr_read_b32 v28, a12
    v_accvgpr_read_b32 v29, a13
    v_accvgpr_read_b32 v30, a14
    v_accvgpr_read_b32 v31, a15
    v_pk_mul_f32 v[20:21], v[20:21], v[254:255] op_sel_hi:[1,0]
    v_pk_mul_f32 v[22:23], v[22:23], v[254:255] op_sel_hi:[1,0]
    v_pk_mul_f32 v[28:29], v[28:29], v[254:255] op_sel_hi:[1,0]
    v_pk_mul_f32 v[30:31], v[30:31], v[254:255] op_sel_hi:[1,0]
    v_mfma_f32_32x32x16_bf16 a[64:79], v[220:223], v[212:215], a[64:79]
    ds_read_b64_tr_b16 v[220:221], v237 offset:59776
    ds_read_b64_tr_b16 v[222:223], v237 offset:64128
    v_cvt_pk_bf16_f32 v20, v20, v21
    v_cvt_pk_bf16_f32 v21, v22, v23
    v_cvt_pk_bf16_f32 v22, v28, v29
    v_cvt_pk_bf16_f32 v23, v30, v31
    ds_write_b128 v253, v[20:23] offset:4688
    v_mfma_f32_32x32x16_bf16 v[80:95], v[224:227], v[200:203], v[80:95]
    s_add_u32 s47, s71, 8192
    s_waitcnt lgkmcnt(9)
    buffer_store_dwordx4 v[16:19], v246, s[16:19], s47 offen nt
    s_add_u32 s47, s71, 9216
    s_waitcnt lgkmcnt(8)
    buffer_store_dwordx4 v[24:27], v246, s[16:19], s47 offen nt
    v_accvgpr_read_b32 v4, a16
    v_accvgpr_read_b32 v5, a17
    v_accvgpr_read_b32 v6, a18
    v_accvgpr_read_b32 v7, a19
    v_mfma_f32_32x32x16_bf16 a[80:95], v[224:227], v[204:207], a[80:95]
    ds_read_b64_tr_b16 v[224:225], v237 offset:51136
    ds_read_b64_tr_b16 v[226:227], v237 offset:55488
    v_accvgpr_read_b32 v12, a20
    v_accvgpr_read_b32 v13, a21
    v_accvgpr_read_b32 v14, a22
    v_accvgpr_read_b32 v15, a23
    v_pk_mul_f32 v[4:5], v[4:5], v[254:255] op_sel_hi:[1,0]
    v_pk_mul_f32 v[6:7], v[6:7], v[254:255] op_sel_hi:[1,0]
    v_pk_mul_f32 v[12:13], v[12:13], v[254:255] op_sel_hi:[1,0]
    v_pk_mul_f32 v[14:15], v[14:15], v[254:255] op_sel_hi:[1,0]
    s_waitcnt lgkmcnt(8)
    v_mfma_f32_32x32x16_bf16 v[80:95], v[228:231], v[208:211], v[80:95]
    v_cvt_pk_bf16_f32 v4, v4, v5
    v_cvt_pk_bf16_f32 v5, v6, v7
    v_cvt_pk_bf16_f32 v6, v12, v13
    v_cvt_pk_bf16_f32 v7, v14, v15
    ds_write_b128 v253, v[4:7] offset:4720
    v_accvgpr_read_b32 v20, a24
    v_accvgpr_read_b32 v21, a25
    v_accvgpr_read_b32 v22, a26
    v_accvgpr_read_b32 v23, a27
    v_mfma_f32_32x32x16_bf16 a[80:95], v[228:231], v[212:215], a[80:95]
    ds_read_b64_tr_b16 v[228:229], v237 offset:59840
    ds_read_b64_tr_b16 v[230:231], v237 offset:64192
    v_accvgpr_read_b32 v28, a28
    v_accvgpr_read_b32 v29, a29
    v_accvgpr_read_b32 v30, a30
    v_accvgpr_read_b32 v31, a31
    v_pk_mul_f32 v[20:21], v[20:21], v[254:255] op_sel_hi:[1,0]
    v_pk_mul_f32 v[22:23], v[22:23], v[254:255] op_sel_hi:[1,0]
    v_pk_mul_f32 v[28:29], v[28:29], v[254:255] op_sel_hi:[1,0]
    v_pk_mul_f32 v[30:31], v[30:31], v[254:255] op_sel_hi:[1,0]
    s_waitcnt lgkmcnt(8)
    v_mfma_f32_32x32x16_bf16 v[96:111], v[216:219], v[200:203], v[96:111]
    v_cvt_pk_bf16_f32 v20, v20, v21
    v_cvt_pk_bf16_f32 v21, v22, v23
    v_cvt_pk_bf16_f32 v22, v28, v29
    v_cvt_pk_bf16_f32 v23, v30, v31
    ds_write_b128 v253, v[20:23] offset:4752
    ds_read_b128 v[4:7], v251 offset:4656
    ds_read_b128 v[12:15], v251 offset:4944
    ds_read_b128 v[20:23], v251 offset:7024
    ds_read_b128 v[28:31], v251 offset:7312
    v_mfma_f32_32x32x16_bf16 a[96:111], v[216:219], v[204:207], a[96:111]
    v_pk_mul_f32 v[32:33], v[32:33], v[252:253] op_sel_hi:[1,0]
    v_pk_mul_f32 v[34:35], v[34:35], v[252:253] op_sel_hi:[1,0]
    v_pk_mul_f32 v[36:37], v[36:37], v[252:253] op_sel_hi:[1,0]
    v_pk_mul_f32 v[38:39], v[38:39], v[252:253] op_sel_hi:[1,0]
    v_cvt_pk_bf16_f32 v32, v32, v33
    v_cvt_pk_bf16_f32 v33, v34, v35
    v_cvt_pk_bf16_f32 v34, v36, v37
    v_cvt_pk_bf16_f32 v35, v38, v39
    ds_write_b128 v253, v[32:35] offset:9312
    s_waitcnt lgkmcnt(12)
    v_mfma_f32_32x32x16_bf16 v[96:111], v[220:223], v[208:211], v[96:111]
    s_add_u32 s47, s71, 16384
    s_waitcnt lgkmcnt(4)
    buffer_store_dwordx4 v[4:7], v246, s[16:19], s47 offen nt
    v_pk_mul_f32 v[40:41], v[40:41], v[252:253] op_sel_hi:[1,0]
    v_pk_mul_f32 v[42:43], v[42:43], v[252:253] op_sel_hi:[1,0]
    v_pk_mul_f32 v[44:45], v[44:45], v[252:253] op_sel_hi:[1,0]
    v_pk_mul_f32 v[46:47], v[46:47], v[252:253] op_sel_hi:[1,0]
    v_mfma_f32_32x32x16_bf16 a[96:111], v[220:223], v[212:215], a[96:111]
    v_cvt_pk_bf16_f32 v40, v40, v41
    v_cvt_pk_bf16_f32 v41, v42, v43
    v_cvt_pk_bf16_f32 v42, v44, v45
    v_cvt_pk_bf16_f32 v43, v46, v47
    ds_write_b128 v253, v[40:43] offset:9344
    s_add_u32 s47, s71, 17408
    s_waitcnt lgkmcnt(4)
    buffer_store_dwordx4 v[12:15], v246, s[16:19], s47 offen nt
    v_mfma_f32_32x32x16_bf16 v[112:127], v[224:227], v[200:203], v[112:127]
    v_pk_mul_f32 v[48:49], v[48:49], v[252:253] op_sel_hi:[1,0]
    v_pk_mul_f32 v[50:51], v[50:51], v[252:253] op_sel_hi:[1,0]
    v_pk_mul_f32 v[52:53], v[52:53], v[252:253] op_sel_hi:[1,0]
    v_pk_mul_f32 v[54:55], v[54:55], v[252:253] op_sel_hi:[1,0]
    v_cvt_pk_bf16_f32 v48, v48, v49
    v_cvt_pk_bf16_f32 v49, v50, v51
    v_cvt_pk_bf16_f32 v50, v52, v53
    v_cvt_pk_bf16_f32 v51, v54, v55
    ds_write_b128 v253, v[48:51] offset:9376
    v_mfma_f32_32x32x16_bf16 a[112:127], v[224:227], v[204:207], a[112:127]
    s_add_u32 s47, s71, 24576
    s_waitcnt lgkmcnt(4)
    buffer_store_dwordx4 v[20:23], v246, s[16:19], s47 offen nt
    v_pk_mul_f32 v[56:57], v[56:57], v[252:253] op_sel_hi:[1,0]
    v_pk_mul_f32 v[58:59], v[58:59], v[252:253] op_sel_hi:[1,0]
    v_pk_mul_f32 v[60:61], v[60:61], v[252:253] op_sel_hi:[1,0]
    v_pk_mul_f32 v[62:63], v[62:63], v[252:253] op_sel_hi:[1,0]
    v_mfma_f32_32x32x16_bf16 v[112:127], v[228:231], v[208:211], v[112:127]
    v_cvt_pk_bf16_f32 v56, v56, v57
    v_cvt_pk_bf16_f32 v57, v58, v59
    v_cvt_pk_bf16_f32 v58, v60, v61
    v_cvt_pk_bf16_f32 v59, v62, v63
    ds_write_b128 v253, v[56:59] offset:9408
    s_add_u32 s47, s71, 25600
    s_waitcnt lgkmcnt(4)
    buffer_store_dwordx4 v[28:31], v246, s[16:19], s47 offen nt
    v_mfma_f32_32x32x16_bf16 a[112:127], v[228:231], v[212:215], a[112:127]
    ds_read_b128 v[32:35], v251 offset:9312
    ds_read_b128 v[40:43], v251 offset:9600
    ds_read_b128 v[48:51], v251 offset:11680
    ds_read_b128 v[56:59], v251 offset:11968
    v_accvgpr_read_b32 v36, a32
    v_accvgpr_read_b32 v37, a33
    v_accvgpr_read_b32 v38, a34
    v_accvgpr_read_b32 v39, a35
    s_nop 7
    s_nop 7
    v_accvgpr_read_b32 v44, a36
    v_accvgpr_read_b32 v45, a37
    v_accvgpr_read_b32 v46, a38
    v_accvgpr_read_b32 v47, a39
    v_pk_mul_f32 v[36:37], v[36:37], v[254:255] op_sel_hi:[1,0]
    v_pk_mul_f32 v[38:39], v[38:39], v[254:255] op_sel_hi:[1,0]
    v_pk_mul_f32 v[44:45], v[44:45], v[254:255] op_sel_hi:[1,0]
    v_pk_mul_f32 v[46:47], v[46:47], v[254:255] op_sel_hi:[1,0]
    v_cvt_pk_bf16_f32 v36, v36, v37
    v_cvt_pk_bf16_f32 v37, v38, v39
    v_cvt_pk_bf16_f32 v38, v44, v45
    v_cvt_pk_bf16_f32 v39, v46, v47
    ds_write_b128 v253, v[36:39] offset:13968
    s_add_u32 s47, s71, 0
    s_waitcnt lgkmcnt(4)
    buffer_store_dwordx4 v[32:35], v246, s[16:19], s47 offen offset:128 nt
    s_add_u32 s47, s71, 1024
    s_waitcnt lgkmcnt(3)
    buffer_store_dwordx4 v[40:43], v246, s[16:19], s47 offen offset:128 nt
    v_accvgpr_read_b32 v52, a40
    v_accvgpr_read_b32 v53, a41
    v_accvgpr_read_b32 v54, a42
    v_accvgpr_read_b32 v55, a43
    v_accvgpr_read_b32 v60, a44
    v_accvgpr_read_b32 v61, a45
    v_accvgpr_read_b32 v62, a46
    v_accvgpr_read_b32 v63, a47
    v_pk_mul_f32 v[52:53], v[52:53], v[254:255] op_sel_hi:[1,0]
    v_pk_mul_f32 v[54:55], v[54:55], v[254:255] op_sel_hi:[1,0]
    v_pk_mul_f32 v[60:61], v[60:61], v[254:255] op_sel_hi:[1,0]
    v_pk_mul_f32 v[62:63], v[62:63], v[254:255] op_sel_hi:[1,0]
    v_cvt_pk_bf16_f32 v52, v52, v53
    v_cvt_pk_bf16_f32 v53, v54, v55
    v_cvt_pk_bf16_f32 v54, v60, v61
    v_cvt_pk_bf16_f32 v55, v62, v63
    ds_write_b128 v253, v[52:55] offset:14000
    s_add_u32 s47, s71, 8192
    s_waitcnt lgkmcnt(3)
    buffer_store_dwordx4 v[48:51], v246, s[16:19], s47 offen offset:128 nt
    s_add_u32 s47, s71, 9216
    s_waitcnt lgkmcnt(2)
    buffer_store_dwordx4 v[56:59], v246, s[16:19], s47 offen offset:128 nt
    v_accvgpr_read_b32 v36, a48
    v_accvgpr_read_b32 v37, a49
    v_accvgpr_read_b32 v38, a50
    v_accvgpr_read_b32 v39, a51
    v_accvgpr_read_b32 v44, a52
    v_accvgpr_read_b32 v45, a53
    v_accvgpr_read_b32 v46, a54
    v_accvgpr_read_b32 v47, a55
    v_pk_mul_f32 v[36:37], v[36:37], v[254:255] op_sel_hi:[1,0]
    v_pk_mul_f32 v[38:39], v[38:39], v[254:255] op_sel_hi:[1,0]
    v_pk_mul_f32 v[44:45], v[44:45], v[254:255] op_sel_hi:[1,0]
    v_pk_mul_f32 v[46:47], v[46:47], v[254:255] op_sel_hi:[1,0]
    v_cvt_pk_bf16_f32 v36, v36, v37
    v_cvt_pk_bf16_f32 v37, v38, v39
    v_cvt_pk_bf16_f32 v38, v44, v45
    v_cvt_pk_bf16_f32 v39, v46, v47
    ds_write_b128 v253, v[36:39] offset:14032
    v_accvgpr_read_b32 v52, a56
    v_accvgpr_read_b32 v53, a57
    v_accvgpr_read_b32 v54, a58
    v_accvgpr_read_b32 v55, a59
    v_accvgpr_read_b32 v60, a60
    v_accvgpr_read_b32 v61, a61
    v_accvgpr_read_b32 v62, a62
    v_accvgpr_read_b32 v63, a63
    v_pk_mul_f32 v[52:53], v[52:53], v[254:255] op_sel_hi:[1,0]
    v_pk_mul_f32 v[54:55], v[54:55], v[254:255] op_sel_hi:[1,0]
    v_pk_mul_f32 v[60:61], v[60:61], v[254:255] op_sel_hi:[1,0]
    v_pk_mul_f32 v[62:63], v[62:63], v[254:255] op_sel_hi:[1,0]
    v_cvt_pk_bf16_f32 v52, v52, v53
    v_cvt_pk_bf16_f32 v53, v54, v55
    v_cvt_pk_bf16_f32 v54, v60, v61
    v_cvt_pk_bf16_f32 v55, v62, v63
    ds_write_b128 v253, v[52:55] offset:14064
    ds_read_b128 v[36:39], v251 offset:13968
    ds_read_b128 v[44:47], v251 offset:14256
    ds_read_b128 v[52:55], v251 offset:16336
    ds_read_b128 v[60:63], v251 offset:16624
    v_pk_mul_f32 v[64:65], v[64:65], v[252:253] op_sel_hi:[1,0]
    v_pk_mul_f32 v[66:67], v[66:67], v[252:253] op_sel_hi:[1,0]
    v_pk_mul_f32 v[68:69], v[68:69], v[252:253] op_sel_hi:[1,0]
    v_pk_mul_f32 v[70:71], v[70:71], v[252:253] op_sel_hi:[1,0]
    v_cvt_pk_bf16_f32 v64, v64, v65
    v_cvt_pk_bf16_f32 v65, v66, v67
    v_cvt_pk_bf16_f32 v66, v68, v69
    v_cvt_pk_bf16_f32 v67, v70, v71
    ds_write_b128 v253, v[64:67] offset:18624
    s_add_u32 s47, s71, 16384
    s_waitcnt lgkmcnt(4)
    buffer_store_dwordx4 v[36:39], v246, s[16:19], s47 offen offset:128 nt
    v_pk_mul_f32 v[72:73], v[72:73], v[252:253] op_sel_hi:[1,0]
    v_pk_mul_f32 v[74:75], v[74:75], v[252:253] op_sel_hi:[1,0]
    v_pk_mul_f32 v[76:77], v[76:77], v[252:253] op_sel_hi:[1,0]
    v_pk_mul_f32 v[78:79], v[78:79], v[252:253] op_sel_hi:[1,0]
    v_cvt_pk_bf16_f32 v72, v72, v73
    v_cvt_pk_bf16_f32 v73, v74, v75
    v_cvt_pk_bf16_f32 v74, v76, v77
    v_cvt_pk_bf16_f32 v75, v78, v79
    ds_write_b128 v253, v[72:75] offset:18656
    s_add_u32 s47, s71, 17408
    s_waitcnt lgkmcnt(4)
    buffer_store_dwordx4 v[44:47], v246, s[16:19], s47 offen offset:128 nt
    v_pk_mul_f32 v[80:81], v[80:81], v[252:253] op_sel_hi:[1,0]
    v_pk_mul_f32 v[82:83], v[82:83], v[252:253] op_sel_hi:[1,0]
    v_pk_mul_f32 v[84:85], v[84:85], v[252:253] op_sel_hi:[1,0]
    v_pk_mul_f32 v[86:87], v[86:87], v[252:253] op_sel_hi:[1,0]
    v_cvt_pk_bf16_f32 v80, v80, v81
    v_cvt_pk_bf16_f32 v81, v82, v83
    v_cvt_pk_bf16_f32 v82, v84, v85
    v_cvt_pk_bf16_f32 v83, v86, v87
    ds_write_b128 v253, v[80:83] offset:18688
    s_add_u32 s47, s71, 24576
    s_waitcnt lgkmcnt(4)
    buffer_store_dwordx4 v[52:55], v246, s[16:19], s47 offen offset:128 nt
    v_pk_mul_f32 v[88:89], v[88:89], v[252:253] op_sel_hi:[1,0]
    v_pk_mul_f32 v[90:91], v[90:91], v[252:253] op_sel_hi:[1,0]
    v_pk_mul_f32 v[92:93], v[92:93], v[252:253] op_sel_hi:[1,0]
    v_pk_mul_f32 v[94:95], v[94:95], v[252:253] op_sel_hi:[1,0]
    v_cvt_pk_bf16_f32 v88, v88, v89
    v_cvt_pk_bf16_f32 v89, v90, v91
    v_cvt_pk_bf16_f32 v90, v92, v93
    v_cvt_pk_bf16_f32 v91, v94, v95
    ds_write_b128 v253, v[88:91] offset:18720
    s_add_u32 s47, s71, 25600
    s_waitcnt lgkmcnt(4)
    buffer_store_dwordx4 v[60:63], v246, s[16:19], s47 offen offset:128 nt
    ds_read_b128 v[64:67], v251 offset:18624
    ds_read_b128 v[72:75], v251 offset:18912
    ds_read_b128 v[80:83], v251 offset:20992
    ds_read_b128 v[88:91], v251 offset:21280
    v_accvgpr_read_b32 v68, a64
    v_accvgpr_read_b32 v69, a65
    v_accvgpr_read_b32 v70, a66
    v_accvgpr_read_b32 v71, a67
    v_accvgpr_read_b32 v76, a68
    v_accvgpr_read_b32 v77, a69
    v_accvgpr_read_b32 v78, a70
    v_accvgpr_read_b32 v79, a71
    v_pk_mul_f32 v[68:69], v[68:69], v[254:255] op_sel_hi:[1,0]
    v_pk_mul_f32 v[70:71], v[70:71], v[254:255] op_sel_hi:[1,0]
    v_pk_mul_f32 v[76:77], v[76:77], v[254:255] op_sel_hi:[1,0]
    v_pk_mul_f32 v[78:79], v[78:79], v[254:255] op_sel_hi:[1,0]
    v_cvt_pk_bf16_f32 v68, v68, v69
    v_cvt_pk_bf16_f32 v69, v70, v71
    v_cvt_pk_bf16_f32 v70, v76, v77
    v_cvt_pk_bf16_f32 v71, v78, v79
    ds_write_b128 v253, v[68:71]
    s_add_u32 s47, s71, 0
    s_waitcnt lgkmcnt(4)
    buffer_store_dwordx4 v[64:67], v246, s[16:19], s47 offen offset:256 nt
    s_add_u32 s47, s71, 1024
    s_waitcnt lgkmcnt(3)
    buffer_store_dwordx4 v[72:75], v246, s[16:19], s47 offen offset:256 nt
    v_accvgpr_read_b32 v84, a72
    v_accvgpr_read_b32 v85, a73
    v_accvgpr_read_b32 v86, a74
    v_accvgpr_read_b32 v87, a75
    v_accvgpr_read_b32 v92, a76
    v_accvgpr_read_b32 v93, a77
    v_accvgpr_read_b32 v94, a78
    v_accvgpr_read_b32 v95, a79
    v_pk_mul_f32 v[84:85], v[84:85], v[254:255] op_sel_hi:[1,0]
    v_pk_mul_f32 v[86:87], v[86:87], v[254:255] op_sel_hi:[1,0]
    v_pk_mul_f32 v[92:93], v[92:93], v[254:255] op_sel_hi:[1,0]
    v_pk_mul_f32 v[94:95], v[94:95], v[254:255] op_sel_hi:[1,0]
    v_cvt_pk_bf16_f32 v84, v84, v85
    v_cvt_pk_bf16_f32 v85, v86, v87
    v_cvt_pk_bf16_f32 v86, v92, v93
    v_cvt_pk_bf16_f32 v87, v94, v95
    ds_write_b128 v253, v[84:87] offset:32
    s_add_u32 s47, s71, 8192
    s_waitcnt lgkmcnt(3)
    buffer_store_dwordx4 v[80:83], v246, s[16:19], s47 offen offset:256 nt
    s_add_u32 s47, s71, 9216
    s_waitcnt lgkmcnt(2)
    buffer_store_dwordx4 v[88:91], v246, s[16:19], s47 offen offset:256 nt
    v_accvgpr_read_b32 v68, a80
    v_accvgpr_read_b32 v69, a81
    v_accvgpr_read_b32 v70, a82
    v_accvgpr_read_b32 v71, a83
    v_accvgpr_read_b32 v76, a84
    v_accvgpr_read_b32 v77, a85
    v_accvgpr_read_b32 v78, a86
    v_accvgpr_read_b32 v79, a87
    v_pk_mul_f32 v[68:69], v[68:69], v[254:255] op_sel_hi:[1,0]
    v_pk_mul_f32 v[70:71], v[70:71], v[254:255] op_sel_hi:[1,0]
    v_pk_mul_f32 v[76:77], v[76:77], v[254:255] op_sel_hi:[1,0]
    v_pk_mul_f32 v[78:79], v[78:79], v[254:255] op_sel_hi:[1,0]
    v_cvt_pk_bf16_f32 v68, v68, v69
    v_cvt_pk_bf16_f32 v69, v70, v71
    v_cvt_pk_bf16_f32 v70, v76, v77
    v_cvt_pk_bf16_f32 v71, v78, v79
    ds_write_b128 v253, v[68:71] offset:64
    v_accvgpr_read_b32 v84, a88
    v_accvgpr_read_b32 v85, a89
    v_accvgpr_read_b32 v86, a90
    v_accvgpr_read_b32 v87, a91
    v_accvgpr_read_b32 v92, a92
    v_accvgpr_read_b32 v93, a93
    v_accvgpr_read_b32 v94, a94
    v_accvgpr_read_b32 v95, a95
    v_pk_mul_f32 v[84:85], v[84:85], v[254:255] op_sel_hi:[1,0]
    v_pk_mul_f32 v[86:87], v[86:87], v[254:255] op_sel_hi:[1,0]
    v_pk_mul_f32 v[92:93], v[92:93], v[254:255] op_sel_hi:[1,0]
    v_pk_mul_f32 v[94:95], v[94:95], v[254:255] op_sel_hi:[1,0]
    v_cvt_pk_bf16_f32 v84, v84, v85
    v_cvt_pk_bf16_f32 v85, v86, v87
    v_cvt_pk_bf16_f32 v86, v92, v93
    v_cvt_pk_bf16_f32 v87, v94, v95
    ds_write_b128 v253, v[84:87] offset:96
    ds_read_b128 v[68:71], v251
    ds_read_b128 v[76:79], v251 offset:288
    ds_read_b128 v[84:87], v251 offset:2368
    ds_read_b128 v[92:95], v251 offset:2656
    v_pk_mul_f32 v[96:97], v[96:97], v[252:253] op_sel_hi:[1,0]
    v_pk_mul_f32 v[98:99], v[98:99], v[252:253] op_sel_hi:[1,0]
    v_pk_mul_f32 v[100:101], v[100:101], v[252:253] op_sel_hi:[1,0]
    v_pk_mul_f32 v[102:103], v[102:103], v[252:253] op_sel_hi:[1,0]
    v_cvt_pk_bf16_f32 v96, v96, v97
    v_cvt_pk_bf16_f32 v97, v98, v99
    v_cvt_pk_bf16_f32 v98, v100, v101
    v_cvt_pk_bf16_f32 v99, v102, v103
    ds_write_b128 v253, v[96:99] offset:4656
    s_add_u32 s47, s71, 16384
    s_waitcnt lgkmcnt(4)
    buffer_store_dwordx4 v[68:71], v246, s[16:19], s47 offen offset:256 nt
    v_pk_mul_f32 v[104:105], v[104:105], v[252:253] op_sel_hi:[1,0]
    v_pk_mul_f32 v[106:107], v[106:107], v[252:253] op_sel_hi:[1,0]
    v_pk_mul_f32 v[108:109], v[108:109], v[252:253] op_sel_hi:[1,0]
    v_pk_mul_f32 v[110:111], v[110:111], v[252:253] op_sel_hi:[1,0]
    v_cvt_pk_bf16_f32 v104, v104, v105
    v_cvt_pk_bf16_f32 v105, v106, v107
    v_cvt_pk_bf16_f32 v106, v108, v109
    v_cvt_pk_bf16_f32 v107, v110, v111
    ds_write_b128 v253, v[104:107] offset:4688
    s_add_u32 s47, s71, 17408
    s_waitcnt lgkmcnt(4)
    buffer_store_dwordx4 v[76:79], v246, s[16:19], s47 offen offset:256 nt
    v_pk_mul_f32 v[112:113], v[112:113], v[252:253] op_sel_hi:[1,0]
    v_pk_mul_f32 v[114:115], v[114:115], v[252:253] op_sel_hi:[1,0]
    v_pk_mul_f32 v[116:117], v[116:117], v[252:253] op_sel_hi:[1,0]
    v_pk_mul_f32 v[118:119], v[118:119], v[252:253] op_sel_hi:[1,0]
    v_cvt_pk_bf16_f32 v112, v112, v113
    v_cvt_pk_bf16_f32 v113, v114, v115
    v_cvt_pk_bf16_f32 v114, v116, v117
    v_cvt_pk_bf16_f32 v115, v118, v119
    ds_write_b128 v253, v[112:115] offset:4720
    s_add_u32 s47, s71, 24576
    s_waitcnt lgkmcnt(4)
    buffer_store_dwordx4 v[84:87], v246, s[16:19], s47 offen offset:256 nt
    v_pk_mul_f32 v[120:121], v[120:121], v[252:253] op_sel_hi:[1,0]
    v_pk_mul_f32 v[122:123], v[122:123], v[252:253] op_sel_hi:[1,0]
    v_pk_mul_f32 v[124:125], v[124:125], v[252:253] op_sel_hi:[1,0]
    v_pk_mul_f32 v[126:127], v[126:127], v[252:253] op_sel_hi:[1,0]
    v_cvt_pk_bf16_f32 v120, v120, v121
    v_cvt_pk_bf16_f32 v121, v122, v123
    v_cvt_pk_bf16_f32 v122, v124, v125
    v_cvt_pk_bf16_f32 v123, v126, v127
    ds_write_b128 v253, v[120:123] offset:4752
    s_add_u32 s47, s71, 25600
    s_waitcnt lgkmcnt(4)
    buffer_store_dwordx4 v[92:95], v246, s[16:19], s47 offen offset:256 nt
    ds_read_b128 v[96:99], v251 offset:4656
    ds_read_b128 v[104:107], v251 offset:4944
    ds_read_b128 v[112:115], v251 offset:7024
    ds_read_b128 v[120:123], v251 offset:7312
    v_accvgpr_read_b32 v100, a96
    v_accvgpr_read_b32 v101, a97
    v_accvgpr_read_b32 v102, a98
    v_accvgpr_read_b32 v103, a99
    v_accvgpr_read_b32 v108, a100
    v_accvgpr_read_b32 v109, a101
    v_accvgpr_read_b32 v110, a102
    v_accvgpr_read_b32 v111, a103
    v_pk_mul_f32 v[100:101], v[100:101], v[254:255] op_sel_hi:[1,0]
    v_pk_mul_f32 v[102:103], v[102:103], v[254:255] op_sel_hi:[1,0]
    v_pk_mul_f32 v[108:109], v[108:109], v[254:255] op_sel_hi:[1,0]
    v_pk_mul_f32 v[110:111], v[110:111], v[254:255] op_sel_hi:[1,0]
    v_cvt_pk_bf16_f32 v100, v100, v101
    v_cvt_pk_bf16_f32 v101, v102, v103
    v_cvt_pk_bf16_f32 v102, v108, v109
    v_cvt_pk_bf16_f32 v103, v110, v111
    ds_write_b128 v253, v[100:103] offset:9312
    s_add_u32 s47, s71, 0
    s_waitcnt lgkmcnt(4)
    buffer_store_dwordx4 v[96:99], v246, s[16:19], s47 offen offset:384 nt
    s_add_u32 s47, s71, 1024
    s_waitcnt lgkmcnt(3)
    buffer_store_dwordx4 v[104:107], v246, s[16:19], s47 offen offset:384 nt
    v_accvgpr_read_b32 v116, a104
    v_accvgpr_read_b32 v117, a105
    v_accvgpr_read_b32 v118, a106
    v_accvgpr_read_b32 v119, a107
    v_accvgpr_read_b32 v124, a108
    v_accvgpr_read_b32 v125, a109
    v_accvgpr_read_b32 v126, a110
    v_accvgpr_read_b32 v127, a111
    v_pk_mul_f32 v[116:117], v[116:117], v[254:255] op_sel_hi:[1,0]
    v_pk_mul_f32 v[118:119], v[118:119], v[254:255] op_sel_hi:[1,0]
    v_pk_mul_f32 v[124:125], v[124:125], v[254:255] op_sel_hi:[1,0]
    v_pk_mul_f32 v[126:127], v[126:127], v[254:255] op_sel_hi:[1,0]
    v_cvt_pk_bf16_f32 v116, v116, v117
    v_cvt_pk_bf16_f32 v117, v118, v119
    v_cvt_pk_bf16_f32 v118, v124, v125
    v_cvt_pk_bf16_f32 v119, v126, v127
    ds_write_b128 v253, v[116:119] offset:9344
    s_add_u32 s47, s71, 8192
    s_waitcnt lgkmcnt(3)
    buffer_store_dwordx4 v[112:115], v246, s[16:19], s47 offen offset:384 nt
    s_add_u32 s47, s71, 9216
    s_waitcnt lgkmcnt(2)
    buffer_store_dwordx4 v[120:123], v246, s[16:19], s47 offen offset:384 nt
    v_accvgpr_read_b32 v100, a112
    v_accvgpr_read_b32 v101, a113
    v_accvgpr_read_b32 v102, a114
    v_accvgpr_read_b32 v103, a115
    v_accvgpr_read_b32 v108, a116
    v_accvgpr_read_b32 v109, a117
    v_accvgpr_read_b32 v110, a118
    v_accvgpr_read_b32 v111, a119
    v_pk_mul_f32 v[100:101], v[100:101], v[254:255] op_sel_hi:[1,0]
    v_pk_mul_f32 v[102:103], v[102:103], v[254:255] op_sel_hi:[1,0]
    v_pk_mul_f32 v[108:109], v[108:109], v[254:255] op_sel_hi:[1,0]
    v_pk_mul_f32 v[110:111], v[110:111], v[254:255] op_sel_hi:[1,0]
    v_cvt_pk_bf16_f32 v100, v100, v101
    v_cvt_pk_bf16_f32 v101, v102, v103
    v_cvt_pk_bf16_f32 v102, v108, v109
    v_cvt_pk_bf16_f32 v103, v110, v111
    ds_write_b128 v253, v[100:103] offset:9376
    v_accvgpr_read_b32 v116, a120
    v_accvgpr_read_b32 v117, a121
    v_accvgpr_read_b32 v118, a122
    v_accvgpr_read_b32 v119, a123
    v_accvgpr_read_b32 v124, a124
    v_accvgpr_read_b32 v125, a125
    v_accvgpr_read_b32 v126, a126
    v_accvgpr_read_b32 v127, a127
    v_pk_mul_f32 v[116:117], v[116:117], v[254:255] op_sel_hi:[1,0]
    v_pk_mul_f32 v[118:119], v[118:119], v[254:255] op_sel_hi:[1,0]
    v_pk_mul_f32 v[124:125], v[124:125], v[254:255] op_sel_hi:[1,0]
    v_pk_mul_f32 v[126:127], v[126:127], v[254:255] op_sel_hi:[1,0]
    v_cvt_pk_bf16_f32 v116, v116, v117
    v_cvt_pk_bf16_f32 v117, v118, v119
    v_cvt_pk_bf16_f32 v118, v124, v125
    v_cvt_pk_bf16_f32 v119, v126, v127
    ds_write_b128 v253, v[116:119] offset:9408
    ds_read_b128 v[100:103], v251 offset:9312
    ds_read_b128 v[108:111], v251 offset:9600
    ds_read_b128 v[116:119], v251 offset:11680
    ds_read_b128 v[124:127], v251 offset:11968
    s_add_u32 s47, s71, 16384
    s_waitcnt lgkmcnt(3)
    buffer_store_dwordx4 v[100:103], v246, s[16:19], s47 offen offset:384 nt
    s_add_u32 s47, s71, 17408
    s_waitcnt lgkmcnt(2)
    buffer_store_dwordx4 v[108:111], v246, s[16:19], s47 offen offset:384 nt
    s_add_u32 s47, s71, 24576
    s_waitcnt lgkmcnt(1)
    buffer_store_dwordx4 v[116:119], v246, s[16:19], s47 offen offset:384 nt
    s_add_u32 s47, s71, 25600
    s_waitcnt lgkmcnt(0)
    buffer_store_dwordx4 v[124:127], v246, s[16:19], s47 offen offset:384 nt
    s_branch L_fin
L_fin:
L_end:
    s_endpgm
L_proB:
    s_mul_hi_u32 s42, s57, 0x55555556
    s_mul_i32 s43, s42, 3
    s_sub_u32 s43, s57, s43
    s_cmp_eq_u32 s43, 2
    s_cselect_b32 s85, 3, 7
    s_cmp_eq_u32 s20, s85
    s_mov_b32 s85, 0x7e967699
    s_cselect_b32 s84, 0xf149f2ca, s85
    s_add_u32 s42, s42, s3
    s_mul_i32 s44, s42, 376832
    s_lshl_b32 s43, s43, 17
    s_add_u32 s44, s44, s43
    s_lshl_b32 s45, s42, 18
    s_lshr_b32 s80, s42, 4
    s_xor_b32 s80, s80, s42
    s_and_b32 s80, s80, 15
    s_lshl_b32 s80, s80, 14
    s_add_u32 s81, s80, 0x1000
    s_sub_u32 s43, 376832, s43
    s_cmp_lt_u32 s57, 96
    s_cselect_b32 s43, s43, 0
    s_cselect_b32 s52, 262144, 0
    s_add_u32 s4, s32, s44
    s_addc_u32 s5, s33, 0
    s_and_b32 s5, s5, 0xffff
    s_mov_b32 s6, s43
    s_add_u32 s54, s38, s44
    s_addc_u32 s55, s39, 0
    s_and_b32 s55, s55, 0xffff
    s_mov_b32 s56, s43
    s_add_u32 s48, s34, s45
    s_addc_u32 s49, s35, 0
    s_and_b32 s49, s49, 0xffff
    s_add_u32 s50, s36, s45
    s_addc_u32 s51, s37, 0
    s_and_b32 s51, s51, 0xffff
    s_mov_b32 s7, 0x00020000
    s_mov_b32 s8, s48
    s_mov_b32 s9, s49
    s_mov_b32 s10, 262144
    s_mov_b32 s11, 0x00020000
    s_mov_b32 s12, s50
    s_mov_b32 s13, s51
    s_mov_b32 s14, 262144
    s_mov_b32 s15, 0x00020000
    s_mov_b32 s16, s54
    s_mov_b32 s17, s55
    s_mov_b32 s18, 0
    s_mov_b32 s19, 0x00020000
    s_mov_b32 s21, 0x3db8aa3b
    s_mov_b32 s30, 0xbdb8aa3b
    s_mov_b32 s22, 0x45800000
    s_mov_b32 s23, s80
    s_mov_b32 s24, s80
    s_mov_b32 s59, 0
    s_mul_i32 s25, s20, 4160
    s_add_u32 s25, s25, 0
    s_mul_i32 s26, s20, 4352
    s_add_u32 s26, s26, 33280
    s_mul_i32 s58, s20, 23280
    s_add_u32 s58, s58, 68096
    s_lshl_b32 s71, s20, 15
    v_lshrrev_b32 v245, 5, v247
    v_lshlrev_b32 v238, 11, v245
    v_and_b32 v248, 31, v247
    v_lshl_add_u32 v238, v248, 4, v238
    s_lshl_b32 s46, s20, 12
    v_add_u32 v238, s46, v238
    v_lshrrev_b32 v232, 3, v247
    v_bfe_u32 v233, v247, 4, 1
    v_and_b32 v234, 7, v247
    v_xor_b32 v234, v234, v233
    v_lshlrev_b32 v249, 9, v232
    v_lshl_add_u32 v249, v234, 4, v249
    s_add_u32 m0, s25, 0
    s_nop 0
    buffer_load_dwordx4 v238, s[8:11], s23 offen nt lds
    s_add_u32 m0, s25, 528
    s_nop 0
    buffer_load_dwordx4 v238, s[8:11], s23 offen offset:512 nt lds
    s_add_u32 m0, s25, 1056
    s_nop 0
    buffer_load_dwordx4 v238, s[8:11], s23 offen offset:1024 nt lds
    s_add_u32 m0, s25, 1584
    s_nop 0
    buffer_load_dwordx4 v238, s[8:11], s23 offen offset:1536 nt lds
    s_add_u32 s23, s23, 16384
    s_and_b32 s23, s23, 0x3ffff
    s_add_u32 m0, s58, 0
    s_add_u32 s40, s71, 0
    buffer_load_dwordx4 v249, s[4:7], s40 offen nt lds
    s_add_u32 m0, s58, 1056
    s_add_u32 s40, s71, 4096
    buffer_load_dwordx4 v249, s[4:7], s40 offen nt lds
    s_add_u32 m0, s58, 2112
    s_add_u32 s40, s71, 8192
    buffer_load_dwordx4 v249, s[4:7], s40 offen nt lds
    s_add_u32 m0, s58, 3168
    s_add_u32 s40, s71, 12288
    buffer_load_dwordx4 v249, s[4:7], s40 offen nt lds
    s_add_u32 m0, s58, 4656
    s_add_u32 s40, s71, 16384
    buffer_load_dwordx4 v249, s[4:7], s40 offen nt lds
    s_add_u32 m0, s58, 5712
    s_add_u32 s40, s71, 20480
    buffer_load_dwordx4 v249, s[4:7], s40 offen nt lds
    s_add_u32 m0, s58, 6768
    s_add_u32 s40, s71, 24576
    buffer_load_dwordx4 v249, s[4:7], s40 offen nt lds
    s_add_u32 m0, s58, 7824
    s_add_u32 s40, s71, 28672
    buffer_load_dwordx4 v249, s[4:7], s40 offen nt lds
    s_add_u32 m0, s58, 9312
    s_add_u32 s40, s71, 128
    buffer_load_dwordx4 v249, s[4:7], s40 offen nt lds
    s_add_u32 m0, s58, 10368
    s_add_u32 s40, s71, 4224
    buffer_load_dwordx4 v249, s[4:7], s40 offen nt lds
    s_add_u32 m0, s58, 11424
    s_add_u32 s40, s71, 8320
    buffer_load_dwordx4 v249, s[4:7], s40 offen nt lds
    s_add_u32 m0, s58, 12480
    s_add_u32 s40, s71, 12416
    buffer_load_dwordx4 v249, s[4:7], s40 offen nt lds
    s_add_u32 m0, s58, 13968
    s_add_u32 s40, s71, 16512
    buffer_load_dwordx4 v249, s[4:7], s40 offen nt lds
    s_add_u32 m0, s58, 15024
    s_add_u32 s40, s71, 20608
    buffer_load_dwordx4 v249, s[4:7], s40 offen nt lds
    s_add_u32 m0, s58, 16080
    s_add_u32 s40, s71, 24704
    buffer_load_dwordx4 v249, s[4:7], s40 offen nt lds
    s_add_u32 m0, s58, 17136
    s_add_u32 s40, s71, 28800
    buffer_load_dwordx4 v249, s[4:7], s40 offen nt lds
    s_add_u32 m0, s58, 18624
    s_add_u32 s40, s71, 256
    buffer_load_dwordx4 v249, s[4:7], s40 offen nt lds
    s_add_u32 m0, s58, 19680
    s_add_u32 s40, s71, 4352
    buffer_load_dwordx4 v249, s[4:7], s40 offen nt lds
    s_add_u32 m0, s58, 20736
    s_add_u32 s40, s71, 8448
    buffer_load_dwordx4 v249, s[4:7], s40 offen nt lds
    s_add_u32 m0, s58, 21792
    s_add_u32 s40, s71, 12544
    buffer_load_dwordx4 v249, s[4:7], s40 offen nt lds
    v_lshrrev_b32 v232, 3, v248
    s_movk_i32 s46, 1056
    v_mul_lo_u32 v250, v232, s46
    v_and_b32 v232, 7, v248
    v_lshl_add_u32 v250, v232, 7, v250
    v_bfe_u32 v232, v248, 1, 1
    v_xor_b32 v232, v232, v245
    v_lshl_add_u32 v250, v232, 4, v250
    v_add_u32 v250, s58, v250
    v_and_b32 v236, 3, v248
    v_lshrrev_b32 v232, 3, v248
    v_lshl_add_u32 v236, v232, 2, v236
    s_movk_i32 s46, 1040
    v_mul_lo_u32 v236, v236, s46
    v_bfe_u32 v232, v248, 2, 1
    v_lshl_add_u32 v236, v232, 9, v236
    v_lshl_add_u32 v236, v245, 4, v236
    v_bfe_u32 v237, v247, 2, 2
    s_movk_i32 s46, 1088
    v_mul_lo_u32 v237, v237, s46
    v_lshl_add_u32 v237, v245, 9, v237
    v_bfe_u32 v232, v247, 4, 1
    v_lshl_add_u32 v237, v232, 5, v237
    v_and_b32 v232, 1, v247
    v_lshl_add_u32 v237, v232, 4, v237
    v_bfe_u32 v232, v247, 1, 1
    v_lshl_add_u32 v237, v232, 3, v237
    v_bfe_u32 v232, v247, 3, 2
    v_lshrrev_b32 v233, 5, v247
    v_lshl_add_u32 v232, v232, 2, v233
    v_and_b32 v233, 7, v247
    v_lshlrev_b32 v246, 9, v232
    v_lshl_add_u32 v246, v233, 4, v246
    v_mul_u32_u24 v251, 0x90, v232
    v_lshl_add_u32 v251, v233, 4, v251
    v_add_u32 v251, s58, v251
    v_mul_u32_u24 v253, 0x90, v248
    v_lshrrev_b32 v232, 4, v248
    v_lshl_add_u32 v253, v232, 6, v253
    v_lshl_add_u32 v253, v245, 4, v253
    v_add_u32 v253, s58, v253
    s_waitcnt vmcnt(16)
    ds_read_b128 a[128:131], v250
    ds_read_b128 a[132:135], v250 offset:32
    ds_read_b128 a[136:139], v250 offset:64
    ds_read_b128 a[140:143], v250 offset:96
    s_waitcnt lgkmcnt(0)
    s_add_u32 m0, s58, 0
    s_add_u32 s40, s71, 16640
    buffer_load_dwordx4 v249, s[4:7], s40 offen nt lds
    s_add_u32 m0, s58, 1056
    s_add_u32 s40, s71, 20736
    buffer_load_dwordx4 v249, s[4:7], s40 offen nt lds
    s_add_u32 m0, s58, 2112
    s_add_u32 s40, s71, 24832
    buffer_load_dwordx4 v249, s[4:7], s40 offen nt lds
    s_add_u32 m0, s58, 3168
    s_add_u32 s40, s71, 28928
    buffer_load_dwordx4 v249, s[4:7], s40 offen nt lds
    s_waitcnt vmcnt(16)
    ds_read_b128 a[192:195], v250 offset:4656
    ds_read_b128 a[196:199], v250 offset:4688
    ds_read_b128 a[200:203], v250 offset:4720
    ds_read_b128 a[204:207], v250 offset:4752
    s_waitcnt lgkmcnt(0)
    s_add_u32 m0, s58, 4656
    s_add_u32 s40, s71, 384
    buffer_load_dwordx4 v249, s[4:7], s40 offen nt lds
    s_add_u32 m0, s58, 5712
    s_add_u32 s40, s71, 4480
    buffer_load_dwordx4 v249, s[4:7], s40 offen nt lds
    s_add_u32 m0, s58, 6768
    s_add_u32 s40, s71, 8576
    buffer_load_dwordx4 v249, s[4:7], s40 offen nt lds
    s_add_u32 m0, s58, 7824
    s_add_u32 s40, s71, 12672
    buffer_load_dwordx4 v249, s[4:7], s40 offen nt lds
    s_waitcnt vmcnt(16)
    ds_read_b128 a[144:147], v250 offset:9312
    ds_read_b128 a[148:151], v250 offset:9344
    ds_read_b128 a[152:155], v250 offset:9376
    ds_read_b128 a[156:159], v250 offset:9408
    s_waitcnt lgkmcnt(0)
    s_add_u32 m0, s58, 9312
    s_add_u32 s40, s71, 16768
    buffer_load_dwordx4 v249, s[4:7], s40 offen nt lds
    s_add_u32 m0, s58, 10368
    s_add_u32 s40, s71, 20864
    buffer_load_dwordx4 v249, s[4:7], s40 offen nt lds
    s_add_u32 m0, s58, 11424
    s_add_u32 s40, s71, 24960
    buffer_load_dwordx4 v249, s[4:7], s40 offen nt lds
    s_add_u32 m0, s58, 12480
    s_add_u32 s40, s71, 29056
    buffer_load_dwordx4 v249, s[4:7], s40 offen nt lds
    s_add_u32 m0, s25, 16640
    s_nop 0
    buffer_load_dwordx4 v238, s[8:11], s23 offen nt lds
    s_add_u32 m0, s25, 17168
    s_nop 0
    buffer_load_dwordx4 v238, s[8:11], s23 offen offset:512 nt lds
    s_add_u32 m0, s25, 17696
    s_nop 0
    buffer_load_dwordx4 v238, s[8:11], s23 offen offset:1024 nt lds
    s_add_u32 m0, s25, 18224
    s_nop 0
    buffer_load_dwordx4 v238, s[8:11], s23 offen offset:1536 nt lds
    s_add_u32 s23, s23, 16384
    s_and_b32 s23, s23, 0x3ffff
    s_add_u32 m0, s26, 0
    s_nop 0
    buffer_load_dwordx4 v238, s[12:15], s24 offen nt lds
    s_add_u32 m0, s26, 576
    s_nop 0
    buffer_load_dwordx4 v238, s[12:15], s24 offen offset:512 nt lds
    s_add_u32 m0, s26, 1152
    s_nop 0
    buffer_load_dwordx4 v238, s[12:15], s24 offen offset:1024 nt lds
    s_add_u32 m0, s26, 1728
    s_nop 0
    buffer_load_dwordx4 v238, s[12:15], s24 offen offset:1536 nt lds
    s_add_u32 s24, s24, 16384
    s_and_b32 s24, s24, 0x3ffff
    v_lshlrev_b32 v238, 7, v247
    s_mov_b32 s74, 0
    s_mov_b32 s75, 0x00020000
    s_sub_u32 s46, s20, 2
    s_lshl_b32 s78, s46, 16
    s_mul_i32 s79, s46, 46560
    s_add_u32 s79, s79, 68096
    s_sub_u32 s76, s58, s79
    s_sub_u32 s77, s79, s58
    s_sub_u32 s76, s76, 18624
    s_barrier
    ds_read_b128 v[216:219], v236
    ds_read_b128 v[220:223], v236 offset:32
    ds_read_b128 v[224:227], v236 offset:64
    ds_read_b128 v[228:231], v236 offset:96
    s_waitcnt lgkmcnt(3)
    v_mfma_f32_32x32x16_bf16 v[128:143], v[216:219], a[128:131], 0
    v_mfma_f32_32x32x16_bf16 v[144:159], v[216:219], a[192:195], 0
    ds_read_b128 v[216:219], v236 offset:128
    s_waitcnt lgkmcnt(3)
    v_mfma_f32_32x32x16_bf16 v[128:143], v[220:223], a[132:135], v[128:143]
    v_mfma_f32_32x32x16_bf16 v[144:159], v[220:223], a[196:199], v[144:159]
    ds_read_b128 v[220:223], v236 offset:160
    s_waitcnt lgkmcnt(3)
    v_mfma_f32_32x32x16_bf16 v[128:143], v[224:227], a[136:139], v[128:143]
    v_mfma_f32_32x32x16_bf16 v[144:159], v[224:227], a[200:203], v[144:159]
    ds_read_b128 v[224:227], v236 offset:192
    s_waitcnt lgkmcnt(3)
    v_mfma_f32_32x32x16_bf16 v[128:143], v[228:231], a[140:143], v[128:143]
    v_mfma_f32_32x32x16_bf16 v[144:159], v[228:231], a[204:207], v[144:159]
    ds_read_b128 v[228:231], v236 offset:224
    s_waitcnt vmcnt(24)
    ds_read_b128 a[208:211], v250 offset:13968
    ds_read_b128 a[212:215], v250 offset:14000
    ds_read_b128 a[216:219], v250 offset:14032
    ds_read_b128 a[220:223], v250 offset:14064
    s_waitcnt lgkmcnt(7)
    v_mfma_f32_32x32x16_bf16 v[128:143], v[216:219], a[144:147], v[128:143]
    s_waitcnt lgkmcnt(3)
    v_mfma_f32_32x32x16_bf16 v[144:159], v[216:219], a[208:211], v[144:159]
    ds_read_b128 v[216:219], v236 offset:256
    v_mfma_f32_32x32x16_bf16 v[128:143], v[220:223], a[148:151], v[128:143]
    s_waitcnt lgkmcnt(3)
    v_mfma_f32_32x32x16_bf16 v[144:159], v[220:223], a[212:215], v[144:159]
    ds_read_b128 v[220:223], v236 offset:288
    v_mfma_f32_32x32x16_bf16 v[128:143], v[224:227], a[152:155], v[128:143]
    s_waitcnt lgkmcnt(3)
    v_mfma_f32_32x32x16_bf16 v[144:159], v[224:227], a[216:219], v[144:159]
    ds_read_b128 v[224:227], v236 offset:320
    v_mfma_f32_32x32x16_bf16 v[128:143], v[228:231], a[156:159], v[128:143]
    s_waitcnt lgkmcnt(3)
    v_mfma_f32_32x32x16_bf16 v[144:159], v[228:231], a[220:223], v[144:159]
    ds_read_b128 v[228:231], v236 offset:352
    s_waitcnt vmcnt(20)
    ds_read_b128 a[160:163], v250 offset:18624
    ds_read_b128 a[164:167], v250 offset:18656
    ds_read_b128 a[168:171], v250 offset:18688
    ds_read_b128 a[172:175], v250 offset:18720
    s_waitcnt vmcnt(16)
    ds_read_b128 a[224:227], v250
    ds_read_b128 a[228:231], v250 offset:32
    ds_read_b128 a[232:235], v250 offset:64
    ds_read_b128 a[236:239], v250 offset:96
    s_waitcnt lgkmcnt(7)
    v_mfma_f32_32x32x16_bf16 v[128:143], v[216:219], a[160:163], v[128:143]
    s_waitcnt lgkmcnt(3)
    v_mfma_f32_32x32x16_bf16 v[144:159], v[216:219], a[224:227], v[144:159]
    ds_read_b128 v[216:219], v236 offset:384
    v_mfma_f32_32x32x16_bf16 v[128:143], v[220:223], a[164:167], v[128:143]
    s_waitcnt lgkmcnt(3)
    v_mfma_f32_32x32x16_bf16 v[144:159], v[220:223], a[228:231], v[144:159]
    ds_read_b128 v[220:223], v236 offset:416
    v_mfma_f32_32x32x16_bf16 v[128:143], v[224:227], a[168:171], v[128:143]
    s_waitcnt lgkmcnt(3)
    v_mfma_f32_32x32x16_bf16 v[144:159], v[224:227], a[232:235], v[144:159]
    ds_read_b128 v[224:227], v236 offset:448
    v_mfma_f32_32x32x16_bf16 v[128:143], v[228:231], a[172:175], v[128:143]
    s_waitcnt lgkmcnt(3)
    v_mfma_f32_32x32x16_bf16 v[144:159], v[228:231], a[236:239], v[144:159]
    ds_read_b128 v[228:231], v236 offset:480
    s_waitcnt vmcnt(12)
    ds_read_b128 a[176:179], v250 offset:4656
    ds_read_b128 a[180:183], v250 offset:4688
    ds_read_b128 a[184:187], v250 offset:4720
    ds_read_b128 a[188:191], v250 offset:4752
    s_waitcnt vmcnt(8)
    ds_read_b128 a[240:243], v250 offset:9312
    ds_read_b128 a[244:247], v250 offset:9344
    ds_read_b128 a[248:251], v250 offset:9376
    ds_read_b128 a[252:255], v250 offset:9408
    s_waitcnt lgkmcnt(7)
    v_mfma_f32_32x32x16_bf16 v[128:143], v[216:219], a[176:179], v[128:143]
    s_waitcnt lgkmcnt(3)
    v_mfma_f32_32x32x16_bf16 v[144:159], v[216:219], a[240:243], v[144:159]
    v_mfma_f32_32x32x16_bf16 v[128:143], v[220:223], a[180:183], v[128:143]
    s_waitcnt lgkmcnt(2)
    v_mfma_f32_32x32x16_bf16 v[144:159], v[220:223], a[244:247], v[144:159]
    s_waitcnt vmcnt(0)
    s_waitcnt lgkmcnt(0)
    s_barrier
    ds_read_b128 v[216:219], v236 offset:16640
    ds_read_b128 v[220:223], v236 offset:16672
    v_mfma_f32_32x32x16_bf16 v[128:143], v[224:227], a[184:187], v[128:143]
    v_mfma_f32_32x32x16_bf16 v[144:159], v[224:227], a[248:251], v[144:159]
    ds_read_b128 v[224:227], v236 offset:16704
    v_mfma_f32_32x32x16_bf16 v[128:143], v[228:231], a[188:191], v[128:143]
    v_mfma_f32_32x32x16_bf16 v[144:159], v[228:231], a[252:255], v[144:159]
    ds_read_b128 v[228:231], v236 offset:16736
    s_nop 7
    s_nop 7
    v_max3_f32 v247, v128, v129, v130
    v_max3_f32 v248, v144, v145, v146
    v_max3_f32 v247, v247, v131, v132
    v_max3_f32 v248, v248, v147, v148
    v_max3_f32 v247, v247, v133, v134
    v_max3_f32 v248, v248, v149, v150
    v_max3_f32 v247, v247, v135, v136
    v_max3_f32 v248, v248, v151, v152
    v_max3_f32 v247, v247, v137, v138
    v_max3_f32 v248, v248, v153, v154
    v_max3_f32 v247, v247, v139, v140
    v_max3_f32 v248, v248, v155, v156
    v_max3_f32 v247, v247, v141, v142
    v_max3_f32 v248, v248, v157, v158
    v_max_f32 v247, v247, v143
    v_max_f32 v248, v248, v159
    v_mov_b32 v245, v247
    v_mov_b32 v255, v248
    s_nop 1
    v_permlane32_swap_b32 v245, v247
    v_permlane32_swap_b32 v255, v248
    s_nop 0
    v_max_f32 v247, v247, v245
    v_max_f32 v248, v248, v255
    v_mul_f32 v239, s30, v247
    v_mul_f32 v240, s30, v248
    v_min_f32 v240, s84, v240
    v_fma_f32 v232, v128, s21, v239
    s_nop 0
    v_fma_f32 v233, v129, s21, v239
    v_exp_f32 v232, v232
    s_nop 0
    v_fma_f32 v234, v130, s21, v239
    v_exp_f32 v233, v233
    s_nop 0
    v_fma_f32 v235, v131, s21, v239
    v_exp_f32 v234, v234
    v_add_f32 v243, v232, v233
    v_cvt_pk_bf16_f32 v192, v232, v233
    s_nop 0
    v_fma_f32 v232, v132, s21, v239
    v_exp_f32 v235, v235
    v_add_f32 v243, v243, v234
    s_nop 0
    v_fma_f32 v233, v133, s21, v239
    v_exp_f32 v232, v232
    v_add_f32 v243, v243, v235
    v_cvt_pk_bf16_f32 v193, v234, v235
    s_nop 0
    v_fma_f32 v234, v134, s21, v239
    v_exp_f32 v233, v233
    v_add_f32 v243, v243, v232
    s_nop 0
    v_fma_f32 v235, v135, s21, v239
    v_exp_f32 v234, v234
    v_add_f32 v243, v243, v233
    v_cvt_pk_bf16_f32 v194, v232, v233
    s_nop 0
    v_fma_f32 v232, v144, s21, v240
    v_exp_f32 v235, v235
    v_add_f32 v243, v243, v234
    s_nop 0
    v_fma_f32 v233, v145, s21, v240
    v_exp_f32 v232, v232
    v_add_f32 v243, v243, v235
    v_cvt_pk_bf16_f32 v195, v234, v235
    s_nop 0
    v_fma_f32 v234, v146, s21, v240
    v_exp_f32 v233, v233
    s_nop 0
    v_fma_f32 v235, v147, s21, v240
    v_exp_f32 v234, v234
    v_add_f32 v244, v232, v233
    v_cvt_pk_bf16_f32 v196, v232, v233
    s_nop 0
    s_waitcnt lgkmcnt(0)
    v_mfma_f32_32x32x16_bf16 v[160:175], v[216:219], a[128:131], 0
    v_fma_f32 v232, v148, s21, v240
    v_exp_f32 v235, v235
    v_add_f32 v244, v244, v234
    v_mfma_f32_32x32x16_bf16 v[176:191], v[216:219], a[192:195], 0
    ds_read_b128 v[216:219], v236 offset:16768
    s_add_u32 s47, s71, 25600
    buffer_store_dwordx4 v[28:31], v246, s[16:19], s47 offen nt
    v_mfma_f32_32x32x16_bf16 v[160:175], v[220:223], a[132:135], v[160:175]
    v_fma_f32 v233, v149, s21, v240
    v_exp_f32 v232, v232
    v_add_f32 v244, v244, v235
    v_cvt_pk_bf16_f32 v197, v234, v235
    v_mfma_f32_32x32x16_bf16 v[176:191], v[220:223], a[196:199], v[176:191]
    ds_read_b128 v[220:223], v236 offset:16800
    v_fma_f32 v234, v150, s21, v240
    v_exp_f32 v233, v233
    v_add_f32 v244, v244, v232
    v_mfma_f32_32x32x16_bf16 v[160:175], v[224:227], a[136:139], v[160:175]
    v_fma_f32 v235, v151, s21, v240
    v_exp_f32 v234, v234
    v_add_f32 v244, v244, v233
    v_cvt_pk_bf16_f32 v198, v232, v233
    v_mfma_f32_32x32x16_bf16 v[176:191], v[224:227], a[200:203], v[176:191]
    ds_read_b128 v[224:227], v236 offset:16832
    v_fma_f32 v232, v136, s21, v239
    v_exp_f32 v235, v235
    v_add_f32 v244, v244, v234
    s_add_u32 s47, s71, 0
    buffer_store_dwordx4 v[32:35], v246, s[16:19], s47 offen offset:128 nt
    s_add_u32 s47, s71, 1024
    buffer_store_dwordx4 v[40:43], v246, s[16:19], s47 offen offset:128 nt
    v_mfma_f32_32x32x16_bf16 v[160:175], v[228:231], a[140:143], v[160:175]
    v_fma_f32 v233, v137, s21, v239
    v_exp_f32 v232, v232
    v_add_f32 v244, v244, v235
    v_cvt_pk_bf16_f32 v199, v234, v235
    v_mfma_f32_32x32x16_bf16 v[176:191], v[228:231], a[204:207], v[176:191]
    ds_read_b128 v[228:231], v236 offset:16864
    v_fma_f32 v234, v138, s21, v239
    v_exp_f32 v233, v233
    v_add_f32 v243, v243, v232
    s_waitcnt lgkmcnt(3)
    v_mfma_f32_32x32x16_bf16 v[160:175], v[216:219], a[144:147], v[160:175]
    v_fma_f32 v235, v139, s21, v239
    v_exp_f32 v234, v234
    v_add_f32 v243, v243, v233
    v_cvt_pk_bf16_f32 v208, v232, v233
    v_mfma_f32_32x32x16_bf16 v[176:191], v[216:219], a[208:211], v[176:191]
    ds_read_b128 v[216:219], v236 offset:16896
    v_fma_f32 v232, v140, s21, v239
    v_exp_f32 v235, v235
    v_add_f32 v243, v243, v234
    s_waitcnt lgkmcnt(3)
    v_mfma_f32_32x32x16_bf16 v[160:175], v[220:223], a[148:151], v[160:175]
    v_fma_f32 v233, v141, s21, v239
    v_exp_f32 v232, v232
    v_add_f32 v243, v243, v235
    v_cvt_pk_bf16_f32 v209, v234, v235
    s_add_u32 s47, s71, 8192
    buffer_store_dwordx4 v[48:51], v246, s[16:19], s47 offen offset:128 nt
    s_add_u32 s47, s71, 9216
    buffer_store_dwordx4 v[56:59], v246, s[16:19], s47 offen offset:128 nt
    v_mfma_f32_32x32x16_bf16 v[176:191], v[220:223], a[212:215], v[176:191]
    ds_read_b128 v[220:223], v236 offset:16928
    v_fma_f32 v234, v142, s21, v239
    v_exp_f32 v233, v233
    v_add_f32 v243, v243, v232
    s_waitcnt lgkmcnt(3)
    v_mfma_f32_32x32x16_bf16 v[160:175], v[224:227], a[152:155], v[160:175]
    v_fma_f32 v235, v143, s21, v239
    v_exp_f32 v234, v234
    v_add_f32 v243, v243, v233
    v_cvt_pk_bf16_f32 v210, v232, v233
    v_mfma_f32_32x32x16_bf16 v[176:191], v[224:227], a[216:219], v[176:191]
    ds_read_b128 v[224:227], v236 offset:16960
    v_fma_f32 v232, v152, s21, v240
    v_exp_f32 v235, v235
    v_add_f32 v243, v243, v234
    s_waitcnt lgkmcnt(3)
    v_mfma_f32_32x32x16_bf16 v[160:175], v[228:231], a[156:159], v[160:175]
    v_fma_f32 v233, v153, s21, v240
    v_exp_f32 v232, v232
    v_add_f32 v243, v243, v235
    v_cvt_pk_bf16_f32 v211, v234, v235
    v_mfma_f32_32x32x16_bf16 v[176:191], v[228:231], a[220:223], v[176:191]
    ds_read_b128 v[228:231], v236 offset:16992
    v_fma_f32 v234, v154, s21, v240
    v_exp_f32 v233, v233
    v_add_f32 v244, v244, v232
    s_waitcnt lgkmcnt(3)
    v_mfma_f32_32x32x16_bf16 v[160:175], v[216:219], a[160:163], v[160:175]
    v_fma_f32 v235, v155, s21, v240
    v_exp_f32 v234, v234
    v_add_f32 v244, v244, v233
    v_cvt_pk_bf16_f32 v212, v232, v233
    v_mfma_f32_32x32x16_bf16 v[176:191], v[216:219], a[224:227], v[176:191]
    ds_read_b128 v[216:219], v236 offset:17024
    v_fma_f32 v232, v156, s21, v240
    v_exp_f32 v235, v235
    v_add_f32 v244, v244, v234
    s_waitcnt lgkmcnt(3)
    v_mfma_f32_32x32x16_bf16 v[160:175], v[220:223], a[164:167], v[160:175]
    v_fma_f32 v233, v157, s21, v240
    v_exp_f32 v232, v232
    v_add_f32 v244, v244, v235
    v_cvt_pk_bf16_f32 v213, v234, v235
    v_mfma_f32_32x32x16_bf16 v[176:191], v[220:223], a[228:231], v[176:191]
    ds_read_b128 v[220:223], v236 offset:17056
    v_fma_f32 v234, v158, s21, v240
    v_exp_f32 v233, v233
    v_add_f32 v244, v244, v232
    s_waitcnt lgkmcnt(3)
    v_mfma_f32_32x32x16_bf16 v[160:175], v[224:227], a[168:171], v[160:175]
    v_fma_f32 v235, v159, s21, v240
    v_exp_f32 v234, v234
    v_add_f32 v244, v244, v233
    v_cvt_pk_bf16_f32 v214, v232, v233
    v_mfma_f32_32x32x16_bf16 v[176:191], v[224:227], a[232:235], v[176:191]
    ds_read_b128 v[224:227], v236 offset:17088
    v_exp_f32 v235, v235
    v_add_f32 v244, v244, v234
    s_waitcnt lgkmcnt(3)
    v_mfma_f32_32x32x16_bf16 v[160:175], v[228:231], a[172:175], v[160:175]
    v_add_f32 v244, v244, v235
    v_cvt_pk_bf16_f32 v215, v234, v235
    v_mfma_f32_32x32x16_bf16 v[176:191], v[228:231], a[236:239], v[176:191]
    ds_read_b128 v[228:231], v236 offset:17120
    s_waitcnt lgkmcnt(3)
    v_mfma_f32_32x32x16_bf16 v[160:175], v[216:219], a[176:179], v[160:175]
    v_mfma_f32_32x32x16_bf16 v[176:191], v[216:219], a[240:243], v[176:191]
    s_waitcnt lgkmcnt(2)
    v_mfma_f32_32x32x16_bf16 v[160:175], v[220:223], a[180:183], v[160:175]
    v_mfma_f32_32x32x16_bf16 v[176:191], v[220:223], a[244:247], v[176:191]
    s_waitcnt lgkmcnt(0)
    s_barrier
    ds_read_b64_tr_b16 v[216:217], v237 offset:33280
    ds_read_b64_tr_b16 v[218:219], v237 offset:37632
    ds_read_b64_tr_b16 v[220:221], v237 offset:41984
    ds_read_b64_tr_b16 v[222:223], v237 offset:46336
    v_mfma_f32_32x32x16_bf16 v[160:175], v[224:227], a[184:187], v[160:175]
    v_mfma_f32_32x32x16_bf16 v[176:191], v[224:227], a[248:251], v[176:191]
    ds_read_b64_tr_b16 v[224:225], v237 offset:33344
    ds_read_b64_tr_b16 v[226:227], v237 offset:37696
    v_mfma_f32_32x32x16_bf16 v[160:175], v[228:231], a[188:191], v[160:175]
    v_mov_b32 v241, v243
    v_mov_b32 v242, v244
    v_mfma_f32_32x32x16_bf16 v[176:191], v[228:231], a[252:255], v[176:191]
    ds_read_b64_tr_b16 v[228:229], v237 offset:42048
    ds_read_b64_tr_b16 v[230:231], v237 offset:46400
    s_waitcnt lgkmcnt(6)
    v_mfma_f32_32x32x16_bf16 v[0:15], v[216:219], v[192:195], 0
    v_mfma_f32_32x32x16_bf16 a[0:15], v[216:219], v[196:199], 0
    ds_read_b64_tr_b16 v[216:217], v237 offset:33408
    ds_read_b64_tr_b16 v[218:219], v237 offset:37760
    s_waitcnt lgkmcnt(6)
    v_mfma_f32_32x32x16_bf16 v[0:15], v[220:223], v[208:211], v[0:15]
    v_mfma_f32_32x32x16_bf16 a[0:15], v[220:223], v[212:215], a[0:15]
    ds_read_b64_tr_b16 v[220:221], v237 offset:42112
    ds_read_b64_tr_b16 v[222:223], v237 offset:46464
    v_fma_f32 v232, v160, s21, v239
    s_waitcnt lgkmcnt(6)
    v_mfma_f32_32x32x16_bf16 v[16:31], v[224:227], v[192:195], 0
    v_fma_f32 v233, v161, s21, v239
    v_exp_f32 v232, v232
    v_mfma_f32_32x32x16_bf16 a[16:31], v[224:227], v[196:199], 0
    ds_read_b64_tr_b16 v[224:225], v237 offset:33472
    ds_read_b64_tr_b16 v[226:227], v237 offset:37824
    v_fma_f32 v234, v162, s21, v239
    v_exp_f32 v233, v233
    s_waitcnt lgkmcnt(6)
    v_mfma_f32_32x32x16_bf16 v[16:31], v[228:231], v[208:211], v[16:31]
    v_fma_f32 v235, v163, s21, v239
    v_exp_f32 v234, v234
    v_add_f32 v243, v232, v233
    v_cvt_pk_bf16_f32 v200, v232, v233
    v_mfma_f32_32x32x16_bf16 a[16:31], v[228:231], v[212:215], a[16:31]
    ds_read_b64_tr_b16 v[228:229], v237 offset:42176
    ds_read_b64_tr_b16 v[230:231], v237 offset:46528
    s_waitcnt lgkmcnt(6)
    v_mfma_f32_32x32x16_bf16 v[32:47], v[216:219], v[192:195], 0
    v_fma_f32 v232, v164, s21, v239
    v_exp_f32 v235, v235
    v_add_f32 v243, v243, v234
    v_mfma_f32_32x32x16_bf16 a[32:47], v[216:219], v[196:199], 0
    ds_read_b64_tr_b16 v[216:217], v237 offset:33536
    ds_read_b64_tr_b16 v[218:219], v237 offset:37888
    s_waitcnt lgkmcnt(6)
    v_mfma_f32_32x32x16_bf16 v[32:47], v[220:223], v[208:211], v[32:47]
    v_fma_f32 v233, v165, s21, v239
    v_exp_f32 v232, v232
    v_add_f32 v243, v243, v235
    v_cvt_pk_bf16_f32 v201, v234, v235
    v_mfma_f32_32x32x16_bf16 a[32:47], v[220:223], v[212:215], a[32:47]
    ds_read_b64_tr_b16 v[220:221], v237 offset:42240
    ds_read_b64_tr_b16 v[222:223], v237 offset:46592
    s_waitcnt lgkmcnt(6)
    v_mfma_f32_32x32x16_bf16 v[48:63], v[224:227], v[192:195], 0
    v_fma_f32 v234, v166, s21, v239
    v_exp_f32 v233, v233
    v_add_f32 v243, v243, v232
    v_mfma_f32_32x32x16_bf16 a[48:63], v[224:227], v[196:199], 0
    ds_read_b64_tr_b16 v[224:225], v237 offset:33600
    ds_read_b64_tr_b16 v[226:227], v237 offset:37952
    s_waitcnt lgkmcnt(6)
    v_mfma_f32_32x32x16_bf16 v[48:63], v[228:231], v[208:211], v[48:63]
    v_fma_f32 v235, v167, s21, v239
    v_exp_f32 v234, v234
    v_add_f32 v243, v243, v233
    v_cvt_pk_bf16_f32 v202, v232, v233
    v_mfma_f32_32x32x16_bf16 a[48:63], v[228:231], v[212:215], a[48:63]
    ds_read_b64_tr_b16 v[228:229], v237 offset:42304
    ds_read_b64_tr_b16 v[230:231], v237 offset:46656
    s_waitcnt lgkmcnt(6)
    v_mfma_f32_32x32x16_bf16 v[64:79], v[216:219], v[192:195], 0
    v_fma_f32 v232, v176, s21, v240
    v_exp_f32 v235, v235
    v_add_f32 v243, v243, v234
    v_mfma_f32_32x32x16_bf16 a[64:79], v[216:219], v[196:199], 0
    ds_read_b64_tr_b16 v[216:217], v237 offset:33664
    ds_read_b64_tr_b16 v[218:219], v237 offset:38016
    s_waitcnt lgkmcnt(6)
    v_mfma_f32_32x32x16_bf16 v[64:79], v[220:223], v[208:211], v[64:79]
    v_fma_f32 v233, v177, s21, v240
    v_exp_f32 v232, v232
    v_add_f32 v243, v243, v235
    v_cvt_pk_bf16_f32 v203, v234, v235
    v_mfma_f32_32x32x16_bf16 a[64:79], v[220:223], v[212:215], a[64:79]
    ds_read_b64_tr_b16 v[220:221], v237 offset:42368
    ds_read_b64_tr_b16 v[222:223], v237 offset:46720
    v_fma_f32 v234, v178, s21, v240
    v_exp_f32 v233, v233
    s_waitcnt lgkmcnt(6)
    v_mfma_f32_32x32x16_bf16 v[80:95], v[224:227], v[192:195], 0
    v_fma_f32 v235, v179, s21, v240
    v_exp_f32 v234, v234
    v_add_f32 v244, v232, v233
    v_cvt_pk_bf16_f32 v204, v232, v233
    v_mfma_f32_32x32x16_bf16 a[80:95], v[224:227], v[196:199], 0
    ds_read_b64_tr_b16 v[224:225], v237 offset:33728
    ds_read_b64_tr_b16 v[226:227], v237 offset:38080
    s_waitcnt lgkmcnt(6)
    v_mfma_f32_32x32x16_bf16 v[80:95], v[228:231], v[208:211], v[80:95]
    v_fma_f32 v232, v180, s21, v240
    v_exp_f32 v235, v235
    v_add_f32 v244, v244, v234
    v_mfma_f32_32x32x16_bf16 a[80:95], v[228:231], v[212:215], a[80:95]
    ds_read_b64_tr_b16 v[228:229], v237 offset:42432
    ds_read_b64_tr_b16 v[230:231], v237 offset:46784
    s_waitcnt lgkmcnt(6)
    v_mfma_f32_32x32x16_bf16 v[96:111], v[216:219], v[192:195], 0
    v_fma_f32 v233, v181, s21, v240
    v_exp_f32 v232, v232
    v_add_f32 v244, v244, v235
    v_cvt_pk_bf16_f32 v205, v234, v235
    v_mfma_f32_32x32x16_bf16 a[96:111], v[216:219], v[196:199], 0
    v_fma_f32 v234, v182, s21, v240
    v_exp_f32 v233, v233
    v_add_f32 v244, v244, v232
    s_waitcnt lgkmcnt(4)
    v_mfma_f32_32x32x16_bf16 v[96:111], v[220:223], v[208:211], v[96:111]
    v_fma_f32 v235, v183, s21, v240
    v_exp_f32 v234, v234
    v_add_f32 v244, v244, v233
    v_cvt_pk_bf16_f32 v206, v232, v233
    v_mfma_f32_32x32x16_bf16 a[96:111], v[220:223], v[212:215], a[96:111]
    s_waitcnt lgkmcnt(0)
    s_barrier
    ds_read_b128 v[216:219], v236
    ds_read_b128 v[220:223], v236 offset:32
    v_mfma_f32_32x32x16_bf16 v[112:127], v[224:227], v[192:195], 0
    v_fma_f32 v232, v168, s21, v239
    v_exp_f32 v235, v235
    v_add_f32 v244, v244, v234
    v_mfma_f32_32x32x16_bf16 a[112:127], v[224:227], v[196:199], 0
    ds_read_b128 v[224:227], v236 offset:64
    v_mfma_f32_32x32x16_bf16 v[112:127], v[228:231], v[208:211], v[112:127]
    v_fma_f32 v233, v169, s21, v239
    v_exp_f32 v232, v232
    v_add_f32 v244, v244, v235
    v_cvt_pk_bf16_f32 v207, v234, v235
    v_mfma_f32_32x32x16_bf16 a[112:127], v[228:231], v[212:215], a[112:127]
    ds_read_b128 v[228:231], v236 offset:96
    v_fma_f32 v234, v170, s21, v239
    v_exp_f32 v233, v233
    v_add_f32 v243, v243, v232
    s_branch L_it0eB
L_saB:
    s_waitcnt lgkmcnt(3)
    v_mfma_f32_32x32x16_bf16 v[160:175], v[216:219], a[128:131], 0
    v_fma_f32 v235, v139, s21, v239
    v_exp_f32 v234, v234
    v_add_f32 v243, v243, v233
    v_cvt_pk_bf16_f32 v208, v232, v233
    v_mfma_f32_32x32x16_bf16 v[176:191], v[216:219], a[192:195], 0
    ds_read_b128 v[216:219], v236 offset:16768
    v_fma_f32 v232, v140, s21, v239
    v_exp_f32 v235, v235
    v_add_f32 v243, v243, v234
    s_waitcnt lgkmcnt(3)
    v_mfma_f32_32x32x16_bf16 v[160:175], v[220:223], a[132:135], v[160:175]
    ds_read_b128 a[128:131], v250
    v_fma_f32 v233, v141, s21, v239
    v_exp_f32 v232, v232
    v_add_f32 v243, v243, v235
    v_cvt_pk_bf16_f32 v209, v234, v235
    v_mfma_f32_32x32x16_bf16 v[176:191], v[220:223], a[196:199], v[176:191]
    ds_read_b128 v[220:223], v236 offset:16800
    ds_read_b128 a[192:195], v250 offset:4656
    v_fma_f32 v234, v142, s21, v239
    v_exp_f32 v233, v233
    v_add_f32 v243, v243, v232
    s_waitcnt lgkmcnt(5)
    v_mfma_f32_32x32x16_bf16 v[160:175], v[224:227], a[136:139], v[160:175]
    ds_read_b128 a[132:135], v250 offset:32
    v_fma_f32 v235, v143, s21, v239
    v_exp_f32 v234, v234
    v_add_f32 v243, v243, v233
    v_cvt_pk_bf16_f32 v210, v232, v233
    v_mfma_f32_32x32x16_bf16 v[176:191], v[224:227], a[200:203], v[176:191]
    ds_read_b128 v[224:227], v236 offset:16832
    ds_read_b128 a[196:199], v250 offset:4688
    v_fma_f32 v232, v152, s21, v240
    v_exp_f32 v235, v235
    v_add_f32 v243, v243, v234
    s_waitcnt lgkmcnt(7)
    v_mfma_f32_32x32x16_bf16 v[160:175], v[228:231], a[140:143], v[160:175]
    ds_read_b128 a[136:139], v250 offset:64
    v_fma_f32 v233, v153, s21, v240
    v_exp_f32 v232, v232
    v_add_f32 v243, v243, v235
    v_cvt_pk_bf16_f32 v211, v234, v235
    v_mfma_f32_32x32x16_bf16 v[176:191], v[228:231], a[204:207], v[176:191]
    ds_read_b128 v[228:231], v236 offset:16864
    ds_read_b128 a[200:203], v250 offset:4720
    v_fma_f32 v234, v154, s21, v240
    v_exp_f32 v233, v233
    v_add_f32 v244, v244, v232
    s_waitcnt lgkmcnt(9)
    v_mfma_f32_32x32x16_bf16 v[160:175], v[216:219], a[144:147], v[160:175]
    ds_read_b128 a[140:143], v250 offset:96
    v_fma_f32 v235, v155, s21, v240
    v_exp_f32 v234, v234
    v_add_f32 v244, v244, v233
    v_cvt_pk_bf16_f32 v212, v232, v233
    v_mfma_f32_32x32x16_bf16 v[176:191], v[216:219], a[208:211], v[176:191]
    ds_read_b128 v[216:219], v236 offset:16896
    ds_read_b128 a[204:207], v250 offset:4752
    v_fma_f32 v232, v156, s21, v240
    v_exp_f32 v235, v235
    v_add_f32 v244, v244, v234
    s_waitcnt lgkmcnt(10)
    v_mfma_f32_32x32x16_bf16 v[160:175], v[220:223], a[148:151], v[160:175]
    ds_read_b128 a[144:147], v250 offset:9312
    v_fma_f32 v233, v157, s21, v240
    v_exp_f32 v232, v232
    v_add_f32 v244, v244, v235
    v_cvt_pk_bf16_f32 v213, v234, v235
    v_mfma_f32_32x32x16_bf16 v[176:191], v[220:223], a[212:215], v[176:191]
    ds_read_b128 v[220:223], v236 offset:16928
    ds_read_b128 a[208:211], v250 offset:13968
    s_waitcnt lgkmcnt(5)
    s_add_u32 m0, s58, 0
    s_add_u32 s40, s71, 16640
    buffer_load_dwordx4 v249, s[4:7], s40 offen nt lds
    v_mfma_f32_32x32x16_bf16 v[160:175], v[224:227], a[152:155], v[160:175]
    ds_read_b128 a[148:151], v250 offset:9344
    s_waitcnt lgkmcnt(4)
    s_add_u32 m0, s58, 4656
    s_add_u32 s40, s71, 384
    buffer_load_dwordx4 v249, s[4:7], s40 offen nt lds
    v_mfma_f32_32x32x16_bf16 v[176:191], v[224:227], a[216:219], v[176:191]
    ds_read_b128 v[224:227], v236 offset:16960
    ds_read_b128 a[212:215], v250 offset:14000
    s_add_u32 m0, s58, 1056
    s_add_u32 s40, s71, 20736
    buffer_load_dwordx4 v249, s[4:7], s40 offen nt lds
    v_mfma_f32_32x32x16_bf16 v[160:175], v[228:231], a[156:159], v[160:175]
    ds_read_b128 a[152:155], v250 offset:9376
    s_add_u32 m0, s58, 5712
    s_add_u32 s40, s71, 4480
    buffer_load_dwordx4 v249, s[4:7], s40 offen nt lds
    v_mfma_f32_32x32x16_bf16 v[176:191], v[228:231], a[220:223], v[176:191]
    ds_read_b128 v[228:231], v236 offset:16992
    ds_read_b128 a[216:219], v250 offset:14032
    s_add_u32 m0, s58, 2112
    s_add_u32 s40, s71, 24832
    buffer_load_dwordx4 v249, s[4:7], s40 offen nt lds
    v_mfma_f32_32x32x16_bf16 v[160:175], v[216:219], a[160:163], v[160:175]
    ds_read_b128 a[156:159], v250 offset:9408
    s_add_u32 m0, s58, 6768
    s_add_u32 s40, s71, 8576
    buffer_load_dwordx4 v249, s[4:7], s40 offen nt lds
    v_mfma_f32_32x32x16_bf16 v[176:191], v[216:219], a[224:227], v[176:191]
    ds_read_b128 v[216:219], v236 offset:17024
    ds_read_b128 a[220:223], v250 offset:14064
    s_add_u32 m0, s58, 3168
    s_add_u32 s40, s71, 28928
    buffer_load_dwordx4 v249, s[4:7], s40 offen nt lds
    s_waitcnt lgkmcnt(10)
    v_mfma_f32_32x32x16_bf16 v[160:175], v[220:223], a[164:167], v[160:175]
    ds_read_b128 a[160:163], v250 offset:18624
    s_add_u32 m0, s58, 7824
    s_add_u32 s40, s71, 12672
    buffer_load_dwordx4 v249, s[4:7], s40 offen nt lds
    v_mfma_f32_32x32x16_bf16 v[176:191], v[220:223], a[228:231], v[176:191]
    ds_read_b128 v[220:223], v236 offset:17056
    s_waitcnt lgkmcnt(4)
    s_add_u32 m0, s58, 9312
    s_add_u32 s40, s71, 16768
    buffer_load_dwordx4 v249, s[4:7], s40 offen nt lds
    v_mfma_f32_32x32x16_bf16 v[160:175], v[224:227], a[168:171], v[160:175]
    ds_read_b128 a[164:167], v250 offset:18656
    v_fma_f32 v234, v158, s21, v240
    v_exp_f32 v233, v233
    v_add_f32 v244, v244, v232
    v_mfma_f32_32x32x16_bf16 v[176:191], v[224:227], a[232:235], v[176:191]
    ds_read_b128 v[224:227], v236 offset:17088
    s_add_u32 m0, s58, 10368
    s_add_u32 s40, s71, 20864
    buffer_load_dwordx4 v249, s[4:7], s40 offen nt lds
    v_mfma_f32_32x32x16_bf16 v[160:175], v[228:231], a[172:175], v[160:175]
    ds_read_b128 a[168:171], v250 offset:18688
    v_fma_f32 v235, v159, s21, v240
    v_exp_f32 v234, v234
    v_add_f32 v244, v244, v233
    v_cvt_pk_bf16_f32 v214, v232, v233
    v_mfma_f32_32x32x16_bf16 v[176:191], v[228:231], a[236:239], v[176:191]
    ds_read_b128 v[228:231], v236 offset:17120
    s_add_u32 m0, s58, 11424
    s_add_u32 s40, s71, 24960
    buffer_load_dwordx4 v249, s[4:7], s40 offen nt lds
    s_waitcnt lgkmcnt(7)
    v_mfma_f32_32x32x16_bf16 v[160:175], v[216:219], a[176:179], v[160:175]
    ds_read_b128 a[172:175], v250 offset:18720
    v_exp_f32 v235, v235
    v_add_f32 v244, v244, v234
    v_add_f32 v244, v244, v235
    v_cvt_pk_bf16_f32 v215, v234, v235
    v_mfma_f32_32x32x16_bf16 v[176:191], v[216:219], a[240:243], v[176:191]
    s_add_u32 m0, s58, 12480
    s_add_u32 s40, s71, 29056
    buffer_load_dwordx4 v249, s[4:7], s40 offen nt lds
    s_waitcnt lgkmcnt(5)
    v_mfma_f32_32x32x16_bf16 v[160:175], v[220:223], a[180:183], v[160:175]
    v_mfma_f32_32x32x16_bf16 v[176:191], v[220:223], a[244:247], v[176:191]
    s_waitcnt lgkmcnt(0)
    s_barrier
    ds_read_b64_tr_b16 v[216:217], v237 offset:33280
    ds_read_b64_tr_b16 v[218:219], v237 offset:37632
    ds_read_b64_tr_b16 v[220:221], v237 offset:41984
    ds_read_b64_tr_b16 v[222:223], v237 offset:46336
    v_mfma_f32_32x32x16_bf16 v[160:175], v[224:227], a[184:187], v[160:175]
    v_mfma_f32_32x32x16_bf16 v[176:191], v[224:227], a[248:251], v[176:191]
    ds_read_b64_tr_b16 v[224:225], v237 offset:33344
    ds_read_b64_tr_b16 v[226:227], v237 offset:37696
    v_add_f32 v245, v243, v244
    v_mfma_f32_32x32x16_bf16 v[160:175], v[228:231], a[188:191], v[160:175]
    v_cmp_nge_f32 vcc, s22, v245
    s_cbranch_vccnz L_rares14B
L_backs14B:
    v_add_f32 v241, v241, v243
    v_add_f32 v242, v242, v244
    v_mfma_f32_32x32x16_bf16 v[176:191], v[228:231], a[252:255], v[176:191]
    ds_read_b64_tr_b16 v[228:229], v237 offset:42048
    ds_read_b64_tr_b16 v[230:231], v237 offset:46400
    s_waitcnt lgkmcnt(6)
    v_mfma_f32_32x32x16_bf16 v[0:15], v[216:219], v[192:195], v[0:15]
    v_mfma_f32_32x32x16_bf16 a[0:15], v[216:219], v[196:199], a[0:15]
    ds_read_b64_tr_b16 v[216:217], v237 offset:33408
    ds_read_b64_tr_b16 v[218:219], v237 offset:37760
    s_waitcnt lgkmcnt(6)
    v_mfma_f32_32x32x16_bf16 v[0:15], v[220:223], v[208:211], v[0:15]
    v_mfma_f32_32x32x16_bf16 a[0:15], v[220:223], v[212:215], a[0:15]
    ds_read_b64_tr_b16 v[220:221], v237 offset:42112
    ds_read_b64_tr_b16 v[222:223], v237 offset:46464
    v_fma_f32 v232, v160, s21, v239
    s_waitcnt lgkmcnt(6)
    v_mfma_f32_32x32x16_bf16 v[16:31], v[224:227], v[192:195], v[16:31]
    v_fma_f32 v233, v161, s21, v239
    v_exp_f32 v232, v232
    v_mfma_f32_32x32x16_bf16 a[16:31], v[224:227], v[196:199], a[16:31]
    ds_read_b64_tr_b16 v[224:225], v237 offset:33472
    ds_read_b64_tr_b16 v[226:227], v237 offset:37824
    v_fma_f32 v234, v162, s21, v239
    v_exp_f32 v233, v233
    s_waitcnt lgkmcnt(6)
    v_mfma_f32_32x32x16_bf16 v[16:31], v[228:231], v[208:211], v[16:31]
    v_fma_f32 v235, v163, s21, v239
    v_exp_f32 v234, v234
    v_add_f32 v243, v232, v233
    v_cvt_pk_bf16_f32 v200, v232, v233
    v_mfma_f32_32x32x16_bf16 a[16:31], v[228:231], v[212:215], a[16:31]
    ds_read_b64_tr_b16 v[228:229], v237 offset:42176
    ds_read_b64_tr_b16 v[230:231], v237 offset:46528
    s_waitcnt lgkmcnt(6)
    v_mfma_f32_32x32x16_bf16 v[32:47], v[216:219], v[192:195], v[32:47]
    v_fma_f32 v232, v164, s21, v239
    v_exp_f32 v235, v235
    v_add_f32 v243, v243, v234
    v_mfma_f32_32x32x16_bf16 a[32:47], v[216:219], v[196:199], a[32:47]
    ds_read_b64_tr_b16 v[216:217], v237 offset:33536
    ds_read_b64_tr_b16 v[218:219], v237 offset:37888
    s_waitcnt lgkmcnt(6)
    v_mfma_f32_32x32x16_bf16 v[32:47], v[220:223], v[208:211], v[32:47]
    v_fma_f32 v233, v165, s21, v239
    v_exp_f32 v232, v232
    v_add_f32 v243, v243, v235
    v_cvt_pk_bf16_f32 v201, v234, v235
    v_mfma_f32_32x32x16_bf16 a[32:47], v[220:223], v[212:215], a[32:47]
    ds_read_b64_tr_b16 v[220:221], v237 offset:42240
    ds_read_b64_tr_b16 v[222:223], v237 offset:46592
    s_waitcnt lgkmcnt(6)
    v_mfma_f32_32x32x16_bf16 v[48:63], v[224:227], v[192:195], v[48:63]
    v_fma_f32 v234, v166, s21, v239
    v_exp_f32 v233, v233
    v_add_f32 v243, v243, v232
    v_mfma_f32_32x32x16_bf16 a[48:63], v[224:227], v[196:199], a[48:63]
    ds_read_b64_tr_b16 v[224:225], v237 offset:33600
    ds_read_b64_tr_b16 v[226:227], v237 offset:37952
    s_waitcnt lgkmcnt(6)
    v_mfma_f32_32x32x16_bf16 v[48:63], v[228:231], v[208:211], v[48:63]
    v_fma_f32 v235, v167, s21, v239
    v_exp_f32 v234, v234
    v_add_f32 v243, v243, v233
    v_cvt_pk_bf16_f32 v202, v232, v233
    v_mfma_f32_32x32x16_bf16 a[48:63], v[228:231], v[212:215], a[48:63]
    ds_read_b64_tr_b16 v[228:229], v237 offset:42304
    ds_read_b64_tr_b16 v[230:231], v237 offset:46656
    s_waitcnt lgkmcnt(6)
    v_mfma_f32_32x32x16_bf16 v[64:79], v[216:219], v[192:195], v[64:79]
    v_fma_f32 v232, v176, s21, v240
    v_exp_f32 v235, v235
    v_add_f32 v243, v243, v234
    v_mfma_f32_32x32x16_bf16 a[64:79], v[216:219], v[196:199], a[64:79]
    ds_read_b64_tr_b16 v[216:217], v237 offset:33664
    ds_read_b64_tr_b16 v[218:219], v237 offset:38016
    s_waitcnt lgkmcnt(6)
    v_mfma_f32_32x32x16_bf16 v[64:79], v[220:223], v[208:211], v[64:79]
    v_fma_f32 v233, v177, s21, v240
    v_exp_f32 v232, v232
    v_add_f32 v243, v243, v235
    v_cvt_pk_bf16_f32 v203, v234, v235
    v_mfma_f32_32x32x16_bf16 a[64:79], v[220:223], v[212:215], a[64:79]
    ds_read_b64_tr_b16 v[220:221], v237 offset:42368
    ds_read_b64_tr_b16 v[222:223], v237 offset:46720
    v_fma_f32 v234, v178, s21, v240
    v_exp_f32 v233, v233
    s_waitcnt lgkmcnt(6)
    v_mfma_f32_32x32x16_bf16 v[80:95], v[224:227], v[192:195], v[80:95]
    v_fma_f32 v235, v179, s21, v240
    v_exp_f32 v234, v234
    v_add_f32 v244, v232, v233
    v_cvt_pk_bf16_f32 v204, v232, v233
    v_mfma_f32_32x32x16_bf16 a[80:95], v[224:227], v[196:199], a[80:95]
    ds_read_b64_tr_b16 v[224:225], v237 offset:33728
    ds_read_b64_tr_b16 v[226:227], v237 offset:38080
    s_waitcnt lgkmcnt(6)
    v_mfma_f32_32x32x16_bf16 v[80:95], v[228:231], v[208:211], v[80:95]
    v_fma_f32 v232, v180, s21, v240
    v_exp_f32 v235, v235
    v_add_f32 v244, v244, v234
    v_mfma_f32_32x32x16_bf16 a[80:95], v[228:231], v[212:215], a[80:95]
    ds_read_b64_tr_b16 v[228:229], v237 offset:42432
    ds_read_b64_tr_b16 v[230:231], v237 offset:46784
    s_waitcnt lgkmcnt(6)
    v_mfma_f32_32x32x16_bf16 v[96:111], v[216:219], v[192:195], v[96:111]
    v_fma_f32 v233, v181, s21, v240
    v_exp_f32 v232, v232
    v_add_f32 v244, v244, v235
    v_cvt_pk_bf16_f32 v205, v234, v235
    v_mfma_f32_32x32x16_bf16 a[96:111], v[216:219], v[196:199], a[96:111]
    v_fma_f32 v234, v182, s21, v240
    v_exp_f32 v233, v233
    v_add_f32 v244, v244, v232
    s_waitcnt lgkmcnt(4)
    v_mfma_f32_32x32x16_bf16 v[96:111], v[220:223], v[208:211], v[96:111]
    v_fma_f32 v235, v183, s21, v240
    v_exp_f32 v234, v234
    v_add_f32 v244, v244, v233
    v_cvt_pk_bf16_f32 v206, v232, v233
    v_mfma_f32_32x32x16_bf16 a[96:111], v[220:223], v[212:215], a[96:111]
    s_waitcnt lgkmcnt(0)
    s_barrier
    ds_read_b128 v[216:219], v236
    ds_read_b128 v[220:223], v236 offset:32
    v_mfma_f32_32x32x16_bf16 v[112:127], v[224:227], v[192:195], v[112:127]
    v_fma_f32 v232, v168, s21, v239
    v_exp_f32 v235, v235
    v_add_f32 v244, v244, v234
    v_mfma_f32_32x32x16_bf16 a[112:127], v[224:227], v[196:199], a[112:127]
    ds_read_b128 v[224:227], v236 offset:64
    v_mfma_f32_32x32x16_bf16 v[112:127], v[228:231], v[208:211], v[112:127]
    v_fma_f32 v233, v169, s21, v239
    v_exp_f32 v232, v232
    v_add_f32 v244, v244, v235
    v_cvt_pk_bf16_f32 v207, v234, v235
    v_mfma_f32_32x32x16_bf16 a[112:127], v[228:231], v[212:215], a[112:127]
    ds_read_b128 v[228:231], v236 offset:96
    v_fma_f32 v234, v170, s21, v239
    v_exp_f32 v233, v233
    v_add_f32 v243, v243, v232
    s_cmp_eq_u32 s59, 3
    s_cbranch_scc1 L_f15B
    s_waitcnt lgkmcnt(3)
    v_mfma_f32_32x32x16_bf16 v[128:143], v[216:219], a[128:131], 0
    v_fma_f32 v235, v171, s21, v239
    v_exp_f32 v234, v234
    v_add_f32 v243, v243, v233
    v_cvt_pk_bf16_f32 v208, v232, v233
    v_mfma_f32_32x32x16_bf16 v[144:159], v[216:219], a[192:195], 0
    ds_read_b128 v[216:219], v236 offset:128
    v_fma_f32 v232, v172, s21, v239
    v_exp_f32 v235, v235
    v_add_f32 v243, v243, v234
    s_waitcnt lgkmcnt(3)
    v_mfma_f32_32x32x16_bf16 v[128:143], v[220:223], a[132:135], v[128:143]
    v_fma_f32 v233, v173, s21, v239
    v_exp_f32 v232, v232
    v_add_f32 v243, v243, v235
    v_cvt_pk_bf16_f32 v209, v234, v235
    v_mfma_f32_32x32x16_bf16 v[144:159], v[220:223], a[196:199], v[144:159]
    ds_read_b128 v[220:223], v236 offset:160
    v_fma_f32 v234, v174, s21, v239
    v_exp_f32 v233, v233
    v_add_f32 v243, v243, v232
    s_waitcnt lgkmcnt(3)
    v_mfma_f32_32x32x16_bf16 v[128:143], v[224:227], a[136:139], v[128:143]
    v_fma_f32 v235, v175, s21, v239
    v_exp_f32 v234, v234
    v_add_f32 v243, v243, v233
    v_cvt_pk_bf16_f32 v210, v232, v233
    v_mfma_f32_32x32x16_bf16 v[144:159], v[224:227], a[200:203], v[144:159]
    ds_read_b128 v[224:227], v236 offset:192
    v_fma_f32 v232, v184, s21, v240
    v_exp_f32 v235, v235
    v_add_f32 v243, v243, v234
    s_waitcnt lgkmcnt(3)
    v_mfma_f32_32x32x16_bf16 v[128:143], v[228:231], a[140:143], v[128:143]
    v_fma_f32 v233, v185, s21, v240
    v_exp_f32 v232, v232
    v_add_f32 v243, v243, v235
    v_cvt_pk_bf16_f32 v211, v234, v235
    v_mfma_f32_32x32x16_bf16 v[144:159], v[228:231], a[204:207], v[144:159]
    ds_read_b128 v[228:231], v236 offset:224
    v_fma_f32 v234, v186, s21, v240
    v_exp_f32 v233, v233
    v_add_f32 v244, v244, v232
    s_waitcnt lgkmcnt(3)
    v_mfma_f32_32x32x16_bf16 v[128:143], v[216:219], a[144:147], v[128:143]
    v_fma_f32 v235, v187, s21, v240
    v_exp_f32 v234, v234
    v_add_f32 v244, v244, v233
    v_cvt_pk_bf16_f32 v212, v232, v233
    v_mfma_f32_32x32x16_bf16 v[144:159], v[216:219], a[208:211], v[144:159]
    ds_read_b128 v[216:219], v236 offset:256
    v_fma_f32 v232, v188, s21, v240
    v_exp_f32 v235, v235
    v_add_f32 v244, v244, v234
    s_waitcnt lgkmcnt(3)
    v_mfma_f32_32x32x16_bf16 v[128:143], v[220:223], a[148:151], v[128:143]
    s_waitcnt vmcnt(5)
    ds_read_b128 a[224:227], v250
    ds_read_b128 a[228:231], v250 offset:32
    ds_read_b128 a[232:235], v250 offset:64
    ds_read_b128 a[236:239], v250 offset:96
    v_mfma_f32_32x32x16_bf16 v[144:159], v[220:223], a[212:215], v[144:159]
    ds_read_b128 v[220:223], v236 offset:288
    s_waitcnt lgkmcnt(7)
    v_mfma_f32_32x32x16_bf16 v[128:143], v[224:227], a[152:155], v[128:143]
    v_fma_f32 v233, v189, s21, v240
    v_exp_f32 v232, v232
    v_add_f32 v244, v244, v235
    v_cvt_pk_bf16_f32 v213, v234, v235
    v_mfma_f32_32x32x16_bf16 v[144:159], v[224:227], a[216:219], v[144:159]
    ds_read_b128 v[224:227], v236 offset:320
    v_fma_f32 v234, v190, s21, v240
    v_exp_f32 v233, v233
    v_add_f32 v244, v244, v232
    s_waitcnt lgkmcnt(7)
    v_mfma_f32_32x32x16_bf16 v[128:143], v[228:231], a[156:159], v[128:143]
    v_fma_f32 v235, v191, s21, v240
    v_exp_f32 v234, v234
    v_add_f32 v244, v244, v233
    v_cvt_pk_bf16_f32 v214, v232, v233
    v_mfma_f32_32x32x16_bf16 v[144:159], v[228:231], a[220:223], v[144:159]
    ds_read_b128 v[228:231], v236 offset:352
    v_exp_f32 v235, v235
    v_add_f32 v244, v244, v234
    s_waitcnt lgkmcnt(7)
    v_mfma_f32_32x32x16_bf16 v[128:143], v[216:219], a[160:163], v[128:143]
    s_waitcnt vmcnt(4)
    ds_read_b128 a[176:179], v250 offset:4656
    ds_read_b128 a[180:183], v250 offset:4688
    ds_read_b128 a[184:187], v250 offset:4720
    ds_read_b128 a[188:191], v250 offset:4752
    s_waitcnt lgkmcnt(10)
    v_mfma_f32_32x32x16_bf16 v[144:159], v[216:219], a[224:227], v[144:159]
    ds_read_b128 v[216:219], v236 offset:384
    v_add_f32 v244, v244, v235
    v_cvt_pk_bf16_f32 v215, v234, v235
    s_waitcnt lgkmcnt(7)
    v_mfma_f32_32x32x16_bf16 v[128:143], v[220:223], a[164:167], v[128:143]
    s_waitcnt vmcnt(0)
    ds_read_b128 a[240:243], v250 offset:9312
    ds_read_b128 a[244:247], v250 offset:9344
    ds_read_b128 a[248:251], v250 offset:9376
    ds_read_b128 a[252:255], v250 offset:9408
    v_mfma_f32_32x32x16_bf16 v[144:159], v[220:223], a[228:231], v[144:159]
    ds_read_b128 v[220:223], v236 offset:416
    s_waitcnt lgkmcnt(11)
    v_mfma_f32_32x32x16_bf16 v[128:143], v[224:227], a[168:171], v[128:143]
    v_mfma_f32_32x32x16_bf16 v[144:159], v[224:227], a[232:235], v[144:159]
    ds_read_b128 v[224:227], v236 offset:448
    s_waitcnt lgkmcnt(11)
    v_mfma_f32_32x32x16_bf16 v[128:143], v[228:231], a[172:175], v[128:143]
    v_mfma_f32_32x32x16_bf16 v[144:159], v[228:231], a[236:239], v[144:159]
    ds_read_b128 v[228:231], v236 offset:480
    s_waitcnt lgkmcnt(7)
    v_mfma_f32_32x32x16_bf16 v[128:143], v[216:219], a[176:179], v[128:143]
    s_waitcnt lgkmcnt(6)
    v_mfma_f32_32x32x16_bf16 v[144:159], v[216:219], a[240:243], v[144:159]
    s_waitcnt lgkmcnt(2)
    v_mfma_f32_32x32x16_bf16 v[128:143], v[220:223], a[180:183], v[128:143]
    v_mbcnt_lo_u32_b32 v253, -1, 0
    v_mbcnt_hi_u32_b32 v253, -1, v253
    v_and_b32 v247, 31, v253
    v_mul_u32_u24 v248, 0x90, v247
    v_mfma_f32_32x32x16_bf16 v[144:159], v[220:223], a[244:247], v[144:159]
    s_waitcnt lgkmcnt(0)
    s_barrier
    ds_read_b64_tr_b16 v[216:217], v237 offset:50688
    ds_read_b64_tr_b16 v[218:219], v237 offset:55040
    ds_read_b64_tr_b16 v[220:221], v237 offset:59392
    ds_read_b64_tr_b16 v[222:223], v237 offset:63744
    v_mfma_f32_32x32x16_bf16 v[128:143], v[224:227], a[184:187], v[128:143]
    v_lshrrev_b32 v247, 4, v247
    v_lshl_add_u32 v248, v247, 6, v248
    v_lshrrev_b32 v253, 5, v253
    v_lshl_add_u32 v253, v253, 4, v248
    v_add_u32 v253, s58, v253
    v_mfma_f32_32x32x16_bf16 v[144:159], v[224:227], a[248:251], v[144:159]
    ds_read_b64_tr_b16 v[224:225], v237 offset:50752
    ds_read_b64_tr_b16 v[226:227], v237 offset:55104
    v_add_f32 v245, v243, v244
    v_mfma_f32_32x32x16_bf16 v[128:143], v[228:231], a[188:191], v[128:143]
    v_cmp_nge_f32 vcc, s22, v245
    s_cbranch_vccnz L_rares15B
L_backs15B:
    v_add_f32 v241, v241, v243
    v_add_f32 v242, v242, v244
    v_add_u32 v251, s76, v251
    v_mfma_f32_32x32x16_bf16 v[144:159], v[228:231], a[252:255], v[144:159]
    ds_read_b64_tr_b16 v[228:229], v237 offset:59456
    ds_read_b64_tr_b16 v[230:231], v237 offset:63808
    s_waitcnt lgkmcnt(6)
    v_mfma_f32_32x32x16_bf16 v[0:15], v[216:219], v[200:203], v[0:15]
    v_mov_b32 v245, v241
    v_mov_b32 v255, v242
    s_nop 1
    v_permlane32_swap_b32 v245, v241
    v_permlane32_swap_b32 v255, v242
    s_nop 0
    v_add_f32 v241, v241, v245
    v_add_f32 v242, v242, v255
    v_rcp_f32 v252, v241
    v_rcp_f32 v254, v242
    v_mfma_f32_32x32x16_bf16 a[0:15], v[216:219], v[204:207], a[0:15]
    ds_read_b64_tr_b16 v[216:217], v237 offset:50816
    ds_read_b64_tr_b16 v[218:219], v237 offset:55168
    s_waitcnt lgkmcnt(6)
    v_mfma_f32_32x32x16_bf16 v[0:15], v[220:223], v[208:211], v[0:15]
    v_max3_f32 v247, v128, v129, v130
    v_max3_f32 v248, v144, v145, v146
    v_max3_f32 v247, v247, v131, v132
    v_max3_f32 v248, v248, v147, v148
    v_mfma_f32_32x32x16_bf16 a[0:15], v[220:223], v[212:215], a[0:15]
    ds_read_b64_tr_b16 v[220:221], v237 offset:59520
    ds_read_b64_tr_b16 v[222:223], v237 offset:63872
    v_max3_f32 v247, v247, v133, v134
    v_max3_f32 v248, v248, v149, v150
    s_waitcnt lgkmcnt(6)
    v_mfma_f32_32x32x16_bf16 v[16:31], v[224:227], v[200:203], v[16:31]
    v_max3_f32 v247, v247, v135, v136
    v_max3_f32 v248, v248, v151, v152
    v_max3_f32 v247, v247, v137, v138
    v_max3_f32 v248, v248, v153, v154
    v_mfma_f32_32x32x16_bf16 a[16:31], v[224:227], v[204:207], a[16:31]
    ds_read_b64_tr_b16 v[224:225], v237 offset:50880
    ds_read_b64_tr_b16 v[226:227], v237 offset:55232
    v_max3_f32 v247, v247, v139, v140
    v_max3_f32 v248, v248, v155, v156
    s_waitcnt lgkmcnt(6)
    v_mfma_f32_32x32x16_bf16 v[16:31], v[228:231], v[208:211], v[16:31]
    v_max3_f32 v247, v247, v141, v142
    v_max3_f32 v248, v248, v157, v158
    v_max_f32 v247, v247, v143
    v_max_f32 v248, v248, v159
    v_pk_mul_f32 v[0:1], v[0:1], v[252:253] op_sel_hi:[1,0]
    v_pk_mul_f32 v[2:3], v[2:3], v[252:253] op_sel_hi:[1,0]
    v_pk_mul_f32 v[4:5], v[4:5], v[252:253] op_sel_hi:[1,0]
    v_pk_mul_f32 v[6:7], v[6:7], v[252:253] op_sel_hi:[1,0]
    v_mfma_f32_32x32x16_bf16 a[16:31], v[228:231], v[212:215], a[16:31]
    ds_read_b64_tr_b16 v[228:229], v237 offset:59584
    ds_read_b64_tr_b16 v[230:231], v237 offset:63936
    v_cvt_pk_bf16_f32 v0, v0, v1
    v_cvt_pk_bf16_f32 v1, v2, v3
    v_cvt_pk_bf16_f32 v2, v4, v5
    v_cvt_pk_bf16_f32 v3, v6, v7
    ds_write_b128 v253, v[0:3] offset:9312
    v_pk_mul_f32 v[8:9], v[8:9], v[252:253] op_sel_hi:[1,0]
    v_pk_mul_f32 v[10:11], v[10:11], v[252:253] op_sel_hi:[1,0]
    v_pk_mul_f32 v[12:13], v[12:13], v[252:253] op_sel_hi:[1,0]
    v_pk_mul_f32 v[14:15], v[14:15], v[252:253] op_sel_hi:[1,0]
    s_waitcnt lgkmcnt(7)
    v_mfma_f32_32x32x16_bf16 v[32:47], v[216:219], v[200:203], v[32:47]
    v_mov_b32 v245, v247
    v_mov_b32 v255, v248
    s_nop 1
    v_permlane32_swap_b32 v245, v247
    v_permlane32_swap_b32 v255, v248
    s_nop 0
    v_max_f32 v247, v247, v245
    v_max_f32 v248, v248, v255
    v_mul_f32 v239, s30, v247
    v_mul_f32 v240, s30, v248
    v_min_f32 v240, s84, v240
    v_mfma_f32_32x32x16_bf16 a[32:47], v[216:219], v[204:207], a[32:47]
    ds_read_b64_tr_b16 v[216:217], v237 offset:50944
    ds_read_b64_tr_b16 v[218:219], v237 offset:55296
    v_fma_f32 v232, v128, s21, v239
    v_cvt_pk_bf16_f32 v8, v8, v9
    v_cvt_pk_bf16_f32 v9, v10, v11
    v_cvt_pk_bf16_f32 v10, v12, v13
    v_cvt_pk_bf16_f32 v11, v14, v15
    ds_write_b128 v253, v[8:11] offset:9344
    s_waitcnt lgkmcnt(8)
    v_mfma_f32_32x32x16_bf16 v[32:47], v[220:223], v[208:211], v[32:47]
    v_fma_f32 v233, v129, s21, v239
    v_exp_f32 v232, v232
    v_pk_mul_f32 v[16:17], v[16:17], v[252:253] op_sel_hi:[1,0]
    v_pk_mul_f32 v[18:19], v[18:19], v[252:253] op_sel_hi:[1,0]
    v_pk_mul_f32 v[20:21], v[20:21], v[252:253] op_sel_hi:[1,0]
    v_pk_mul_f32 v[22:23], v[22:23], v[252:253] op_sel_hi:[1,0]
    v_mfma_f32_32x32x16_bf16 a[32:47], v[220:223], v[212:215], a[32:47]
    ds_read_b64_tr_b16 v[220:221], v237 offset:59648
    ds_read_b64_tr_b16 v[222:223], v237 offset:64000
    v_cvt_pk_bf16_f32 v16, v16, v17
    v_cvt_pk_bf16_f32 v17, v18, v19
    v_cvt_pk_bf16_f32 v18, v20, v21
    v_cvt_pk_bf16_f32 v19, v22, v23
    ds_write_b128 v253, v[16:19] offset:9376
    v_pk_mul_f32 v[24:25], v[24:25], v[252:253] op_sel_hi:[1,0]
    v_pk_mul_f32 v[26:27], v[26:27], v[252:253] op_sel_hi:[1,0]
    v_pk_mul_f32 v[28:29], v[28:29], v[252:253] op_sel_hi:[1,0]
    v_pk_mul_f32 v[30:31], v[30:31], v[252:253] op_sel_hi:[1,0]
    s_waitcnt lgkmcnt(9)
    v_mfma_f32_32x32x16_bf16 v[48:63], v[224:227], v[200:203], v[48:63]
    v_fma_f32 v234, v130, s21, v239
    v_exp_f32 v233, v233
    v_cvt_pk_bf16_f32 v24, v24, v25
    v_cvt_pk_bf16_f32 v25, v26, v27
    v_cvt_pk_bf16_f32 v26, v28, v29
    v_cvt_pk_bf16_f32 v27, v30, v31
    ds_write_b128 v253, v[24:27] offset:9408
    v_mfma_f32_32x32x16_bf16 a[48:63], v[224:227], v[204:207], a[48:63]
    ds_read_b64_tr_b16 v[224:225], v237 offset:51008
    ds_read_b64_tr_b16 v[226:227], v237 offset:55360
    ds_read_b128 v[0:3], v251 offset:9312
    ds_read_b128 v[8:11], v251 offset:9600
    ds_read_b128 v[16:19], v251 offset:11680
    s_waitcnt lgkmcnt(8)
    ds_read_b128 v[24:27], v251 offset:11968
    v_accvgpr_read_b32 v4, a0
    v_accvgpr_read_b32 v5, a1
    v_accvgpr_read_b32 v6, a2
    v_accvgpr_read_b32 v7, a3
    v_mfma_f32_32x32x16_bf16 v[48:63], v[228:231], v[208:211], v[48:63]
    v_fma_f32 v235, v131, s21, v239
    v_exp_f32 v234, v234
    v_add_f32 v243, v232, v233
    v_cvt_pk_bf16_f32 v192, v232, v233
    v_accvgpr_read_b32 v12, a4
    v_accvgpr_read_b32 v13, a5
    v_accvgpr_read_b32 v14, a6
    v_accvgpr_read_b32 v15, a7
    v_mfma_f32_32x32x16_bf16 a[48:63], v[228:231], v[212:215], a[48:63]
    ds_read_b64_tr_b16 v[228:229], v237 offset:59712
    ds_read_b64_tr_b16 v[230:231], v237 offset:64064
    v_pk_mul_f32 v[4:5], v[4:5], v[254:255] op_sel_hi:[1,0]
    v_pk_mul_f32 v[6:7], v[6:7], v[254:255] op_sel_hi:[1,0]
    v_pk_mul_f32 v[12:13], v[12:13], v[254:255] op_sel_hi:[1,0]
    v_pk_mul_f32 v[14:15], v[14:15], v[254:255] op_sel_hi:[1,0]
    v_cvt_pk_bf16_f32 v4, v4, v5
    v_cvt_pk_bf16_f32 v5, v6, v7
    v_cvt_pk_bf16_f32 v6, v12, v13
    v_cvt_pk_bf16_f32 v7, v14, v15
    ds_write_b128 v253, v[4:7] offset:13968
    v_mfma_f32_32x32x16_bf16 v[64:79], v[216:219], v[200:203], v[64:79]
    v_fma_f32 v232, v132, s21, v239
    v_exp_f32 v235, v235
    v_add_f32 v243, v243, v234
    s_add_u32 s47, s71, 0
    s_waitcnt lgkmcnt(6)
    buffer_store_dwordx4 v[0:3], v246, s[16:19], s47 offen nt
    s_add_u32 s47, s71, 1024
    s_waitcnt lgkmcnt(5)
    buffer_store_dwordx4 v[8:11], v246, s[16:19], s47 offen nt
    v_mfma_f32_32x32x16_bf16 a[64:79], v[216:219], v[204:207], a[64:79]
    ds_read_b64_tr_b16 v[216:217], v237 offset:51072
    ds_read_b64_tr_b16 v[218:219], v237 offset:55424
    v_accvgpr_read_b32 v20, a8
    v_accvgpr_read_b32 v21, a9
    v_accvgpr_read_b32 v22, a10
    v_accvgpr_read_b32 v23, a11
    v_accvgpr_read_b32 v28, a12
    v_accvgpr_read_b32 v29, a13
    v_accvgpr_read_b32 v30, a14
    v_accvgpr_read_b32 v31, a15
    v_mfma_f32_32x32x16_bf16 v[64:79], v[220:223], v[208:211], v[64:79]
    v_fma_f32 v233, v133, s21, v239
    v_exp_f32 v232, v232
    v_add_f32 v243, v243, v235
    v_cvt_pk_bf16_f32 v193, v234, v235
    v_pk_mul_f32 v[20:21], v[20:21], v[254:255] op_sel_hi:[1,0]
    v_pk_mul_f32 v[22:23], v[22:23], v[254:255] op_sel_hi:[1,0]
    v_pk_mul_f32 v[28:29], v[28:29], v[254:255] op_sel_hi:[1,0]
    v_pk_mul_f32 v[30:31], v[30:31], v[254:255] op_sel_hi:[1,0]
    v_mfma_f32_32x32x16_bf16 a[64:79], v[220:223], v[212:215], a[64:79]
    ds_read_b64_tr_b16 v[220:221], v237 offset:59776
    ds_read_b64_tr_b16 v[222:223], v237 offset:64128
    v_cvt_pk_bf16_f32 v20, v20, v21
    v_cvt_pk_bf16_f32 v21, v22, v23
    v_cvt_pk_bf16_f32 v22, v28, v29
    v_cvt_pk_bf16_f32 v23, v30, v31
    ds_write_b128 v253, v[20:23] offset:14000
    s_add_u32 s47, s71, 8192
    s_waitcnt lgkmcnt(9)
    buffer_store_dwordx4 v[16:19], v246, s[16:19], s47 offen nt
    v_mfma_f32_32x32x16_bf16 v[80:95], v[224:227], v[200:203], v[80:95]
    v_fma_f32 v234, v134, s21, v239
    v_exp_f32 v233, v233
    v_add_f32 v243, v243, v232
    s_add_u32 s47, s71, 9216
    s_waitcnt lgkmcnt(8)
    buffer_store_dwordx4 v[24:27], v246, s[16:19], s47 offen nt
    v_accvgpr_read_b32 v4, a16
    v_accvgpr_read_b32 v5, a17
    v_accvgpr_read_b32 v6, a18
    v_accvgpr_read_b32 v7, a19
    v_mfma_f32_32x32x16_bf16 a[80:95], v[224:227], v[204:207], a[80:95]
    ds_read_b64_tr_b16 v[224:225], v237 offset:51136
    ds_read_b64_tr_b16 v[226:227], v237 offset:55488
    v_accvgpr_read_b32 v12, a20
    v_accvgpr_read_b32 v13, a21
    v_accvgpr_read_b32 v14, a22
    v_accvgpr_read_b32 v15, a23
    v_pk_mul_f32 v[4:5], v[4:5], v[254:255] op_sel_hi:[1,0]
    v_pk_mul_f32 v[6:7], v[6:7], v[254:255] op_sel_hi:[1,0]
    v_pk_mul_f32 v[12:13], v[12:13], v[254:255] op_sel_hi:[1,0]
    v_pk_mul_f32 v[14:15], v[14:15], v[254:255] op_sel_hi:[1,0]
    s_waitcnt lgkmcnt(8)
    v_mfma_f32_32x32x16_bf16 v[80:95], v[228:231], v[208:211], v[80:95]
    v_fma_f32 v235, v135, s21, v239
    v_exp_f32 v234, v234
    v_add_f32 v243, v243, v233
    v_cvt_pk_bf16_f32 v194, v232, v233
    v_cvt_pk_bf16_f32 v4, v4, v5
    v_cvt_pk_bf16_f32 v5, v6, v7
    v_cvt_pk_bf16_f32 v6, v12, v13
    v_cvt_pk_bf16_f32 v7, v14, v15
    ds_write_b128 v253, v[4:7] offset:14032
    v_mfma_f32_32x32x16_bf16 a[80:95], v[228:231], v[212:215], a[80:95]
    ds_read_b64_tr_b16 v[228:229], v237 offset:59840
    ds_read_b64_tr_b16 v[230:231], v237 offset:64192
    v_accvgpr_read_b32 v20, a24
    v_accvgpr_read_b32 v21, a25
    v_accvgpr_read_b32 v22, a26
    v_accvgpr_read_b32 v23, a27
    v_accvgpr_read_b32 v28, a28
    v_accvgpr_read_b32 v29, a29
    v_accvgpr_read_b32 v30, a30
    v_accvgpr_read_b32 v31, a31
    s_waitcnt lgkmcnt(8)
    v_mfma_f32_32x32x16_bf16 v[96:111], v[216:219], v[200:203], v[96:111]
    v_fma_f32 v232, v144, s21, v240
    v_exp_f32 v235, v235
    v_add_f32 v243, v243, v234
    v_pk_mul_f32 v[20:21], v[20:21], v[254:255] op_sel_hi:[1,0]
    v_pk_mul_f32 v[22:23], v[22:23], v[254:255] op_sel_hi:[1,0]
    v_pk_mul_f32 v[28:29], v[28:29], v[254:255] op_sel_hi:[1,0]
    v_pk_mul_f32 v[30:31], v[30:31], v[254:255] op_sel_hi:[1,0]
    v_mfma_f32_32x32x16_bf16 a[96:111], v[216:219], v[204:207], a[96:111]
    v_fma_f32 v233, v145, s21, v240
    v_exp_f32 v232, v232
    v_add_f32 v243, v243, v235
    v_cvt_pk_bf16_f32 v195, v234, v235
    v_cvt_pk_bf16_f32 v20, v20, v21
    v_cvt_pk_bf16_f32 v21, v22, v23
    v_cvt_pk_bf16_f32 v22, v28, v29
    v_cvt_pk_bf16_f32 v23, v30, v31
    ds_write_b128 v253, v[20:23] offset:14064
    s_waitcnt lgkmcnt(7)
    v_mfma_f32_32x32x16_bf16 v[96:111], v[220:223], v[208:211], v[96:111]
    v_fma_f32 v234, v146, s21, v240
    v_exp_f32 v233, v233
    ds_read_b128 v[4:7], v251 offset:13968
    ds_read_b128 v[12:15], v251 offset:14256
    ds_read_b128 v[20:23], v251 offset:16336
    ds_read_b128 v[28:31], v251 offset:16624
    v_pk_mul_f32 v[32:33], v[32:33], v[252:253] op_sel_hi:[1,0]
    v_pk_mul_f32 v[34:35], v[34:35], v[252:253] op_sel_hi:[1,0]
    v_pk_mul_f32 v[36:37], v[36:37], v[252:253] op_sel_hi:[1,0]
    v_pk_mul_f32 v[38:39], v[38:39], v[252:253] op_sel_hi:[1,0]
    v_mfma_f32_32x32x16_bf16 a[96:111], v[220:223], v[212:215], a[96:111]
    s_waitcnt lgkmcnt(0)
    s_barrier
    ds_read_b128 v[216:219], v236 offset:16640
    ds_read_b128 v[220:223], v236 offset:16672
    v_cvt_pk_bf16_f32 v32, v32, v33
    v_cvt_pk_bf16_f32 v33, v34, v35
    v_cvt_pk_bf16_f32 v34, v36, v37
    v_cvt_pk_bf16_f32 v35, v38, v39
    ds_write_b128 v253, v[32:35] offset:18624
    v_mfma_f32_32x32x16_bf16 v[112:127], v[224:227], v[200:203], v[112:127]
    v_fma_f32 v235, v147, s21, v240
    v_exp_f32 v234, v234
    v_add_f32 v244, v232, v233
    v_cvt_pk_bf16_f32 v196, v232, v233
    s_add_u32 s47, s71, 16384
    buffer_store_dwordx4 v[4:7], v246, s[16:19], s47 offen nt
    v_pk_mul_f32 v[40:41], v[40:41], v[252:253] op_sel_hi:[1,0]
    v_pk_mul_f32 v[42:43], v[42:43], v[252:253] op_sel_hi:[1,0]
    v_pk_mul_f32 v[44:45], v[44:45], v[252:253] op_sel_hi:[1,0]
    v_pk_mul_f32 v[46:47], v[46:47], v[252:253] op_sel_hi:[1,0]
    v_mfma_f32_32x32x16_bf16 a[112:127], v[224:227], v[204:207], a[112:127]
    ds_read_b128 v[224:227], v236 offset:16704
    v_cvt_pk_bf16_f32 v40, v40, v41
    v_cvt_pk_bf16_f32 v41, v42, v43
    v_cvt_pk_bf16_f32 v42, v44, v45
    v_cvt_pk_bf16_f32 v43, v46, v47
    ds_write_b128 v253, v[40:43] offset:18656
    s_add_u32 s47, s71, 17408
    buffer_store_dwordx4 v[12:15], v246, s[16:19], s47 offen nt
    v_mfma_f32_32x32x16_bf16 v[112:127], v[228:231], v[208:211], v[112:127]
    v_pk_mul_f32 v[48:49], v[48:49], v[252:253] op_sel_hi:[1,0]
    v_pk_mul_f32 v[50:51], v[50:51], v[252:253] op_sel_hi:[1,0]
    v_pk_mul_f32 v[52:53], v[52:53], v[252:253] op_sel_hi:[1,0]
    v_pk_mul_f32 v[54:55], v[54:55], v[252:253] op_sel_hi:[1,0]
    v_cvt_pk_bf16_f32 v48, v48, v49
    v_cvt_pk_bf16_f32 v49, v50, v51
    v_cvt_pk_bf16_f32 v50, v52, v53
    v_cvt_pk_bf16_f32 v51, v54, v55
    ds_write_b128 v253, v[48:51] offset:18688
    v_mfma_f32_32x32x16_bf16 a[112:127], v[228:231], v[212:215], a[112:127]
    ds_read_b128 v[228:231], v236 offset:16736
    s_add_u32 s47, s71, 24576
    buffer_store_dwordx4 v[20:23], v246, s[16:19], s47 offen nt
    v_pk_mul_f32 v[56:57], v[56:57], v[252:253] op_sel_hi:[1,0]
    v_pk_mul_f32 v[58:59], v[58:59], v[252:253] op_sel_hi:[1,0]
    v_pk_mul_f32 v[60:61], v[60:61], v[252:253] op_sel_hi:[1,0]
    v_pk_mul_f32 v[62:63], v[62:63], v[252:253] op_sel_hi:[1,0]
L_it0B:
    s_waitcnt lgkmcnt(6)
    v_mfma_f32_32x32x16_bf16 v[160:175], v[216:219], a[128:131], 0
    v_fma_f32 v232, v148, s21, v240
    v_exp_f32 v235, v235
    v_add_f32 v244, v244, v234
    v_cvt_pk_bf16_f32 v56, v56, v57
    v_cvt_pk_bf16_f32 v57, v58, v59
    v_cvt_pk_bf16_f32 v58, v60, v61
    v_cvt_pk_bf16_f32 v59, v62, v63
    ds_write_b128 v253, v[56:59] offset:18720
    v_mfma_f32_32x32x16_bf16 v[176:191], v[216:219], a[192:195], 0
    ds_read_b128 v[216:219], v236 offset:16768
    s_add_u32 s47, s71, 25600
    buffer_store_dwordx4 v[28:31], v246, s[16:19], s47 offen nt
    ds_read_b128 v[32:35], v251 offset:18624
    ds_read_b128 v[40:43], v251 offset:18912
    ds_read_b128 v[48:51], v251 offset:20992
    ds_read_b128 v[56:59], v251 offset:21280
    v_accvgpr_read_b32 v36, a32
    v_accvgpr_read_b32 v37, a33
    v_accvgpr_read_b32 v38, a34
    v_accvgpr_read_b32 v39, a35
    s_waitcnt lgkmcnt(11)
    v_mfma_f32_32x32x16_bf16 v[160:175], v[220:223], a[132:135], v[160:175]
    v_fma_f32 v233, v149, s21, v240
    v_exp_f32 v232, v232
    v_add_f32 v244, v244, v235
    v_cvt_pk_bf16_f32 v197, v234, v235
    v_accvgpr_read_b32 v44, a36
    v_accvgpr_read_b32 v45, a37
    v_accvgpr_read_b32 v46, a38
    v_accvgpr_read_b32 v47, a39
    v_mfma_f32_32x32x16_bf16 v[176:191], v[220:223], a[196:199], v[176:191]
    ds_read_b128 v[220:223], v236 offset:16800
    v_fma_f32 v234, v150, s21, v240
    v_exp_f32 v233, v233
    v_add_f32 v244, v244, v232
    v_pk_mul_f32 v[36:37], v[36:37], v[254:255] op_sel_hi:[1,0]
    v_pk_mul_f32 v[38:39], v[38:39], v[254:255] op_sel_hi:[1,0]
    v_pk_mul_f32 v[44:45], v[44:45], v[254:255] op_sel_hi:[1,0]
    v_pk_mul_f32 v[46:47], v[46:47], v[254:255] op_sel_hi:[1,0]
    s_waitcnt lgkmcnt(10)
    v_mfma_f32_32x32x16_bf16 v[160:175], v[224:227], a[136:139], v[160:175]
    v_fma_f32 v235, v151, s21, v240
    v_exp_f32 v234, v234
    v_add_f32 v244, v244, v233
    v_cvt_pk_bf16_f32 v198, v232, v233
    v_cvt_pk_bf16_f32 v36, v36, v37
    v_cvt_pk_bf16_f32 v37, v38, v39
    v_cvt_pk_bf16_f32 v38, v44, v45
    v_cvt_pk_bf16_f32 v39, v46, v47
    ds_write_b128 v253, v[36:39]
    v_mfma_f32_32x32x16_bf16 v[176:191], v[224:227], a[200:203], v[176:191]
    ds_read_b128 v[224:227], v236 offset:16832
    v_fma_f32 v232, v136, s21, v239
    v_exp_f32 v235, v235
    v_add_f32 v244, v244, v234
    s_add_u32 s47, s71, 0
    s_waitcnt lgkmcnt(6)
    buffer_store_dwordx4 v[32:35], v246, s[16:19], s47 offen offset:128 nt
    s_add_u32 s47, s71, 1024
    s_waitcnt lgkmcnt(5)
    buffer_store_dwordx4 v[40:43], v246, s[16:19], s47 offen offset:128 nt
    v_mfma_f32_32x32x16_bf16 v[160:175], v[228:231], a[140:143], v[160:175]
    v_fma_f32 v233, v137, s21, v239
    v_exp_f32 v232, v232
    v_add_f32 v244, v244, v235
    v_cvt_pk_bf16_f32 v199, v234, v235
    v_accvgpr_read_b32 v52, a40
    v_accvgpr_read_b32 v53, a41
    v_accvgpr_read_b32 v54, a42
    v_accvgpr_read_b32 v55, a43
    v_mfma_f32_32x32x16_bf16 v[176:191], v[228:231], a[204:207], v[176:191]
    ds_read_b128 v[228:231], v236 offset:16864
    v_fma_f32 v234, v138, s21, v239
    v_exp_f32 v233, v233
    v_add_f32 v243, v243, v232
    v_accvgpr_read_b32 v60, a44
    v_accvgpr_read_b32 v61, a45
    v_accvgpr_read_b32 v62, a46
    v_accvgpr_read_b32 v63, a47
    v_mfma_f32_32x32x16_bf16 v[160:175], v[216:219], a[144:147], v[160:175]
    v_fma_f32 v235, v139, s21, v239
    v_exp_f32 v234, v234
    v_add_f32 v243, v243, v233
    v_cvt_pk_bf16_f32 v208, v232, v233
    v_pk_mul_f32 v[52:53], v[52:53], v[254:255] op_sel_hi:[1,0]
    v_pk_mul_f32 v[54:55], v[54:55], v[254:255] op_sel_hi:[1,0]
    v_pk_mul_f32 v[60:61], v[60:61], v[254:255] op_sel_hi:[1,0]
    v_pk_mul_f32 v[62:63], v[62:63], v[254:255] op_sel_hi:[1,0]
    v_mfma_f32_32x32x16_bf16 v[176:191], v[216:219], a[208:211], v[176:191]
    ds_read_b128 v[216:219], v236 offset:16896
    v_fma_f32 v232, v140, s21, v239
    v_exp_f32 v235, v235
    v_add_f32 v243, v243, v234
    v_cvt_pk_bf16_f32 v52, v52, v53
    v_cvt_pk_bf16_f32 v53, v54, v55
    v_cvt_pk_bf16_f32 v54, v60, v61
    v_cvt_pk_bf16_f32 v55, v62, v63
    ds_write_b128 v253, v[52:55] offset:32
    s_waitcnt lgkmcnt(5)
    v_mfma_f32_32x32x16_bf16 v[160:175], v[220:223], a[148:151], v[160:175]
    v_fma_f32 v233, v141, s21, v239
    v_exp_f32 v232, v232
    v_add_f32 v243, v243, v235
    v_cvt_pk_bf16_f32 v209, v234, v235
    s_add_u32 s47, s71, 8192
    buffer_store_dwordx4 v[48:51], v246, s[16:19], s47 offen offset:128 nt
    s_add_u32 s47, s71, 9216
    buffer_store_dwordx4 v[56:59], v246, s[16:19], s47 offen offset:128 nt
    v_mfma_f32_32x32x16_bf16 v[176:191], v[220:223], a[212:215], v[176:191]
    ds_read_b128 v[220:223], v236 offset:16928
    v_fma_f32 v234, v142, s21, v239
    v_exp_f32 v233, v233
    v_add_f32 v243, v243, v232
    v_accvgpr_read_b32 v36, a48
    v_accvgpr_read_b32 v37, a49
    v_accvgpr_read_b32 v38, a50
    v_accvgpr_read_b32 v39, a51
    s_waitcnt lgkmcnt(4)
    v_mfma_f32_32x32x16_bf16 v[160:175], v[224:227], a[152:155], v[160:175]
    v_fma_f32 v235, v143, s21, v239
    v_exp_f32 v234, v234
    v_add_f32 v243, v243, v233
    v_cvt_pk_bf16_f32 v210, v232, v233
    v_accvgpr_read_b32 v44, a52
    v_accvgpr_read_b32 v45, a53
    v_accvgpr_read_b32 v46, a54
    v_accvgpr_read_b32 v47, a55
    v_mfma_f32_32x32x16_bf16 v[176:191], v[224:227], a[216:219], v[176:191]
    ds_read_b128 v[224:227], v236 offset:16960
    v_fma_f32 v232, v152, s21, v240
    v_exp_f32 v235, v235
    v_add_f32 v243, v243, v234
    v_pk_mul_f32 v[36:37], v[36:37], v[254:255] op_sel_hi:[1,0]
    v_pk_mul_f32 v[38:39], v[38:39], v[254:255] op_sel_hi:[1,0]
    v_pk_mul_f32 v[44:45], v[44:45], v[254:255] op_sel_hi:[1,0]
    v_pk_mul_f32 v[46:47], v[46:47], v[254:255] op_sel_hi:[1,0]
    s_waitcnt lgkmcnt(4)
    v_mfma_f32_32x32x16_bf16 v[160:175], v[228:231], a[156:159], v[160:175]
    v_fma_f32 v233, v153, s21, v240
    v_exp_f32 v232, v232
    v_add_f32 v243, v243, v235
    v_cvt_pk_bf16_f32 v211, v234, v235
    v_cvt_pk_bf16_f32 v36, v36, v37
    v_cvt_pk_bf16_f32 v37, v38, v39
    v_cvt_pk_bf16_f32 v38, v44, v45
    v_cvt_pk_bf16_f32 v39, v46, v47
    ds_write_b128 v253, v[36:39] offset:64
    v_mfma_f32_32x32x16_bf16 v[176:191], v[228:231], a[220:223], v[176:191]
    ds_read_b128 v[228:231], v236 offset:16992
    v_fma_f32 v234, v154, s21, v240
    v_exp_f32 v233, v233
    v_add_f32 v244, v244, v232
    v_accvgpr_read_b32 v52, a56
    v_accvgpr_read_b32 v53, a57
    v_accvgpr_read_b32 v54, a58
    v_accvgpr_read_b32 v55, a59
    s_waitcnt lgkmcnt(5)
    v_mfma_f32_32x32x16_bf16 v[160:175], v[216:219], a[160:163], v[160:175]
    v_fma_f32 v235, v155, s21, v240
    v_exp_f32 v234, v234
    v_add_f32 v244, v244, v233
    v_cvt_pk_bf16_f32 v212, v232, v233
    v_accvgpr_read_b32 v60, a60
    v_accvgpr_read_b32 v61, a61
    v_accvgpr_read_b32 v62, a62
    v_accvgpr_read_b32 v63, a63
    v_mfma_f32_32x32x16_bf16 v[176:191], v[216:219], a[224:227], v[176:191]
    ds_read_b128 v[216:219], v236 offset:17024
    v_fma_f32 v232, v156, s21, v240
    v_exp_f32 v235, v235
    v_add_f32 v244, v244, v234
    v_pk_mul_f32 v[52:53], v[52:53], v[254:255] op_sel_hi:[1,0]
    v_pk_mul_f32 v[54:55], v[54:55], v[254:255] op_sel_hi:[1,0]
    v_pk_mul_f32 v[60:61], v[60:61], v[254:255] op_sel_hi:[1,0]
    v_pk_mul_f32 v[62:63], v[62:63], v[254:255] op_sel_hi:[1,0]
    s_waitcnt lgkmcnt(4)
    v_mfma_f32_32x32x16_bf16 v[160:175], v[220:223], a[164:167], v[160:175]
    v_fma_f32 v233, v157, s21, v240
    v_exp_f32 v232, v232
    v_add_f32 v244, v244, v235
    v_cvt_pk_bf16_f32 v213, v234, v235
    v_cvt_pk_bf16_f32 v52, v52, v53
    v_cvt_pk_bf16_f32 v53, v54, v55
    v_cvt_pk_bf16_f32 v54, v60, v61
    v_cvt_pk_bf16_f32 v55, v62, v63
    ds_write_b128 v253, v[52:55] offset:96
    v_mfma_f32_32x32x16_bf16 v[176:191], v[220:223], a[228:231], v[176:191]
    ds_read_b128 v[220:223], v236 offset:17056
    v_fma_f32 v234, v158, s21, v240
    v_exp_f32 v233, v233
    v_add_f32 v244, v244, v232
    v_pk_mul_f32 v[64:65], v[64:65], v[252:253] op_sel_hi:[1,0]
    v_pk_mul_f32 v[66:67], v[66:67], v[252:253] op_sel_hi:[1,0]
    v_pk_mul_f32 v[68:69], v[68:69], v[252:253] op_sel_hi:[1,0]
    v_pk_mul_f32 v[70:71], v[70:71], v[252:253] op_sel_hi:[1,0]
    s_waitcnt lgkmcnt(5)
    v_mfma_f32_32x32x16_bf16 v[160:175], v[224:227], a[168:171], v[160:175]
    v_fma_f32 v235, v159, s21, v240
    v_exp_f32 v234, v234
    v_add_f32 v244, v244, v233
    v_cvt_pk_bf16_f32 v214, v232, v233
    v_cvt_pk_bf16_f32 v64, v64, v65
    v_cvt_pk_bf16_f32 v65, v66, v67
    v_cvt_pk_bf16_f32 v66, v68, v69
    v_cvt_pk_bf16_f32 v67, v70, v71
    ds_write_b128 v253, v[64:67] offset:4656
    v_mfma_f32_32x32x16_bf16 v[176:191], v[224:227], a[232:235], v[176:191]
    ds_read_b128 v[224:227], v236 offset:17088
    v_exp_f32 v235, v235
    v_add_f32 v244, v244, v234
    v_pk_mul_f32 v[72:73], v[72:73], v[252:253] op_sel_hi:[1,0]
    v_pk_mul_f32 v[74:75], v[74:75], v[252:253] op_sel_hi:[1,0]
    v_pk_mul_f32 v[76:77], v[76:77], v[252:253] op_sel_hi:[1,0]
    v_pk_mul_f32 v[78:79], v[78:79], v[252:253] op_sel_hi:[1,0]
    s_waitcnt lgkmcnt(5)
    v_mfma_f32_32x32x16_bf16 v[160:175], v[228:231], a[172:175], v[160:175]
    v_add_f32 v244, v244, v235
    v_cvt_pk_bf16_f32 v215, v234, v235
    v_cvt_pk_bf16_f32 v72, v72, v73
    v_cvt_pk_bf16_f32 v73, v74, v75
    v_cvt_pk_bf16_f32 v74, v76, v77
    v_cvt_pk_bf16_f32 v75, v78, v79
    ds_write_b128 v253, v[72:75] offset:4688
    v_pk_mul_f32 v[80:81], v[80:81], v[252:253] op_sel_hi:[1,0]
    v_pk_mul_f32 v[82:83], v[82:83], v[252:253] op_sel_hi:[1,0]
    v_pk_mul_f32 v[84:85], v[84:85], v[252:253] op_sel_hi:[1,0]
    v_pk_mul_f32 v[86:87], v[86:87], v[252:253] op_sel_hi:[1,0]
    v_mfma_f32_32x32x16_bf16 v[176:191], v[228:231], a[236:239], v[176:191]
    ds_read_b128 v[228:231], v236 offset:17120
    v_cvt_pk_bf16_f32 v80, v80, v81
    v_cvt_pk_bf16_f32 v81, v82, v83
    v_cvt_pk_bf16_f32 v82, v84, v85
    v_cvt_pk_bf16_f32 v83, v86, v87
    ds_write_b128 v253, v[80:83] offset:4720
    v_pk_mul_f32 v[88:89], v[88:89], v[252:253] op_sel_hi:[1,0]
    v_pk_mul_f32 v[90:91], v[90:91], v[252:253] op_sel_hi:[1,0]
    v_pk_mul_f32 v[92:93], v[92:93], v[252:253] op_sel_hi:[1,0]
    v_pk_mul_f32 v[94:95], v[94:95], v[252:253] op_sel_hi:[1,0]
    s_waitcnt lgkmcnt(7)
    v_mfma_f32_32x32x16_bf16 v[160:175], v[216:219], a[176:179], v[160:175]
    v_cvt_pk_bf16_f32 v88, v88, v89
    v_cvt_pk_bf16_f32 v89, v90, v91
    v_cvt_pk_bf16_f32 v90, v92, v93
    v_cvt_pk_bf16_f32 v91, v94, v95
    ds_write_b128 v253, v[88:91] offset:4752
    v_accvgpr_read_b32 v68, a64
    v_accvgpr_read_b32 v69, a65
    v_accvgpr_read_b32 v70, a66
    v_accvgpr_read_b32 v71, a67
    v_mfma_f32_32x32x16_bf16 v[176:191], v[216:219], a[240:243], v[176:191]
    v_accvgpr_read_b32 v76, a68
    v_accvgpr_read_b32 v77, a69
    v_accvgpr_read_b32 v78, a70
    v_accvgpr_read_b32 v79, a71
    v_pk_mul_f32 v[68:69], v[68:69], v[254:255] op_sel_hi:[1,0]
    v_pk_mul_f32 v[70:71], v[70:71], v[254:255] op_sel_hi:[1,0]
    v_pk_mul_f32 v[76:77], v[76:77], v[254:255] op_sel_hi:[1,0]
    v_pk_mul_f32 v[78:79], v[78:79], v[254:255] op_sel_hi:[1,0]
    s_waitcnt lgkmcnt(6)
    v_mfma_f32_32x32x16_bf16 v[160:175], v[220:223], a[180:183], v[160:175]
    v_cvt_pk_bf16_f32 v68, v68, v69
    v_cvt_pk_bf16_f32 v69, v70, v71
    v_cvt_pk_bf16_f32 v70, v76, v77
    v_cvt_pk_bf16_f32 v71, v78, v79
    ds_write_b128 v253, v[68:71] offset:9312
    v_accvgpr_read_b32 v84, a72
    v_accvgpr_read_b32 v85, a73
    v_accvgpr_read_b32 v86, a74
    v_accvgpr_read_b32 v87, a75
    v_mfma_f32_32x32x16_bf16 v[176:191], v[220:223], a[244:247], v[176:191]
    s_waitcnt lgkmcnt(0)
    s_barrier
    ds_read_b64_tr_b16 v[216:217], v237 offset:33280
    ds_read_b64_tr_b16 v[218:219], v237 offset:37632
    ds_read_b64_tr_b16 v[220:221], v237 offset:41984
    ds_read_b64_tr_b16 v[222:223], v237 offset:46336
    v_accvgpr_read_b32 v92, a76
    v_accvgpr_read_b32 v93, a77
    v_accvgpr_read_b32 v94, a78
    v_accvgpr_read_b32 v95, a79
    v_mfma_f32_32x32x16_bf16 v[160:175], v[224:227], a[184:187], v[160:175]
    v_pk_mul_f32 v[84:85], v[84:85], v[254:255] op_sel_hi:[1,0]
    v_pk_mul_f32 v[86:87], v[86:87], v[254:255] op_sel_hi:[1,0]
    v_pk_mul_f32 v[92:93], v[92:93], v[254:255] op_sel_hi:[1,0]
    v_pk_mul_f32 v[94:95], v[94:95], v[254:255] op_sel_hi:[1,0]
    v_cvt_pk_bf16_f32 v84, v84, v85
    v_cvt_pk_bf16_f32 v85, v86, v87
    v_cvt_pk_bf16_f32 v86, v92, v93
    v_cvt_pk_bf16_f32 v87, v94, v95
    ds_write_b128 v253, v[84:87] offset:9344
    v_mfma_f32_32x32x16_bf16 v[176:191], v[224:227], a[248:251], v[176:191]
    ds_read_b64_tr_b16 v[224:225], v237 offset:33344
    ds_read_b64_tr_b16 v[226:227], v237 offset:37696
    v_accvgpr_read_b32 v68, a80
    v_accvgpr_read_b32 v69, a81
    v_accvgpr_read_b32 v70, a82
    v_accvgpr_read_b32 v71, a83
    v_accvgpr_read_b32 v76, a84
    v_accvgpr_read_b32 v77, a85
    v_accvgpr_read_b32 v78, a86
    v_accvgpr_read_b32 v79, a87
    v_mfma_f32_32x32x16_bf16 v[160:175], v[228:231], a[188:191], v[160:175]
    v_mov_b32 v241, v243
    v_mov_b32 v242, v244
    v_pk_mul_f32 v[68:69], v[68:69], v[254:255] op_sel_hi:[1,0]
    v_pk_mul_f32 v[70:71], v[70:71], v[254:255] op_sel_hi:[1,0]
    v_pk_mul_f32 v[76:77], v[76:77], v[254:255] op_sel_hi:[1,0]
    v_pk_mul_f32 v[78:79], v[78:79], v[254:255] op_sel_hi:[1,0]
    v_cvt_pk_bf16_f32 v68, v68, v69
    v_cvt_pk_bf16_f32 v69, v70, v71
    v_cvt_pk_bf16_f32 v70, v76, v77
    v_cvt_pk_bf16_f32 v71, v78, v79
    ds_write_b128 v253, v[68:71] offset:9376
    v_mfma_f32_32x32x16_bf16 v[176:191], v[228:231], a[252:255], v[176:191]
    ds_read_b64_tr_b16 v[228:229], v237 offset:42048
    ds_read_b64_tr_b16 v[230:231], v237 offset:46400
    v_accvgpr_read_b32 v84, a88
    v_accvgpr_read_b32 v85, a89
    v_accvgpr_read_b32 v86, a90
    v_accvgpr_read_b32 v87, a91
    v_accvgpr_read_b32 v92, a92
    v_accvgpr_read_b32 v93, a93
    v_accvgpr_read_b32 v94, a94
    v_accvgpr_read_b32 v95, a95
    s_waitcnt lgkmcnt(8)
    v_mfma_f32_32x32x16_bf16 v[0:15], v[216:219], v[192:195], 0
    v_pk_mul_f32 v[84:85], v[84:85], v[254:255] op_sel_hi:[1,0]
    v_pk_mul_f32 v[86:87], v[86:87], v[254:255] op_sel_hi:[1,0]
    v_pk_mul_f32 v[92:93], v[92:93], v[254:255] op_sel_hi:[1,0]
    v_pk_mul_f32 v[94:95], v[94:95], v[254:255] op_sel_hi:[1,0]
    v_cvt_pk_bf16_f32 v84, v84, v85
    v_cvt_pk_bf16_f32 v85, v86, v87
    v_cvt_pk_bf16_f32 v86, v92, v93
    v_cvt_pk_bf16_f32 v87, v94, v95
    ds_write_b128 v253, v[84:87] offset:9408
    v_mfma_f32_32x32x16_bf16 a[0:15], v[216:219], v[196:199], 0
    ds_read_b64_tr_b16 v[216:217], v237 offset:33408
    ds_read_b64_tr_b16 v[218:219], v237 offset:37760
    v_pk_mul_f32 v[96:97], v[96:97], v[252:253] op_sel_hi:[1,0]
    v_pk_mul_f32 v[98:99], v[98:99], v[252:253] op_sel_hi:[1,0]
    v_pk_mul_f32 v[100:101], v[100:101], v[252:253] op_sel_hi:[1,0]
    v_pk_mul_f32 v[102:103], v[102:103], v[252:253] op_sel_hi:[1,0]
    v_cvt_pk_bf16_f32 v96, v96, v97
    v_cvt_pk_bf16_f32 v97, v98, v99
    v_cvt_pk_bf16_f32 v98, v100, v101
    v_cvt_pk_bf16_f32 v99, v102, v103
    ds_write_b128 v253, v[96:99] offset:13968
    s_waitcnt lgkmcnt(10)
    v_mfma_f32_32x32x16_bf16 v[0:15], v[220:223], v[208:211], v[0:15]
    v_pk_mul_f32 v[104:105], v[104:105], v[252:253] op_sel_hi:[1,0]
    v_pk_mul_f32 v[106:107], v[106:107], v[252:253] op_sel_hi:[1,0]
    v_pk_mul_f32 v[108:109], v[108:109], v[252:253] op_sel_hi:[1,0]
    v_pk_mul_f32 v[110:111], v[110:111], v[252:253] op_sel_hi:[1,0]
    v_cvt_pk_bf16_f32 v104, v104, v105
    v_cvt_pk_bf16_f32 v105, v106, v107
    v_cvt_pk_bf16_f32 v106, v108, v109
    v_cvt_pk_bf16_f32 v107, v110, v111
    ds_write_b128 v253, v[104:107] offset:14000
    v_mfma_f32_32x32x16_bf16 a[0:15], v[220:223], v[212:215], a[0:15]
    ds_read_b64_tr_b16 v[220:221], v237 offset:42112
    ds_read_b64_tr_b16 v[222:223], v237 offset:46464
    v_fma_f32 v232, v160, s21, v239
    v_pk_mul_f32 v[112:113], v[112:113], v[252:253] op_sel_hi:[1,0]
    v_pk_mul_f32 v[114:115], v[114:115], v[252:253] op_sel_hi:[1,0]
    v_pk_mul_f32 v[116:117], v[116:117], v[252:253] op_sel_hi:[1,0]
    v_pk_mul_f32 v[118:119], v[118:119], v[252:253] op_sel_hi:[1,0]
    s_waitcnt lgkmcnt(10)
    v_mfma_f32_32x32x16_bf16 v[16:31], v[224:227], v[192:195], 0
    v_fma_f32 v233, v161, s21, v239
    v_exp_f32 v232, v232
    v_cvt_pk_bf16_f32 v112, v112, v113
    v_cvt_pk_bf16_f32 v113, v114, v115
    v_cvt_pk_bf16_f32 v114, v116, v117
    v_cvt_pk_bf16_f32 v115, v118, v119
    ds_write_b128 v253, v[112:115] offset:14032
    v_mfma_f32_32x32x16_bf16 a[16:31], v[224:227], v[196:199], 0
    ds_read_b64_tr_b16 v[224:225], v237 offset:33472
    ds_read_b64_tr_b16 v[226:227], v237 offset:37824
    v_fma_f32 v234, v162, s21, v239
    v_exp_f32 v233, v233
    v_pk_mul_f32 v[120:121], v[120:121], v[252:253] op_sel_hi:[1,0]
    v_pk_mul_f32 v[122:123], v[122:123], v[252:253] op_sel_hi:[1,0]
    v_pk_mul_f32 v[124:125], v[124:125], v[252:253] op_sel_hi:[1,0]
    v_pk_mul_f32 v[126:127], v[126:127], v[252:253] op_sel_hi:[1,0]
    s_waitcnt lgkmcnt(10)
    v_mfma_f32_32x32x16_bf16 v[16:31], v[228:231], v[208:211], v[16:31]
    v_fma_f32 v235, v163, s21, v239
    v_exp_f32 v234, v234
    v_add_f32 v243, v232, v233
    v_cvt_pk_bf16_f32 v200, v232, v233
    v_cvt_pk_bf16_f32 v120, v120, v121
    v_cvt_pk_bf16_f32 v121, v122, v123
    v_cvt_pk_bf16_f32 v122, v124, v125
    v_cvt_pk_bf16_f32 v123, v126, v127
    ds_write_b128 v253, v[120:123] offset:14064
    v_mfma_f32_32x32x16_bf16 a[16:31], v[228:231], v[212:215], a[16:31]
    ds_read_b64_tr_b16 v[228:229], v237 offset:42176
    ds_read_b64_tr_b16 v[230:231], v237 offset:46528
    v_accvgpr_read_b32 v100, a96
    v_accvgpr_read_b32 v101, a97
    v_accvgpr_read_b32 v102, a98
    v_accvgpr_read_b32 v103, a99
    v_accvgpr_read_b32 v108, a100
    v_accvgpr_read_b32 v109, a101
    v_accvgpr_read_b32 v110, a102
    v_accvgpr_read_b32 v111, a103
    s_waitcnt lgkmcnt(10)
    v_mfma_f32_32x32x16_bf16 v[32:47], v[216:219], v[192:195], 0
    v_fma_f32 v232, v164, s21, v239
    v_exp_f32 v235, v235
    v_add_f32 v243, v243, v234
    v_pk_mul_f32 v[100:101], v[100:101], v[254:255] op_sel_hi:[1,0]
    v_pk_mul_f32 v[102:103], v[102:103], v[254:255] op_sel_hi:[1,0]
    v_pk_mul_f32 v[108:109], v[108:109], v[254:255] op_sel_hi:[1,0]
    v_pk_mul_f32 v[110:111], v[110:111], v[254:255] op_sel_hi:[1,0]
    v_mfma_f32_32x32x16_bf16 a[32:47], v[216:219], v[196:199], 0
    ds_read_b64_tr_b16 v[216:217], v237 offset:33536
    ds_read_b64_tr_b16 v[218:219], v237 offset:37888
    v_cvt_pk_bf16_f32 v100, v100, v101
    v_cvt_pk_bf16_f32 v101, v102, v103
    v_cvt_pk_bf16_f32 v102, v108, v109
    v_cvt_pk_bf16_f32 v103, v110, v111
    ds_write_b128 v253, v[100:103] offset:18624
    v_accvgpr_read_b32 v116, a104
    v_accvgpr_read_b32 v117, a105
    v_accvgpr_read_b32 v118, a106
    v_accvgpr_read_b32 v119, a107
    s_waitcnt lgkmcnt(9)
    v_mfma_f32_32x32x16_bf16 v[32:47], v[220:223], v[208:211], v[32:47]
    v_fma_f32 v233, v165, s21, v239
    v_exp_f32 v232, v232
    v_add_f32 v243, v243, v235
    v_cvt_pk_bf16_f32 v201, v234, v235
    v_accvgpr_read_b32 v124, a108
    v_accvgpr_read_b32 v125, a109
    v_accvgpr_read_b32 v126, a110
    v_accvgpr_read_b32 v127, a111
    v_mfma_f32_32x32x16_bf16 a[32:47], v[220:223], v[212:215], a[32:47]
    ds_read_b64_tr_b16 v[220:221], v237 offset:42240
    ds_read_b64_tr_b16 v[222:223], v237 offset:46592
    v_pk_mul_f32 v[116:117], v[116:117], v[254:255] op_sel_hi:[1,0]
    v_pk_mul_f32 v[118:119], v[118:119], v[254:255] op_sel_hi:[1,0]
    v_pk_mul_f32 v[124:125], v[124:125], v[254:255] op_sel_hi:[1,0]
    v_pk_mul_f32 v[126:127], v[126:127], v[254:255] op_sel_hi:[1,0]
    v_cvt_pk_bf16_f32 v116, v116, v117
    v_cvt_pk_bf16_f32 v117, v118, v119
    v_cvt_pk_bf16_f32 v118, v124, v125
    v_cvt_pk_bf16_f32 v119, v126, v127
    ds_write_b128 v253, v[116:119] offset:18656
    s_waitcnt lgkmcnt(9)
    v_mfma_f32_32x32x16_bf16 v[48:63], v[224:227], v[192:195], 0
    v_fma_f32 v234, v166, s21, v239
    v_exp_f32 v233, v233
    v_add_f32 v243, v243, v232
    v_accvgpr_read_b32 v100, a112
    v_accvgpr_read_b32 v101, a113
    v_accvgpr_read_b32 v102, a114
    v_accvgpr_read_b32 v103, a115
    v_accvgpr_read_b32 v108, a116
    v_accvgpr_read_b32 v109, a117
    v_accvgpr_read_b32 v110, a118
    v_accvgpr_read_b32 v111, a119
    v_mfma_f32_32x32x16_bf16 a[48:63], v[224:227], v[196:199], 0
    ds_read_b64_tr_b16 v[224:225], v237 offset:33600
    ds_read_b64_tr_b16 v[226:227], v237 offset:37952
    v_pk_mul_f32 v[100:101], v[100:101], v[254:255] op_sel_hi:[1,0]
    v_pk_mul_f32 v[102:103], v[102:103], v[254:255] op_sel_hi:[1,0]
    v_pk_mul_f32 v[108:109], v[108:109], v[254:255] op_sel_hi:[1,0]
    v_pk_mul_f32 v[110:111], v[110:111], v[254:255] op_sel_hi:[1,0]
    v_cvt_pk_bf16_f32 v100, v100, v101
    v_cvt_pk_bf16_f32 v101, v102, v103
    v_cvt_pk_bf16_f32 v102, v108, v109
    v_cvt_pk_bf16_f32 v103, v110, v111
    ds_write_b128 v253, v[100:103] offset:18688
    s_waitcnt lgkmcnt(9)
    v_mfma_f32_32x32x16_bf16 v[48:63], v[228:231], v[208:211], v[48:63]
    v_fma_f32 v235, v167, s21, v239
    v_exp_f32 v234, v234
    v_add_f32 v243, v243, v233
    v_cvt_pk_bf16_f32 v202, v232, v233
    v_accvgpr_read_b32 v116, a120
    v_accvgpr_read_b32 v117, a121
    v_accvgpr_read_b32 v118, a122
    v_accvgpr_read_b32 v119, a123
    v_mfma_f32_32x32x16_bf16 a[48:63], v[228:231], v[212:215], a[48:63]
    ds_read_b64_tr_b16 v[228:229], v237 offset:42304
    ds_read_b64_tr_b16 v[230:231], v237 offset:46656
    v_accvgpr_read_b32 v124, a124
    v_accvgpr_read_b32 v125, a125
    v_accvgpr_read_b32 v126, a126
    v_accvgpr_read_b32 v127, a127
    v_pk_mul_f32 v[116:117], v[116:117], v[254:255] op_sel_hi:[1,0]
    v_pk_mul_f32 v[118:119], v[118:119], v[254:255] op_sel_hi:[1,0]
    v_pk_mul_f32 v[124:125], v[124:125], v[254:255] op_sel_hi:[1,0]
    v_pk_mul_f32 v[126:127], v[126:127], v[254:255] op_sel_hi:[1,0]
    s_waitcnt lgkmcnt(9)
    v_mfma_f32_32x32x16_bf16 v[64:79], v[216:219], v[192:195], 0
    v_fma_f32 v232, v176, s21, v240
    v_exp_f32 v235, v235
    v_add_f32 v243, v243, v234
    v_cvt_pk_bf16_f32 v116, v116, v117
    v_cvt_pk_bf16_f32 v117, v118, v119
    v_cvt_pk_bf16_f32 v118, v124, v125
    v_cvt_pk_bf16_f32 v119, v126, v127
    ds_write_b128 v253, v[116:119] offset:18720
    v_mfma_f32_32x32x16_bf16 a[64:79], v[216:219], v[196:199], 0
    ds_read_b64_tr_b16 v[216:217], v237 offset:33664
    ds_read_b64_tr_b16 v[218:219], v237 offset:38016
    s_waitcnt lgkmcnt(9)
    v_mfma_f32_32x32x16_bf16 v[64:79], v[220:223], v[208:211], v[64:79]
    v_fma_f32 v233, v177, s21, v240
    v_exp_f32 v232, v232
    v_add_f32 v243, v243, v235
    v_cvt_pk_bf16_f32 v203, v234, v235
    v_mfma_f32_32x32x16_bf16 a[64:79], v[220:223], v[212:215], a[64:79]
    ds_read_b64_tr_b16 v[220:221], v237 offset:42368
    ds_read_b64_tr_b16 v[222:223], v237 offset:46720
    v_fma_f32 v234, v178, s21, v240
    v_exp_f32 v233, v233
    s_waitcnt lgkmcnt(8)
    v_mfma_f32_32x32x16_bf16 v[80:95], v[224:227], v[192:195], 0
    v_fma_f32 v235, v179, s21, v240
    v_exp_f32 v234, v234
    v_add_f32 v244, v232, v233
    v_cvt_pk_bf16_f32 v204, v232, v233
    v_mfma_f32_32x32x16_bf16 a[80:95], v[224:227], v[196:199], 0
    ds_read_b64_tr_b16 v[224:225], v237 offset:33728
    ds_read_b64_tr_b16 v[226:227], v237 offset:38080
    s_waitcnt lgkmcnt(7)
    v_mfma_f32_32x32x16_bf16 v[80:95], v[228:231], v[208:211], v[80:95]
    v_fma_f32 v232, v180, s21, v240
    v_exp_f32 v235, v235
    v_add_f32 v244, v244, v234
    v_mfma_f32_32x32x16_bf16 a[80:95], v[228:231], v[212:215], a[80:95]
    ds_read_b64_tr_b16 v[228:229], v237 offset:42432
    ds_read_b64_tr_b16 v[230:231], v237 offset:46784
    s_waitcnt lgkmcnt(6)
    v_mfma_f32_32x32x16_bf16 v[96:111], v[216:219], v[192:195], 0
    v_fma_f32 v233, v181, s21, v240
    v_exp_f32 v232, v232
    v_add_f32 v244, v244, v235
    v_cvt_pk_bf16_f32 v205, v234, v235
    v_mfma_f32_32x32x16_bf16 a[96:111], v[216:219], v[196:199], 0
    v_fma_f32 v234, v182, s21, v240
    v_exp_f32 v233, v233
    v_add_f32 v244, v244, v232
    s_waitcnt lgkmcnt(4)
    v_mfma_f32_32x32x16_bf16 v[96:111], v[220:223], v[208:211], v[96:111]
    v_fma_f32 v235, v183, s21, v240
    v_exp_f32 v234, v234
    v_add_f32 v244, v244, v233
    v_cvt_pk_bf16_f32 v206, v232, v233
    v_mfma_f32_32x32x16_bf16 a[96:111], v[220:223], v[212:215], a[96:111]
    s_waitcnt lgkmcnt(0)
    s_barrier
    ds_read_b128 v[216:219], v236
    ds_read_b128 v[220:223], v236 offset:32
    v_mfma_f32_32x32x16_bf16 v[112:127], v[224:227], v[192:195], 0
    v_fma_f32 v232, v168, s21, v239
    v_exp_f32 v235, v235
    v_add_f32 v244, v244, v234
    v_mfma_f32_32x32x16_bf16 a[112:127], v[224:227], v[196:199], 0
    ds_read_b128 v[224:227], v236 offset:64
    v_mfma_f32_32x32x16_bf16 v[112:127], v[228:231], v[208:211], v[112:127]
    v_fma_f32 v233, v169, s21, v239
    v_exp_f32 v232, v232
    v_add_f32 v244, v244, v235
    v_cvt_pk_bf16_f32 v207, v234, v235
    v_mfma_f32_32x32x16_bf16 a[112:127], v[228:231], v[212:215], a[112:127]
    ds_read_b128 v[228:231], v236 offset:96
    v_fma_f32 v234, v170, s21, v239
    v_exp_f32 v233, v233
    v_add_f32 v243, v243, v232
L_it0eB:
    s_add_u32 s59, s59, 1
    s_waitcnt lgkmcnt(3)
    v_mfma_f32_32x32x16_bf16 v[128:143], v[216:219], a[128:131], 0
    v_fma_f32 v235, v171, s21, v239
    v_exp_f32 v234, v234
    v_add_f32 v243, v243, v233
    v_cvt_pk_bf16_f32 v208, v232, v233
    v_add_u32 v251, s77, v251
    s_mov_b32 s72, s16
    s_mov_b32 s73, s17
    s_mov_b32 s74, s18
    s_add_u32 s70, s78, 16512
    v_mfma_f32_32x32x16_bf16 v[144:159], v[216:219], a[192:195], 0
    ds_read_b128 v[216:219], v236 offset:128
    ds_read_b128 v[252:255], v251
    s_waitcnt lgkmcnt(4)
    v_mfma_f32_32x32x16_bf16 v[128:143], v[220:223], a[132:135], v[128:143]
    v_fma_f32 v232, v172, s21, v239
    v_exp_f32 v235, v235
    v_add_f32 v243, v243, v234
    v_mfma_f32_32x32x16_bf16 v[144:159], v[220:223], a[196:199], v[144:159]
    ds_read_b128 v[220:223], v236 offset:160
    s_mov_b32 s16, s54
    s_mov_b32 s17, s55
    s_mov_b32 s18, s56
    s_add_u32 s57, s57, 32
    s_waitcnt lgkmcnt(4)
    v_mfma_f32_32x32x16_bf16 v[128:143], v[224:227], a[136:139], v[128:143]
    v_fma_f32 v233, v173, s21, v239
    v_exp_f32 v232, v232
    v_add_f32 v243, v243, v235
    v_cvt_pk_bf16_f32 v209, v234, v235
    v_mfma_f32_32x32x16_bf16 v[144:159], v[224:227], a[200:203], v[144:159]
    ds_read_b128 v[224:227], v236 offset:192
    s_add_u32 s47, s70, 0
    s_waitcnt lgkmcnt(2)
    buffer_store_dwordx4 v[252:255], v246, s[72:75], s47 offen nt
    s_mul_hi_u32 s42, s57, 0x55555556
    v_mfma_f32_32x32x16_bf16 v[128:143], v[228:231], a[140:143], v[128:143]
    v_fma_f32 v234, v174, s21, v239
    v_exp_f32 v233, v233
    v_add_f32 v243, v243, v232
    s_mul_i32 s43, s42, 3
    v_mfma_f32_32x32x16_bf16 v[144:159], v[228:231], a[204:207], v[144:159]
    ds_read_b128 v[228:231], v236 offset:224
    ds_read_b128 v[252:255], v251 offset:288
    s_sub_u32 s43, s57, s43
    v_mfma_f32_32x32x16_bf16 v[128:143], v[216:219], a[144:147], v[128:143]
    v_fma_f32 v235, v175, s21, v239
    v_exp_f32 v234, v234
    v_add_f32 v243, v243, v233
    v_cvt_pk_bf16_f32 v210, v232, v233
    v_mfma_f32_32x32x16_bf16 v[144:159], v[216:219], a[208:211], v[144:159]
    ds_read_b128 v[216:219], v236 offset:256
    s_waitcnt lgkmcnt(4)
    v_mfma_f32_32x32x16_bf16 v[128:143], v[220:223], a[148:151], v[128:143]
    v_fma_f32 v232, v184, s21, v240
    v_exp_f32 v235, v235
    v_add_f32 v243, v243, v234
    v_mfma_f32_32x32x16_bf16 v[144:159], v[220:223], a[212:215], v[144:159]
    ds_read_b128 v[220:223], v236 offset:288
    s_add_u32 s47, s70, 1024
    s_waitcnt lgkmcnt(2)
    buffer_store_dwordx4 v[252:255], v246, s[72:75], s47 offen nt
    v_mfma_f32_32x32x16_bf16 v[128:143], v[224:227], a[152:155], v[128:143]
    v_fma_f32 v233, v185, s21, v240
    v_exp_f32 v232, v232
    v_add_f32 v243, v243, v235
    v_cvt_pk_bf16_f32 v211, v234, v235
    v_mfma_f32_32x32x16_bf16 v[144:159], v[224:227], a[216:219], v[144:159]
    ds_read_b128 v[224:227], v236 offset:320
    ds_read_b128 v[252:255], v251 offset:2368
    v_mfma_f32_32x32x16_bf16 v[128:143], v[228:231], a[156:159], v[128:143]
    v_fma_f32 v234, v186, s21, v240
    v_exp_f32 v233, v233
    v_add_f32 v244, v244, v232
    v_mfma_f32_32x32x16_bf16 v[144:159], v[228:231], a[220:223], v[144:159]
    ds_read_b128 v[228:231], v236 offset:352
    s_waitcnt lgkmcnt(4)
    v_mfma_f32_32x32x16_bf16 v[128:143], v[216:219], a[160:163], v[128:143]
    v_fma_f32 v235, v187, s21, v240
    v_exp_f32 v234, v234
    v_add_f32 v244, v244, v233
    v_cvt_pk_bf16_f32 v212, v232, v233
    v_mfma_f32_32x32x16_bf16 v[144:159], v[216:219], a[224:227], v[144:159]
    ds_read_b128 v[216:219], v236 offset:384
    s_add_u32 s47, s70, 8192
    s_waitcnt lgkmcnt(2)
    buffer_store_dwordx4 v[252:255], v246, s[72:75], s47 offen nt
    v_mfma_f32_32x32x16_bf16 v[128:143], v[220:223], a[164:167], v[128:143]
    v_fma_f32 v232, v188, s21, v240
    v_exp_f32 v235, v235
    v_add_f32 v244, v244, v234
    v_mfma_f32_32x32x16_bf16 v[144:159], v[220:223], a[228:231], v[144:159]
    ds_read_b128 v[220:223], v236 offset:416
    ds_read_b128 v[252:255], v251 offset:2656
    v_mfma_f32_32x32x16_bf16 v[128:143], v[224:227], a[168:171], v[128:143]
    v_fma_f32 v233, v189, s21, v240
    v_exp_f32 v232, v232
    v_add_f32 v244, v244, v235
    v_cvt_pk_bf16_f32 v213, v234, v235
    v_mfma_f32_32x32x16_bf16 v[144:159], v[224:227], a[232:235], v[144:159]
    ds_read_b128 v[224:227], v236 offset:448
    s_waitcnt lgkmcnt(4)
    v_mfma_f32_32x32x16_bf16 v[128:143], v[228:231], a[172:175], v[128:143]
    v_fma_f32 v234, v190, s21, v240
    v_exp_f32 v233, v233
    v_add_f32 v244, v244, v232
    v_mfma_f32_32x32x16_bf16 v[144:159], v[228:231], a[236:239], v[144:159]
    ds_read_b128 v[228:231], v236 offset:480
    s_add_u32 s47, s70, 9216
    s_waitcnt lgkmcnt(2)
    buffer_store_dwordx4 v[252:255], v246, s[72:75], s47 offen nt
    v_mfma_f32_32x32x16_bf16 v[128:143], v[216:219], a[176:179], v[128:143]
    v_fma_f32 v235, v191, s21, v240
    v_exp_f32 v234, v234
    v_add_f32 v244, v244, v233
    v_cvt_pk_bf16_f32 v214, v232, v233
    v_mfma_f32_32x32x16_bf16 v[144:159], v[216:219], a[240:243], v[144:159]
    v_exp_f32 v235, v235
    v_add_f32 v244, v244, v234
    v_mfma_f32_32x32x16_bf16 v[128:143], v[220:223], a[180:183], v[128:143]
    v_add_f32 v244, v244, v235
    v_cvt_pk_bf16_f32 v215, v234, v235
    v_mfma_f32_32x32x16_bf16 v[144:159], v[220:223], a[244:247], v[144:159]
    s_waitcnt lgkmcnt(0)
    s_barrier
    ds_read_b64_tr_b16 v[216:217], v237 offset:50688
    ds_read_b64_tr_b16 v[218:219], v237 offset:55040
    ds_read_b64_tr_b16 v[220:221], v237 offset:59392
    ds_read_b64_tr_b16 v[222:223], v237 offset:63744
    v_mfma_f32_32x32x16_bf16 v[128:143], v[224:227], a[184:187], v[128:143]
    s_cmp_eq_u32 s43, 2
    s_cselect_b32 s85, 3, 7
    s_cmp_eq_u32 s20, s85
    s_mov_b32 s85, 0x7e967699
    s_cselect_b32 s84, 0xf149f2ca, s85
    v_mfma_f32_32x32x16_bf16 v[144:159], v[224:227], a[248:251], v[144:159]
    ds_read_b64_tr_b16 v[224:225], v237 offset:50752
    ds_read_b64_tr_b16 v[226:227], v237 offset:55104
    v_add_f32 v245, v243, v244
    s_add_u32 s42, s42, s3
    s_mul_i32 s44, s42, 376832
    v_mfma_f32_32x32x16_bf16 v[128:143], v[228:231], a[188:191], v[128:143]
    v_cmp_nge_f32 vcc, s22, v245
    s_cbranch_vccnz L_rares1B
L_backs1B:
    v_add_f32 v241, v241, v243
    v_add_f32 v242, v242, v244
    s_lshl_b32 s43, s43, 17
    v_mfma_f32_32x32x16_bf16 v[144:159], v[228:231], a[252:255], v[144:159]
    ds_read_b64_tr_b16 v[228:229], v237 offset:59456
    ds_read_b64_tr_b16 v[230:231], v237 offset:63808
    s_add_u32 s44, s44, s43
    s_lshl_b32 s45, s42, 18
    s_lshr_b32 s80, s42, 4
    s_waitcnt lgkmcnt(6)
    v_mfma_f32_32x32x16_bf16 v[0:15], v[216:219], v[200:203], v[0:15]
    s_xor_b32 s80, s80, s42
    s_and_b32 s80, s80, 15
    s_lshl_b32 s80, s80, 14
    s_add_u32 s81, s80, 0x1000
    s_sub_u32 s43, 376832, s43
    v_mfma_f32_32x32x16_bf16 a[0:15], v[216:219], v[204:207], a[0:15]
    ds_read_b64_tr_b16 v[216:217], v237 offset:50816
    ds_read_b64_tr_b16 v[218:219], v237 offset:55168
    s_cmp_lt_u32 s57, 96
    s_cselect_b32 s43, s43, 0
    s_cselect_b32 s52, 262144, 0
    s_waitcnt lgkmcnt(6)
    v_mfma_f32_32x32x16_bf16 v[0:15], v[220:223], v[208:211], v[0:15]
    s_add_u32 s4, s32, s44
    s_addc_u32 s5, s33, 0
    s_and_b32 s5, s5, 0xffff
    s_mov_b32 s6, s43
    v_mfma_f32_32x32x16_bf16 a[0:15], v[220:223], v[212:215], a[0:15]
    ds_read_b64_tr_b16 v[220:221], v237 offset:59520
    ds_read_b64_tr_b16 v[222:223], v237 offset:63872
    v_fma_f32 v232, v128, s21, v239
    s_add_u32 s54, s38, s44
    s_addc_u32 s55, s39, 0
    s_waitcnt lgkmcnt(6)
    v_mfma_f32_32x32x16_bf16 v[16:31], v[224:227], v[200:203], v[16:31]
    v_fma_f32 v233, v129, s21, v239
    v_exp_f32 v232, v232
    s_and_b32 s55, s55, 0xffff
    s_mov_b32 s56, s43
    v_mfma_f32_32x32x16_bf16 a[16:31], v[224:227], v[204:207], a[16:31]
    ds_read_b64_tr_b16 v[224:225], v237 offset:50880
    ds_read_b64_tr_b16 v[226:227], v237 offset:55232
    v_fma_f32 v234, v130, s21, v239
    v_exp_f32 v233, v233
    s_waitcnt lgkmcnt(6)
    v_mfma_f32_32x32x16_bf16 v[16:31], v[228:231], v[208:211], v[16:31]
    v_fma_f32 v235, v131, s21, v239
    v_exp_f32 v234, v234
    v_add_f32 v243, v232, v233
    v_cvt_pk_bf16_f32 v192, v232, v233
    v_mfma_f32_32x32x16_bf16 a[16:31], v[228:231], v[212:215], a[16:31]
    ds_read_b64_tr_b16 v[228:229], v237 offset:59584
    ds_read_b64_tr_b16 v[230:231], v237 offset:63936
    s_add_u32 s48, s34, s45
    s_addc_u32 s49, s35, 0
    s_and_b32 s49, s49, 0xffff
    s_waitcnt lgkmcnt(6)
    v_mfma_f32_32x32x16_bf16 v[32:47], v[216:219], v[200:203], v[32:47]
    v_fma_f32 v232, v132, s21, v239
    v_exp_f32 v235, v235
    v_add_f32 v243, v243, v234
    v_mfma_f32_32x32x16_bf16 a[32:47], v[216:219], v[204:207], a[32:47]
    ds_read_b64_tr_b16 v[216:217], v237 offset:50944
    ds_read_b64_tr_b16 v[218:219], v237 offset:55296
    s_add_u32 s50, s36, s45
    s_addc_u32 s51, s37, 0
    s_and_b32 s51, s51, 0xffff
    s_waitcnt lgkmcnt(6)
    v_mfma_f32_32x32x16_bf16 v[32:47], v[220:223], v[208:211], v[32:47]
    v_fma_f32 v233, v133, s21, v239
    v_exp_f32 v232, v232
    v_add_f32 v243, v243, v235
    v_cvt_pk_bf16_f32 v193, v234, v235
    v_mfma_f32_32x32x16_bf16 a[32:47], v[220:223], v[212:215], a[32:47]
    ds_read_b64_tr_b16 v[220:221], v237 offset:59648
    ds_read_b64_tr_b16 v[222:223], v237 offset:64000
    s_mov_b32 s27, 0
    s_waitcnt lgkmcnt(6)
    v_mfma_f32_32x32x16_bf16 v[48:63], v[224:227], v[200:203], v[48:63]
    v_fma_f32 v234, v134, s21, v239
    v_exp_f32 v233, v233
    v_add_f32 v243, v243, v232
    v_mfma_f32_32x32x16_bf16 a[48:63], v[224:227], v[204:207], a[48:63]
    ds_read_b64_tr_b16 v[224:225], v237 offset:51008
    ds_read_b64_tr_b16 v[226:227], v237 offset:55360
    s_waitcnt lgkmcnt(6)
    v_mfma_f32_32x32x16_bf16 v[48:63], v[228:231], v[208:211], v[48:63]
    v_fma_f32 v235, v135, s21, v239
    v_exp_f32 v234, v234
    v_add_f32 v243, v243, v233
    v_cvt_pk_bf16_f32 v194, v232, v233
    v_mfma_f32_32x32x16_bf16 a[48:63], v[228:231], v[212:215], a[48:63]
    ds_read_b64_tr_b16 v[228:229], v237 offset:59712
    ds_read_b64_tr_b16 v[230:231], v237 offset:64064
    s_waitcnt lgkmcnt(6)
    v_mfma_f32_32x32x16_bf16 v[64:79], v[216:219], v[200:203], v[64:79]
    v_fma_f32 v232, v144, s21, v240
    v_exp_f32 v235, v235
    v_add_f32 v243, v243, v234
    v_mfma_f32_32x32x16_bf16 a[64:79], v[216:219], v[204:207], a[64:79]
    ds_read_b64_tr_b16 v[216:217], v237 offset:51072
    ds_read_b64_tr_b16 v[218:219], v237 offset:55424
    s_waitcnt lgkmcnt(6)
    v_mfma_f32_32x32x16_bf16 v[64:79], v[220:223], v[208:211], v[64:79]
    v_fma_f32 v233, v145, s21, v240
    v_exp_f32 v232, v232
    v_add_f32 v243, v243, v235
    v_cvt_pk_bf16_f32 v195, v234, v235
    v_mfma_f32_32x32x16_bf16 a[64:79], v[220:223], v[212:215], a[64:79]
    ds_read_b64_tr_b16 v[220:221], v237 offset:59776
    ds_read_b64_tr_b16 v[222:223], v237 offset:64128
    v_fma_f32 v234, v146, s21, v240
    v_exp_f32 v233, v233
    s_waitcnt lgkmcnt(6)
    v_mfma_f32_32x32x16_bf16 v[80:95], v[224:227], v[200:203], v[80:95]
    v_fma_f32 v235, v147, s21, v240
    v_exp_f32 v234, v234
    v_add_f32 v244, v232, v233
    v_cvt_pk_bf16_f32 v196, v232, v233
    v_mfma_f32_32x32x16_bf16 a[80:95], v[224:227], v[204:207], a[80:95]
    ds_read_b64_tr_b16 v[224:225], v237 offset:51136
    ds_read_b64_tr_b16 v[226:227], v237 offset:55488
    s_waitcnt lgkmcnt(6)
    v_mfma_f32_32x32x16_bf16 v[80:95], v[228:231], v[208:211], v[80:95]
    v_fma_f32 v232, v148, s21, v240
    v_exp_f32 v235, v235
    v_add_f32 v244, v244, v234
    v_mfma_f32_32x32x16_bf16 a[80:95], v[228:231], v[212:215], a[80:95]
    ds_read_b64_tr_b16 v[228:229], v237 offset:59840
    ds_read_b64_tr_b16 v[230:231], v237 offset:64192
    s_waitcnt lgkmcnt(6)
    v_mfma_f32_32x32x16_bf16 v[96:111], v[216:219], v[200:203], v[96:111]
    v_fma_f32 v233, v149, s21, v240
    v_exp_f32 v232, v232
    v_add_f32 v244, v244, v235
    v_cvt_pk_bf16_f32 v197, v234, v235
    v_mfma_f32_32x32x16_bf16 a[96:111], v[216:219], v[204:207], a[96:111]
    v_fma_f32 v234, v150, s21, v240
    v_exp_f32 v233, v233
    v_add_f32 v244, v244, v232
    s_waitcnt lgkmcnt(4)
    v_mfma_f32_32x32x16_bf16 v[96:111], v[220:223], v[208:211], v[96:111]
    v_fma_f32 v235, v151, s21, v240
    v_exp_f32 v234, v234
    v_add_f32 v244, v244, v233
    v_cvt_pk_bf16_f32 v198, v232, v233
    v_mfma_f32_32x32x16_bf16 a[96:111], v[220:223], v[212:215], a[96:111]
    s_waitcnt lgkmcnt(0)
    s_barrier
    ds_read_b128 v[216:219], v236 offset:16640
    ds_read_b128 v[220:223], v236 offset:16672
    v_mfma_f32_32x32x16_bf16 v[112:127], v[224:227], v[200:203], v[112:127]
    v_fma_f32 v232, v136, s21, v239
    v_exp_f32 v235, v235
    v_add_f32 v244, v244, v234
    v_mfma_f32_32x32x16_bf16 a[112:127], v[224:227], v[204:207], a[112:127]
    ds_read_b128 v[224:227], v236 offset:16704
    v_mfma_f32_32x32x16_bf16 v[112:127], v[228:231], v[208:211], v[112:127]
    v_fma_f32 v233, v137, s21, v239
    v_exp_f32 v232, v232
    v_add_f32 v244, v244, v235
    v_cvt_pk_bf16_f32 v199, v234, v235
    v_mfma_f32_32x32x16_bf16 a[112:127], v[228:231], v[212:215], a[112:127]
    ds_read_b128 v[228:231], v236 offset:16736
    v_fma_f32 v234, v138, s21, v239
    v_exp_f32 v233, v233
    v_add_f32 v243, v243, v232
L_loopB:
    s_waitcnt lgkmcnt(3)
    v_mfma_f32_32x32x16_bf16 v[160:175], v[216:219], a[128:131], 0
    v_fma_f32 v235, v139, s21, v239
    v_exp_f32 v234, v234
    v_add_f32 v243, v243, v233
    v_cvt_pk_bf16_f32 v208, v232, v233
    v_mfma_f32_32x32x16_bf16 v[176:191], v[216:219], a[192:195], 0
    ds_read_b128 v[216:219], v236 offset:16768
    ds_read_b128 v[252:255], v251 offset:23280
    s_waitcnt lgkmcnt(4)
    v_mfma_f32_32x32x16_bf16 v[160:175], v[220:223], a[132:135], v[160:175]
    v_fma_f32 v232, v140, s21, v239
    v_exp_f32 v235, v235
    v_add_f32 v243, v243, v234
    v_mfma_f32_32x32x16_bf16 v[176:191], v[220:223], a[196:199], v[176:191]
    ds_read_b128 v[220:223], v236 offset:16800
    s_and_b32 s42, s27, 1
    s_waitcnt lgkmcnt(4)
    v_mfma_f32_32x32x16_bf16 v[160:175], v[224:227], a[136:139], v[160:175]
    v_fma_f32 v233, v141, s21, v239
    v_exp_f32 v232, v232
    v_add_f32 v243, v243, v235
    v_cvt_pk_bf16_f32 v209, v234, v235
    v_mfma_f32_32x32x16_bf16 v[176:191], v[224:227], a[200:203], v[176:191]
    ds_read_b128 v[224:227], v236 offset:16832
    s_lshl_b32 s42, s42, 14
    s_add_u32 s47, s70, 32768
    s_waitcnt lgkmcnt(2)
    buffer_store_dwordx4 v[252:255], v246, s[72:75], s47 offen nt
    v_mfma_f32_32x32x16_bf16 v[160:175], v[228:231], a[140:143], v[160:175]
    v_fma_f32 v234, v142, s21, v239
    v_exp_f32 v233, v233
    v_add_f32 v243, v243, v232
    v_mfma_f32_32x32x16_bf16 v[176:191], v[228:231], a[204:207], v[176:191]
    ds_read_b128 v[228:231], v236 offset:16864
    s_lshr_b32 s43, s27, 1
    ds_read_b128 v[252:255], v251 offset:23568
    v_mfma_f32_32x32x16_bf16 v[160:175], v[216:219], a[144:147], v[160:175]
    v_fma_f32 v235, v143, s21, v239
    v_exp_f32 v234, v234
    v_add_f32 v243, v243, v233
    v_cvt_pk_bf16_f32 v210, v232, v233
    v_mfma_f32_32x32x16_bf16 v[176:191], v[216:219], a[208:211], v[176:191]
    ds_read_b128 v[216:219], v236 offset:16896
    s_lshl_b32 s43, s43, 7
    s_waitcnt lgkmcnt(4)
    v_mfma_f32_32x32x16_bf16 v[160:175], v[220:223], a[148:151], v[160:175]
    v_fma_f32 v232, v152, s21, v240
    v_exp_f32 v235, v235
    v_add_f32 v243, v243, v234
    v_mfma_f32_32x32x16_bf16 v[176:191], v[220:223], a[212:215], v[176:191]
    ds_read_b128 v[220:223], v236 offset:16928
    s_or_b32 s44, s42, s43
    s_add_u32 s47, s70, 33792
    s_waitcnt lgkmcnt(2)
    buffer_store_dwordx4 v[252:255], v246, s[72:75], s47 offen nt
    v_mfma_f32_32x32x16_bf16 v[160:175], v[224:227], a[152:155], v[160:175]
    v_fma_f32 v233, v153, s21, v240
    v_exp_f32 v232, v232
    v_add_f32 v243, v243, v235
    v_cvt_pk_bf16_f32 v211, v234, v235
    v_mfma_f32_32x32x16_bf16 v[176:191], v[224:227], a[216:219], v[176:191]
    ds_read_b128 v[224:227], v236 offset:16960
    s_mul_i32 s45, s27, 4656
    ds_read_b128 v[252:255], v251 offset:25648
    v_mfma_f32_32x32x16_bf16 v[160:175], v[228:231], a[156:159], v[160:175]
    v_fma_f32 v234, v154, s21, v240
    v_exp_f32 v233, v233
    v_add_f32 v244, v244, v232
    v_mfma_f32_32x32x16_bf16 v[176:191], v[228:231], a[220:223], v[176:191]
    ds_read_b128 v[228:231], v236 offset:16992
    s_add_u32 s45, s45, s79
    s_waitcnt lgkmcnt(4)
    v_mfma_f32_32x32x16_bf16 v[160:175], v[216:219], a[160:163], v[160:175]
    v_fma_f32 v235, v155, s21, v240
    v_exp_f32 v234, v234
    v_add_f32 v244, v244, v233
    v_cvt_pk_bf16_f32 v212, v232, v233
    v_mfma_f32_32x32x16_bf16 v[176:191], v[216:219], a[224:227], v[176:191]
    ds_read_b128 v[216:219], v236 offset:17024
    s_add_u32 s47, s70, 40960
    s_waitcnt lgkmcnt(2)
    buffer_store_dwordx4 v[252:255], v246, s[72:75], s47 offen nt
    v_mfma_f32_32x32x16_bf16 v[160:175], v[220:223], a[164:167], v[160:175]
    s_cmp_eq_u32 s27, 5
    s_cselect_b32 s44, 0x40000000, s44
    s_cselect_b32 s46, 0, 23280
    s_cselect_b32 s29, 0, 1056
    s_cselect_b32 s45, 161216, s45
    v_mfma_f32_32x32x16_bf16 v[176:191], v[220:223], a[228:231], v[176:191]
    ds_read_b128 v[220:223], v236 offset:17056
    ds_read_b128 v[252:255], v251 offset:25936
    v_mfma_f32_32x32x16_bf16 v[160:175], v[224:227], a[168:171], v[160:175]
    v_fma_f32 v232, v156, s21, v240
    v_exp_f32 v235, v235
    v_add_f32 v244, v244, v234
    v_mfma_f32_32x32x16_bf16 v[176:191], v[224:227], a[232:235], v[176:191]
    ds_read_b128 v[224:227], v236 offset:17088
    s_waitcnt lgkmcnt(4)
    v_mfma_f32_32x32x16_bf16 v[160:175], v[228:231], a[172:175], v[160:175]
    s_add_u32 s28, s44, s78
    s_mov_b32 s31, s45
    v_mfma_f32_32x32x16_bf16 v[176:191], v[228:231], a[236:239], v[176:191]
    ds_read_b128 v[228:231], v236 offset:17120
    s_add_u32 s47, s70, 41984
    s_waitcnt lgkmcnt(2)
    buffer_store_dwordx4 v[252:255], v246, s[72:75], s47 offen nt
    v_mfma_f32_32x32x16_bf16 v[160:175], v[216:219], a[176:179], v[160:175]
    v_fma_f32 v233, v157, s21, v240
    v_exp_f32 v232, v232
    v_add_f32 v244, v244, v235
    v_cvt_pk_bf16_f32 v213, v234, v235
    v_mfma_f32_32x32x16_bf16 v[176:191], v[216:219], a[240:243], v[176:191]
    v_fma_f32 v234, v158, s21, v240
    v_exp_f32 v233, v233
    v_add_f32 v244, v244, v232
    v_mfma_f32_32x32x16_bf16 v[160:175], v[220:223], a[180:183], v[160:175]
    v_fma_f32 v235, v159, s21, v240
    v_exp_f32 v234, v234
    v_add_f32 v244, v244, v233
    v_cvt_pk_bf16_f32 v214, v232, v233
    v_mfma_f32_32x32x16_bf16 v[176:191], v[220:223], a[244:247], v[176:191]
    s_waitcnt lgkmcnt(0)
    s_barrier
    ds_read_b64_tr_b16 v[216:217], v237 offset:33280
    ds_read_b64_tr_b16 v[218:219], v237 offset:37632
    ds_read_b64_tr_b16 v[220:221], v237 offset:41984
    ds_read_b64_tr_b16 v[222:223], v237 offset:46336
    v_mfma_f32_32x32x16_bf16 v[160:175], v[224:227], a[184:187], v[160:175]
    v_exp_f32 v235, v235
    v_add_f32 v244, v244, v234
    v_add_f32 v244, v244, v235
    v_cvt_pk_bf16_f32 v215, v234, v235
    v_mfma_f32_32x32x16_bf16 v[176:191], v[224:227], a[248:251], v[176:191]
    ds_read_b64_tr_b16 v[224:225], v237 offset:33344
    ds_read_b64_tr_b16 v[226:227], v237 offset:37696
    v_add_f32 v245, v243, v244
    v_mfma_f32_32x32x16_bf16 v[160:175], v[228:231], a[188:191], v[160:175]
    v_cmp_nge_f32 vcc, s22, v245
    s_cbranch_vccnz L_rarel0B
L_backl0B:
    v_add_f32 v241, v241, v243
    v_add_f32 v242, v242, v244
    v_mfma_f32_32x32x16_bf16 v[176:191], v[228:231], a[252:255], v[176:191]
    ds_read_b64_tr_b16 v[228:229], v237 offset:42048
    ds_read_b64_tr_b16 v[230:231], v237 offset:46400
    s_waitcnt lgkmcnt(6)
    v_mfma_f32_32x32x16_bf16 v[0:15], v[216:219], v[192:195], v[0:15]
    v_mfma_f32_32x32x16_bf16 a[0:15], v[216:219], v[196:199], a[0:15]
    ds_read_b64_tr_b16 v[216:217], v237 offset:33408
    ds_read_b64_tr_b16 v[218:219], v237 offset:37760
    s_add_u32 s92, s27, 4
    s_waitcnt lgkmcnt(6)
    v_mfma_f32_32x32x16_bf16 v[0:15], v[220:223], v[208:211], v[0:15]
    s_mov_b32 m0, s31
    s_add_u32 s31, s31, s29
    buffer_load_dwordx4 v249, s[4:7], s28 offen nt lds
    s_add_u32 s28, s28, 0x1000
    v_mfma_f32_32x32x16_bf16 a[0:15], v[220:223], v[212:215], a[0:15]
    ds_read_b64_tr_b16 v[220:221], v237 offset:42112
    ds_read_b64_tr_b16 v[222:223], v237 offset:46464
    s_and_b32 s93, s92, 1
    v_fma_f32 v232, v160, s21, v239
    s_waitcnt lgkmcnt(6)
    v_mfma_f32_32x32x16_bf16 v[16:31], v[224:227], v[192:195], v[16:31]
    v_fma_f32 v233, v161, s21, v239
    v_exp_f32 v232, v232
    v_fma_f32 v234, v162, s21, v239
    v_exp_f32 v233, v233
    v_mfma_f32_32x32x16_bf16 a[16:31], v[224:227], v[196:199], a[16:31]
    ds_read_b64_tr_b16 v[224:225], v237 offset:33472
    ds_read_b64_tr_b16 v[226:227], v237 offset:37824
    s_lshl_b32 s93, s93, 14
    s_waitcnt lgkmcnt(6)
    v_mfma_f32_32x32x16_bf16 v[16:31], v[228:231], v[208:211], v[16:31]
    s_mov_b32 m0, s31
    s_add_u32 s31, s31, s29
    buffer_load_dwordx4 v249, s[4:7], s28 offen nt lds
    s_add_u32 s28, s28, 0x1000
    v_mfma_f32_32x32x16_bf16 a[16:31], v[228:231], v[212:215], a[16:31]
    ds_read_b64_tr_b16 v[228:229], v237 offset:42176
    ds_read_b64_tr_b16 v[230:231], v237 offset:46528
    s_lshr_b32 s92, s92, 1
    s_waitcnt lgkmcnt(6)
    v_mfma_f32_32x32x16_bf16 v[32:47], v[216:219], v[192:195], v[32:47]
    v_fma_f32 v235, v163, s21, v239
    v_exp_f32 v234, v234
    v_add_f32 v243, v232, v233
    v_cvt_pk_bf16_f32 v200, v232, v233
    v_mfma_f32_32x32x16_bf16 a[32:47], v[216:219], v[196:199], a[32:47]
    ds_read_b64_tr_b16 v[216:217], v237 offset:33536
    ds_read_b64_tr_b16 v[218:219], v237 offset:37888
    s_lshl_b32 s92, s92, 7
    s_waitcnt lgkmcnt(6)
    v_mfma_f32_32x32x16_bf16 v[32:47], v[220:223], v[208:211], v[32:47]
    s_mov_b32 m0, s31
    s_add_u32 s31, s31, s29
    buffer_load_dwordx4 v249, s[4:7], s28 offen nt lds
    s_add_u32 s28, s28, 0x1000
    v_mfma_f32_32x32x16_bf16 a[32:47], v[220:223], v[212:215], a[32:47]
    ds_read_b64_tr_b16 v[220:221], v237 offset:42240
    ds_read_b64_tr_b16 v[222:223], v237 offset:46592
    s_or_b32 s92, s92, s93
    s_waitcnt lgkmcnt(6)
    v_mfma_f32_32x32x16_bf16 v[48:63], v[224:227], v[192:195], v[48:63]
    v_fma_f32 v232, v164, s21, v239
    v_exp_f32 v235, v235
    v_add_f32 v243, v243, v234
    v_mfma_f32_32x32x16_bf16 a[48:63], v[224:227], v[196:199], a[48:63]
    ds_read_b64_tr_b16 v[224:225], v237 offset:33600
    ds_read_b64_tr_b16 v[226:227], v237 offset:37952
    s_add_u32 s92, s92, s78
    s_waitcnt lgkmcnt(6)
    v_mfma_f32_32x32x16_bf16 v[48:63], v[228:231], v[208:211], v[48:63]
    s_mov_b32 m0, s31
    s_add_u32 s31, s31, s29
    buffer_load_dwordx4 v249, s[4:7], s28 offen nt lds
    s_add_u32 s28, s28, 0x1000
    v_mfma_f32_32x32x16_bf16 a[48:63], v[228:231], v[212:215], a[48:63]
    ds_read_b64_tr_b16 v[228:229], v237 offset:42304
    ds_read_b64_tr_b16 v[230:231], v237 offset:46656
    s_waitcnt lgkmcnt(6)
    v_mfma_f32_32x32x16_bf16 v[64:79], v[216:219], v[192:195], v[64:79]
    v_fma_f32 v233, v165, s21, v239
    v_exp_f32 v232, v232
    v_add_f32 v243, v243, v235
    v_cvt_pk_bf16_f32 v201, v234, v235
    v_mfma_f32_32x32x16_bf16 a[64:79], v[216:219], v[196:199], a[64:79]
    ds_read_b64_tr_b16 v[216:217], v237 offset:33664
    ds_read_b64_tr_b16 v[218:219], v237 offset:38016
    v_fma_f32 v234, v166, s21, v239
    v_exp_f32 v233, v233
    v_add_f32 v243, v243, v232
    s_waitcnt lgkmcnt(6)
    v_mfma_f32_32x32x16_bf16 v[64:79], v[220:223], v[208:211], v[64:79]
    v_fma_f32 v235, v167, s21, v239
    v_exp_f32 v234, v234
    v_add_f32 v243, v243, v233
    v_cvt_pk_bf16_f32 v202, v232, v233
    v_mfma_f32_32x32x16_bf16 a[64:79], v[220:223], v[212:215], a[64:79]
    ds_read_b64_tr_b16 v[220:221], v237 offset:42368
    ds_read_b64_tr_b16 v[222:223], v237 offset:46720
    v_fma_f32 v232, v176, s21, v240
    v_exp_f32 v235, v235
    v_add_f32 v243, v243, v234
    s_waitcnt lgkmcnt(6)
    v_mfma_f32_32x32x16_bf16 v[80:95], v[224:227], v[192:195], v[80:95]
    v_fma_f32 v233, v177, s21, v240
    v_exp_f32 v232, v232
    v_add_f32 v243, v243, v235
    v_cvt_pk_bf16_f32 v203, v234, v235
    v_mfma_f32_32x32x16_bf16 a[80:95], v[224:227], v[196:199], a[80:95]
    ds_read_b64_tr_b16 v[224:225], v237 offset:33728
    ds_read_b64_tr_b16 v[226:227], v237 offset:38080
    v_fma_f32 v234, v178, s21, v240
    v_exp_f32 v233, v233
    s_waitcnt lgkmcnt(6)
    v_mfma_f32_32x32x16_bf16 v[80:95], v[228:231], v[208:211], v[80:95]
    v_fma_f32 v235, v179, s21, v240
    v_exp_f32 v234, v234
    v_add_f32 v244, v232, v233
    v_cvt_pk_bf16_f32 v204, v232, v233
    v_mfma_f32_32x32x16_bf16 a[80:95], v[228:231], v[212:215], a[80:95]
    ds_read_b64_tr_b16 v[228:229], v237 offset:42432
    ds_read_b64_tr_b16 v[230:231], v237 offset:46784
    v_fma_f32 v232, v180, s21, v240
    v_exp_f32 v235, v235
    v_add_f32 v244, v244, v234
    s_waitcnt lgkmcnt(6)
    v_mfma_f32_32x32x16_bf16 v[96:111], v[216:219], v[192:195], v[96:111]
    v_fma_f32 v233, v181, s21, v240
    v_exp_f32 v232, v232
    v_add_f32 v244, v244, v235
    v_cvt_pk_bf16_f32 v205, v234, v235
    v_mfma_f32_32x32x16_bf16 a[96:111], v[216:219], v[196:199], a[96:111]
    v_fma_f32 v234, v182, s21, v240
    v_exp_f32 v233, v233
    v_add_f32 v244, v244, v232
    s_waitcnt lgkmcnt(4)
    v_mfma_f32_32x32x16_bf16 v[96:111], v[220:223], v[208:211], v[96:111]
    v_fma_f32 v235, v183, s21, v240
    v_exp_f32 v234, v234
    v_add_f32 v244, v244, v233
    v_cvt_pk_bf16_f32 v206, v232, v233
    v_mfma_f32_32x32x16_bf16 a[96:111], v[220:223], v[212:215], a[96:111]
    s_waitcnt lgkmcnt(0)
    s_barrier
    ds_read_b128 v[216:219], v236
    ds_read_b128 v[220:223], v236 offset:32
    v_mfma_f32_32x32x16_bf16 v[112:127], v[224:227], v[192:195], v[112:127]
    v_fma_f32 v232, v168, s21, v239
    v_exp_f32 v235, v235
    v_add_f32 v244, v244, v234
    v_mfma_f32_32x32x16_bf16 a[112:127], v[224:227], v[196:199], a[112:127]
    ds_read_b128 v[224:227], v236 offset:64
    v_fma_f32 v233, v169, s21, v239
    v_exp_f32 v232, v232
    v_add_f32 v244, v244, v235
    v_cvt_pk_bf16_f32 v207, v234, v235
    v_mfma_f32_32x32x16_bf16 v[112:127], v[228:231], v[208:211], v[112:127]
    v_fma_f32 v234, v170, s21, v239
    v_exp_f32 v233, v233
    v_add_f32 v243, v243, v232
    v_mfma_f32_32x32x16_bf16 a[112:127], v[228:231], v[212:215], a[112:127]
    ds_read_b128 v[228:231], v236 offset:96
    s_cmp_ge_u32 s27, 4
    s_cselect_b32 s70, 0x40000000, s92
    s_cselect_b32 s93, 0, 4656
    s_waitcnt lgkmcnt(3)
    v_mfma_f32_32x32x16_bf16 v[128:143], v[216:219], a[128:131], 0
    v_fma_f32 v235, v171, s21, v239
    v_exp_f32 v234, v234
    v_add_f32 v243, v243, v233
    v_cvt_pk_bf16_f32 v208, v232, v233
    v_mfma_f32_32x32x16_bf16 v[144:159], v[216:219], a[192:195], 0
    ds_read_b128 v[216:219], v236 offset:128
    ds_read_b128 v[252:255], v251 offset:4656
    s_waitcnt lgkmcnt(4)
    v_mfma_f32_32x32x16_bf16 v[128:143], v[220:223], a[132:135], v[128:143]
    v_fma_f32 v232, v172, s21, v239
    v_exp_f32 v235, v235
    v_add_f32 v243, v243, v234
    v_mfma_f32_32x32x16_bf16 v[144:159], v[220:223], a[196:199], v[144:159]
    ds_read_b128 v[220:223], v236 offset:160
    s_waitcnt lgkmcnt(4)
    v_mfma_f32_32x32x16_bf16 v[128:143], v[224:227], a[136:139], v[128:143]
    v_fma_f32 v233, v173, s21, v239
    v_exp_f32 v232, v232
    v_add_f32 v243, v243, v235
    v_cvt_pk_bf16_f32 v209, v234, v235
    v_mfma_f32_32x32x16_bf16 v[144:159], v[224:227], a[200:203], v[144:159]
    ds_read_b128 v[224:227], v236 offset:192
    s_add_u32 s47, s70, 0
    s_waitcnt lgkmcnt(2)
    buffer_store_dwordx4 v[252:255], v246, s[72:75], s47 offen nt
    v_mfma_f32_32x32x16_bf16 v[128:143], v[228:231], a[140:143], v[128:143]
    v_fma_f32 v234, v174, s21, v239
    v_exp_f32 v233, v233
    v_add_f32 v243, v243, v232
    v_mfma_f32_32x32x16_bf16 v[144:159], v[228:231], a[204:207], v[144:159]
    ds_read_b128 v[228:231], v236 offset:224
    ds_read_b128 v[252:255], v251 offset:4944
    v_mfma_f32_32x32x16_bf16 v[128:143], v[216:219], a[144:147], v[128:143]
    v_fma_f32 v235, v175, s21, v239
    v_exp_f32 v234, v234
    v_add_f32 v243, v243, v233
    v_cvt_pk_bf16_f32 v210, v232, v233
    v_mfma_f32_32x32x16_bf16 v[144:159], v[216:219], a[208:211], v[144:159]
    ds_read_b128 v[216:219], v236 offset:256
    s_waitcnt lgkmcnt(4)
    v_mfma_f32_32x32x16_bf16 v[128:143], v[220:223], a[148:151], v[128:143]
    v_fma_f32 v232, v184, s21, v240
    v_exp_f32 v235, v235
    v_add_f32 v243, v243, v234
    v_mfma_f32_32x32x16_bf16 v[144:159], v[220:223], a[212:215], v[144:159]
    ds_read_b128 v[220:223], v236 offset:288
    s_add_u32 s47, s70, 1024
    s_waitcnt lgkmcnt(2)
    buffer_store_dwordx4 v[252:255], v246, s[72:75], s47 offen nt
    v_mfma_f32_32x32x16_bf16 v[128:143], v[224:227], a[152:155], v[128:143]
    v_fma_f32 v233, v185, s21, v240
    v_exp_f32 v232, v232
    v_add_f32 v243, v243, v235
    v_cvt_pk_bf16_f32 v211, v234, v235
    v_mfma_f32_32x32x16_bf16 v[144:159], v[224:227], a[216:219], v[144:159]
    ds_read_b128 v[224:227], v236 offset:320
    ds_read_b128 v[252:255], v251 offset:7024
    v_mfma_f32_32x32x16_bf16 v[128:143], v[228:231], a[156:159], v[128:143]
    v_fma_f32 v234, v186, s21, v240
    v_exp_f32 v233, v233
    v_add_f32 v244, v244, v232
    v_mfma_f32_32x32x16_bf16 v[144:159], v[228:231], a[220:223], v[144:159]
    ds_read_b128 v[228:231], v236 offset:352
    s_waitcnt lgkmcnt(4)
    v_mfma_f32_32x32x16_bf16 v[128:143], v[216:219], a[160:163], v[128:143]
    v_fma_f32 v235, v187, s21, v240
    v_exp_f32 v234, v234
    v_add_f32 v244, v244, v233
    v_cvt_pk_bf16_f32 v212, v232, v233
    v_mfma_f32_32x32x16_bf16 v[144:159], v[216:219], a[224:227], v[144:159]
    ds_read_b128 v[216:219], v236 offset:384
    s_add_u32 s47, s70, 8192
    s_waitcnt lgkmcnt(2)
    buffer_store_dwordx4 v[252:255], v246, s[72:75], s47 offen nt
    v_mfma_f32_32x32x16_bf16 v[128:143], v[220:223], a[164:167], v[128:143]
    v_fma_f32 v232, v188, s21, v240
    v_exp_f32 v235, v235
    v_add_f32 v244, v244, v234
    v_mfma_f32_32x32x16_bf16 v[144:159], v[220:223], a[228:231], v[144:159]
    ds_read_b128 v[220:223], v236 offset:416
    ds_read_b128 v[252:255], v251 offset:7312
    v_mfma_f32_32x32x16_bf16 v[128:143], v[224:227], a[168:171], v[128:143]
    v_fma_f32 v233, v189, s21, v240
    v_exp_f32 v232, v232
    v_add_f32 v244, v244, v235
    v_cvt_pk_bf16_f32 v213, v234, v235
    v_mfma_f32_32x32x16_bf16 v[144:159], v[224:227], a[232:235], v[144:159]
    ds_read_b128 v[224:227], v236 offset:448
    s_waitcnt lgkmcnt(4)
    v_mfma_f32_32x32x16_bf16 v[128:143], v[228:231], a[172:175], v[128:143]
    s_add_u32 s28, s44, s78
    s_add_u32 s28, s28, 32768
    s_add_u32 s31, s45, s46
    v_mfma_f32_32x32x16_bf16 v[144:159], v[228:231], a[236:239], v[144:159]
    ds_read_b128 v[228:231], v236 offset:480
    s_add_u32 s47, s70, 9216
    s_waitcnt lgkmcnt(2)
    buffer_store_dwordx4 v[252:255], v246, s[72:75], s47 offen nt
    v_mfma_f32_32x32x16_bf16 v[128:143], v[216:219], a[176:179], v[128:143]
    v_fma_f32 v234, v190, s21, v240
    v_exp_f32 v233, v233
    v_add_f32 v244, v244, v232
    v_mfma_f32_32x32x16_bf16 v[144:159], v[216:219], a[240:243], v[144:159]
    v_fma_f32 v235, v191, s21, v240
    v_exp_f32 v234, v234
    v_add_f32 v244, v244, v233
    v_cvt_pk_bf16_f32 v214, v232, v233
    v_mfma_f32_32x32x16_bf16 v[128:143], v[220:223], a[180:183], v[128:143]
    v_exp_f32 v235, v235
    v_add_f32 v244, v244, v234
    v_mfma_f32_32x32x16_bf16 v[144:159], v[220:223], a[244:247], v[144:159]
    s_waitcnt lgkmcnt(0)
    s_barrier
    ds_read_b64_tr_b16 v[216:217], v237 offset:50688
    ds_read_b64_tr_b16 v[218:219], v237 offset:55040
    ds_read_b64_tr_b16 v[220:221], v237 offset:59392
    ds_read_b64_tr_b16 v[222:223], v237 offset:63744
    v_mfma_f32_32x32x16_bf16 v[128:143], v[224:227], a[184:187], v[128:143]
    v_add_u32 v251, s93, v251
    v_add_f32 v244, v244, v235
    v_cvt_pk_bf16_f32 v215, v234, v235
    v_mfma_f32_32x32x16_bf16 v[144:159], v[224:227], a[248:251], v[144:159]
    ds_read_b64_tr_b16 v[224:225], v237 offset:50752
    ds_read_b64_tr_b16 v[226:227], v237 offset:55104
    v_add_f32 v245, v243, v244
    v_mfma_f32_32x32x16_bf16 v[128:143], v[228:231], a[188:191], v[128:143]
    v_cmp_nge_f32 vcc, s22, v245
    s_cbranch_vccnz L_rarel1B
L_backl1B:
    v_add_f32 v241, v241, v243
    v_add_f32 v242, v242, v244
    v_mfma_f32_32x32x16_bf16 v[144:159], v[228:231], a[252:255], v[144:159]
    ds_read_b64_tr_b16 v[228:229], v237 offset:59456
    ds_read_b64_tr_b16 v[230:231], v237 offset:63808
    s_waitcnt lgkmcnt(6)
    v_mfma_f32_32x32x16_bf16 v[0:15], v[216:219], v[200:203], v[0:15]
    v_mfma_f32_32x32x16_bf16 a[0:15], v[216:219], v[204:207], a[0:15]
    ds_read_b64_tr_b16 v[216:217], v237 offset:50816
    ds_read_b64_tr_b16 v[218:219], v237 offset:55168
    s_waitcnt lgkmcnt(6)
    v_mfma_f32_32x32x16_bf16 v[0:15], v[220:223], v[208:211], v[0:15]
    s_mov_b32 m0, s31
    s_add_u32 s31, s31, s29
    buffer_load_dwordx4 v249, s[4:7], s28 offen nt lds
    s_add_u32 s28, s28, 0x1000
    v_mfma_f32_32x32x16_bf16 a[0:15], v[220:223], v[212:215], a[0:15]
    ds_read_b64_tr_b16 v[220:221], v237 offset:59520
    ds_read_b64_tr_b16 v[222:223], v237 offset:63872
    v_fma_f32 v232, v128, s21, v239
    v_fma_f32 v233, v129, s21, v239
    v_exp_f32 v232, v232
    s_waitcnt lgkmcnt(6)
    v_mfma_f32_32x32x16_bf16 v[16:31], v[224:227], v[200:203], v[16:31]
    v_fma_f32 v234, v130, s21, v239
    v_exp_f32 v233, v233
    v_mfma_f32_32x32x16_bf16 a[16:31], v[224:227], v[204:207], a[16:31]
    ds_read_b64_tr_b16 v[224:225], v237 offset:50880
    ds_read_b64_tr_b16 v[226:227], v237 offset:55232
    s_waitcnt lgkmcnt(6)
    v_mfma_f32_32x32x16_bf16 v[16:31], v[228:231], v[208:211], v[16:31]
    s_mov_b32 m0, s31
    s_add_u32 s31, s31, s29
    buffer_load_dwordx4 v249, s[4:7], s28 offen nt lds
    s_add_u32 s28, s28, 0x1000
    v_mfma_f32_32x32x16_bf16 a[16:31], v[228:231], v[212:215], a[16:31]
    ds_read_b64_tr_b16 v[228:229], v237 offset:59584
    ds_read_b64_tr_b16 v[230:231], v237 offset:63936
    s_waitcnt lgkmcnt(6)
    v_mfma_f32_32x32x16_bf16 v[32:47], v[216:219], v[200:203], v[32:47]
    v_fma_f32 v235, v131, s21, v239
    v_exp_f32 v234, v234
    v_add_f32 v243, v232, v233
    v_cvt_pk_bf16_f32 v192, v232, v233
    v_mfma_f32_32x32x16_bf16 a[32:47], v[216:219], v[204:207], a[32:47]
    ds_read_b64_tr_b16 v[216:217], v237 offset:50944
    ds_read_b64_tr_b16 v[218:219], v237 offset:55296
    v_fma_f32 v232, v132, s21, v239
    v_exp_f32 v235, v235
    v_add_f32 v243, v243, v234
    s_waitcnt lgkmcnt(6)
    v_mfma_f32_32x32x16_bf16 v[32:47], v[220:223], v[208:211], v[32:47]
    s_mov_b32 m0, s31
    s_add_u32 s31, s31, s29
    buffer_load_dwordx4 v249, s[4:7], s28 offen nt lds
    s_add_u32 s28, s28, 0x1000
    v_mfma_f32_32x32x16_bf16 a[32:47], v[220:223], v[212:215], a[32:47]
    ds_read_b64_tr_b16 v[220:221], v237 offset:59648
    ds_read_b64_tr_b16 v[222:223], v237 offset:64000
    s_waitcnt lgkmcnt(6)
    v_mfma_f32_32x32x16_bf16 v[48:63], v[224:227], v[200:203], v[48:63]
    v_fma_f32 v233, v133, s21, v239
    v_exp_f32 v232, v232
    v_add_f32 v243, v243, v235
    v_cvt_pk_bf16_f32 v193, v234, v235
    v_mfma_f32_32x32x16_bf16 a[48:63], v[224:227], v[204:207], a[48:63]
    ds_read_b64_tr_b16 v[224:225], v237 offset:51008
    ds_read_b64_tr_b16 v[226:227], v237 offset:55360
    v_fma_f32 v234, v134, s21, v239
    v_exp_f32 v233, v233
    v_add_f32 v243, v243, v232
    s_waitcnt lgkmcnt(6)
    v_mfma_f32_32x32x16_bf16 v[48:63], v[228:231], v[208:211], v[48:63]
    s_mov_b32 m0, s31
    s_add_u32 s31, s31, s29
    buffer_load_dwordx4 v249, s[4:7], s28 offen nt lds
    s_add_u32 s28, s28, 0x1000
    v_mfma_f32_32x32x16_bf16 a[48:63], v[228:231], v[212:215], a[48:63]
    ds_read_b64_tr_b16 v[228:229], v237 offset:59712
    ds_read_b64_tr_b16 v[230:231], v237 offset:64064
    s_waitcnt lgkmcnt(6)
    v_mfma_f32_32x32x16_bf16 v[64:79], v[216:219], v[200:203], v[64:79]
    v_fma_f32 v235, v135, s21, v239
    v_exp_f32 v234, v234
    v_add_f32 v243, v243, v233
    v_cvt_pk_bf16_f32 v194, v232, v233
    v_mfma_f32_32x32x16_bf16 a[64:79], v[216:219], v[204:207], a[64:79]
    ds_read_b64_tr_b16 v[216:217], v237 offset:51072
    ds_read_b64_tr_b16 v[218:219], v237 offset:55424
    v_fma_f32 v232, v144, s21, v240
    v_exp_f32 v235, v235
    v_add_f32 v243, v243, v234
    s_waitcnt lgkmcnt(6)
    v_mfma_f32_32x32x16_bf16 v[64:79], v[220:223], v[208:211], v[64:79]
    v_fma_f32 v233, v145, s21, v240
    v_exp_f32 v232, v232
    v_add_f32 v243, v243, v235
    v_cvt_pk_bf16_f32 v195, v234, v235
    v_mfma_f32_32x32x16_bf16 a[64:79], v[220:223], v[212:215], a[64:79]
    ds_read_b64_tr_b16 v[220:221], v237 offset:59776
    ds_read_b64_tr_b16 v[222:223], v237 offset:64128
    v_fma_f32 v234, v146, s21, v240
    v_exp_f32 v233, v233
    s_waitcnt lgkmcnt(6)
    v_mfma_f32_32x32x16_bf16 v[80:95], v[224:227], v[200:203], v[80:95]
    v_fma_f32 v235, v147, s21, v240
    v_exp_f32 v234, v234
    v_add_f32 v244, v232, v233
    v_cvt_pk_bf16_f32 v196, v232, v233
    v_mfma_f32_32x32x16_bf16 a[80:95], v[224:227], v[204:207], a[80:95]
    ds_read_b64_tr_b16 v[224:225], v237 offset:51136
    ds_read_b64_tr_b16 v[226:227], v237 offset:55488
    v_fma_f32 v232, v148, s21, v240
    v_exp_f32 v235, v235
    v_add_f32 v244, v244, v234
    s_waitcnt lgkmcnt(6)
    v_mfma_f32_32x32x16_bf16 v[80:95], v[228:231], v[208:211], v[80:95]
    v_fma_f32 v233, v149, s21, v240
    v_exp_f32 v232, v232
    v_add_f32 v244, v244, v235
    v_cvt_pk_bf16_f32 v197, v234, v235
    v_mfma_f32_32x32x16_bf16 a[80:95], v[228:231], v[212:215], a[80:95]
    ds_read_b64_tr_b16 v[228:229], v237 offset:59840
    ds_read_b64_tr_b16 v[230:231], v237 offset:64192
    v_fma_f32 v234, v150, s21, v240
    v_exp_f32 v233, v233
    v_add_f32 v244, v244, v232
    s_waitcnt lgkmcnt(6)
    v_mfma_f32_32x32x16_bf16 v[96:111], v[216:219], v[200:203], v[96:111]
    v_fma_f32 v235, v151, s21, v240
    v_exp_f32 v234, v234
    v_add_f32 v244, v244, v233
    v_cvt_pk_bf16_f32 v198, v232, v233
    v_mfma_f32_32x32x16_bf16 a[96:111], v[216:219], v[204:207], a[96:111]
    v_fma_f32 v232, v136, s21, v239
    v_exp_f32 v235, v235
    v_add_f32 v244, v244, v234
    s_waitcnt lgkmcnt(4)
    v_mfma_f32_32x32x16_bf16 v[96:111], v[220:223], v[208:211], v[96:111]
    v_fma_f32 v233, v137, s21, v239
    v_exp_f32 v232, v232
    v_add_f32 v244, v244, v235
    v_cvt_pk_bf16_f32 v199, v234, v235
    v_mfma_f32_32x32x16_bf16 a[96:111], v[220:223], v[212:215], a[96:111]
    s_cmp_lg_u32 s27, 5
    s_cbranch_scc1 L_skipq
    s_waitcnt vmcnt(16)
L_skipq:
    s_waitcnt lgkmcnt(0)
    s_barrier
    ds_read_b128 v[216:219], v236 offset:16640
    ds_read_b128 v[220:223], v236 offset:16672
    v_mfma_f32_32x32x16_bf16 v[112:127], v[224:227], v[200:203], v[112:127]
    v_fma_f32 v234, v138, s21, v239
    v_exp_f32 v233, v233
    v_add_f32 v243, v243, v232
    v_mfma_f32_32x32x16_bf16 a[112:127], v[224:227], v[204:207], a[112:127]
    ds_read_b128 v[224:227], v236 offset:16704
    v_mfma_f32_32x32x16_bf16 v[112:127], v[228:231], v[208:211], v[112:127]
    v_mfma_f32_32x32x16_bf16 a[112:127], v[228:231], v[212:215], a[112:127]
    ds_read_b128 v[228:231], v236 offset:16736
    s_add_u32 s27, s27, 1
    s_cmp_lt_u32 s27, 6
    s_cbranch_scc1 L_loopB
    s_branch L_saB
L_f15B:
    v_fma_f32 v235, v171, s21, v239
    v_exp_f32 v234, v234
    v_add_f32 v243, v243, v233
    v_cvt_pk_bf16_f32 v208, v232, v233
    s_nop 0
    v_fma_f32 v232, v172, s21, v239
    v_exp_f32 v235, v235
    v_add_f32 v243, v243, v234
    s_nop 0
    v_fma_f32 v233, v173, s21, v239
    v_exp_f32 v232, v232
    v_add_f32 v243, v243, v235
    v_cvt_pk_bf16_f32 v209, v234, v235
    s_nop 0
    v_fma_f32 v234, v174, s21, v239
    v_exp_f32 v233, v233
    v_add_f32 v243, v243, v232
    s_nop 0
    v_fma_f32 v235, v175, s21, v239
    v_exp_f32 v234, v234
    v_add_f32 v243, v243, v233
    v_cvt_pk_bf16_f32 v210, v232, v233
    s_nop 0
    v_fma_f32 v232, v184, s21, v240
    v_exp_f32 v235, v235
    v_add_f32 v243, v243, v234
    s_nop 0
    v_fma_f32 v233, v185, s21, v240
    v_exp_f32 v232, v232
    v_add_f32 v243, v243, v235
    v_cvt_pk_bf16_f32 v211, v234, v235
    s_nop 0
    v_fma_f32 v234, v186, s21, v240
    v_exp_f32 v233, v233
    v_add_f32 v244, v244, v232
    s_nop 0
    v_fma_f32 v235, v187, s21, v240
    v_exp_f32 v234, v234
    v_add_f32 v244, v244, v233
    v_cvt_pk_bf16_f32 v212, v232, v233
    s_nop 0
    v_fma_f32 v232, v188, s21, v240
    v_exp_f32 v235, v235
    v_add_f32 v244, v244, v234
    s_nop 0
    v_fma_f32 v233, v189, s21, v240
    v_exp_f32 v232, v232
    v_add_f32 v244, v244, v235
    v_cvt_pk_bf16_f32 v213, v234, v235
    s_nop 0
    v_fma_f32 v234, v190, s21, v240
    v_exp_f32 v233, v233
    v_add_f32 v244, v244, v232
    s_nop 0
    v_fma_f32 v235, v191, s21, v240
    v_exp_f32 v234, v234
    v_add_f32 v244, v244, v233
    v_cvt_pk_bf16_f32 v214, v232, v233
    s_nop 0
    v_exp_f32 v235, v235
    v_add_f32 v244, v244, v234
    s_nop 0
    v_add_f32 v244, v244, v235
    v_cvt_pk_bf16_f32 v215, v234, v235
    s_nop 0
    v_add_f32 v245, v243, v244
    s_nop 0
    v_cmp_nge_f32 vcc, s22, v245
    s_cbranch_vccnz L_raref15B
L_backf15B:
    v_add_f32 v241, v241, v243
    v_add_f32 v242, v242, v244
    s_waitcnt vmcnt(0)
    s_waitcnt lgkmcnt(0)
    s_barrier
    ds_read_b64_tr_b16 v[216:217], v237 offset:50688
    ds_read_b64_tr_b16 v[218:219], v237 offset:55040
    ds_read_b64_tr_b16 v[220:221], v237 offset:59392
    ds_read_b64_tr_b16 v[222:223], v237 offset:63744
    ds_read_b64_tr_b16 v[224:225], v237 offset:50752
    ds_read_b64_tr_b16 v[226:227], v237 offset:55104
    ds_read_b64_tr_b16 v[228:229], v237 offset:59456
    ds_read_b64_tr_b16 v[230:231], v237 offset:63808
    v_mov_b32 v245, v241
    v_mov_b32 v255, v242
    s_nop 1
    v_permlane32_swap_b32 v245, v241
    v_permlane32_swap_b32 v255, v242
    s_nop 0
    v_add_f32 v241, v241, v245
    v_add_f32 v242, v242, v255
    v_rcp_f32 v252, v241
    v_rcp_f32 v254, v242
    v_mbcnt_lo_u32_b32 v253, -1, 0
    v_mbcnt_hi_u32_b32 v253, -1, v253
    v_and_b32 v247, 31, v253
    v_mul_u32_u24 v248, 0x90, v247
    v_lshrrev_b32 v247, 4, v247
    v_lshl_add_u32 v248, v247, 6, v248
    v_lshrrev_b32 v253, 5, v253
    v_lshl_add_u32 v253, v253, 4, v248
    v_add_u32 v253, s58, v253
    v_add_u32 v251, s76, v251
    s_nop 3
    s_waitcnt lgkmcnt(6)
    v_mfma_f32_32x32x16_bf16 v[0:15], v[216:219], v[200:203], v[0:15]
    v_mfma_f32_32x32x16_bf16 a[0:15], v[216:219], v[204:207], a[0:15]
    ds_read_b64_tr_b16 v[216:217], v237 offset:50816
    ds_read_b64_tr_b16 v[218:219], v237 offset:55168
    s_waitcnt lgkmcnt(6)
    v_mfma_f32_32x32x16_bf16 v[0:15], v[220:223], v[208:211], v[0:15]
    v_mfma_f32_32x32x16_bf16 a[0:15], v[220:223], v[212:215], a[0:15]
    ds_read_b64_tr_b16 v[220:221], v237 offset:59520
    ds_read_b64_tr_b16 v[222:223], v237 offset:63872
    s_waitcnt lgkmcnt(6)
    v_mfma_f32_32x32x16_bf16 v[16:31], v[224:227], v[200:203], v[16:31]
    v_mfma_f32_32x32x16_bf16 a[16:31], v[224:227], v[204:207], a[16:31]
    ds_read_b64_tr_b16 v[224:225], v237 offset:50880
    ds_read_b64_tr_b16 v[226:227], v237 offset:55232
    s_waitcnt lgkmcnt(6)
    v_mfma_f32_32x32x16_bf16 v[16:31], v[228:231], v[208:211], v[16:31]
    v_mfma_f32_32x32x16_bf16 a[16:31], v[228:231], v[212:215], a[16:31]
    ds_read_b64_tr_b16 v[228:229], v237 offset:59584
    ds_read_b64_tr_b16 v[230:231], v237 offset:63936
    v_pk_mul_f32 v[0:1], v[0:1], v[252:253] op_sel_hi:[1,0]
    v_pk_mul_f32 v[2:3], v[2:3], v[252:253] op_sel_hi:[1,0]
    v_pk_mul_f32 v[4:5], v[4:5], v[252:253] op_sel_hi:[1,0]
    v_pk_mul_f32 v[6:7], v[6:7], v[252:253] op_sel_hi:[1,0]
    s_waitcnt lgkmcnt(6)
    v_mfma_f32_32x32x16_bf16 v[32:47], v[216:219], v[200:203], v[32:47]
    v_cvt_pk_bf16_f32 v0, v0, v1
    v_cvt_pk_bf16_f32 v1, v2, v3
    v_cvt_pk_bf16_f32 v2, v4, v5
    v_cvt_pk_bf16_f32 v3, v6, v7
    ds_write_b128 v253, v[0:3]
    v_pk_mul_f32 v[8:9], v[8:9], v[252:253] op_sel_hi:[1,0]
    v_pk_mul_f32 v[10:11], v[10:11], v[252:253] op_sel_hi:[1,0]
    v_pk_mul_f32 v[12:13], v[12:13], v[252:253] op_sel_hi:[1,0]
    v_pk_mul_f32 v[14:15], v[14:15], v[252:253] op_sel_hi:[1,0]
    v_mfma_f32_32x32x16_bf16 a[32:47], v[216:219], v[204:207], a[32:47]
    ds_read_b64_tr_b16 v[216:217], v237 offset:50944
    ds_read_b64_tr_b16 v[218:219], v237 offset:55296
    v_cvt_pk_bf16_f32 v8, v8, v9
    v_cvt_pk_bf16_f32 v9, v10, v11
    v_cvt_pk_bf16_f32 v10, v12, v13
    v_cvt_pk_bf16_f32 v11, v14, v15
    ds_write_b128 v253, v[8:11] offset:32
    s_waitcnt lgkmcnt(8)
    v_mfma_f32_32x32x16_bf16 v[32:47], v[220:223], v[208:211], v[32:47]
    v_mfma_f32_32x32x16_bf16 a[32:47], v[220:223], v[212:215], a[32:47]
    ds_read_b64_tr_b16 v[220:221], v237 offset:59648
    ds_read_b64_tr_b16 v[222:223], v237 offset:64000
    v_pk_mul_f32 v[16:17], v[16:17], v[252:253] op_sel_hi:[1,0]
    v_pk_mul_f32 v[18:19], v[18:19], v[252:253] op_sel_hi:[1,0]
    v_pk_mul_f32 v[20:21], v[20:21], v[252:253] op_sel_hi:[1,0]
    v_pk_mul_f32 v[22:23], v[22:23], v[252:253] op_sel_hi:[1,0]
    s_waitcnt lgkmcnt(8)
    v_mfma_f32_32x32x16_bf16 v[48:63], v[224:227], v[200:203], v[48:63]
    v_cvt_pk_bf16_f32 v16, v16, v17
    v_cvt_pk_bf16_f32 v17, v18, v19
    v_cvt_pk_bf16_f32 v18, v20, v21
    v_cvt_pk_bf16_f32 v19, v22, v23
    ds_write_b128 v253, v[16:19] offset:64
    v_pk_mul_f32 v[24:25], v[24:25], v[252:253] op_sel_hi:[1,0]
    v_pk_mul_f32 v[26:27], v[26:27], v[252:253] op_sel_hi:[1,0]
    v_pk_mul_f32 v[28:29], v[28:29], v[252:253] op_sel_hi:[1,0]
    v_pk_mul_f32 v[30:31], v[30:31], v[252:253] op_sel_hi:[1,0]
    v_mfma_f32_32x32x16_bf16 a[48:63], v[224:227], v[204:207], a[48:63]
    ds_read_b64_tr_b16 v[224:225], v237 offset:51008
    ds_read_b64_tr_b16 v[226:227], v237 offset:55360
    v_cvt_pk_bf16_f32 v24, v24, v25
    v_cvt_pk_bf16_f32 v25, v26, v27
    v_cvt_pk_bf16_f32 v26, v28, v29
    v_cvt_pk_bf16_f32 v27, v30, v31
    ds_write_b128 v253, v[24:27] offset:96
    s_waitcnt lgkmcnt(10)
    v_mfma_f32_32x32x16_bf16 v[48:63], v[228:231], v[208:211], v[48:63]
    ds_read_b128 v[0:3], v251
    ds_read_b128 v[8:11], v251 offset:288
    ds_read_b128 v[16:19], v251 offset:2368
    ds_read_b128 v[24:27], v251 offset:2656
    v_accvgpr_read_b32 v4, a0
    v_accvgpr_read_b32 v5, a1
    v_accvgpr_read_b32 v6, a2
    v_accvgpr_read_b32 v7, a3
    v_mfma_f32_32x32x16_bf16 a[48:63], v[228:231], v[212:215], a[48:63]
    ds_read_b64_tr_b16 v[228:229], v237 offset:59712
    s_waitcnt lgkmcnt(8)
    ds_read_b64_tr_b16 v[230:231], v237 offset:64064
    v_accvgpr_read_b32 v12, a4
    v_accvgpr_read_b32 v13, a5
    v_accvgpr_read_b32 v14, a6
    v_accvgpr_read_b32 v15, a7
    v_pk_mul_f32 v[4:5], v[4:5], v[254:255] op_sel_hi:[1,0]
    v_pk_mul_f32 v[6:7], v[6:7], v[254:255] op_sel_hi:[1,0]
    v_pk_mul_f32 v[12:13], v[12:13], v[254:255] op_sel_hi:[1,0]
    v_pk_mul_f32 v[14:15], v[14:15], v[254:255] op_sel_hi:[1,0]
    v_mfma_f32_32x32x16_bf16 v[64:79], v[216:219], v[200:203], v[64:79]
    v_cvt_pk_bf16_f32 v4, v4, v5
    v_cvt_pk_bf16_f32 v5, v6, v7
    v_cvt_pk_bf16_f32 v6, v12, v13
    v_cvt_pk_bf16_f32 v7, v14, v15
    ds_write_b128 v253, v[4:7] offset:4656
    s_add_u32 s47, s71, 0
    s_waitcnt lgkmcnt(6)
    buffer_store_dwordx4 v[0:3], v246, s[16:19], s47 offen nt
    v_mfma_f32_32x32x16_bf16 a[64:79], v[216:219], v[204:207], a[64:79]
    ds_read_b64_tr_b16 v[216:217], v237 offset:51072
    ds_read_b64_tr_b16 v[218:219], v237 offset:55424
    s_add_u32 s47, s71, 1024
    s_waitcnt lgkmcnt(7)
    buffer_store_dwordx4 v[8:11], v246, s[16:19], s47 offen nt
    v_accvgpr_read_b32 v20, a8
    v_accvgpr_read_b32 v21, a9
    v_accvgpr_read_b32 v22, a10
    v_accvgpr_read_b32 v23, a11
    v_mfma_f32_32x32x16_bf16 v[64:79], v[220:223], v[208:211], v[64:79]
    v_accvgpr_read_b32 v28, a12
    v_accvgpr_read_b32 v29, a13
    v_accvgpr_read_b32 v30, a14
    v_accvgpr_read_b32 v31, a15
    v_pk_mul_f32 v[20:21], v[20:21], v[254:255] op_sel_hi:[1,0]
    v_pk_mul_f32 v[22:23], v[22:23], v[254:255] op_sel_hi:[1,0]
    v_pk_mul_f32 v[28:29], v[28:29], v[254:255] op_sel_hi:[1,0]
    v_pk_mul_f32 v[30:31], v[30:31], v[254:255] op_sel_hi:[1,0]
    v_mfma_f32_32x32x16_bf16 a[64:79], v[220:223], v[212:215], a[64:79]
    ds_read_b64_tr_b16 v[220:221], v237 offset:59776
    ds_read_b64_tr_b16 v[222:223], v237 offset:64128
    v_cvt_pk_bf16_f32 v20, v20, v21
    v_cvt_pk_bf16_f32 v21, v22, v23
    v_cvt_pk_bf16_f32 v22, v28, v29
    v_cvt_pk_bf16_f32 v23, v30, v31
    ds_write_b128 v253, v[20:23] offset:4688
    v_mfma_f32_32x32x16_bf16 v[80:95], v[224:227], v[200:203], v[80:95]
    s_add_u32 s47, s71, 8192
    s_waitcnt lgkmcnt(9)
    buffer_store_dwordx4 v[16:19], v246, s[16:19], s47 offen nt
    s_add_u32 s47, s71, 9216
    s_waitcnt lgkmcnt(8)
    buffer_store_dwordx4 v[24:27], v246, s[16:19], s47 offen nt
    v_accvgpr_read_b32 v4, a16
    v_accvgpr_read_b32 v5, a17
    v_accvgpr_read_b32 v6, a18
    v_accvgpr_read_b32 v7, a19
    v_mfma_f32_32x32x16_bf16 a[80:95], v[224:227], v[204:207], a[80:95]
    ds_read_b64_tr_b16 v[224:225], v237 offset:51136
    ds_read_b64_tr_b16 v[226:227], v237 offset:55488
    v_accvgpr_read_b32 v12, a20
    v_accvgpr_read_b32 v13, a21
    v_accvgpr_read_b32 v14, a22
    v_accvgpr_read_b32 v15, a23
    v_pk_mul_f32 v[4:5], v[4:5], v[254:255] op_sel_hi:[1,0]
    v_pk_mul_f32 v[6:7], v[6:7], v[254:255] op_sel_hi:[1,0]
    v_pk_mul_f32 v[12:13], v[12:13], v[254:255] op_sel_hi:[1,0]
    v_pk_mul_f32 v[14:15], v[14:15], v[254:255] op_sel_hi:[1,0]
    s_waitcnt lgkmcnt(8)
    v_mfma_f32_32x32x16_bf16 v[80:95], v[228:231], v[208:211], v[80:95]
    v_cvt_pk_bf16_f32 v4, v4, v5
    v_cvt_pk_bf16_f32 v5, v6, v7
    v_cvt_pk_bf16_f32 v6, v12, v13
    v_cvt_pk_bf16_f32 v7, v14, v15
    ds_write_b128 v253, v[4:7] offset:4720
    v_accvgpr_read_b32 v20, a24
    v_accvgpr_read_b32 v21, a25
    v_accvgpr_read_b32 v22, a26
    v_accvgpr_read_b32 v23, a27
    v_mfma_f32_32x32x16_bf16 a[80:95], v[228:231], v[212:215], a[80:95]
    ds_read_b64_tr_b16 v[228:229], v237 offset:59840
    ds_read_b64_tr_b16 v[230:231], v237 offset:64192
    v_accvgpr_read_b32 v28, a28
    v_accvgpr_read_b32 v29, a29
    v_accvgpr_read_b32 v30, a30
    v_accvgpr_read_b32 v31, a31
    v_pk_mul_f32 v[20:21], v[20:21], v[254:255] op_sel_hi:[1,0]
    v_pk_mul_f32 v[22:23], v[22:23], v[254:255] op_sel_hi:[1,0]
    v_pk_mul_f32 v[28:29], v[28:29], v[254:255] op_sel_hi:[1,0]
    v_pk_mul_f32 v[30:31], v[30:31], v[254:255] op_sel_hi:[1,0]
    s_waitcnt lgkmcnt(8)
    v_mfma_f32_32x32x16_bf16 v[96:111], v[216:219], v[200:203], v[96:111]
    v_cvt_pk_bf16_f32 v20, v20, v21
    v_cvt_pk_bf16_f32 v21, v22, v23
    v_cvt_pk_bf16_f32 v22, v28, v29
    v_cvt_pk_bf16_f32 v23, v30, v31
    ds_write_b128 v253, v[20:23] offset:4752
    ds_read_b128 v[4:7], v251 offset:4656
    ds_read_b128 v[12:15], v251 offset:4944
    ds_read_b128 v[20:23], v251 offset:7024
    ds_read_b128 v[28:31], v251 offset:7312
    v_mfma_f32_32x32x16_bf16 a[96:111], v[216:219], v[204:207], a[96:111]
    v_pk_mul_f32 v[32:33], v[32:33], v[252:253] op_sel_hi:[1,0]
    v_pk_mul_f32 v[34:35], v[34:35], v[252:253] op_sel_hi:[1,0]
    v_pk_mul_f32 v[36:37], v[36:37], v[252:253] op_sel_hi:[1,0]
    v_pk_mul_f32 v[38:39], v[38:39], v[252:253] op_sel_hi:[1,0]
    v_cvt_pk_bf16_f32 v32, v32, v33
    v_cvt_pk_bf16_f32 v33, v34, v35
    v_cvt_pk_bf16_f32 v34, v36, v37
    v_cvt_pk_bf16_f32 v35, v38, v39
    ds_write_b128 v253, v[32:35] offset:9312
    s_waitcnt lgkmcnt(12)
    v_mfma_f32_32x32x16_bf16 v[96:111], v[220:223], v[208:211], v[96:111]
    s_add_u32 s47, s71, 16384
    s_waitcnt lgkmcnt(4)
    buffer_store_dwordx4 v[4:7], v246, s[16:19], s47 offen nt
    v_pk_mul_f32 v[40:41], v[40:41], v[252:253] op_sel_hi:[1,0]
    v_pk_mul_f32 v[42:43], v[42:43], v[252:253] op_sel_hi:[1,0]
    v_pk_mul_f32 v[44:45], v[44:45], v[252:253] op_sel_hi:[1,0]
    v_pk_mul_f32 v[46:47], v[46:47], v[252:253] op_sel_hi:[1,0]
    v_mfma_f32_32x32x16_bf16 a[96:111], v[220:223], v[212:215], a[96:111]
    v_cvt_pk_bf16_f32 v40, v40, v41
    v_cvt_pk_bf16_f32 v41, v42, v43
    v_cvt_pk_bf16_f32 v42, v44, v45
    v_cvt_pk_bf16_f32 v43, v46, v47
    ds_write_b128 v253, v[40:43] offset:9344
    s_add_u32 s47, s71, 17408
    s_waitcnt lgkmcnt(4)
    buffer_store_dwordx4 v[12:15], v246, s[16:19], s47 offen nt
    v_mfma_f32_32x32x16_bf16 v[112:127], v[224:227], v[200:203], v[112:127]
    v_pk_mul_f32 v[48:49], v[48:49], v[252:253] op_sel_hi:[1,0]
    v_pk_mul_f32 v[50:51], v[50:51], v[252:253] op_sel_hi:[1,0]
    v_pk_mul_f32 v[52:53], v[52:53], v[252:253] op_sel_hi:[1,0]
    v_pk_mul_f32 v[54:55], v[54:55], v[252:253] op_sel_hi:[1,0]
    v_cvt_pk_bf16_f32 v48, v48, v49
    v_cvt_pk_bf16_f32 v49, v50, v51
    v_cvt_pk_bf16_f32 v50, v52, v53
    v_cvt_pk_bf16_f32 v51, v54, v55
    ds_write_b128 v253, v[48:51] offset:9376
    v_mfma_f32_32x32x16_bf16 a[112:127], v[224:227], v[204:207], a[112:127]
    s_add_u32 s47, s71, 24576
    s_waitcnt lgkmcnt(4)
    buffer_store_dwordx4 v[20:23], v246, s[16:19], s47 offen nt
    v_pk_mul_f32 v[56:57], v[56:57], v[252:253] op_sel_hi:[1,0]
    v_pk_mul_f32 v[58:59], v[58:59], v[252:253] op_sel_hi:[1,0]
    v_pk_mul_f32 v[60:61], v[60:61], v[252:253] op_sel_hi:[1,0]
    v_pk_mul_f32 v[62:63], v[62:63], v[252:253] op_sel_hi:[1,0]
    v_mfma_f32_32x32x16_bf16 v[112:127], v[228:231], v[208:211], v[112:127]
    v_cvt_pk_bf16_f32 v56, v56, v57
    v_cvt_pk_bf16_f32 v57, v58, v59
    v_cvt_pk_bf16_f32 v58, v60, v61
    v_cvt_pk_bf16_f32 v59, v62, v63
    ds_write_b128 v253, v[56:59] offset:9408
    s_add_u32 s47, s71, 25600
    s_waitcnt lgkmcnt(4)
    buffer_store_dwordx4 v[28:31], v246, s[16:19], s47 offen nt
    v_mfma_f32_32x32x16_bf16 a[112:127], v[228:231], v[212:215], a[112:127]
    ds_read_b128 v[32:35], v251 offset:9312
    ds_read_b128 v[40:43], v251 offset:9600
    ds_read_b128 v[48:51], v251 offset:11680
    ds_read_b128 v[56:59], v251 offset:11968
    v_accvgpr_read_b32 v36, a32
    v_accvgpr_read_b32 v37, a33
    v_accvgpr_read_b32 v38, a34
    v_accvgpr_read_b32 v39, a35
    s_nop 7
    s_nop 7
    v_accvgpr_read_b32 v44, a36
    v_accvgpr_read_b32 v45, a37
    v_accvgpr_read_b32 v46, a38
    v_accvgpr_read_b32 v47, a39
    v_pk_mul_f32 v[36:37], v[36:37], v[254:255] op_sel_hi:[1,0]
    v_pk_mul_f32 v[38:39], v[38:39], v[254:255] op_sel_hi:[1,0]
    v_pk_mul_f32 v[44:45], v[44:45], v[254:255] op_sel_hi:[1,0]
    v_pk_mul_f32 v[46:47], v[46:47], v[254:255] op_sel_hi:[1,0]
    v_cvt_pk_bf16_f32 v36, v36, v37
    v_cvt_pk_bf16_f32 v37, v38, v39
    v_cvt_pk_bf16_f32 v38, v44, v45
    v_cvt_pk_bf16_f32 v39, v46, v47
    ds_write_b128 v253, v[36:39] offset:13968
    s_add_u32 s47, s71, 0
    s_waitcnt lgkmcnt(4)
    buffer_store_dwordx4 v[32:35], v246, s[16:19], s47 offen offset:128 nt
    s_add_u32 s47, s71, 1024
    s_waitcnt lgkmcnt(3)
    buffer_store_dwordx4 v[40:43], v246, s[16:19], s47 offen offset:128 nt
    v_accvgpr_read_b32 v52, a40
    v_accvgpr_read_b32 v53, a41
    v_accvgpr_read_b32 v54, a42
    v_accvgpr_read_b32 v55, a43
    v_accvgpr_read_b32 v60, a44
    v_accvgpr_read_b32 v61, a45
    v_accvgpr_read_b32 v62, a46
    v_accvgpr_read_b32 v63, a47
    v_pk_mul_f32 v[52:53], v[52:53], v[254:255] op_sel_hi:[1,0]
    v_pk_mul_f32 v[54:55], v[54:55], v[254:255] op_sel_hi:[1,0]
    v_pk_mul_f32 v[60:61], v[60:61], v[254:255] op_sel_hi:[1,0]
    v_pk_mul_f32 v[62:63], v[62:63], v[254:255] op_sel_hi:[1,0]
    v_cvt_pk_bf16_f32 v52, v52, v53
    v_cvt_pk_bf16_f32 v53, v54, v55
    v_cvt_pk_bf16_f32 v54, v60, v61
    v_cvt_pk_bf16_f32 v55, v62, v63
    ds_write_b128 v253, v[52:55] offset:14000
    s_add_u32 s47, s71, 8192
    s_waitcnt lgkmcnt(3)
    buffer_store_dwordx4 v[48:51], v246, s[16:19], s47 offen offset:128 nt
    s_add_u32 s47, s71, 9216
    s_waitcnt lgkmcnt(2)
    buffer_store_dwordx4 v[56:59], v246, s[16:19], s47 offen offset:128 nt
    v_accvgpr_read_b32 v36, a48
    v_accvgpr_read_b32 v37, a49
    v_accvgpr_read_b32 v38, a50
    v_accvgpr_read_b32 v39, a51
    v_accvgpr_read_b32 v44, a52
    v_accvgpr_read_b32 v45, a53
    v_accvgpr_read_b32 v46, a54
    v_accvgpr_read_b32 v47, a55
    v_pk_mul_f32 v[36:37], v[36:37], v[254:255] op_sel_hi:[1,0]
    v_pk_mul_f32 v[38:39], v[38:39], v[254:255] op_sel_hi:[1,0]
    v_pk_mul_f32 v[44:45], v[44:45], v[254:255] op_sel_hi:[1,0]
    v_pk_mul_f32 v[46:47], v[46:47], v[254:255] op_sel_hi:[1,0]
    v_cvt_pk_bf16_f32 v36, v36, v37
    v_cvt_pk_bf16_f32 v37, v38, v39
    v_cvt_pk_bf16_f32 v38, v44, v45
    v_cvt_pk_bf16_f32 v39, v46, v47
    ds_write_b128 v253, v[36:39] offset:14032
    v_accvgpr_read_b32 v52, a56
    v_accvgpr_read_b32 v53, a57
    v_accvgpr_read_b32 v54, a58
    v_accvgpr_read_b32 v55, a59
    v_accvgpr_read_b32 v60, a60
    v_accvgpr_read_b32 v61, a61
    v_accvgpr_read_b32 v62, a62
    v_accvgpr_read_b32 v63, a63
    v_pk_mul_f32 v[52:53], v[52:53], v[254:255] op_sel_hi:[1,0]
    v_pk_mul_f32 v[54:55], v[54:55], v[254:255] op_sel_hi:[1,0]
    v_pk_mul_f32 v[60:61], v[60:61], v[254:255] op_sel_hi:[1,0]
    v_pk_mul_f32 v[62:63], v[62:63], v[254:255] op_sel_hi:[1,0]
    v_cvt_pk_bf16_f32 v52, v52, v53
    v_cvt_pk_bf16_f32 v53, v54, v55
    v_cvt_pk_bf16_f32 v54, v60, v61
    v_cvt_pk_bf16_f32 v55, v62, v63
    ds_write_b128 v253, v[52:55] offset:14064
    ds_read_b128 v[36:39], v251 offset:13968
    ds_read_b128 v[44:47], v251 offset:14256
    ds_read_b128 v[52:55], v251 offset:16336
    ds_read_b128 v[60:63], v251 offset:16624
    v_pk_mul_f32 v[64:65], v[64:65], v[252:253] op_sel_hi:[1,0]
    v_pk_mul_f32 v[66:67], v[66:67], v[252:253] op_sel_hi:[1,0]
    v_pk_mul_f32 v[68:69], v[68:69], v[252:253] op_sel_hi:[1,0]
    v_pk_mul_f32 v[70:71], v[70:71], v[252:253] op_sel_hi:[1,0]
    v_cvt_pk_bf16_f32 v64, v64, v65
    v_cvt_pk_bf16_f32 v65, v66, v67
    v_cvt_pk_bf16_f32 v66, v68, v69
    v_cvt_pk_bf16_f32 v67, v70, v71
    ds_write_b128 v253, v[64:67] offset:18624
    s_add_u32 s47, s71, 16384
    s_waitcnt lgkmcnt(4)
    buffer_store_dwordx4 v[36:39], v246, s[16:19], s47 offen offset:128 nt
    v_pk_mul_f32 v[72:73], v[72:73], v[252:253] op_sel_hi:[1,0]
    v_pk_mul_f32 v[74:75], v[74:75], v[252:253] op_sel_hi:[1,0]
    v_pk_mul_f32 v[76:77], v[76:77], v[252:253] op_sel_hi:[1,0]
    v_pk_mul_f32 v[78:79], v[78:79], v[252:253] op_sel_hi:[1,0]
    v_cvt_pk_bf16_f32 v72, v72, v73
    v_cvt_pk_bf16_f32 v73, v74, v75
    v_cvt_pk_bf16_f32 v74, v76, v77
    v_cvt_pk_bf16_f32 v75, v78, v79
    ds_write_b128 v253, v[72:75] offset:18656
    s_add_u32 s47, s71, 17408
    s_waitcnt lgkmcnt(4)
    buffer_store_dwordx4 v[44:47], v246, s[16:19], s47 offen offset:128 nt
    v_pk_mul_f32 v[80:81], v[80:81], v[252:253] op_sel_hi:[1,0]
    v_pk_mul_f32 v[82:83], v[82:83], v[252:253] op_sel_hi:[1,0]
    v_pk_mul_f32 v[84:85], v[84:85], v[252:253] op_sel_hi:[1,0]
    v_pk_mul_f32 v[86:87], v[86:87], v[252:253] op_sel_hi:[1,0]
    v_cvt_pk_bf16_f32 v80, v80, v81
    v_cvt_pk_bf16_f32 v81, v82, v83
    v_cvt_pk_bf16_f32 v82, v84, v85
    v_cvt_pk_bf16_f32 v83, v86, v87
    ds_write_b128 v253, v[80:83] offset:18688
    s_add_u32 s47, s71, 24576
    s_waitcnt lgkmcnt(4)
    buffer_store_dwordx4 v[52:55], v246, s[16:19], s47 offen offset:128 nt
    v_pk_mul_f32 v[88:89], v[88:89], v[252:253] op_sel_hi:[1,0]
    v_pk_mul_f32 v[90:91], v[90:91], v[252:253] op_sel_hi:[1,0]
    v_pk_mul_f32 v[92:93], v[92:93], v[252:253] op_sel_hi:[1,0]
    v_pk_mul_f32 v[94:95], v[94:95], v[252:253] op_sel_hi:[1,0]
    v_cvt_pk_bf16_f32 v88, v88, v89
    v_cvt_pk_bf16_f32 v89, v90, v91
    v_cvt_pk_bf16_f32 v90, v92, v93
    v_cvt_pk_bf16_f32 v91, v94, v95
    ds_write_b128 v253, v[88:91] offset:18720
    s_add_u32 s47, s71, 25600
    s_waitcnt lgkmcnt(4)
    buffer_store_dwordx4 v[60:63], v246, s[16:19], s47 offen offset:128 nt
    ds_read_b128 v[64:67], v251 offset:18624
    ds_read_b128 v[72:75], v251 offset:18912
    ds_read_b128 v[80:83], v251 offset:20992
    ds_read_b128 v[88:91], v251 offset:21280
    v_accvgpr_read_b32 v68, a64
    v_accvgpr_read_b32 v69, a65
    v_accvgpr_read_b32 v70, a66
    v_accvgpr_read_b32 v71, a67
    v_accvgpr_read_b32 v76, a68
    v_accvgpr_read_b32 v77, a69
    v_accvgpr_read_b32 v78, a70
    v_accvgpr_read_b32 v79, a71
    v_pk_mul_f32 v[68:69], v[68:69], v[254:255] op_sel_hi:[1,0]
    v_pk_mul_f32 v[70:71], v[70:71], v[254:255] op_sel_hi:[1,0]
    v_pk_mul_f32 v[76:77], v[76:77], v[254:255] op_sel_hi:[1,0]
    v_pk_mul_f32 v[78:79], v[78:79], v[254:255] op_sel_hi:[1,0]
    v_cvt_pk_bf16_f32 v68, v68, v69
    v_cvt_pk_bf16_f32 v69, v70, v71
    v_cvt_pk_bf16_f32 v70, v76, v77
    v_cvt_pk_bf16_f32 v71, v78, v79
    ds_write_b128 v253, v[68:71]
    s_add_u32 s47, s71, 0
    s_waitcnt lgkmcnt(4)
    buffer_store_dwordx4 v[64:67], v246, s[16:19], s47 offen offset:256 nt
    s_add_u32 s47, s71, 1024
    s_waitcnt lgkmcnt(3)
    buffer_store_dwordx4 v[72:75], v246, s[16:19], s47 offen offset:256 nt
    v_accvgpr_read_b32 v84, a72
    v_accvgpr_read_b32 v85, a73
    v_accvgpr_read_b32 v86, a74
    v_accvgpr_read_b32 v87, a75
    v_accvgpr_read_b32 v92, a76
    v_accvgpr_read_b32 v93, a77
    v_accvgpr_read_b32 v94, a78
    v_accvgpr_read_b32 v95, a79
    v_pk_mul_f32 v[84:85], v[84:85], v[254:255] op_sel_hi:[1,0]
    v_pk_mul_f32 v[86:87], v[86:87], v[254:255] op_sel_hi:[1,0]
    v_pk_mul_f32 v[92:93], v[92:93], v[254:255] op_sel_hi:[1,0]
    v_pk_mul_f32 v[94:95], v[94:95], v[254:255] op_sel_hi:[1,0]
    v_cvt_pk_bf16_f32 v84, v84, v85
    v_cvt_pk_bf16_f32 v85, v86, v87
    v_cvt_pk_bf16_f32 v86, v92, v93
    v_cvt_pk_bf16_f32 v87, v94, v95
    ds_write_b128 v253, v[84:87] offset:32
    s_add_u32 s47, s71, 8192
    s_waitcnt lgkmcnt(3)
    buffer_store_dwordx4 v[80:83], v246, s[16:19], s47 offen offset:256 nt
    s_add_u32 s47, s71, 9216
    s_waitcnt lgkmcnt(2)
    buffer_store_dwordx4 v[88:91], v246, s[16:19], s47 offen offset:256 nt
    v_accvgpr_read_b32 v68, a80
    v_accvgpr_read_b32 v69, a81
    v_accvgpr_read_b32 v70, a82
    v_accvgpr_read_b32 v71, a83
    v_accvgpr_read_b32 v76, a84
    v_accvgpr_read_b32 v77, a85
    v_accvgpr_read_b32 v78, a86
    v_accvgpr_read_b32 v79, a87
    v_pk_mul_f32 v[68:69], v[68:69], v[254:255] op_sel_hi:[1,0]
    v_pk_mul_f32 v[70:71], v[70:71], v[254:255] op_sel_hi:[1,0]
    v_pk_mul_f32 v[76:77], v[76:77], v[254:255] op_sel_hi:[1,0]
    v_pk_mul_f32 v[78:79], v[78:79], v[254:255] op_sel_hi:[1,0]
    v_cvt_pk_bf16_f32 v68, v68, v69
    v_cvt_pk_bf16_f32 v69, v70, v71
    v_cvt_pk_bf16_f32 v70, v76, v77
    v_cvt_pk_bf16_f32 v71, v78, v79
    ds_write_b128 v253, v[68:71] offset:64
    v_accvgpr_read_b32 v84, a88
    v_accvgpr_read_b32 v85, a89
    v_accvgpr_read_b32 v86, a90
    v_accvgpr_read_b32 v87, a91
    v_accvgpr_read_b32 v92, a92
    v_accvgpr_read_b32 v93, a93
    v_accvgpr_read_b32 v94, a94
    v_accvgpr_read_b32 v95, a95
    v_pk_mul_f32 v[84:85], v[84:85], v[254:255] op_sel_hi:[1,0]
    v_pk_mul_f32 v[86:87], v[86:87], v[254:255] op_sel_hi:[1,0]
    v_pk_mul_f32 v[92:93], v[92:93], v[254:255] op_sel_hi:[1,0]
    v_pk_mul_f32 v[94:95], v[94:95], v[254:255] op_sel_hi:[1,0]
    v_cvt_pk_bf16_f32 v84, v84, v85
    v_cvt_pk_bf16_f32 v85, v86, v87
    v_cvt_pk_bf16_f32 v86, v92, v93
    v_cvt_pk_bf16_f32 v87, v94, v95
    ds_write_b128 v253, v[84:87] offset:96
    ds_read_b128 v[68:71], v251
    ds_read_b128 v[76:79], v251 offset:288
    ds_read_b128 v[84:87], v251 offset:2368
    ds_read_b128 v[92:95], v251 offset:2656
    v_pk_mul_f32 v[96:97], v[96:97], v[252:253] op_sel_hi:[1,0]
    v_pk_mul_f32 v[98:99], v[98:99], v[252:253] op_sel_hi:[1,0]
    v_pk_mul_f32 v[100:101], v[100:101], v[252:253] op_sel_hi:[1,0]
    v_pk_mul_f32 v[102:103], v[102:103], v[252:253] op_sel_hi:[1,0]
    v_cvt_pk_bf16_f32 v96, v96, v97
    v_cvt_pk_bf16_f32 v97, v98, v99
    v_cvt_pk_bf16_f32 v98, v100, v101
    v_cvt_pk_bf16_f32 v99, v102, v103
    ds_write_b128 v253, v[96:99] offset:4656
    s_add_u32 s47, s71, 16384
    s_waitcnt lgkmcnt(4)
    buffer_store_dwordx4 v[68:71], v246, s[16:19], s47 offen offset:256 nt
    v_pk_mul_f32 v[104:105], v[104:105], v[252:253] op_sel_hi:[1,0]
    v_pk_mul_f32 v[106:107], v[106:107], v[252:253] op_sel_hi:[1,0]
    v_pk_mul_f32 v[108:109], v[108:109], v[252:253] op_sel_hi:[1,0]
    v_pk_mul_f32 v[110:111], v[110:111], v[252:253] op_sel_hi:[1,0]
    v_cvt_pk_bf16_f32 v104, v104, v105
    v_cvt_pk_bf16_f32 v105, v106, v107
    v_cvt_pk_bf16_f32 v106, v108, v109
    v_cvt_pk_bf16_f32 v107, v110, v111
    ds_write_b128 v253, v[104:107] offset:4688
    s_add_u32 s47, s71, 17408
    s_waitcnt lgkmcnt(4)
    buffer_store_dwordx4 v[76:79], v246, s[16:19], s47 offen offset:256 nt
    v_pk_mul_f32 v[112:113], v[112:113], v[252:253] op_sel_hi:[1,0]
    v_pk_mul_f32 v[114:115], v[114:115], v[252:253] op_sel_hi:[1,0]
    v_pk_mul_f32 v[116:117], v[116:117], v[252:253] op_sel_hi:[1,0]
    v_pk_mul_f32 v[118:119], v[118:119], v[252:253] op_sel_hi:[1,0]
    v_cvt_pk_bf16_f32 v112, v112, v113
    v_cvt_pk_bf16_f32 v113, v114, v115
    v_cvt_pk_bf16_f32 v114, v116, v117
    v_cvt_pk_bf16_f32 v115, v118, v119
    ds_write_b128 v253, v[112:115] offset:4720
    s_add_u32 s47, s71, 24576
    s_waitcnt lgkmcnt(4)
    buffer_store_dwordx4 v[84:87], v246, s[16:19], s47 offen offset:256 nt
    v_pk_mul_f32 v[120:121], v[120:121], v[252:253] op_sel_hi:[1,0]
    v_pk_mul_f32 v[122:123], v[122:123], v[252:253] op_sel_hi:[1,0]
    v_pk_mul_f32 v[124:125], v[124:125], v[252:253] op_sel_hi:[1,0]
    v_pk_mul_f32 v[126:127], v[126:127], v[252:253] op_sel_hi:[1,0]
    v_cvt_pk_bf16_f32 v120, v120, v121
    v_cvt_pk_bf16_f32 v121, v122, v123
    v_cvt_pk_bf16_f32 v122, v124, v125
    v_cvt_pk_bf16_f32 v123, v126, v127
    ds_write_b128 v253, v[120:123] offset:4752
    s_add_u32 s47, s71, 25600
    s_waitcnt lgkmcnt(4)
    buffer_store_dwordx4 v[92:95], v246, s[16:19], s47 offen offset:256 nt
    ds_read_b128 v[96:99], v251 offset:4656
    ds_read_b128 v[104:107], v251 offset:4944
    ds_read_b128 v[112:115], v251 offset:7024
    ds_read_b128 v[120:123], v251 offset:7312
    v_accvgpr_read_b32 v100, a96
    v_accvgpr_read_b32 v101, a97
    v_accvgpr_read_b32 v102, a98
    v_accvgpr_read_b32 v103, a99
    v_accvgpr_read_b32 v108, a100
    v_accvgpr_read_b32 v109, a101
    v_accvgpr_read_b32 v110, a102
    v_accvgpr_read_b32 v111, a103
    v_pk_mul_f32 v[100:101], v[100:101], v[254:255] op_sel_hi:[1,0]
    v_pk_mul_f32 v[102:103], v[102:103], v[254:255] op_sel_hi:[1,0]
    v_pk_mul_f32 v[108:109], v[108:109], v[254:255] op_sel_hi:[1,0]
    v_pk_mul_f32 v[110:111], v[110:111], v[254:255] op_sel_hi:[1,0]
    v_cvt_pk_bf16_f32 v100, v100, v101
    v_cvt_pk_bf16_f32 v101, v102, v103
    v_cvt_pk_bf16_f32 v102, v108, v109
    v_cvt_pk_bf16_f32 v103, v110, v111
    ds_write_b128 v253, v[100:103] offset:9312
    s_add_u32 s47, s71, 0
    s_waitcnt lgkmcnt(4)
    buffer_store_dwordx4 v[96:99], v246, s[16:19], s47 offen offset:384 nt
    s_add_u32 s47, s71, 1024
    s_waitcnt lgkmcnt(3)
    buffer_store_dwordx4 v[104:107], v246, s[16:19], s47 offen offset:384 nt
    v_accvgpr_read_b32 v116, a104
    v_accvgpr_read_b32 v117, a105
    v_accvgpr_read_b32 v118, a106
    v_accvgpr_read_b32 v119, a107
    v_accvgpr_read_b32 v124, a108
    v_accvgpr_read_b32 v125, a109
    v_accvgpr_read_b32 v126, a110
    v_accvgpr_read_b32 v127, a111
    v_pk_mul_f32 v[116:117], v[116:117], v[254:255] op_sel_hi:[1,0]
    v_pk_mul_f32 v[118:119], v[118:119], v[254:255] op_sel_hi:[1,0]
    v_pk_mul_f32 v[124:125], v[124:125], v[254:255] op_sel_hi:[1,0]
    v_pk_mul_f32 v[126:127], v[126:127], v[254:255] op_sel_hi:[1,0]
    v_cvt_pk_bf16_f32 v116, v116, v117
    v_cvt_pk_bf16_f32 v117, v118, v119
    v_cvt_pk_bf16_f32 v118, v124, v125
    v_cvt_pk_bf16_f32 v119, v126, v127
    ds_write_b128 v253, v[116:119] offset:9344
    s_add_u32 s47, s71, 8192
    s_waitcnt lgkmcnt(3)
    buffer_store_dwordx4 v[112:115], v246, s[16:19], s47 offen offset:384 nt
    s_add_u32 s47, s71, 9216
    s_waitcnt lgkmcnt(2)
    buffer_store_dwordx4 v[120:123], v246, s[16:19], s47 offen offset:384 nt
    v_accvgpr_read_b32 v100, a112
    v_accvgpr_read_b32 v101, a113
    v_accvgpr_read_b32 v102, a114
    v_accvgpr_read_b32 v103, a115
    v_accvgpr_read_b32 v108, a116
    v_accvgpr_read_b32 v109, a117
    v_accvgpr_read_b32 v110, a118
    v_accvgpr_read_b32 v111, a119
    v_pk_mul_f32 v[100:101], v[100:101], v[254:255] op_sel_hi:[1,0]
    v_pk_mul_f32 v[102:103], v[102:103], v[254:255] op_sel_hi:[1,0]
    v_pk_mul_f32 v[108:109], v[108:109], v[254:255] op_sel_hi:[1,0]
    v_pk_mul_f32 v[110:111], v[110:111], v[254:255] op_sel_hi:[1,0]
    v_cvt_pk_bf16_f32 v100, v100, v101
    v_cvt_pk_bf16_f32 v101, v102, v103
    v_cvt_pk_bf16_f32 v102, v108, v109
    v_cvt_pk_bf16_f32 v103, v110, v111
    ds_write_b128 v253, v[100:103] offset:9376
    v_accvgpr_read_b32 v116, a120
    v_accvgpr_read_b32 v117, a121
    v_accvgpr_read_b32 v118, a122
    v_accvgpr_read_b32 v119, a123
    v_accvgpr_read_b32 v124, a124
    v_accvgpr_read_b32 v125, a125
    v_accvgpr_read_b32 v126, a126
    v_accvgpr_read_b32 v127, a127
    v_pk_mul_f32 v[116:117], v[116:117], v[254:255] op_sel_hi:[1,0]
    v_pk_mul_f32 v[118:119], v[118:119], v[254:255] op_sel_hi:[1,0]
    v_pk_mul_f32 v[124:125], v[124:125], v[254:255] op_sel_hi:[1,0]
    v_pk_mul_f32 v[126:127], v[126:127], v[254:255] op_sel_hi:[1,0]
    v_cvt_pk_bf16_f32 v116, v116, v117
    v_cvt_pk_bf16_f32 v117, v118, v119
    v_cvt_pk_bf16_f32 v118, v124, v125
    v_cvt_pk_bf16_f32 v119, v126, v127
    ds_write_b128 v253, v[116:119] offset:9408
    ds_read_b128 v[100:103], v251 offset:9312
    ds_read_b128 v[108:111], v251 offset:9600
    ds_read_b128 v[116:119], v251 offset:11680
    ds_read_b128 v[124:127], v251 offset:11968
    s_add_u32 s47, s71, 16384
    s_waitcnt lgkmcnt(3)
    buffer_store_dwordx4 v[100:103], v246, s[16:19], s47 offen offset:384 nt
    s_add_u32 s47, s71, 17408
    s_waitcnt lgkmcnt(2)
    buffer_store_dwordx4 v[108:111], v246, s[16:19], s47 offen offset:384 nt
    s_add_u32 s47, s71, 24576
    s_waitcnt lgkmcnt(1)
    buffer_store_dwordx4 v[116:119], v246, s[16:19], s47 offen offset:384 nt
    s_add_u32 s47, s71, 25600
    s_waitcnt lgkmcnt(0)
    buffer_store_dwordx4 v[124:127], v246, s[16:19], s47 offen offset:384 nt
    s_branch L_fin
L_rarel0A:
    s_nop 7
    v_max3_f32 v247, v128, v129, v130
    v_max3_f32 v247, v247, v131, v132
    v_max3_f32 v247, v247, v133, v134
    v_max3_f32 v247, v247, v135, v136
    v_max3_f32 v247, v247, v137, v138
    v_max3_f32 v247, v247, v139, v140
    v_max3_f32 v247, v247, v141, v142
    v_max_f32 v247, v247, v143
    v_mov_b32 v245, v247
    s_nop 1
    v_permlane32_swap_b32 v245, v247
    s_nop 0
    v_max_f32 v247, v247, v245
    v_mul_f32 v247, s30, v247
    v_min_f32 v247, v247, v239
    v_sub_f32 v248, v247, v239
    v_exp_f32 v248, v248
    v_mov_b32 v239, v247
    v_mul_f32 v241, v241, v248
    v_mul_f32 v0, v0, v248
    v_mul_f32 v1, v1, v248
    v_mul_f32 v2, v2, v248
    v_mul_f32 v3, v3, v248
    v_mul_f32 v4, v4, v248
    v_mul_f32 v5, v5, v248
    v_mul_f32 v6, v6, v248
    v_mul_f32 v7, v7, v248
    v_mul_f32 v8, v8, v248
    v_mul_f32 v9, v9, v248
    v_mul_f32 v10, v10, v248
    v_mul_f32 v11, v11, v248
    v_mul_f32 v12, v12, v248
    v_mul_f32 v13, v13, v248
    v_mul_f32 v14, v14, v248
    v_mul_f32 v15, v15, v248
    v_mul_f32 v16, v16, v248
    v_mul_f32 v17, v17, v248
    v_mul_f32 v18, v18, v248
    v_mul_f32 v19, v19, v248
    v_mul_f32 v20, v20, v248
    v_mul_f32 v21, v21, v248
    v_mul_f32 v22, v22, v248
    v_mul_f32 v23, v23, v248
    v_mul_f32 v24, v24, v248
    v_mul_f32 v25, v25, v248
    v_mul_f32 v26, v26, v248
    v_mul_f32 v27, v27, v248
    v_mul_f32 v28, v28, v248
    v_mul_f32 v29, v29, v248
    v_mul_f32 v30, v30, v248
    v_mul_f32 v31, v31, v248
    v_mul_f32 v32, v32, v248
    v_mul_f32 v33, v33, v248
    v_mul_f32 v34, v34, v248
    v_mul_f32 v35, v35, v248
    v_mul_f32 v36, v36, v248
    v_mul_f32 v37, v37, v248
    v_mul_f32 v38, v38, v248
    v_mul_f32 v39, v39, v248
    v_mul_f32 v40, v40, v248
    v_mul_f32 v41, v41, v248
    v_mul_f32 v42, v42, v248
    v_mul_f32 v43, v43, v248
    v_mul_f32 v44, v44, v248
    v_mul_f32 v45, v45, v248
    v_mul_f32 v46, v46, v248
    v_mul_f32 v47, v47, v248
    v_mul_f32 v48, v48, v248
    v_mul_f32 v49, v49, v248
    v_mul_f32 v50, v50, v248
    v_mul_f32 v51, v51, v248
    v_mul_f32 v52, v52, v248
    v_mul_f32 v53, v53, v248
    v_mul_f32 v54, v54, v248
    v_mul_f32 v55, v55, v248
    v_mul_f32 v56, v56, v248
    v_mul_f32 v57, v57, v248
    v_mul_f32 v58, v58, v248
    v_mul_f32 v59, v59, v248
    v_mul_f32 v60, v60, v248
    v_mul_f32 v61, v61, v248
    v_mul_f32 v62, v62, v248
    v_mul_f32 v63, v63, v248
    v_mul_f32 v64, v64, v248
    v_mul_f32 v65, v65, v248
    v_mul_f32 v66, v66, v248
    v_mul_f32 v67, v67, v248
    v_mul_f32 v68, v68, v248
    v_mul_f32 v69, v69, v248
    v_mul_f32 v70, v70, v248
    v_mul_f32 v71, v71, v248
    v_mul_f32 v72, v72, v248
    v_mul_f32 v73, v73, v248
    v_mul_f32 v74, v74, v248
    v_mul_f32 v75, v75, v248
    v_mul_f32 v76, v76, v248
    v_mul_f32 v77, v77, v248
    v_mul_f32 v78, v78, v248
    v_mul_f32 v79, v79, v248
    v_mul_f32 v80, v80, v248
    v_mul_f32 v81, v81, v248
    v_mul_f32 v82, v82, v248
    v_mul_f32 v83, v83, v248
    v_mul_f32 v84, v84, v248
    v_mul_f32 v85, v85, v248
    v_mul_f32 v86, v86, v248
    v_mul_f32 v87, v87, v248
    v_mul_f32 v88, v88, v248
    v_mul_f32 v89, v89, v248
    v_mul_f32 v90, v90, v248
    v_mul_f32 v91, v91, v248
    v_mul_f32 v92, v92, v248
    v_mul_f32 v93, v93, v248
    v_mul_f32 v94, v94, v248
    v_mul_f32 v95, v95, v248
    v_mul_f32 v96, v96, v248
    v_mul_f32 v97, v97, v248
    v_mul_f32 v98, v98, v248
    v_mul_f32 v99, v99, v248
    v_mul_f32 v100, v100, v248
    v_mul_f32 v101, v101, v248
    v_mul_f32 v102, v102, v248
    v_mul_f32 v103, v103, v248
    v_mul_f32 v104, v104, v248
    v_mul_f32 v105, v105, v248
    v_mul_f32 v106, v106, v248
    v_mul_f32 v107, v107, v248
    v_mul_f32 v108, v108, v248
    v_mul_f32 v109, v109, v248
    v_mul_f32 v110, v110, v248
    v_mul_f32 v111, v111, v248
    v_mul_f32 v112, v112, v248
    v_mul_f32 v113, v113, v248
    v_mul_f32 v114, v114, v248
    v_mul_f32 v115, v115, v248
    v_mul_f32 v116, v116, v248
    v_mul_f32 v117, v117, v248
    v_mul_f32 v118, v118, v248
    v_mul_f32 v119, v119, v248
    v_mul_f32 v120, v120, v248
    v_mul_f32 v121, v121, v248
    v_mul_f32 v122, v122, v248
    v_mul_f32 v123, v123, v248
    v_mul_f32 v124, v124, v248
    v_mul_f32 v125, v125, v248
    v_mul_f32 v126, v126, v248
    v_mul_f32 v127, v127, v248
    v_max3_f32 v247, v144, v145, v146
    v_max3_f32 v247, v247, v147, v148
    v_max3_f32 v247, v247, v149, v150
    v_max3_f32 v247, v247, v151, v152
    v_max3_f32 v247, v247, v153, v154
    v_max3_f32 v247, v247, v155, v156
    v_max3_f32 v247, v247, v157, v158
    v_max_f32 v247, v247, v159
    v_mov_b32 v245, v247
    s_nop 1
    v_permlane32_swap_b32 v245, v247
    s_nop 0
    v_max_f32 v247, v247, v245
    v_mul_f32 v247, s30, v247
    v_min_f32 v247, v247, v240
    v_sub_f32 v248, v247, v240
    v_exp_f32 v248, v248
    v_mov_b32 v240, v247
    v_mul_f32 v242, v242, v248
    v_accvgpr_read_b32 v245, a0
    v_mul_f32 v245, v245, v248
    v_accvgpr_write_b32 a0, v245
    v_accvgpr_read_b32 v245, a1
    v_mul_f32 v245, v245, v248
    v_accvgpr_write_b32 a1, v245
    v_accvgpr_read_b32 v245, a2
    v_mul_f32 v245, v245, v248
    v_accvgpr_write_b32 a2, v245
    v_accvgpr_read_b32 v245, a3
    v_mul_f32 v245, v245, v248
    v_accvgpr_write_b32 a3, v245
    v_accvgpr_read_b32 v245, a4
    v_mul_f32 v245, v245, v248
    v_accvgpr_write_b32 a4, v245
    v_accvgpr_read_b32 v245, a5
    v_mul_f32 v245, v245, v248
    v_accvgpr_write_b32 a5, v245
    v_accvgpr_read_b32 v245, a6
    v_mul_f32 v245, v245, v248
    v_accvgpr_write_b32 a6, v245
    v_accvgpr_read_b32 v245, a7
    v_mul_f32 v245, v245, v248
    v_accvgpr_write_b32 a7, v245
    v_accvgpr_read_b32 v245, a8
    v_mul_f32 v245, v245, v248
    v_accvgpr_write_b32 a8, v245
    v_accvgpr_read_b32 v245, a9
    v_mul_f32 v245, v245, v248
    v_accvgpr_write_b32 a9, v245
    v_accvgpr_read_b32 v245, a10
    v_mul_f32 v245, v245, v248
    v_accvgpr_write_b32 a10, v245
    v_accvgpr_read_b32 v245, a11
    v_mul_f32 v245, v245, v248
    v_accvgpr_write_b32 a11, v245
    v_accvgpr_read_b32 v245, a12
    v_mul_f32 v245, v245, v248
    v_accvgpr_write_b32 a12, v245
    v_accvgpr_read_b32 v245, a13
    v_mul_f32 v245, v245, v248
    v_accvgpr_write_b32 a13, v245
    v_accvgpr_read_b32 v245, a14
    v_mul_f32 v245, v245, v248
    v_accvgpr_write_b32 a14, v245
    v_accvgpr_read_b32 v245, a15
    v_mul_f32 v245, v245, v248
    v_accvgpr_write_b32 a15, v245
    v_accvgpr_read_b32 v245, a16
    v_mul_f32 v245, v245, v248
    v_accvgpr_write_b32 a16, v245
    v_accvgpr_read_b32 v245, a17
    v_mul_f32 v245, v245, v248
    v_accvgpr_write_b32 a17, v245
    v_accvgpr_read_b32 v245, a18
    v_mul_f32 v245, v245, v248
    v_accvgpr_write_b32 a18, v245
    v_accvgpr_read_b32 v245, a19
    v_mul_f32 v245, v245, v248
    v_accvgpr_write_b32 a19, v245
    v_accvgpr_read_b32 v245, a20
    v_mul_f32 v245, v245, v248
    v_accvgpr_write_b32 a20, v245
    v_accvgpr_read_b32 v245, a21
    v_mul_f32 v245, v245, v248
    v_accvgpr_write_b32 a21, v245
    v_accvgpr_read_b32 v245, a22
    v_mul_f32 v245, v245, v248
    v_accvgpr_write_b32 a22, v245
    v_accvgpr_read_b32 v245, a23
    v_mul_f32 v245, v245, v248
    v_accvgpr_write_b32 a23, v245
    v_accvgpr_read_b32 v245, a24
    v_mul_f32 v245, v245, v248
    v_accvgpr_write_b32 a24, v245
    v_accvgpr_read_b32 v245, a25
    v_mul_f32 v245, v245, v248
    v_accvgpr_write_b32 a25, v245
    v_accvgpr_read_b32 v245, a26
    v_mul_f32 v245, v245, v248
    v_accvgpr_write_b32 a26, v245
    v_accvgpr_read_b32 v245, a27
    v_mul_f32 v245, v245, v248
    v_accvgpr_write_b32 a27, v245
    v_accvgpr_read_b32 v245, a28
    v_mul_f32 v245, v245, v248
    v_accvgpr_write_b32 a28, v245
    v_accvgpr_read_b32 v245, a29
    v_mul_f32 v245, v245, v248
    v_accvgpr_write_b32 a29, v245
    v_accvgpr_read_b32 v245, a30
    v_mul_f32 v245, v245, v248
    v_accvgpr_write_b32 a30, v245
    v_accvgpr_read_b32 v245, a31
    v_mul_f32 v245, v245, v248
    v_accvgpr_write_b32 a31, v245
    v_accvgpr_read_b32 v245, a32
    v_mul_f32 v245, v245, v248
    v_accvgpr_write_b32 a32, v245
    v_accvgpr_read_b32 v245, a33
    v_mul_f32 v245, v245, v248
    v_accvgpr_write_b32 a33, v245
    v_accvgpr_read_b32 v245, a34
    v_mul_f32 v245, v245, v248
    v_accvgpr_write_b32 a34, v245
    v_accvgpr_read_b32 v245, a35
    v_mul_f32 v245, v245, v248
    v_accvgpr_write_b32 a35, v245
    v_accvgpr_read_b32 v245, a36
    v_mul_f32 v245, v245, v248
    v_accvgpr_write_b32 a36, v245
    v_accvgpr_read_b32 v245, a37
    v_mul_f32 v245, v245, v248
    v_accvgpr_write_b32 a37, v245
    v_accvgpr_read_b32 v245, a38
    v_mul_f32 v245, v245, v248
    v_accvgpr_write_b32 a38, v245
    v_accvgpr_read_b32 v245, a39
    v_mul_f32 v245, v245, v248
    v_accvgpr_write_b32 a39, v245
    v_accvgpr_read_b32 v245, a40
    v_mul_f32 v245, v245, v248
    v_accvgpr_write_b32 a40, v245
    v_accvgpr_read_b32 v245, a41
    v_mul_f32 v245, v245, v248
    v_accvgpr_write_b32 a41, v245
    v_accvgpr_read_b32 v245, a42
    v_mul_f32 v245, v245, v248
    v_accvgpr_write_b32 a42, v245
    v_accvgpr_read_b32 v245, a43
    v_mul_f32 v245, v245, v248
    v_accvgpr_write_b32 a43, v245
    v_accvgpr_read_b32 v245, a44
    v_mul_f32 v245, v245, v248
    v_accvgpr_write_b32 a44, v245
    v_accvgpr_read_b32 v245, a45
    v_mul_f32 v245, v245, v248
    v_accvgpr_write_b32 a45, v245
    v_accvgpr_read_b32 v245, a46
    v_mul_f32 v245, v245, v248
    v_accvgpr_write_b32 a46, v245
    v_accvgpr_read_b32 v245, a47
    v_mul_f32 v245, v245, v248
    v_accvgpr_write_b32 a47, v245
    v_accvgpr_read_b32 v245, a48
    v_mul_f32 v245, v245, v248
    v_accvgpr_write_b32 a48, v245
    v_accvgpr_read_b32 v245, a49
    v_mul_f32 v245, v245, v248
    v_accvgpr_write_b32 a49, v245
    v_accvgpr_read_b32 v245, a50
    v_mul_f32 v245, v245, v248
    v_accvgpr_write_b32 a50, v245
    v_accvgpr_read_b32 v245, a51
    v_mul_f32 v245, v245, v248
    v_accvgpr_write_b32 a51, v245
    v_accvgpr_read_b32 v245, a52
    v_mul_f32 v245, v245, v248
    v_accvgpr_write_b32 a52, v245
    v_accvgpr_read_b32 v245, a53
    v_mul_f32 v245, v245, v248
    v_accvgpr_write_b32 a53, v245
    v_accvgpr_read_b32 v245, a54
    v_mul_f32 v245, v245, v248
    v_accvgpr_write_b32 a54, v245
    v_accvgpr_read_b32 v245, a55
    v_mul_f32 v245, v245, v248
    v_accvgpr_write_b32 a55, v245
    v_accvgpr_read_b32 v245, a56
    v_mul_f32 v245, v245, v248
    v_accvgpr_write_b32 a56, v245
    v_accvgpr_read_b32 v245, a57
    v_mul_f32 v245, v245, v248
    v_accvgpr_write_b32 a57, v245
    v_accvgpr_read_b32 v245, a58
    v_mul_f32 v245, v245, v248
    v_accvgpr_write_b32 a58, v245
    v_accvgpr_read_b32 v245, a59
    v_mul_f32 v245, v245, v248
    v_accvgpr_write_b32 a59, v245
    v_accvgpr_read_b32 v245, a60
    v_mul_f32 v245, v245, v248
    v_accvgpr_write_b32 a60, v245
    v_accvgpr_read_b32 v245, a61
    v_mul_f32 v245, v245, v248
    v_accvgpr_write_b32 a61, v245
    v_accvgpr_read_b32 v245, a62
    v_mul_f32 v245, v245, v248
    v_accvgpr_write_b32 a62, v245
    v_accvgpr_read_b32 v245, a63
    v_mul_f32 v245, v245, v248
    v_accvgpr_write_b32 a63, v245
    v_accvgpr_read_b32 v245, a64
    v_mul_f32 v245, v245, v248
    v_accvgpr_write_b32 a64, v245
    v_accvgpr_read_b32 v245, a65
    v_mul_f32 v245, v245, v248
    v_accvgpr_write_b32 a65, v245
    v_accvgpr_read_b32 v245, a66
    v_mul_f32 v245, v245, v248
    v_accvgpr_write_b32 a66, v245
    v_accvgpr_read_b32 v245, a67
    v_mul_f32 v245, v245, v248
    v_accvgpr_write_b32 a67, v245
    v_accvgpr_read_b32 v245, a68
    v_mul_f32 v245, v245, v248
    v_accvgpr_write_b32 a68, v245
    v_accvgpr_read_b32 v245, a69
    v_mul_f32 v245, v245, v248
    v_accvgpr_write_b32 a69, v245
    v_accvgpr_read_b32 v245, a70
    v_mul_f32 v245, v245, v248
    v_accvgpr_write_b32 a70, v245
    v_accvgpr_read_b32 v245, a71
    v_mul_f32 v245, v245, v248
    v_accvgpr_write_b32 a71, v245
    v_accvgpr_read_b32 v245, a72
    v_mul_f32 v245, v245, v248
    v_accvgpr_write_b32 a72, v245
    v_accvgpr_read_b32 v245, a73
    v_mul_f32 v245, v245, v248
    v_accvgpr_write_b32 a73, v245
    v_accvgpr_read_b32 v245, a74
    v_mul_f32 v245, v245, v248
    v_accvgpr_write_b32 a74, v245
    v_accvgpr_read_b32 v245, a75
    v_mul_f32 v245, v245, v248
    v_accvgpr_write_b32 a75, v245
    v_accvgpr_read_b32 v245, a76
    v_mul_f32 v245, v245, v248
    v_accvgpr_write_b32 a76, v245
    v_accvgpr_read_b32 v245, a77
    v_mul_f32 v245, v245, v248
    v_accvgpr_write_b32 a77, v245
    v_accvgpr_read_b32 v245, a78
    v_mul_f32 v245, v245, v248
    v_accvgpr_write_b32 a78, v245
    v_accvgpr_read_b32 v245, a79
    v_mul_f32 v245, v245, v248
    v_accvgpr_write_b32 a79, v245
    v_accvgpr_read_b32 v245, a80
    v_mul_f32 v245, v245, v248
    v_accvgpr_write_b32 a80, v245
    v_accvgpr_read_b32 v245, a81
    v_mul_f32 v245, v245, v248
    v_accvgpr_write_b32 a81, v245
    v_accvgpr_read_b32 v245, a82
    v_mul_f32 v245, v245, v248
    v_accvgpr_write_b32 a82, v245
    v_accvgpr_read_b32 v245, a83
    v_mul_f32 v245, v245, v248
    v_accvgpr_write_b32 a83, v245
    v_accvgpr_read_b32 v245, a84
    v_mul_f32 v245, v245, v248
    v_accvgpr_write_b32 a84, v245
    v_accvgpr_read_b32 v245, a85
    v_mul_f32 v245, v245, v248
    v_accvgpr_write_b32 a85, v245
    v_accvgpr_read_b32 v245, a86
    v_mul_f32 v245, v245, v248
    v_accvgpr_write_b32 a86, v245
    v_accvgpr_read_b32 v245, a87
    v_mul_f32 v245, v245, v248
    v_accvgpr_write_b32 a87, v245
    v_accvgpr_read_b32 v245, a88
    v_mul_f32 v245, v245, v248
    v_accvgpr_write_b32 a88, v245
    v_accvgpr_read_b32 v245, a89
    v_mul_f32 v245, v245, v248
    v_accvgpr_write_b32 a89, v245
    v_accvgpr_read_b32 v245, a90
    v_mul_f32 v245, v245, v248
    v_accvgpr_write_b32 a90, v245
    v_accvgpr_read_b32 v245, a91
    v_mul_f32 v245, v245, v248
    v_accvgpr_write_b32 a91, v245
    v_accvgpr_read_b32 v245, a92
    v_mul_f32 v245, v245, v248
    v_accvgpr_write_b32 a92, v245
    v_accvgpr_read_b32 v245, a93
    v_mul_f32 v245, v245, v248
    v_accvgpr_write_b32 a93, v245
    v_accvgpr_read_b32 v245, a94
    v_mul_f32 v245, v245, v248
    v_accvgpr_write_b32 a94, v245
    v_accvgpr_read_b32 v245, a95
    v_mul_f32 v245, v245, v248
    v_accvgpr_write_b32 a95, v245
    v_accvgpr_read_b32 v245, a96
    v_mul_f32 v245, v245, v248
    v_accvgpr_write_b32 a96, v245
    v_accvgpr_read_b32 v245, a97
    v_mul_f32 v245, v245, v248
    v_accvgpr_write_b32 a97, v245
    v_accvgpr_read_b32 v245, a98
    v_mul_f32 v245, v245, v248
    v_accvgpr_write_b32 a98, v245
    v_accvgpr_read_b32 v245, a99
    v_mul_f32 v245, v245, v248
    v_accvgpr_write_b32 a99, v245
    v_accvgpr_read_b32 v245, a100
    v_mul_f32 v245, v245, v248
    v_accvgpr_write_b32 a100, v245
    v_accvgpr_read_b32 v245, a101
    v_mul_f32 v245, v245, v248
    v_accvgpr_write_b32 a101, v245
    v_accvgpr_read_b32 v245, a102
    v_mul_f32 v245, v245, v248
    v_accvgpr_write_b32 a102, v245
    v_accvgpr_read_b32 v245, a103
    v_mul_f32 v245, v245, v248
    v_accvgpr_write_b32 a103, v245
    v_accvgpr_read_b32 v245, a104
    v_mul_f32 v245, v245, v248
    v_accvgpr_write_b32 a104, v245
    v_accvgpr_read_b32 v245, a105
    v_mul_f32 v245, v245, v248
    v_accvgpr_write_b32 a105, v245
    v_accvgpr_read_b32 v245, a106
    v_mul_f32 v245, v245, v248
    v_accvgpr_write_b32 a106, v245
    v_accvgpr_read_b32 v245, a107
    v_mul_f32 v245, v245, v248
    v_accvgpr_write_b32 a107, v245
    v_accvgpr_read_b32 v245, a108
    v_mul_f32 v245, v245, v248
    v_accvgpr_write_b32 a108, v245
    v_accvgpr_read_b32 v245, a109
    v_mul_f32 v245, v245, v248
    v_accvgpr_write_b32 a109, v245
    v_accvgpr_read_b32 v245, a110
    v_mul_f32 v245, v245, v248
    v_accvgpr_write_b32 a110, v245
    v_accvgpr_read_b32 v245, a111
    v_mul_f32 v245, v245, v248
    v_accvgpr_write_b32 a111, v245
    v_accvgpr_read_b32 v245, a112
    v_mul_f32 v245, v245, v248
    v_accvgpr_write_b32 a112, v245
    v_accvgpr_read_b32 v245, a113
    v_mul_f32 v245, v245, v248
    v_accvgpr_write_b32 a113, v245
    v_accvgpr_read_b32 v245, a114
    v_mul_f32 v245, v245, v248
    v_accvgpr_write_b32 a114, v245
    v_accvgpr_read_b32 v245, a115
    v_mul_f32 v245, v245, v248
    v_accvgpr_write_b32 a115, v245
    v_accvgpr_read_b32 v245, a116
    v_mul_f32 v245, v245, v248
    v_accvgpr_write_b32 a116, v245
    v_accvgpr_read_b32 v245, a117
    v_mul_f32 v245, v245, v248
    v_accvgpr_write_b32 a117, v245
    v_accvgpr_read_b32 v245, a118
    v_mul_f32 v245, v245, v248
    v_accvgpr_write_b32 a118, v245
    v_accvgpr_read_b32 v245, a119
    v_mul_f32 v245, v245, v248
    v_accvgpr_write_b32 a119, v245
    v_accvgpr_read_b32 v245, a120
    v_mul_f32 v245, v245, v248
    v_accvgpr_write_b32 a120, v245
    v_accvgpr_read_b32 v245, a121
    v_mul_f32 v245, v245, v248
    v_accvgpr_write_b32 a121, v245
    v_accvgpr_read_b32 v245, a122
    v_mul_f32 v245, v245, v248
    v_accvgpr_write_b32 a122, v245
    v_accvgpr_read_b32 v245, a123
    v_mul_f32 v245, v245, v248
    v_accvgpr_write_b32 a123, v245
    v_accvgpr_read_b32 v245, a124
    v_mul_f32 v245, v245, v248
    v_accvgpr_write_b32 a124, v245
    v_accvgpr_read_b32 v245, a125
    v_mul_f32 v245, v245, v248
    v_accvgpr_write_b32 a125, v245
    v_accvgpr_read_b32 v245, a126
    v_mul_f32 v245, v245, v248
    v_accvgpr_write_b32 a126, v245
    v_accvgpr_read_b32 v245, a127
    v_mul_f32 v245, v245, v248
    v_accvgpr_write_b32 a127, v245
    v_fma_f32 v232, v128, s21, v239
    s_nop 0
    v_fma_f32 v233, v129, s21, v239
    v_exp_f32 v232, v232
    s_nop 0
    v_fma_f32 v234, v130, s21, v239
    v_exp_f32 v233, v233
    s_nop 0
    v_fma_f32 v235, v131, s21, v239
    v_exp_f32 v234, v234
    v_add_f32 v243, v232, v233
    v_cvt_pk_bf16_f32 v192, v232, v233
    s_nop 0
    v_fma_f32 v232, v132, s21, v239
    v_exp_f32 v235, v235
    v_add_f32 v243, v243, v234
    s_nop 0
    v_fma_f32 v233, v133, s21, v239
    v_exp_f32 v232, v232
    v_add_f32 v243, v243, v235
    v_cvt_pk_bf16_f32 v193, v234, v235
    s_nop 0
    v_fma_f32 v234, v134, s21, v239
    v_exp_f32 v233, v233
    v_add_f32 v243, v243, v232
    s_nop 0
    v_fma_f32 v235, v135, s21, v239
    v_exp_f32 v234, v234
    v_add_f32 v243, v243, v233
    v_cvt_pk_bf16_f32 v194, v232, v233
    s_nop 0
    v_fma_f32 v232, v144, s21, v240
    v_exp_f32 v235, v235
    v_add_f32 v243, v243, v234
    s_nop 0
    v_fma_f32 v233, v145, s21, v240
    v_exp_f32 v232, v232
    v_add_f32 v243, v243, v235
    v_cvt_pk_bf16_f32 v195, v234, v235
    s_nop 0
    v_fma_f32 v234, v146, s21, v240
    v_exp_f32 v233, v233
    s_nop 0
    v_fma_f32 v235, v147, s21, v240
    v_exp_f32 v234, v234
    v_add_f32 v244, v232, v233
    v_cvt_pk_bf16_f32 v196, v232, v233
    s_nop 0
    v_fma_f32 v232, v148, s21, v240
    v_exp_f32 v235, v235
    v_add_f32 v244, v244, v234
    s_nop 0
    v_fma_f32 v233, v149, s21, v240
    v_exp_f32 v232, v232
    v_add_f32 v244, v244, v235
    v_cvt_pk_bf16_f32 v197, v234, v235
    s_nop 0
    v_fma_f32 v234, v150, s21, v240
    v_exp_f32 v233, v233
    v_add_f32 v244, v244, v232
    s_nop 0
    v_fma_f32 v235, v151, s21, v240
    v_exp_f32 v234, v234
    v_add_f32 v244, v244, v233
    v_cvt_pk_bf16_f32 v198, v232, v233
    s_nop 0
    v_fma_f32 v232, v136, s21, v239
    v_exp_f32 v235, v235
    v_add_f32 v244, v244, v234
    s_nop 0
    v_fma_f32 v233, v137, s21, v239
    v_exp_f32 v232, v232
    v_add_f32 v244, v244, v235
    v_cvt_pk_bf16_f32 v199, v234, v235
    s_nop 0
    v_fma_f32 v234, v138, s21, v239
    v_exp_f32 v233, v233
    v_add_f32 v243, v243, v232
    s_nop 0
    v_fma_f32 v235, v139, s21, v239
    v_exp_f32 v234, v234
    v_add_f32 v243, v243, v233
    v_cvt_pk_bf16_f32 v208, v232, v233
    s_nop 0
    v_fma_f32 v232, v140, s21, v239
    v_exp_f32 v235, v235
    v_add_f32 v243, v243, v234
    s_nop 0
    v_fma_f32 v233, v141, s21, v239
    v_exp_f32 v232, v232
    v_add_f32 v243, v243, v235
    v_cvt_pk_bf16_f32 v209, v234, v235
    s_nop 0
    v_fma_f32 v234, v142, s21, v239
    v_exp_f32 v233, v233
    v_add_f32 v243, v243, v232
    s_nop 0
    v_fma_f32 v235, v143, s21, v239
    v_exp_f32 v234, v234
    v_add_f32 v243, v243, v233
    v_cvt_pk_bf16_f32 v210, v232, v233
    s_nop 0
    v_fma_f32 v232, v152, s21, v240
    v_exp_f32 v235, v235
    v_add_f32 v243, v243, v234
    s_nop 0
    v_fma_f32 v233, v153, s21, v240
    v_exp_f32 v232, v232
    v_add_f32 v243, v243, v235
    v_cvt_pk_bf16_f32 v211, v234, v235
    s_nop 0
    v_fma_f32 v234, v154, s21, v240
    v_exp_f32 v233, v233
    v_add_f32 v244, v244, v232
    s_nop 0
    v_fma_f32 v235, v155, s21, v240
    v_exp_f32 v234, v234
    v_add_f32 v244, v244, v233
    v_cvt_pk_bf16_f32 v212, v232, v233
    s_nop 0
    v_fma_f32 v232, v156, s21, v240
    v_exp_f32 v235, v235
    v_add_f32 v244, v244, v234
    s_nop 0
    v_fma_f32 v233, v157, s21, v240
    v_exp_f32 v232, v232
    v_add_f32 v244, v244, v235
    v_cvt_pk_bf16_f32 v213, v234, v235
    s_nop 0
    v_fma_f32 v234, v158, s21, v240
    v_exp_f32 v233, v233
    v_add_f32 v244, v244, v232
    s_nop 0
    v_fma_f32 v235, v159, s21, v240
    v_exp_f32 v234, v234
    v_add_f32 v244, v244, v233
    v_cvt_pk_bf16_f32 v214, v232, v233
    s_nop 0
    v_exp_f32 v235, v235
    v_add_f32 v244, v244, v234
    s_nop 0
    v_add_f32 v244, v244, v235
    v_cvt_pk_bf16_f32 v215, v234, v235
    s_nop 0
    s_nop 3
    s_branch L_backl0A
L_rarel1A:
    s_nop 7
    v_max3_f32 v247, v160, v161, v162
    v_max3_f32 v247, v247, v163, v164
    v_max3_f32 v247, v247, v165, v166
    v_max3_f32 v247, v247, v167, v168
    v_max3_f32 v247, v247, v169, v170
    v_max3_f32 v247, v247, v171, v172
    v_max3_f32 v247, v247, v173, v174
    v_max_f32 v247, v247, v175
    v_mov_b32 v245, v247
    s_nop 1
    v_permlane32_swap_b32 v245, v247
    s_nop 0
    v_max_f32 v247, v247, v245
    v_mul_f32 v247, s30, v247
    v_min_f32 v247, v247, v239
    v_sub_f32 v248, v247, v239
    v_exp_f32 v248, v248
    v_mov_b32 v239, v247
    v_mul_f32 v241, v241, v248
    v_mul_f32 v0, v0, v248
    v_mul_f32 v1, v1, v248
    v_mul_f32 v2, v2, v248
    v_mul_f32 v3, v3, v248
    v_mul_f32 v4, v4, v248
    v_mul_f32 v5, v5, v248
    v_mul_f32 v6, v6, v248
    v_mul_f32 v7, v7, v248
    v_mul_f32 v8, v8, v248
    v_mul_f32 v9, v9, v248
    v_mul_f32 v10, v10, v248
    v_mul_f32 v11, v11, v248
    v_mul_f32 v12, v12, v248
    v_mul_f32 v13, v13, v248
    v_mul_f32 v14, v14, v248
    v_mul_f32 v15, v15, v248
    v_mul_f32 v16, v16, v248
    v_mul_f32 v17, v17, v248
    v_mul_f32 v18, v18, v248
    v_mul_f32 v19, v19, v248
    v_mul_f32 v20, v20, v248
    v_mul_f32 v21, v21, v248
    v_mul_f32 v22, v22, v248
    v_mul_f32 v23, v23, v248
    v_mul_f32 v24, v24, v248
    v_mul_f32 v25, v25, v248
    v_mul_f32 v26, v26, v248
    v_mul_f32 v27, v27, v248
    v_mul_f32 v28, v28, v248
    v_mul_f32 v29, v29, v248
    v_mul_f32 v30, v30, v248
    v_mul_f32 v31, v31, v248
    v_mul_f32 v32, v32, v248
    v_mul_f32 v33, v33, v248
    v_mul_f32 v34, v34, v248
    v_mul_f32 v35, v35, v248
    v_mul_f32 v36, v36, v248
    v_mul_f32 v37, v37, v248
    v_mul_f32 v38, v38, v248
    v_mul_f32 v39, v39, v248
    v_mul_f32 v40, v40, v248
    v_mul_f32 v41, v41, v248
    v_mul_f32 v42, v42, v248
    v_mul_f32 v43, v43, v248
    v_mul_f32 v44, v44, v248
    v_mul_f32 v45, v45, v248
    v_mul_f32 v46, v46, v248
    v_mul_f32 v47, v47, v248
    v_mul_f32 v48, v48, v248
    v_mul_f32 v49, v49, v248
    v_mul_f32 v50, v50, v248
    v_mul_f32 v51, v51, v248
    v_mul_f32 v52, v52, v248
    v_mul_f32 v53, v53, v248
    v_mul_f32 v54, v54, v248
    v_mul_f32 v55, v55, v248
    v_mul_f32 v56, v56, v248
    v_mul_f32 v57, v57, v248
    v_mul_f32 v58, v58, v248
    v_mul_f32 v59, v59, v248
    v_mul_f32 v60, v60, v248
    v_mul_f32 v61, v61, v248
    v_mul_f32 v62, v62, v248
    v_mul_f32 v63, v63, v248
    v_mul_f32 v64, v64, v248
    v_mul_f32 v65, v65, v248
    v_mul_f32 v66, v66, v248
    v_mul_f32 v67, v67, v248
    v_mul_f32 v68, v68, v248
    v_mul_f32 v69, v69, v248
    v_mul_f32 v70, v70, v248
    v_mul_f32 v71, v71, v248
    v_mul_f32 v72, v72, v248
    v_mul_f32 v73, v73, v248
    v_mul_f32 v74, v74, v248
    v_mul_f32 v75, v75, v248
    v_mul_f32 v76, v76, v248
    v_mul_f32 v77, v77, v248
    v_mul_f32 v78, v78, v248
    v_mul_f32 v79, v79, v248
    v_mul_f32 v80, v80, v248
    v_mul_f32 v81, v81, v248
    v_mul_f32 v82, v82, v248
    v_mul_f32 v83, v83, v248
    v_mul_f32 v84, v84, v248
    v_mul_f32 v85, v85, v248
    v_mul_f32 v86, v86, v248
    v_mul_f32 v87, v87, v248
    v_mul_f32 v88, v88, v248
    v_mul_f32 v89, v89, v248
    v_mul_f32 v90, v90, v248
    v_mul_f32 v91, v91, v248
    v_mul_f32 v92, v92, v248
    v_mul_f32 v93, v93, v248
    v_mul_f32 v94, v94, v248
    v_mul_f32 v95, v95, v248
    v_mul_f32 v96, v96, v248
    v_mul_f32 v97, v97, v248
    v_mul_f32 v98, v98, v248
    v_mul_f32 v99, v99, v248
    v_mul_f32 v100, v100, v248
    v_mul_f32 v101, v101, v248
    v_mul_f32 v102, v102, v248
    v_mul_f32 v103, v103, v248
    v_mul_f32 v104, v104, v248
    v_mul_f32 v105, v105, v248
    v_mul_f32 v106, v106, v248
    v_mul_f32 v107, v107, v248
    v_mul_f32 v108, v108, v248
    v_mul_f32 v109, v109, v248
    v_mul_f32 v110, v110, v248
    v_mul_f32 v111, v111, v248
    v_mul_f32 v112, v112, v248
    v_mul_f32 v113, v113, v248
    v_mul_f32 v114, v114, v248
    v_mul_f32 v115, v115, v248
    v_mul_f32 v116, v116, v248
    v_mul_f32 v117, v117, v248
    v_mul_f32 v118, v118, v248
    v_mul_f32 v119, v119, v248
    v_mul_f32 v120, v120, v248
    v_mul_f32 v121, v121, v248
    v_mul_f32 v122, v122, v248
    v_mul_f32 v123, v123, v248
    v_mul_f32 v124, v124, v248
    v_mul_f32 v125, v125, v248
    v_mul_f32 v126, v126, v248
    v_mul_f32 v127, v127, v248
    v_max3_f32 v247, v176, v177, v178
    v_max3_f32 v247, v247, v179, v180
    v_max3_f32 v247, v247, v181, v182
    v_max3_f32 v247, v247, v183, v184
    v_max3_f32 v247, v247, v185, v186
    v_max3_f32 v247, v247, v187, v188
    v_max3_f32 v247, v247, v189, v190
    v_max_f32 v247, v247, v191
    v_mov_b32 v245, v247
    s_nop 1
    v_permlane32_swap_b32 v245, v247
    s_nop 0
    v_max_f32 v247, v247, v245
    v_mul_f32 v247, s30, v247
    v_min_f32 v247, v247, v240
    v_sub_f32 v248, v247, v240
    v_exp_f32 v248, v248
    v_mov_b32 v240, v247
    v_mul_f32 v242, v242, v248
    v_accvgpr_read_b32 v245, a0
    v_mul_f32 v245, v245, v248
    v_accvgpr_write_b32 a0, v245
    v_accvgpr_read_b32 v245, a1
    v_mul_f32 v245, v245, v248
    v_accvgpr_write_b32 a1, v245
    v_accvgpr_read_b32 v245, a2
    v_mul_f32 v245, v245, v248
    v_accvgpr_write_b32 a2, v245
    v_accvgpr_read_b32 v245, a3
    v_mul_f32 v245, v245, v248
    v_accvgpr_write_b32 a3, v245
    v_accvgpr_read_b32 v245, a4
    v_mul_f32 v245, v245, v248
    v_accvgpr_write_b32 a4, v245
    v_accvgpr_read_b32 v245, a5
    v_mul_f32 v245, v245, v248
    v_accvgpr_write_b32 a5, v245
    v_accvgpr_read_b32 v245, a6
    v_mul_f32 v245, v245, v248
    v_accvgpr_write_b32 a6, v245
    v_accvgpr_read_b32 v245, a7
    v_mul_f32 v245, v245, v248
    v_accvgpr_write_b32 a7, v245
    v_accvgpr_read_b32 v245, a8
    v_mul_f32 v245, v245, v248
    v_accvgpr_write_b32 a8, v245
    v_accvgpr_read_b32 v245, a9
    v_mul_f32 v245, v245, v248
    v_accvgpr_write_b32 a9, v245
    v_accvgpr_read_b32 v245, a10
    v_mul_f32 v245, v245, v248
    v_accvgpr_write_b32 a10, v245
    v_accvgpr_read_b32 v245, a11
    v_mul_f32 v245, v245, v248
    v_accvgpr_write_b32 a11, v245
    v_accvgpr_read_b32 v245, a12
    v_mul_f32 v245, v245, v248
    v_accvgpr_write_b32 a12, v245
    v_accvgpr_read_b32 v245, a13
    v_mul_f32 v245, v245, v248
    v_accvgpr_write_b32 a13, v245
    v_accvgpr_read_b32 v245, a14
    v_mul_f32 v245, v245, v248
    v_accvgpr_write_b32 a14, v245
    v_accvgpr_read_b32 v245, a15
    v_mul_f32 v245, v245, v248
    v_accvgpr_write_b32 a15, v245
    v_accvgpr_read_b32 v245, a16
    v_mul_f32 v245, v245, v248
    v_accvgpr_write_b32 a16, v245
    v_accvgpr_read_b32 v245, a17
    v_mul_f32 v245, v245, v248
    v_accvgpr_write_b32 a17, v245
    v_accvgpr_read_b32 v245, a18
    v_mul_f32 v245, v245, v248
    v_accvgpr_write_b32 a18, v245
    v_accvgpr_read_b32 v245, a19
    v_mul_f32 v245, v245, v248
    v_accvgpr_write_b32 a19, v245
    v_accvgpr_read_b32 v245, a20
    v_mul_f32 v245, v245, v248
    v_accvgpr_write_b32 a20, v245
    v_accvgpr_read_b32 v245, a21
    v_mul_f32 v245, v245, v248
    v_accvgpr_write_b32 a21, v245
    v_accvgpr_read_b32 v245, a22
    v_mul_f32 v245, v245, v248
    v_accvgpr_write_b32 a22, v245
    v_accvgpr_read_b32 v245, a23
    v_mul_f32 v245, v245, v248
    v_accvgpr_write_b32 a23, v245
    v_accvgpr_read_b32 v245, a24
    v_mul_f32 v245, v245, v248
    v_accvgpr_write_b32 a24, v245
    v_accvgpr_read_b32 v245, a25
    v_mul_f32 v245, v245, v248
    v_accvgpr_write_b32 a25, v245
    v_accvgpr_read_b32 v245, a26
    v_mul_f32 v245, v245, v248
    v_accvgpr_write_b32 a26, v245
    v_accvgpr_read_b32 v245, a27
    v_mul_f32 v245, v245, v248
    v_accvgpr_write_b32 a27, v245
    v_accvgpr_read_b32 v245, a28
    v_mul_f32 v245, v245, v248
    v_accvgpr_write_b32 a28, v245
    v_accvgpr_read_b32 v245, a29
    v_mul_f32 v245, v245, v248
    v_accvgpr_write_b32 a29, v245
    v_accvgpr_read_b32 v245, a30
    v_mul_f32 v245, v245, v248
    v_accvgpr_write_b32 a30, v245
    v_accvgpr_read_b32 v245, a31
    v_mul_f32 v245, v245, v248
    v_accvgpr_write_b32 a31, v245
    v_accvgpr_read_b32 v245, a32
    v_mul_f32 v245, v245, v248
    v_accvgpr_write_b32 a32, v245
    v_accvgpr_read_b32 v245, a33
    v_mul_f32 v245, v245, v248
    v_accvgpr_write_b32 a33, v245
    v_accvgpr_read_b32 v245, a34
    v_mul_f32 v245, v245, v248
    v_accvgpr_write_b32 a34, v245
    v_accvgpr_read_b32 v245, a35
    v_mul_f32 v245, v245, v248
    v_accvgpr_write_b32 a35, v245
    v_accvgpr_read_b32 v245, a36
    v_mul_f32 v245, v245, v248
    v_accvgpr_write_b32 a36, v245
    v_accvgpr_read_b32 v245, a37
    v_mul_f32 v245, v245, v248
    v_accvgpr_write_b32 a37, v245
    v_accvgpr_read_b32 v245, a38
    v_mul_f32 v245, v245, v248
    v_accvgpr_write_b32 a38, v245
    v_accvgpr_read_b32 v245, a39
    v_mul_f32 v245, v245, v248
    v_accvgpr_write_b32 a39, v245
    v_accvgpr_read_b32 v245, a40
    v_mul_f32 v245, v245, v248
    v_accvgpr_write_b32 a40, v245
    v_accvgpr_read_b32 v245, a41
    v_mul_f32 v245, v245, v248
    v_accvgpr_write_b32 a41, v245
    v_accvgpr_read_b32 v245, a42
    v_mul_f32 v245, v245, v248
    v_accvgpr_write_b32 a42, v245
    v_accvgpr_read_b32 v245, a43
    v_mul_f32 v245, v245, v248
    v_accvgpr_write_b32 a43, v245
    v_accvgpr_read_b32 v245, a44
    v_mul_f32 v245, v245, v248
    v_accvgpr_write_b32 a44, v245
    v_accvgpr_read_b32 v245, a45
    v_mul_f32 v245, v245, v248
    v_accvgpr_write_b32 a45, v245
    v_accvgpr_read_b32 v245, a46
    v_mul_f32 v245, v245, v248
    v_accvgpr_write_b32 a46, v245
    v_accvgpr_read_b32 v245, a47
    v_mul_f32 v245, v245, v248
    v_accvgpr_write_b32 a47, v245
    v_accvgpr_read_b32 v245, a48
    v_mul_f32 v245, v245, v248
    v_accvgpr_write_b32 a48, v245
    v_accvgpr_read_b32 v245, a49
    v_mul_f32 v245, v245, v248
    v_accvgpr_write_b32 a49, v245
    v_accvgpr_read_b32 v245, a50
    v_mul_f32 v245, v245, v248
    v_accvgpr_write_b32 a50, v245
    v_accvgpr_read_b32 v245, a51
    v_mul_f32 v245, v245, v248
    v_accvgpr_write_b32 a51, v245
    v_accvgpr_read_b32 v245, a52
    v_mul_f32 v245, v245, v248
    v_accvgpr_write_b32 a52, v245
    v_accvgpr_read_b32 v245, a53
    v_mul_f32 v245, v245, v248
    v_accvgpr_write_b32 a53, v245
    v_accvgpr_read_b32 v245, a54
    v_mul_f32 v245, v245, v248
    v_accvgpr_write_b32 a54, v245
    v_accvgpr_read_b32 v245, a55
    v_mul_f32 v245, v245, v248
    v_accvgpr_write_b32 a55, v245
    v_accvgpr_read_b32 v245, a56
    v_mul_f32 v245, v245, v248
    v_accvgpr_write_b32 a56, v245
    v_accvgpr_read_b32 v245, a57
    v_mul_f32 v245, v245, v248
    v_accvgpr_write_b32 a57, v245
    v_accvgpr_read_b32 v245, a58
    v_mul_f32 v245, v245, v248
    v_accvgpr_write_b32 a58, v245
    v_accvgpr_read_b32 v245, a59
    v_mul_f32 v245, v245, v248
    v_accvgpr_write_b32 a59, v245
    v_accvgpr_read_b32 v245, a60
    v_mul_f32 v245, v245, v248
    v_accvgpr_write_b32 a60, v245
    v_accvgpr_read_b32 v245, a61
    v_mul_f32 v245, v245, v248
    v_accvgpr_write_b32 a61, v245
    v_accvgpr_read_b32 v245, a62
    v_mul_f32 v245, v245, v248
    v_accvgpr_write_b32 a62, v245
    v_accvgpr_read_b32 v245, a63
    v_mul_f32 v245, v245, v248
    v_accvgpr_write_b32 a63, v245
    v_accvgpr_read_b32 v245, a64
    v_mul_f32 v245, v245, v248
    v_accvgpr_write_b32 a64, v245
    v_accvgpr_read_b32 v245, a65
    v_mul_f32 v245, v245, v248
    v_accvgpr_write_b32 a65, v245
    v_accvgpr_read_b32 v245, a66
    v_mul_f32 v245, v245, v248
    v_accvgpr_write_b32 a66, v245
    v_accvgpr_read_b32 v245, a67
    v_mul_f32 v245, v245, v248
    v_accvgpr_write_b32 a67, v245
    v_accvgpr_read_b32 v245, a68
    v_mul_f32 v245, v245, v248
    v_accvgpr_write_b32 a68, v245
    v_accvgpr_read_b32 v245, a69
    v_mul_f32 v245, v245, v248
    v_accvgpr_write_b32 a69, v245
    v_accvgpr_read_b32 v245, a70
    v_mul_f32 v245, v245, v248
    v_accvgpr_write_b32 a70, v245
    v_accvgpr_read_b32 v245, a71
    v_mul_f32 v245, v245, v248
    v_accvgpr_write_b32 a71, v245
    v_accvgpr_read_b32 v245, a72
    v_mul_f32 v245, v245, v248
    v_accvgpr_write_b32 a72, v245
    v_accvgpr_read_b32 v245, a73
    v_mul_f32 v245, v245, v248
    v_accvgpr_write_b32 a73, v245
    v_accvgpr_read_b32 v245, a74
    v_mul_f32 v245, v245, v248
    v_accvgpr_write_b32 a74, v245
    v_accvgpr_read_b32 v245, a75
    v_mul_f32 v245, v245, v248
    v_accvgpr_write_b32 a75, v245
    v_accvgpr_read_b32 v245, a76
    v_mul_f32 v245, v245, v248
    v_accvgpr_write_b32 a76, v245
    v_accvgpr_read_b32 v245, a77
    v_mul_f32 v245, v245, v248
    v_accvgpr_write_b32 a77, v245
    v_accvgpr_read_b32 v245, a78
    v_mul_f32 v245, v245, v248
    v_accvgpr_write_b32 a78, v245
    v_accvgpr_read_b32 v245, a79
    v_mul_f32 v245, v245, v248
    v_accvgpr_write_b32 a79, v245
    v_accvgpr_read_b32 v245, a80
    v_mul_f32 v245, v245, v248
    v_accvgpr_write_b32 a80, v245
    v_accvgpr_read_b32 v245, a81
    v_mul_f32 v245, v245, v248
    v_accvgpr_write_b32 a81, v245
    v_accvgpr_read_b32 v245, a82
    v_mul_f32 v245, v245, v248
    v_accvgpr_write_b32 a82, v245
    v_accvgpr_read_b32 v245, a83
    v_mul_f32 v245, v245, v248
    v_accvgpr_write_b32 a83, v245
    v_accvgpr_read_b32 v245, a84
    v_mul_f32 v245, v245, v248
    v_accvgpr_write_b32 a84, v245
    v_accvgpr_read_b32 v245, a85
    v_mul_f32 v245, v245, v248
    v_accvgpr_write_b32 a85, v245
    v_accvgpr_read_b32 v245, a86
    v_mul_f32 v245, v245, v248
    v_accvgpr_write_b32 a86, v245
    v_accvgpr_read_b32 v245, a87
    v_mul_f32 v245, v245, v248
    v_accvgpr_write_b32 a87, v245
    v_accvgpr_read_b32 v245, a88
    v_mul_f32 v245, v245, v248
    v_accvgpr_write_b32 a88, v245
    v_accvgpr_read_b32 v245, a89
    v_mul_f32 v245, v245, v248
    v_accvgpr_write_b32 a89, v245
    v_accvgpr_read_b32 v245, a90
    v_mul_f32 v245, v245, v248
    v_accvgpr_write_b32 a90, v245
    v_accvgpr_read_b32 v245, a91
    v_mul_f32 v245, v245, v248
    v_accvgpr_write_b32 a91, v245
    v_accvgpr_read_b32 v245, a92
    v_mul_f32 v245, v245, v248
    v_accvgpr_write_b32 a92, v245
    v_accvgpr_read_b32 v245, a93
    v_mul_f32 v245, v245, v248
    v_accvgpr_write_b32 a93, v245
    v_accvgpr_read_b32 v245, a94
    v_mul_f32 v245, v245, v248
    v_accvgpr_write_b32 a94, v245
    v_accvgpr_read_b32 v245, a95
    v_mul_f32 v245, v245, v248
    v_accvgpr_write_b32 a95, v245
    v_accvgpr_read_b32 v245, a96
    v_mul_f32 v245, v245, v248
    v_accvgpr_write_b32 a96, v245
    v_accvgpr_read_b32 v245, a97
    v_mul_f32 v245, v245, v248
    v_accvgpr_write_b32 a97, v245
    v_accvgpr_read_b32 v245, a98
    v_mul_f32 v245, v245, v248
    v_accvgpr_write_b32 a98, v245
    v_accvgpr_read_b32 v245, a99
    v_mul_f32 v245, v245, v248
    v_accvgpr_write_b32 a99, v245
    v_accvgpr_read_b32 v245, a100
    v_mul_f32 v245, v245, v248
    v_accvgpr_write_b32 a100, v245
    v_accvgpr_read_b32 v245, a101
    v_mul_f32 v245, v245, v248
    v_accvgpr_write_b32 a101, v245
    v_accvgpr_read_b32 v245, a102
    v_mul_f32 v245, v245, v248
    v_accvgpr_write_b32 a102, v245
    v_accvgpr_read_b32 v245, a103
    v_mul_f32 v245, v245, v248
    v_accvgpr_write_b32 a103, v245
    v_accvgpr_read_b32 v245, a104
    v_mul_f32 v245, v245, v248
    v_accvgpr_write_b32 a104, v245
    v_accvgpr_read_b32 v245, a105
    v_mul_f32 v245, v245, v248
    v_accvgpr_write_b32 a105, v245
    v_accvgpr_read_b32 v245, a106
    v_mul_f32 v245, v245, v248
    v_accvgpr_write_b32 a106, v245
    v_accvgpr_read_b32 v245, a107
    v_mul_f32 v245, v245, v248
    v_accvgpr_write_b32 a107, v245
    v_accvgpr_read_b32 v245, a108
    v_mul_f32 v245, v245, v248
    v_accvgpr_write_b32 a108, v245
    v_accvgpr_read_b32 v245, a109
    v_mul_f32 v245, v245, v248
    v_accvgpr_write_b32 a109, v245
    v_accvgpr_read_b32 v245, a110
    v_mul_f32 v245, v245, v248
    v_accvgpr_write_b32 a110, v245
    v_accvgpr_read_b32 v245, a111
    v_mul_f32 v245, v245, v248
    v_accvgpr_write_b32 a111, v245
    v_accvgpr_read_b32 v245, a112
    v_mul_f32 v245, v245, v248
    v_accvgpr_write_b32 a112, v245
    v_accvgpr_read_b32 v245, a113
    v_mul_f32 v245, v245, v248
    v_accvgpr_write_b32 a113, v245
    v_accvgpr_read_b32 v245, a114
    v_mul_f32 v245, v245, v248
    v_accvgpr_write_b32 a114, v245
    v_accvgpr_read_b32 v245, a115
    v_mul_f32 v245, v245, v248
    v_accvgpr_write_b32 a115, v245
    v_accvgpr_read_b32 v245, a116
    v_mul_f32 v245, v245, v248
    v_accvgpr_write_b32 a116, v245
    v_accvgpr_read_b32 v245, a117
    v_mul_f32 v245, v245, v248
    v_accvgpr_write_b32 a117, v245
    v_accvgpr_read_b32 v245, a118
    v_mul_f32 v245, v245, v248
    v_accvgpr_write_b32 a118, v245
    v_accvgpr_read_b32 v245, a119
    v_mul_f32 v245, v245, v248
    v_accvgpr_write_b32 a119, v245
    v_accvgpr_read_b32 v245, a120
    v_mul_f32 v245, v245, v248
    v_accvgpr_write_b32 a120, v245
    v_accvgpr_read_b32 v245, a121
    v_mul_f32 v245, v245, v248
    v_accvgpr_write_b32 a121, v245
    v_accvgpr_read_b32 v245, a122
    v_mul_f32 v245, v245, v248
    v_accvgpr_write_b32 a122, v245
    v_accvgpr_read_b32 v245, a123
    v_mul_f32 v245, v245, v248
    v_accvgpr_write_b32 a123, v245
    v_accvgpr_read_b32 v245, a124
    v_mul_f32 v245, v245, v248
    v_accvgpr_write_b32 a124, v245
    v_accvgpr_read_b32 v245, a125
    v_mul_f32 v245, v245, v248
    v_accvgpr_write_b32 a125, v245
    v_accvgpr_read_b32 v245, a126
    v_mul_f32 v245, v245, v248
    v_accvgpr_write_b32 a126, v245
    v_accvgpr_read_b32 v245, a127
    v_mul_f32 v245, v245, v248
    v_accvgpr_write_b32 a127, v245
    v_fma_f32 v232, v160, s21, v239
    s_nop 0
    v_fma_f32 v233, v161, s21, v239
    v_exp_f32 v232, v232
    s_nop 0
    v_fma_f32 v234, v162, s21, v239
    v_exp_f32 v233, v233
    s_nop 0
    v_fma_f32 v235, v163, s21, v239
    v_exp_f32 v234, v234
    v_add_f32 v243, v232, v233
    v_cvt_pk_bf16_f32 v200, v232, v233
    s_nop 0
    v_fma_f32 v232, v164, s21, v239
    v_exp_f32 v235, v235
    v_add_f32 v243, v243, v234
    s_nop 0
    v_fma_f32 v233, v165, s21, v239
    v_exp_f32 v232, v232
    v_add_f32 v243, v243, v235
    v_cvt_pk_bf16_f32 v201, v234, v235
    s_nop 0
    v_fma_f32 v234, v166, s21, v239
    v_exp_f32 v233, v233
    v_add_f32 v243, v243, v232
    s_nop 0
    v_fma_f32 v235, v167, s21, v239
    v_exp_f32 v234, v234
    v_add_f32 v243, v243, v233
    v_cvt_pk_bf16_f32 v202, v232, v233
    s_nop 0
    v_fma_f32 v232, v176, s21, v240
    v_exp_f32 v235, v235
    v_add_f32 v243, v243, v234
    s_nop 0
    v_fma_f32 v233, v177, s21, v240
    v_exp_f32 v232, v232
    v_add_f32 v243, v243, v235
    v_cvt_pk_bf16_f32 v203, v234, v235
    s_nop 0
    v_fma_f32 v234, v178, s21, v240
    v_exp_f32 v233, v233
    s_nop 0
    v_fma_f32 v235, v179, s21, v240
    v_exp_f32 v234, v234
    v_add_f32 v244, v232, v233
    v_cvt_pk_bf16_f32 v204, v232, v233
    s_nop 0
    v_fma_f32 v232, v180, s21, v240
    v_exp_f32 v235, v235
    v_add_f32 v244, v244, v234
    s_nop 0
    v_fma_f32 v233, v181, s21, v240
    v_exp_f32 v232, v232
    v_add_f32 v244, v244, v235
    v_cvt_pk_bf16_f32 v205, v234, v235
    s_nop 0
    v_fma_f32 v234, v182, s21, v240
    v_exp_f32 v233, v233
    v_add_f32 v244, v244, v232
    s_nop 0
    v_fma_f32 v235, v183, s21, v240
    v_exp_f32 v234, v234
    v_add_f32 v244, v244, v233
    v_cvt_pk_bf16_f32 v206, v232, v233
    s_nop 0
    v_fma_f32 v232, v168, s21, v239
    v_exp_f32 v235, v235
    v_add_f32 v244, v244, v234
    s_nop 0
    v_fma_f32 v233, v169, s21, v239
    v_exp_f32 v232, v232
    v_add_f32 v244, v244, v235
    v_cvt_pk_bf16_f32 v207, v234, v235
    s_nop 0
    v_fma_f32 v234, v170, s21, v239
    v_exp_f32 v233, v233
    v_add_f32 v243, v243, v232
    s_nop 0
    v_fma_f32 v235, v171, s21, v239
    v_exp_f32 v234, v234
    v_add_f32 v243, v243, v233
    v_cvt_pk_bf16_f32 v208, v232, v233
    s_nop 0
    v_fma_f32 v232, v172, s21, v239
    v_exp_f32 v235, v235
    v_add_f32 v243, v243, v234
    s_nop 0
    v_fma_f32 v233, v173, s21, v239
    v_exp_f32 v232, v232
    v_add_f32 v243, v243, v235
    v_cvt_pk_bf16_f32 v209, v234, v235
    s_nop 0
    v_fma_f32 v234, v174, s21, v239
    v_exp_f32 v233, v233
    v_add_f32 v243, v243, v232
    s_nop 0
    v_fma_f32 v235, v175, s21, v239
    v_exp_f32 v234, v234
    v_add_f32 v243, v243, v233
    v_cvt_pk_bf16_f32 v210, v232, v233
    s_nop 0
    v_fma_f32 v232, v184, s21, v240
    v_exp_f32 v235, v235
    v_add_f32 v243, v243, v234
    s_nop 0
    v_fma_f32 v233, v185, s21, v240
    v_exp_f32 v232, v232
    v_add_f32 v243, v243, v235
    v_cvt_pk_bf16_f32 v211, v234, v235
    s_nop 0
    v_fma_f32 v234, v186, s21, v240
    v_exp_f32 v233, v233
    v_add_f32 v244, v244, v232
    s_nop 0
    v_fma_f32 v235, v187, s21, v240
    v_exp_f32 v234, v234
    v_add_f32 v244, v244, v233
    v_cvt_pk_bf16_f32 v212, v232, v233
    s_nop 0
    v_fma_f32 v232, v188, s21, v240
    v_exp_f32 v235, v235
    v_add_f32 v244, v244, v234
    s_nop 0
    v_fma_f32 v233, v189, s21, v240
    v_exp_f32 v232, v232
    v_add_f32 v244, v244, v235
    v_cvt_pk_bf16_f32 v213, v234, v235
    s_nop 0
    v_fma_f32 v234, v190, s21, v240
    v_exp_f32 v233, v233
    v_add_f32 v244, v244, v232
    s_nop 0
    v_fma_f32 v235, v191, s21, v240
    v_exp_f32 v234, v234
    v_add_f32 v244, v244, v233
    v_cvt_pk_bf16_f32 v214, v232, v233
    s_nop 0
    v_exp_f32 v235, v235
    v_add_f32 v244, v244, v234
    s_nop 0
    v_add_f32 v244, v244, v235
    v_cvt_pk_bf16_f32 v215, v234, v235
    s_nop 0
    s_nop 3
    s_branch L_backl1A
L_rares14A:
    s_nop 7
    v_max3_f32 v247, v128, v129, v130
    v_max3_f32 v247, v247, v131, v132
    v_max3_f32 v247, v247, v133, v134
    v_max3_f32 v247, v247, v135, v136
    v_max3_f32 v247, v247, v137, v138
    v_max3_f32 v247, v247, v139, v140
    v_max3_f32 v247, v247, v141, v142
    v_max_f32 v247, v247, v143
    v_mov_b32 v245, v247
    s_nop 1
    v_permlane32_swap_b32 v245, v247
    s_nop 0
    v_max_f32 v247, v247, v245
    v_mul_f32 v247, s30, v247
    v_min_f32 v247, v247, v239
    v_sub_f32 v248, v247, v239
    v_exp_f32 v248, v248
    v_mov_b32 v239, v247
    v_mul_f32 v241, v241, v248
    v_mul_f32 v0, v0, v248
    v_mul_f32 v1, v1, v248
    v_mul_f32 v2, v2, v248
    v_mul_f32 v3, v3, v248
    v_mul_f32 v4, v4, v248
    v_mul_f32 v5, v5, v248
    v_mul_f32 v6, v6, v248
    v_mul_f32 v7, v7, v248
    v_mul_f32 v8, v8, v248
    v_mul_f32 v9, v9, v248
    v_mul_f32 v10, v10, v248
    v_mul_f32 v11, v11, v248
    v_mul_f32 v12, v12, v248
    v_mul_f32 v13, v13, v248
    v_mul_f32 v14, v14, v248
    v_mul_f32 v15, v15, v248
    v_mul_f32 v16, v16, v248
    v_mul_f32 v17, v17, v248
    v_mul_f32 v18, v18, v248
    v_mul_f32 v19, v19, v248
    v_mul_f32 v20, v20, v248
    v_mul_f32 v21, v21, v248
    v_mul_f32 v22, v22, v248
    v_mul_f32 v23, v23, v248
    v_mul_f32 v24, v24, v248
    v_mul_f32 v25, v25, v248
    v_mul_f32 v26, v26, v248
    v_mul_f32 v27, v27, v248
    v_mul_f32 v28, v28, v248
    v_mul_f32 v29, v29, v248
    v_mul_f32 v30, v30, v248
    v_mul_f32 v31, v31, v248
    v_mul_f32 v32, v32, v248
    v_mul_f32 v33, v33, v248
    v_mul_f32 v34, v34, v248
    v_mul_f32 v35, v35, v248
    v_mul_f32 v36, v36, v248
    v_mul_f32 v37, v37, v248
    v_mul_f32 v38, v38, v248
    v_mul_f32 v39, v39, v248
    v_mul_f32 v40, v40, v248
    v_mul_f32 v41, v41, v248
    v_mul_f32 v42, v42, v248
    v_mul_f32 v43, v43, v248
    v_mul_f32 v44, v44, v248
    v_mul_f32 v45, v45, v248
    v_mul_f32 v46, v46, v248
    v_mul_f32 v47, v47, v248
    v_mul_f32 v48, v48, v248
    v_mul_f32 v49, v49, v248
    v_mul_f32 v50, v50, v248
    v_mul_f32 v51, v51, v248
    v_mul_f32 v52, v52, v248
    v_mul_f32 v53, v53, v248
    v_mul_f32 v54, v54, v248
    v_mul_f32 v55, v55, v248
    v_mul_f32 v56, v56, v248
    v_mul_f32 v57, v57, v248
    v_mul_f32 v58, v58, v248
    v_mul_f32 v59, v59, v248
    v_mul_f32 v60, v60, v248
    v_mul_f32 v61, v61, v248
    v_mul_f32 v62, v62, v248
    v_mul_f32 v63, v63, v248
    v_mul_f32 v64, v64, v248
    v_mul_f32 v65, v65, v248
    v_mul_f32 v66, v66, v248
    v_mul_f32 v67, v67, v248
    v_mul_f32 v68, v68, v248
    v_mul_f32 v69, v69, v248
    v_mul_f32 v70, v70, v248
    v_mul_f32 v71, v71, v248
    v_mul_f32 v72, v72, v248
    v_mul_f32 v73, v73, v248
    v_mul_f32 v74, v74, v248
    v_mul_f32 v75, v75, v248
    v_mul_f32 v76, v76, v248
    v_mul_f32 v77, v77, v248
    v_mul_f32 v78, v78, v248
    v_mul_f32 v79, v79, v248
    v_mul_f32 v80, v80, v248
    v_mul_f32 v81, v81, v248
    v_mul_f32 v82, v82, v248
    v_mul_f32 v83, v83, v248
    v_mul_f32 v84, v84, v248
    v_mul_f32 v85, v85, v248
    v_mul_f32 v86, v86, v248
    v_mul_f32 v87, v87, v248
    v_mul_f32 v88, v88, v248
    v_mul_f32 v89, v89, v248
    v_mul_f32 v90, v90, v248
    v_mul_f32 v91, v91, v248
    v_mul_f32 v92, v92, v248
    v_mul_f32 v93, v93, v248
    v_mul_f32 v94, v94, v248
    v_mul_f32 v95, v95, v248
    v_mul_f32 v96, v96, v248
    v_mul_f32 v97, v97, v248
    v_mul_f32 v98, v98, v248
    v_mul_f32 v99, v99, v248
    v_mul_f32 v100, v100, v248
    v_mul_f32 v101, v101, v248
    v_mul_f32 v102, v102, v248
    v_mul_f32 v103, v103, v248
    v_mul_f32 v104, v104, v248
    v_mul_f32 v105, v105, v248
    v_mul_f32 v106, v106, v248
    v_mul_f32 v107, v107, v248
    v_mul_f32 v108, v108, v248
    v_mul_f32 v109, v109, v248
    v_mul_f32 v110, v110, v248
    v_mul_f32 v111, v111, v248
    v_mul_f32 v112, v112, v248
    v_mul_f32 v113, v113, v248
    v_mul_f32 v114, v114, v248
    v_mul_f32 v115, v115, v248
    v_mul_f32 v116, v116, v248
    v_mul_f32 v117, v117, v248
    v_mul_f32 v118, v118, v248
    v_mul_f32 v119, v119, v248
    v_mul_f32 v120, v120, v248
    v_mul_f32 v121, v121, v248
    v_mul_f32 v122, v122, v248
    v_mul_f32 v123, v123, v248
    v_mul_f32 v124, v124, v248
    v_mul_f32 v125, v125, v248
    v_mul_f32 v126, v126, v248
    v_mul_f32 v127, v127, v248
    v_max3_f32 v247, v144, v145, v146
    v_max3_f32 v247, v247, v147, v148
    v_max3_f32 v247, v247, v149, v150
    v_max3_f32 v247, v247, v151, v152
    v_max3_f32 v247, v247, v153, v154
    v_max3_f32 v247, v247, v155, v156
    v_max3_f32 v247, v247, v157, v158
    v_max_f32 v247, v247, v159
    v_mov_b32 v245, v247
    s_nop 1
    v_permlane32_swap_b32 v245, v247
    s_nop 0
    v_max_f32 v247, v247, v245
    v_mul_f32 v247, s30, v247
    v_min_f32 v247, v247, v240
    v_sub_f32 v248, v247, v240
    v_exp_f32 v248, v248
    v_mov_b32 v240, v247
    v_mul_f32 v242, v242, v248
    v_accvgpr_read_b32 v245, a0
    v_mul_f32 v245, v245, v248
    v_accvgpr_write_b32 a0, v245
    v_accvgpr_read_b32 v245, a1
    v_mul_f32 v245, v245, v248
    v_accvgpr_write_b32 a1, v245
    v_accvgpr_read_b32 v245, a2
    v_mul_f32 v245, v245, v248
    v_accvgpr_write_b32 a2, v245
    v_accvgpr_read_b32 v245, a3
    v_mul_f32 v245, v245, v248
    v_accvgpr_write_b32 a3, v245
    v_accvgpr_read_b32 v245, a4
    v_mul_f32 v245, v245, v248
    v_accvgpr_write_b32 a4, v245
    v_accvgpr_read_b32 v245, a5
    v_mul_f32 v245, v245, v248
    v_accvgpr_write_b32 a5, v245
    v_accvgpr_read_b32 v245, a6
    v_mul_f32 v245, v245, v248
    v_accvgpr_write_b32 a6, v245
    v_accvgpr_read_b32 v245, a7
    v_mul_f32 v245, v245, v248
    v_accvgpr_write_b32 a7, v245
    v_accvgpr_read_b32 v245, a8
    v_mul_f32 v245, v245, v248
    v_accvgpr_write_b32 a8, v245
    v_accvgpr_read_b32 v245, a9
    v_mul_f32 v245, v245, v248
    v_accvgpr_write_b32 a9, v245
    v_accvgpr_read_b32 v245, a10
    v_mul_f32 v245, v245, v248
    v_accvgpr_write_b32 a10, v245
    v_accvgpr_read_b32 v245, a11
    v_mul_f32 v245, v245, v248
    v_accvgpr_write_b32 a11, v245
    v_accvgpr_read_b32 v245, a12
    v_mul_f32 v245, v245, v248
    v_accvgpr_write_b32 a12, v245
    v_accvgpr_read_b32 v245, a13
    v_mul_f32 v245, v245, v248
    v_accvgpr_write_b32 a13, v245
    v_accvgpr_read_b32 v245, a14
    v_mul_f32 v245, v245, v248
    v_accvgpr_write_b32 a14, v245
    v_accvgpr_read_b32 v245, a15
    v_mul_f32 v245, v245, v248
    v_accvgpr_write_b32 a15, v245
    v_accvgpr_read_b32 v245, a16
    v_mul_f32 v245, v245, v248
    v_accvgpr_write_b32 a16, v245
    v_accvgpr_read_b32 v245, a17
    v_mul_f32 v245, v245, v248
    v_accvgpr_write_b32 a17, v245
    v_accvgpr_read_b32 v245, a18
    v_mul_f32 v245, v245, v248
    v_accvgpr_write_b32 a18, v245
    v_accvgpr_read_b32 v245, a19
    v_mul_f32 v245, v245, v248
    v_accvgpr_write_b32 a19, v245
    v_accvgpr_read_b32 v245, a20
    v_mul_f32 v245, v245, v248
    v_accvgpr_write_b32 a20, v245
    v_accvgpr_read_b32 v245, a21
    v_mul_f32 v245, v245, v248
    v_accvgpr_write_b32 a21, v245
    v_accvgpr_read_b32 v245, a22
    v_mul_f32 v245, v245, v248
    v_accvgpr_write_b32 a22, v245
    v_accvgpr_read_b32 v245, a23
    v_mul_f32 v245, v245, v248
    v_accvgpr_write_b32 a23, v245
    v_accvgpr_read_b32 v245, a24
    v_mul_f32 v245, v245, v248
    v_accvgpr_write_b32 a24, v245
    v_accvgpr_read_b32 v245, a25
    v_mul_f32 v245, v245, v248
    v_accvgpr_write_b32 a25, v245
    v_accvgpr_read_b32 v245, a26
    v_mul_f32 v245, v245, v248
    v_accvgpr_write_b32 a26, v245
    v_accvgpr_read_b32 v245, a27
    v_mul_f32 v245, v245, v248
    v_accvgpr_write_b32 a27, v245
    v_accvgpr_read_b32 v245, a28
    v_mul_f32 v245, v245, v248
    v_accvgpr_write_b32 a28, v245
    v_accvgpr_read_b32 v245, a29
    v_mul_f32 v245, v245, v248
    v_accvgpr_write_b32 a29, v245
    v_accvgpr_read_b32 v245, a30
    v_mul_f32 v245, v245, v248
    v_accvgpr_write_b32 a30, v245
    v_accvgpr_read_b32 v245, a31
    v_mul_f32 v245, v245, v248
    v_accvgpr_write_b32 a31, v245
    v_accvgpr_read_b32 v245, a32
    v_mul_f32 v245, v245, v248
    v_accvgpr_write_b32 a32, v245
    v_accvgpr_read_b32 v245, a33
    v_mul_f32 v245, v245, v248
    v_accvgpr_write_b32 a33, v245
    v_accvgpr_read_b32 v245, a34
    v_mul_f32 v245, v245, v248
    v_accvgpr_write_b32 a34, v245
    v_accvgpr_read_b32 v245, a35
    v_mul_f32 v245, v245, v248
    v_accvgpr_write_b32 a35, v245
    v_accvgpr_read_b32 v245, a36
    v_mul_f32 v245, v245, v248
    v_accvgpr_write_b32 a36, v245
    v_accvgpr_read_b32 v245, a37
    v_mul_f32 v245, v245, v248
    v_accvgpr_write_b32 a37, v245
    v_accvgpr_read_b32 v245, a38
    v_mul_f32 v245, v245, v248
    v_accvgpr_write_b32 a38, v245
    v_accvgpr_read_b32 v245, a39
    v_mul_f32 v245, v245, v248
    v_accvgpr_write_b32 a39, v245
    v_accvgpr_read_b32 v245, a40
    v_mul_f32 v245, v245, v248
    v_accvgpr_write_b32 a40, v245
    v_accvgpr_read_b32 v245, a41
    v_mul_f32 v245, v245, v248
    v_accvgpr_write_b32 a41, v245
    v_accvgpr_read_b32 v245, a42
    v_mul_f32 v245, v245, v248
    v_accvgpr_write_b32 a42, v245
    v_accvgpr_read_b32 v245, a43
    v_mul_f32 v245, v245, v248
    v_accvgpr_write_b32 a43, v245
    v_accvgpr_read_b32 v245, a44
    v_mul_f32 v245, v245, v248
    v_accvgpr_write_b32 a44, v245
    v_accvgpr_read_b32 v245, a45
    v_mul_f32 v245, v245, v248
    v_accvgpr_write_b32 a45, v245
    v_accvgpr_read_b32 v245, a46
    v_mul_f32 v245, v245, v248
    v_accvgpr_write_b32 a46, v245
    v_accvgpr_read_b32 v245, a47
    v_mul_f32 v245, v245, v248
    v_accvgpr_write_b32 a47, v245
    v_accvgpr_read_b32 v245, a48
    v_mul_f32 v245, v245, v248
    v_accvgpr_write_b32 a48, v245
    v_accvgpr_read_b32 v245, a49
    v_mul_f32 v245, v245, v248
    v_accvgpr_write_b32 a49, v245
    v_accvgpr_read_b32 v245, a50
    v_mul_f32 v245, v245, v248
    v_accvgpr_write_b32 a50, v245
    v_accvgpr_read_b32 v245, a51
    v_mul_f32 v245, v245, v248
    v_accvgpr_write_b32 a51, v245
    v_accvgpr_read_b32 v245, a52
    v_mul_f32 v245, v245, v248
    v_accvgpr_write_b32 a52, v245
    v_accvgpr_read_b32 v245, a53
    v_mul_f32 v245, v245, v248
    v_accvgpr_write_b32 a53, v245
    v_accvgpr_read_b32 v245, a54
    v_mul_f32 v245, v245, v248
    v_accvgpr_write_b32 a54, v245
    v_accvgpr_read_b32 v245, a55
    v_mul_f32 v245, v245, v248
    v_accvgpr_write_b32 a55, v245
    v_accvgpr_read_b32 v245, a56
    v_mul_f32 v245, v245, v248
    v_accvgpr_write_b32 a56, v245
    v_accvgpr_read_b32 v245, a57
    v_mul_f32 v245, v245, v248
    v_accvgpr_write_b32 a57, v245
    v_accvgpr_read_b32 v245, a58
    v_mul_f32 v245, v245, v248
    v_accvgpr_write_b32 a58, v245
    v_accvgpr_read_b32 v245, a59
    v_mul_f32 v245, v245, v248
    v_accvgpr_write_b32 a59, v245
    v_accvgpr_read_b32 v245, a60
    v_mul_f32 v245, v245, v248
    v_accvgpr_write_b32 a60, v245
    v_accvgpr_read_b32 v245, a61
    v_mul_f32 v245, v245, v248
    v_accvgpr_write_b32 a61, v245
    v_accvgpr_read_b32 v245, a62
    v_mul_f32 v245, v245, v248
    v_accvgpr_write_b32 a62, v245
    v_accvgpr_read_b32 v245, a63
    v_mul_f32 v245, v245, v248
    v_accvgpr_write_b32 a63, v245
    v_accvgpr_read_b32 v245, a64
    v_mul_f32 v245, v245, v248
    v_accvgpr_write_b32 a64, v245
    v_accvgpr_read_b32 v245, a65
    v_mul_f32 v245, v245, v248
    v_accvgpr_write_b32 a65, v245
    v_accvgpr_read_b32 v245, a66
    v_mul_f32 v245, v245, v248
    v_accvgpr_write_b32 a66, v245
    v_accvgpr_read_b32 v245, a67
    v_mul_f32 v245, v245, v248
    v_accvgpr_write_b32 a67, v245
    v_accvgpr_read_b32 v245, a68
    v_mul_f32 v245, v245, v248
    v_accvgpr_write_b32 a68, v245
    v_accvgpr_read_b32 v245, a69
    v_mul_f32 v245, v245, v248
    v_accvgpr_write_b32 a69, v245
    v_accvgpr_read_b32 v245, a70
    v_mul_f32 v245, v245, v248
    v_accvgpr_write_b32 a70, v245
    v_accvgpr_read_b32 v245, a71
    v_mul_f32 v245, v245, v248
    v_accvgpr_write_b32 a71, v245
    v_accvgpr_read_b32 v245, a72
    v_mul_f32 v245, v245, v248
    v_accvgpr_write_b32 a72, v245
    v_accvgpr_read_b32 v245, a73
    v_mul_f32 v245, v245, v248
    v_accvgpr_write_b32 a73, v245
    v_accvgpr_read_b32 v245, a74
    v_mul_f32 v245, v245, v248
    v_accvgpr_write_b32 a74, v245
    v_accvgpr_read_b32 v245, a75
    v_mul_f32 v245, v245, v248
    v_accvgpr_write_b32 a75, v245
    v_accvgpr_read_b32 v245, a76
    v_mul_f32 v245, v245, v248
    v_accvgpr_write_b32 a76, v245
    v_accvgpr_read_b32 v245, a77
    v_mul_f32 v245, v245, v248
    v_accvgpr_write_b32 a77, v245
    v_accvgpr_read_b32 v245, a78
    v_mul_f32 v245, v245, v248
    v_accvgpr_write_b32 a78, v245
    v_accvgpr_read_b32 v245, a79
    v_mul_f32 v245, v245, v248
    v_accvgpr_write_b32 a79, v245
    v_accvgpr_read_b32 v245, a80
    v_mul_f32 v245, v245, v248
    v_accvgpr_write_b32 a80, v245
    v_accvgpr_read_b32 v245, a81
    v_mul_f32 v245, v245, v248
    v_accvgpr_write_b32 a81, v245
    v_accvgpr_read_b32 v245, a82
    v_mul_f32 v245, v245, v248
    v_accvgpr_write_b32 a82, v245
    v_accvgpr_read_b32 v245, a83
    v_mul_f32 v245, v245, v248
    v_accvgpr_write_b32 a83, v245
    v_accvgpr_read_b32 v245, a84
    v_mul_f32 v245, v245, v248
    v_accvgpr_write_b32 a84, v245
    v_accvgpr_read_b32 v245, a85
    v_mul_f32 v245, v245, v248
    v_accvgpr_write_b32 a85, v245
    v_accvgpr_read_b32 v245, a86
    v_mul_f32 v245, v245, v248
    v_accvgpr_write_b32 a86, v245
    v_accvgpr_read_b32 v245, a87
    v_mul_f32 v245, v245, v248
    v_accvgpr_write_b32 a87, v245
    v_accvgpr_read_b32 v245, a88
    v_mul_f32 v245, v245, v248
    v_accvgpr_write_b32 a88, v245
    v_accvgpr_read_b32 v245, a89
    v_mul_f32 v245, v245, v248
    v_accvgpr_write_b32 a89, v245
    v_accvgpr_read_b32 v245, a90
    v_mul_f32 v245, v245, v248
    v_accvgpr_write_b32 a90, v245
    v_accvgpr_read_b32 v245, a91
    v_mul_f32 v245, v245, v248
    v_accvgpr_write_b32 a91, v245
    v_accvgpr_read_b32 v245, a92
    v_mul_f32 v245, v245, v248
    v_accvgpr_write_b32 a92, v245
    v_accvgpr_read_b32 v245, a93
    v_mul_f32 v245, v245, v248
    v_accvgpr_write_b32 a93, v245
    v_accvgpr_read_b32 v245, a94
    v_mul_f32 v245, v245, v248
    v_accvgpr_write_b32 a94, v245
    v_accvgpr_read_b32 v245, a95
    v_mul_f32 v245, v245, v248
    v_accvgpr_write_b32 a95, v245
    v_accvgpr_read_b32 v245, a96
    v_mul_f32 v245, v245, v248
    v_accvgpr_write_b32 a96, v245
    v_accvgpr_read_b32 v245, a97
    v_mul_f32 v245, v245, v248
    v_accvgpr_write_b32 a97, v245
    v_accvgpr_read_b32 v245, a98
    v_mul_f32 v245, v245, v248
    v_accvgpr_write_b32 a98, v245
    v_accvgpr_read_b32 v245, a99
    v_mul_f32 v245, v245, v248
    v_accvgpr_write_b32 a99, v245
    v_accvgpr_read_b32 v245, a100
    v_mul_f32 v245, v245, v248
    v_accvgpr_write_b32 a100, v245
    v_accvgpr_read_b32 v245, a101
    v_mul_f32 v245, v245, v248
    v_accvgpr_write_b32 a101, v245
    v_accvgpr_read_b32 v245, a102
    v_mul_f32 v245, v245, v248
    v_accvgpr_write_b32 a102, v245
    v_accvgpr_read_b32 v245, a103
    v_mul_f32 v245, v245, v248
    v_accvgpr_write_b32 a103, v245
    v_accvgpr_read_b32 v245, a104
    v_mul_f32 v245, v245, v248
    v_accvgpr_write_b32 a104, v245
    v_accvgpr_read_b32 v245, a105
    v_mul_f32 v245, v245, v248
    v_accvgpr_write_b32 a105, v245
    v_accvgpr_read_b32 v245, a106
    v_mul_f32 v245, v245, v248
    v_accvgpr_write_b32 a106, v245
    v_accvgpr_read_b32 v245, a107
    v_mul_f32 v245, v245, v248
    v_accvgpr_write_b32 a107, v245
    v_accvgpr_read_b32 v245, a108
    v_mul_f32 v245, v245, v248
    v_accvgpr_write_b32 a108, v245
    v_accvgpr_read_b32 v245, a109
    v_mul_f32 v245, v245, v248
    v_accvgpr_write_b32 a109, v245
    v_accvgpr_read_b32 v245, a110
    v_mul_f32 v245, v245, v248
    v_accvgpr_write_b32 a110, v245
    v_accvgpr_read_b32 v245, a111
    v_mul_f32 v245, v245, v248
    v_accvgpr_write_b32 a111, v245
    v_accvgpr_read_b32 v245, a112
    v_mul_f32 v245, v245, v248
    v_accvgpr_write_b32 a112, v245
    v_accvgpr_read_b32 v245, a113
    v_mul_f32 v245, v245, v248
    v_accvgpr_write_b32 a113, v245
    v_accvgpr_read_b32 v245, a114
    v_mul_f32 v245, v245, v248
    v_accvgpr_write_b32 a114, v245
    v_accvgpr_read_b32 v245, a115
    v_mul_f32 v245, v245, v248
    v_accvgpr_write_b32 a115, v245
    v_accvgpr_read_b32 v245, a116
    v_mul_f32 v245, v245, v248
    v_accvgpr_write_b32 a116, v245
    v_accvgpr_read_b32 v245, a117
    v_mul_f32 v245, v245, v248
    v_accvgpr_write_b32 a117, v245
    v_accvgpr_read_b32 v245, a118
    v_mul_f32 v245, v245, v248
    v_accvgpr_write_b32 a118, v245
    v_accvgpr_read_b32 v245, a119
    v_mul_f32 v245, v245, v248
    v_accvgpr_write_b32 a119, v245
    v_accvgpr_read_b32 v245, a120
    v_mul_f32 v245, v245, v248
    v_accvgpr_write_b32 a120, v245
    v_accvgpr_read_b32 v245, a121
    v_mul_f32 v245, v245, v248
    v_accvgpr_write_b32 a121, v245
    v_accvgpr_read_b32 v245, a122
    v_mul_f32 v245, v245, v248
    v_accvgpr_write_b32 a122, v245
    v_accvgpr_read_b32 v245, a123
    v_mul_f32 v245, v245, v248
    v_accvgpr_write_b32 a123, v245
    v_accvgpr_read_b32 v245, a124
    v_mul_f32 v245, v245, v248
    v_accvgpr_write_b32 a124, v245
    v_accvgpr_read_b32 v245, a125
    v_mul_f32 v245, v245, v248
    v_accvgpr_write_b32 a125, v245
    v_accvgpr_read_b32 v245, a126
    v_mul_f32 v245, v245, v248
    v_accvgpr_write_b32 a126, v245
    v_accvgpr_read_b32 v245, a127
    v_mul_f32 v245, v245, v248
    v_accvgpr_write_b32 a127, v245
    v_fma_f32 v232, v128, s21, v239
    s_nop 0
    v_fma_f32 v233, v129, s21, v239
    v_exp_f32 v232, v232
    s_nop 0
    v_fma_f32 v234, v130, s21, v239
    v_exp_f32 v233, v233
    s_nop 0
    v_fma_f32 v235, v131, s21, v239
    v_exp_f32 v234, v234
    v_add_f32 v243, v232, v233
    v_cvt_pk_bf16_f32 v192, v232, v233
    s_nop 0
    v_fma_f32 v232, v132, s21, v239
    v_exp_f32 v235, v235
    v_add_f32 v243, v243, v234
    s_nop 0
    v_fma_f32 v233, v133, s21, v239
    v_exp_f32 v232, v232
    v_add_f32 v243, v243, v235
    v_cvt_pk_bf16_f32 v193, v234, v235
    s_nop 0
    v_fma_f32 v234, v134, s21, v239
    v_exp_f32 v233, v233
    v_add_f32 v243, v243, v232
    s_nop 0
    v_fma_f32 v235, v135, s21, v239
    v_exp_f32 v234, v234
    v_add_f32 v243, v243, v233
    v_cvt_pk_bf16_f32 v194, v232, v233
    s_nop 0
    v_fma_f32 v232, v144, s21, v240
    v_exp_f32 v235, v235
    v_add_f32 v243, v243, v234
    s_nop 0
    v_fma_f32 v233, v145, s21, v240
    v_exp_f32 v232, v232
    v_add_f32 v243, v243, v235
    v_cvt_pk_bf16_f32 v195, v234, v235
    s_nop 0
    v_fma_f32 v234, v146, s21, v240
    v_exp_f32 v233, v233
    s_nop 0
    v_fma_f32 v235, v147, s21, v240
    v_exp_f32 v234, v234
    v_add_f32 v244, v232, v233
    v_cvt_pk_bf16_f32 v196, v232, v233
    s_nop 0
    v_fma_f32 v232, v148, s21, v240
    v_exp_f32 v235, v235
    v_add_f32 v244, v244, v234
    s_nop 0
    v_fma_f32 v233, v149, s21, v240
    v_exp_f32 v232, v232
    v_add_f32 v244, v244, v235
    v_cvt_pk_bf16_f32 v197, v234, v235
    s_nop 0
    v_fma_f32 v234, v150, s21, v240
    v_exp_f32 v233, v233
    v_add_f32 v244, v244, v232
    s_nop 0
    v_fma_f32 v235, v151, s21, v240
    v_exp_f32 v234, v234
    v_add_f32 v244, v244, v233
    v_cvt_pk_bf16_f32 v198, v232, v233
    s_nop 0
    v_fma_f32 v232, v136, s21, v239
    v_exp_f32 v235, v235
    v_add_f32 v244, v244, v234
    s_nop 0
    v_fma_f32 v233, v137, s21, v239
    v_exp_f32 v232, v232
    v_add_f32 v244, v244, v235
    v_cvt_pk_bf16_f32 v199, v234, v235
    s_nop 0
    v_fma_f32 v234, v138, s21, v239
    v_exp_f32 v233, v233
    v_add_f32 v243, v243, v232
    s_nop 0
    v_fma_f32 v235, v139, s21, v239
    v_exp_f32 v234, v234
    v_add_f32 v243, v243, v233
    v_cvt_pk_bf16_f32 v208, v232, v233
    s_nop 0
    v_fma_f32 v232, v140, s21, v239
    v_exp_f32 v235, v235
    v_add_f32 v243, v243, v234
    s_nop 0
    v_fma_f32 v233, v141, s21, v239
    v_exp_f32 v232, v232
    v_add_f32 v243, v243, v235
    v_cvt_pk_bf16_f32 v209, v234, v235
    s_nop 0
    v_fma_f32 v234, v142, s21, v239
    v_exp_f32 v233, v233
    v_add_f32 v243, v243, v232
    s_nop 0
    v_fma_f32 v235, v143, s21, v239
    v_exp_f32 v234, v234
    v_add_f32 v243, v243, v233
    v_cvt_pk_bf16_f32 v210, v232, v233
    s_nop 0
    v_fma_f32 v232, v152, s21, v240
    v_exp_f32 v235, v235
    v_add_f32 v243, v243, v234
    s_nop 0
    v_fma_f32 v233, v153, s21, v240
    v_exp_f32 v232, v232
    v_add_f32 v243, v243, v235
    v_cvt_pk_bf16_f32 v211, v234, v235
    s_nop 0
    v_fma_f32 v234, v154, s21, v240
    v_exp_f32 v233, v233
    v_add_f32 v244, v244, v232
    s_nop 0
    v_fma_f32 v235, v155, s21, v240
    v_exp_f32 v234, v234
    v_add_f32 v244, v244, v233
    v_cvt_pk_bf16_f32 v212, v232, v233
    s_nop 0
    v_fma_f32 v232, v156, s21, v240
    v_exp_f32 v235, v235
    v_add_f32 v244, v244, v234
    s_nop 0
    v_fma_f32 v233, v157, s21, v240
    v_exp_f32 v232, v232
    v_add_f32 v244, v244, v235
    v_cvt_pk_bf16_f32 v213, v234, v235
    s_nop 0
    v_fma_f32 v234, v158, s21, v240
    v_exp_f32 v233, v233
    v_add_f32 v244, v244, v232
    s_nop 0
    v_fma_f32 v235, v159, s21, v240
    v_exp_f32 v234, v234
    v_add_f32 v244, v244, v233
    v_cvt_pk_bf16_f32 v214, v232, v233
    s_nop 0
    v_exp_f32 v235, v235
    v_add_f32 v244, v244, v234
    s_nop 0
    v_add_f32 v244, v244, v235
    v_cvt_pk_bf16_f32 v215, v234, v235
    s_nop 0
    s_nop 3
    s_branch L_backs14A
L_rares15A:
    s_nop 7
    v_max3_f32 v247, v160, v161, v162
    v_max3_f32 v247, v247, v163, v164
    v_max3_f32 v247, v247, v165, v166
    v_max3_f32 v247, v247, v167, v168
    v_max3_f32 v247, v247, v169, v170
    v_max3_f32 v247, v247, v171, v172
    v_max3_f32 v247, v247, v173, v174
    v_max_f32 v247, v247, v175
    v_mov_b32 v245, v247
    s_nop 1
    v_permlane32_swap_b32 v245, v247
    s_nop 0
    v_max_f32 v247, v247, v245
    v_mul_f32 v247, s30, v247
    v_min_f32 v247, v247, v239
    v_sub_f32 v248, v247, v239
    v_exp_f32 v248, v248
    v_mov_b32 v239, v247
    v_mul_f32 v241, v241, v248
    v_mul_f32 v0, v0, v248
    v_mul_f32 v1, v1, v248
    v_mul_f32 v2, v2, v248
    v_mul_f32 v3, v3, v248
    v_mul_f32 v4, v4, v248
    v_mul_f32 v5, v5, v248
    v_mul_f32 v6, v6, v248
    v_mul_f32 v7, v7, v248
    v_mul_f32 v8, v8, v248
    v_mul_f32 v9, v9, v248
    v_mul_f32 v10, v10, v248
    v_mul_f32 v11, v11, v248
    v_mul_f32 v12, v12, v248
    v_mul_f32 v13, v13, v248
    v_mul_f32 v14, v14, v248
    v_mul_f32 v15, v15, v248
    v_mul_f32 v16, v16, v248
    v_mul_f32 v17, v17, v248
    v_mul_f32 v18, v18, v248
    v_mul_f32 v19, v19, v248
    v_mul_f32 v20, v20, v248
    v_mul_f32 v21, v21, v248
    v_mul_f32 v22, v22, v248
    v_mul_f32 v23, v23, v248
    v_mul_f32 v24, v24, v248
    v_mul_f32 v25, v25, v248
    v_mul_f32 v26, v26, v248
    v_mul_f32 v27, v27, v248
    v_mul_f32 v28, v28, v248
    v_mul_f32 v29, v29, v248
    v_mul_f32 v30, v30, v248
    v_mul_f32 v31, v31, v248
    v_mul_f32 v32, v32, v248
    v_mul_f32 v33, v33, v248
    v_mul_f32 v34, v34, v248
    v_mul_f32 v35, v35, v248
    v_mul_f32 v36, v36, v248
    v_mul_f32 v37, v37, v248
    v_mul_f32 v38, v38, v248
    v_mul_f32 v39, v39, v248
    v_mul_f32 v40, v40, v248
    v_mul_f32 v41, v41, v248
    v_mul_f32 v42, v42, v248
    v_mul_f32 v43, v43, v248
    v_mul_f32 v44, v44, v248
    v_mul_f32 v45, v45, v248
    v_mul_f32 v46, v46, v248
    v_mul_f32 v47, v47, v248
    v_mul_f32 v48, v48, v248
    v_mul_f32 v49, v49, v248
    v_mul_f32 v50, v50, v248
    v_mul_f32 v51, v51, v248
    v_mul_f32 v52, v52, v248
    v_mul_f32 v53, v53, v248
    v_mul_f32 v54, v54, v248
    v_mul_f32 v55, v55, v248
    v_mul_f32 v56, v56, v248
    v_mul_f32 v57, v57, v248
    v_mul_f32 v58, v58, v248
    v_mul_f32 v59, v59, v248
    v_mul_f32 v60, v60, v248
    v_mul_f32 v61, v61, v248
    v_mul_f32 v62, v62, v248
    v_mul_f32 v63, v63, v248
    v_mul_f32 v64, v64, v248
    v_mul_f32 v65, v65, v248
    v_mul_f32 v66, v66, v248
    v_mul_f32 v67, v67, v248
    v_mul_f32 v68, v68, v248
    v_mul_f32 v69, v69, v248
    v_mul_f32 v70, v70, v248
    v_mul_f32 v71, v71, v248
    v_mul_f32 v72, v72, v248
    v_mul_f32 v73, v73, v248
    v_mul_f32 v74, v74, v248
    v_mul_f32 v75, v75, v248
    v_mul_f32 v76, v76, v248
    v_mul_f32 v77, v77, v248
    v_mul_f32 v78, v78, v248
    v_mul_f32 v79, v79, v248
    v_mul_f32 v80, v80, v248
    v_mul_f32 v81, v81, v248
    v_mul_f32 v82, v82, v248
    v_mul_f32 v83, v83, v248
    v_mul_f32 v84, v84, v248
    v_mul_f32 v85, v85, v248
    v_mul_f32 v86, v86, v248
    v_mul_f32 v87, v87, v248
    v_mul_f32 v88, v88, v248
    v_mul_f32 v89, v89, v248
    v_mul_f32 v90, v90, v248
    v_mul_f32 v91, v91, v248
    v_mul_f32 v92, v92, v248
    v_mul_f32 v93, v93, v248
    v_mul_f32 v94, v94, v248
    v_mul_f32 v95, v95, v248
    v_mul_f32 v96, v96, v248
    v_mul_f32 v97, v97, v248
    v_mul_f32 v98, v98, v248
    v_mul_f32 v99, v99, v248
    v_mul_f32 v100, v100, v248
    v_mul_f32 v101, v101, v248
    v_mul_f32 v102, v102, v248
    v_mul_f32 v103, v103, v248
    v_mul_f32 v104, v104, v248
    v_mul_f32 v105, v105, v248
    v_mul_f32 v106, v106, v248
    v_mul_f32 v107, v107, v248
    v_mul_f32 v108, v108, v248
    v_mul_f32 v109, v109, v248
    v_mul_f32 v110, v110, v248
    v_mul_f32 v111, v111, v248
    v_mul_f32 v112, v112, v248
    v_mul_f32 v113, v113, v248
    v_mul_f32 v114, v114, v248
    v_mul_f32 v115, v115, v248
    v_mul_f32 v116, v116, v248
    v_mul_f32 v117, v117, v248
    v_mul_f32 v118, v118, v248
    v_mul_f32 v119, v119, v248
    v_mul_f32 v120, v120, v248
    v_mul_f32 v121, v121, v248
    v_mul_f32 v122, v122, v248
    v_mul_f32 v123, v123, v248
    v_mul_f32 v124, v124, v248
    v_mul_f32 v125, v125, v248
    v_mul_f32 v126, v126, v248
    v_mul_f32 v127, v127, v248
    v_max3_f32 v247, v176, v177, v178
    v_max3_f32 v247, v247, v179, v180
    v_max3_f32 v247, v247, v181, v182
    v_max3_f32 v247, v247, v183, v184
    v_max3_f32 v247, v247, v185, v186
    v_max3_f32 v247, v247, v187, v188
    v_max3_f32 v247, v247, v189, v190
    v_max_f32 v247, v247, v191
    v_mov_b32 v245, v247
    s_nop 1
    v_permlane32_swap_b32 v245, v247
    s_nop 0
    v_max_f32 v247, v247, v245
    v_mul_f32 v247, s30, v247
    v_min_f32 v247, v247, v240
    v_sub_f32 v248, v247, v240
    v_exp_f32 v248, v248
    v_mov_b32 v240, v247
    v_mul_f32 v242, v242, v248
    v_accvgpr_read_b32 v245, a0
    v_mul_f32 v245, v245, v248
    v_accvgpr_write_b32 a0, v245
    v_accvgpr_read_b32 v245, a1
    v_mul_f32 v245, v245, v248
    v_accvgpr_write_b32 a1, v245
    v_accvgpr_read_b32 v245, a2
    v_mul_f32 v245, v245, v248
    v_accvgpr_write_b32 a2, v245
    v_accvgpr_read_b32 v245, a3
    v_mul_f32 v245, v245, v248
    v_accvgpr_write_b32 a3, v245
    v_accvgpr_read_b32 v245, a4
    v_mul_f32 v245, v245, v248
    v_accvgpr_write_b32 a4, v245
    v_accvgpr_read_b32 v245, a5
    v_mul_f32 v245, v245, v248
    v_accvgpr_write_b32 a5, v245
    v_accvgpr_read_b32 v245, a6
    v_mul_f32 v245, v245, v248
    v_accvgpr_write_b32 a6, v245
    v_accvgpr_read_b32 v245, a7
    v_mul_f32 v245, v245, v248
    v_accvgpr_write_b32 a7, v245
    v_accvgpr_read_b32 v245, a8
    v_mul_f32 v245, v245, v248
    v_accvgpr_write_b32 a8, v245
    v_accvgpr_read_b32 v245, a9
    v_mul_f32 v245, v245, v248
    v_accvgpr_write_b32 a9, v245
    v_accvgpr_read_b32 v245, a10
    v_mul_f32 v245, v245, v248
    v_accvgpr_write_b32 a10, v245
    v_accvgpr_read_b32 v245, a11
    v_mul_f32 v245, v245, v248
    v_accvgpr_write_b32 a11, v245
    v_accvgpr_read_b32 v245, a12
    v_mul_f32 v245, v245, v248
    v_accvgpr_write_b32 a12, v245
    v_accvgpr_read_b32 v245, a13
    v_mul_f32 v245, v245, v248
    v_accvgpr_write_b32 a13, v245
    v_accvgpr_read_b32 v245, a14
    v_mul_f32 v245, v245, v248
    v_accvgpr_write_b32 a14, v245
    v_accvgpr_read_b32 v245, a15
    v_mul_f32 v245, v245, v248
    v_accvgpr_write_b32 a15, v245
    v_accvgpr_read_b32 v245, a16
    v_mul_f32 v245, v245, v248
    v_accvgpr_write_b32 a16, v245
    v_accvgpr_read_b32 v245, a17
    v_mul_f32 v245, v245, v248
    v_accvgpr_write_b32 a17, v245
    v_accvgpr_read_b32 v245, a18
    v_mul_f32 v245, v245, v248
    v_accvgpr_write_b32 a18, v245
    v_accvgpr_read_b32 v245, a19
    v_mul_f32 v245, v245, v248
    v_accvgpr_write_b32 a19, v245
    v_accvgpr_read_b32 v245, a20
    v_mul_f32 v245, v245, v248
    v_accvgpr_write_b32 a20, v245
    v_accvgpr_read_b32 v245, a21
    v_mul_f32 v245, v245, v248
    v_accvgpr_write_b32 a21, v245
    v_accvgpr_read_b32 v245, a22
    v_mul_f32 v245, v245, v248
    v_accvgpr_write_b32 a22, v245
    v_accvgpr_read_b32 v245, a23
    v_mul_f32 v245, v245, v248
    v_accvgpr_write_b32 a23, v245
    v_accvgpr_read_b32 v245, a24
    v_mul_f32 v245, v245, v248
    v_accvgpr_write_b32 a24, v245
    v_accvgpr_read_b32 v245, a25
    v_mul_f32 v245, v245, v248
    v_accvgpr_write_b32 a25, v245
    v_accvgpr_read_b32 v245, a26
    v_mul_f32 v245, v245, v248
    v_accvgpr_write_b32 a26, v245
    v_accvgpr_read_b32 v245, a27
    v_mul_f32 v245, v245, v248
    v_accvgpr_write_b32 a27, v245
    v_accvgpr_read_b32 v245, a28
    v_mul_f32 v245, v245, v248
    v_accvgpr_write_b32 a28, v245
    v_accvgpr_read_b32 v245, a29
    v_mul_f32 v245, v245, v248
    v_accvgpr_write_b32 a29, v245
    v_accvgpr_read_b32 v245, a30
    v_mul_f32 v245, v245, v248
    v_accvgpr_write_b32 a30, v245
    v_accvgpr_read_b32 v245, a31
    v_mul_f32 v245, v245, v248
    v_accvgpr_write_b32 a31, v245
    v_accvgpr_read_b32 v245, a32
    v_mul_f32 v245, v245, v248
    v_accvgpr_write_b32 a32, v245
    v_accvgpr_read_b32 v245, a33
    v_mul_f32 v245, v245, v248
    v_accvgpr_write_b32 a33, v245
    v_accvgpr_read_b32 v245, a34
    v_mul_f32 v245, v245, v248
    v_accvgpr_write_b32 a34, v245
    v_accvgpr_read_b32 v245, a35
    v_mul_f32 v245, v245, v248
    v_accvgpr_write_b32 a35, v245
    v_accvgpr_read_b32 v245, a36
    v_mul_f32 v245, v245, v248
    v_accvgpr_write_b32 a36, v245
    v_accvgpr_read_b32 v245, a37
    v_mul_f32 v245, v245, v248
    v_accvgpr_write_b32 a37, v245
    v_accvgpr_read_b32 v245, a38
    v_mul_f32 v245, v245, v248
    v_accvgpr_write_b32 a38, v245
    v_accvgpr_read_b32 v245, a39
    v_mul_f32 v245, v245, v248
    v_accvgpr_write_b32 a39, v245
    v_accvgpr_read_b32 v245, a40
    v_mul_f32 v245, v245, v248
    v_accvgpr_write_b32 a40, v245
    v_accvgpr_read_b32 v245, a41
    v_mul_f32 v245, v245, v248
    v_accvgpr_write_b32 a41, v245
    v_accvgpr_read_b32 v245, a42
    v_mul_f32 v245, v245, v248
    v_accvgpr_write_b32 a42, v245
    v_accvgpr_read_b32 v245, a43
    v_mul_f32 v245, v245, v248
    v_accvgpr_write_b32 a43, v245
    v_accvgpr_read_b32 v245, a44
    v_mul_f32 v245, v245, v248
    v_accvgpr_write_b32 a44, v245
    v_accvgpr_read_b32 v245, a45
    v_mul_f32 v245, v245, v248
    v_accvgpr_write_b32 a45, v245
    v_accvgpr_read_b32 v245, a46
    v_mul_f32 v245, v245, v248
    v_accvgpr_write_b32 a46, v245
    v_accvgpr_read_b32 v245, a47
    v_mul_f32 v245, v245, v248
    v_accvgpr_write_b32 a47, v245
    v_accvgpr_read_b32 v245, a48
    v_mul_f32 v245, v245, v248
    v_accvgpr_write_b32 a48, v245
    v_accvgpr_read_b32 v245, a49
    v_mul_f32 v245, v245, v248
    v_accvgpr_write_b32 a49, v245
    v_accvgpr_read_b32 v245, a50
    v_mul_f32 v245, v245, v248
    v_accvgpr_write_b32 a50, v245
    v_accvgpr_read_b32 v245, a51
    v_mul_f32 v245, v245, v248
    v_accvgpr_write_b32 a51, v245
    v_accvgpr_read_b32 v245, a52
    v_mul_f32 v245, v245, v248
    v_accvgpr_write_b32 a52, v245
    v_accvgpr_read_b32 v245, a53
    v_mul_f32 v245, v245, v248
    v_accvgpr_write_b32 a53, v245
    v_accvgpr_read_b32 v245, a54
    v_mul_f32 v245, v245, v248
    v_accvgpr_write_b32 a54, v245
    v_accvgpr_read_b32 v245, a55
    v_mul_f32 v245, v245, v248
    v_accvgpr_write_b32 a55, v245
    v_accvgpr_read_b32 v245, a56
    v_mul_f32 v245, v245, v248
    v_accvgpr_write_b32 a56, v245
    v_accvgpr_read_b32 v245, a57
    v_mul_f32 v245, v245, v248
    v_accvgpr_write_b32 a57, v245
    v_accvgpr_read_b32 v245, a58
    v_mul_f32 v245, v245, v248
    v_accvgpr_write_b32 a58, v245
    v_accvgpr_read_b32 v245, a59
    v_mul_f32 v245, v245, v248
    v_accvgpr_write_b32 a59, v245
    v_accvgpr_read_b32 v245, a60
    v_mul_f32 v245, v245, v248
    v_accvgpr_write_b32 a60, v245
    v_accvgpr_read_b32 v245, a61
    v_mul_f32 v245, v245, v248
    v_accvgpr_write_b32 a61, v245
    v_accvgpr_read_b32 v245, a62
    v_mul_f32 v245, v245, v248
    v_accvgpr_write_b32 a62, v245
    v_accvgpr_read_b32 v245, a63
    v_mul_f32 v245, v245, v248
    v_accvgpr_write_b32 a63, v245
    v_accvgpr_read_b32 v245, a64
    v_mul_f32 v245, v245, v248
    v_accvgpr_write_b32 a64, v245
    v_accvgpr_read_b32 v245, a65
    v_mul_f32 v245, v245, v248
    v_accvgpr_write_b32 a65, v245
    v_accvgpr_read_b32 v245, a66
    v_mul_f32 v245, v245, v248
    v_accvgpr_write_b32 a66, v245
    v_accvgpr_read_b32 v245, a67
    v_mul_f32 v245, v245, v248
    v_accvgpr_write_b32 a67, v245
    v_accvgpr_read_b32 v245, a68
    v_mul_f32 v245, v245, v248
    v_accvgpr_write_b32 a68, v245
    v_accvgpr_read_b32 v245, a69
    v_mul_f32 v245, v245, v248
    v_accvgpr_write_b32 a69, v245
    v_accvgpr_read_b32 v245, a70
    v_mul_f32 v245, v245, v248
    v_accvgpr_write_b32 a70, v245
    v_accvgpr_read_b32 v245, a71
    v_mul_f32 v245, v245, v248
    v_accvgpr_write_b32 a71, v245
    v_accvgpr_read_b32 v245, a72
    v_mul_f32 v245, v245, v248
    v_accvgpr_write_b32 a72, v245
    v_accvgpr_read_b32 v245, a73
    v_mul_f32 v245, v245, v248
    v_accvgpr_write_b32 a73, v245
    v_accvgpr_read_b32 v245, a74
    v_mul_f32 v245, v245, v248
    v_accvgpr_write_b32 a74, v245
    v_accvgpr_read_b32 v245, a75
    v_mul_f32 v245, v245, v248
    v_accvgpr_write_b32 a75, v245
    v_accvgpr_read_b32 v245, a76
    v_mul_f32 v245, v245, v248
    v_accvgpr_write_b32 a76, v245
    v_accvgpr_read_b32 v245, a77
    v_mul_f32 v245, v245, v248
    v_accvgpr_write_b32 a77, v245
    v_accvgpr_read_b32 v245, a78
    v_mul_f32 v245, v245, v248
    v_accvgpr_write_b32 a78, v245
    v_accvgpr_read_b32 v245, a79
    v_mul_f32 v245, v245, v248
    v_accvgpr_write_b32 a79, v245
    v_accvgpr_read_b32 v245, a80
    v_mul_f32 v245, v245, v248
    v_accvgpr_write_b32 a80, v245
    v_accvgpr_read_b32 v245, a81
    v_mul_f32 v245, v245, v248
    v_accvgpr_write_b32 a81, v245
    v_accvgpr_read_b32 v245, a82
    v_mul_f32 v245, v245, v248
    v_accvgpr_write_b32 a82, v245
    v_accvgpr_read_b32 v245, a83
    v_mul_f32 v245, v245, v248
    v_accvgpr_write_b32 a83, v245
    v_accvgpr_read_b32 v245, a84
    v_mul_f32 v245, v245, v248
    v_accvgpr_write_b32 a84, v245
    v_accvgpr_read_b32 v245, a85
    v_mul_f32 v245, v245, v248
    v_accvgpr_write_b32 a85, v245
    v_accvgpr_read_b32 v245, a86
    v_mul_f32 v245, v245, v248
    v_accvgpr_write_b32 a86, v245
    v_accvgpr_read_b32 v245, a87
    v_mul_f32 v245, v245, v248
    v_accvgpr_write_b32 a87, v245
    v_accvgpr_read_b32 v245, a88
    v_mul_f32 v245, v245, v248
    v_accvgpr_write_b32 a88, v245
    v_accvgpr_read_b32 v245, a89
    v_mul_f32 v245, v245, v248
    v_accvgpr_write_b32 a89, v245
    v_accvgpr_read_b32 v245, a90
    v_mul_f32 v245, v245, v248
    v_accvgpr_write_b32 a90, v245
    v_accvgpr_read_b32 v245, a91
    v_mul_f32 v245, v245, v248
    v_accvgpr_write_b32 a91, v245
    v_accvgpr_read_b32 v245, a92
    v_mul_f32 v245, v245, v248
    v_accvgpr_write_b32 a92, v245
    v_accvgpr_read_b32 v245, a93
    v_mul_f32 v245, v245, v248
    v_accvgpr_write_b32 a93, v245
    v_accvgpr_read_b32 v245, a94
    v_mul_f32 v245, v245, v248
    v_accvgpr_write_b32 a94, v245
    v_accvgpr_read_b32 v245, a95
    v_mul_f32 v245, v245, v248
    v_accvgpr_write_b32 a95, v245
    v_accvgpr_read_b32 v245, a96
    v_mul_f32 v245, v245, v248
    v_accvgpr_write_b32 a96, v245
    v_accvgpr_read_b32 v245, a97
    v_mul_f32 v245, v245, v248
    v_accvgpr_write_b32 a97, v245
    v_accvgpr_read_b32 v245, a98
    v_mul_f32 v245, v245, v248
    v_accvgpr_write_b32 a98, v245
    v_accvgpr_read_b32 v245, a99
    v_mul_f32 v245, v245, v248
    v_accvgpr_write_b32 a99, v245
    v_accvgpr_read_b32 v245, a100
    v_mul_f32 v245, v245, v248
    v_accvgpr_write_b32 a100, v245
    v_accvgpr_read_b32 v245, a101
    v_mul_f32 v245, v245, v248
    v_accvgpr_write_b32 a101, v245
    v_accvgpr_read_b32 v245, a102
    v_mul_f32 v245, v245, v248
    v_accvgpr_write_b32 a102, v245
    v_accvgpr_read_b32 v245, a103
    v_mul_f32 v245, v245, v248
    v_accvgpr_write_b32 a103, v245
    v_accvgpr_read_b32 v245, a104
    v_mul_f32 v245, v245, v248
    v_accvgpr_write_b32 a104, v245
    v_accvgpr_read_b32 v245, a105
    v_mul_f32 v245, v245, v248
    v_accvgpr_write_b32 a105, v245
    v_accvgpr_read_b32 v245, a106
    v_mul_f32 v245, v245, v248
    v_accvgpr_write_b32 a106, v245
    v_accvgpr_read_b32 v245, a107
    v_mul_f32 v245, v245, v248
    v_accvgpr_write_b32 a107, v245
    v_accvgpr_read_b32 v245, a108
    v_mul_f32 v245, v245, v248
    v_accvgpr_write_b32 a108, v245
    v_accvgpr_read_b32 v245, a109
    v_mul_f32 v245, v245, v248
    v_accvgpr_write_b32 a109, v245
    v_accvgpr_read_b32 v245, a110
    v_mul_f32 v245, v245, v248
    v_accvgpr_write_b32 a110, v245
    v_accvgpr_read_b32 v245, a111
    v_mul_f32 v245, v245, v248
    v_accvgpr_write_b32 a111, v245
    v_accvgpr_read_b32 v245, a112
    v_mul_f32 v245, v245, v248
    v_accvgpr_write_b32 a112, v245
    v_accvgpr_read_b32 v245, a113
    v_mul_f32 v245, v245, v248
    v_accvgpr_write_b32 a113, v245
    v_accvgpr_read_b32 v245, a114
    v_mul_f32 v245, v245, v248
    v_accvgpr_write_b32 a114, v245
    v_accvgpr_read_b32 v245, a115
    v_mul_f32 v245, v245, v248
    v_accvgpr_write_b32 a115, v245
    v_accvgpr_read_b32 v245, a116
    v_mul_f32 v245, v245, v248
    v_accvgpr_write_b32 a116, v245
    v_accvgpr_read_b32 v245, a117
    v_mul_f32 v245, v245, v248
    v_accvgpr_write_b32 a117, v245
    v_accvgpr_read_b32 v245, a118
    v_mul_f32 v245, v245, v248
    v_accvgpr_write_b32 a118, v245
    v_accvgpr_read_b32 v245, a119
    v_mul_f32 v245, v245, v248
    v_accvgpr_write_b32 a119, v245
    v_accvgpr_read_b32 v245, a120
    v_mul_f32 v245, v245, v248
    v_accvgpr_write_b32 a120, v245
    v_accvgpr_read_b32 v245, a121
    v_mul_f32 v245, v245, v248
    v_accvgpr_write_b32 a121, v245
    v_accvgpr_read_b32 v245, a122
    v_mul_f32 v245, v245, v248
    v_accvgpr_write_b32 a122, v245
    v_accvgpr_read_b32 v245, a123
    v_mul_f32 v245, v245, v248
    v_accvgpr_write_b32 a123, v245
    v_accvgpr_read_b32 v245, a124
    v_mul_f32 v245, v245, v248
    v_accvgpr_write_b32 a124, v245
    v_accvgpr_read_b32 v245, a125
    v_mul_f32 v245, v245, v248
    v_accvgpr_write_b32 a125, v245
    v_accvgpr_read_b32 v245, a126
    v_mul_f32 v245, v245, v248
    v_accvgpr_write_b32 a126, v245
    v_accvgpr_read_b32 v245, a127
    v_mul_f32 v245, v245, v248
    v_accvgpr_write_b32 a127, v245
    v_fma_f32 v232, v160, s21, v239
    s_nop 0
    v_fma_f32 v233, v161, s21, v239
    v_exp_f32 v232, v232
    s_nop 0
    v_fma_f32 v234, v162, s21, v239
    v_exp_f32 v233, v233
    s_nop 0
    v_fma_f32 v235, v163, s21, v239
    v_exp_f32 v234, v234
    v_add_f32 v243, v232, v233
    v_cvt_pk_bf16_f32 v200, v232, v233
    s_nop 0
    v_fma_f32 v232, v164, s21, v239
    v_exp_f32 v235, v235
    v_add_f32 v243, v243, v234
    s_nop 0
    v_fma_f32 v233, v165, s21, v239
    v_exp_f32 v232, v232
    v_add_f32 v243, v243, v235
    v_cvt_pk_bf16_f32 v201, v234, v235
    s_nop 0
    v_fma_f32 v234, v166, s21, v239
    v_exp_f32 v233, v233
    v_add_f32 v243, v243, v232
    s_nop 0
    v_fma_f32 v235, v167, s21, v239
    v_exp_f32 v234, v234
    v_add_f32 v243, v243, v233
    v_cvt_pk_bf16_f32 v202, v232, v233
    s_nop 0
    v_fma_f32 v232, v176, s21, v240
    v_exp_f32 v235, v235
    v_add_f32 v243, v243, v234
    s_nop 0
    v_fma_f32 v233, v177, s21, v240
    v_exp_f32 v232, v232
    v_add_f32 v243, v243, v235
    v_cvt_pk_bf16_f32 v203, v234, v235
    s_nop 0
    v_fma_f32 v234, v178, s21, v240
    v_exp_f32 v233, v233
    s_nop 0
    v_fma_f32 v235, v179, s21, v240
    v_exp_f32 v234, v234
    v_add_f32 v244, v232, v233
    v_cvt_pk_bf16_f32 v204, v232, v233
    s_nop 0
    v_fma_f32 v232, v180, s21, v240
    v_exp_f32 v235, v235
    v_add_f32 v244, v244, v234
    s_nop 0
    v_fma_f32 v233, v181, s21, v240
    v_exp_f32 v232, v232
    v_add_f32 v244, v244, v235
    v_cvt_pk_bf16_f32 v205, v234, v235
    s_nop 0
    v_fma_f32 v234, v182, s21, v240
    v_exp_f32 v233, v233
    v_add_f32 v244, v244, v232
    s_nop 0
    v_fma_f32 v235, v183, s21, v240
    v_exp_f32 v234, v234
    v_add_f32 v244, v244, v233
    v_cvt_pk_bf16_f32 v206, v232, v233
    s_nop 0
    v_fma_f32 v232, v168, s21, v239
    v_exp_f32 v235, v235
    v_add_f32 v244, v244, v234
    s_nop 0
    v_fma_f32 v233, v169, s21, v239
    v_exp_f32 v232, v232
    v_add_f32 v244, v244, v235
    v_cvt_pk_bf16_f32 v207, v234, v235
    s_nop 0
    v_fma_f32 v234, v170, s21, v239
    v_exp_f32 v233, v233
    v_add_f32 v243, v243, v232
    s_nop 0
    v_fma_f32 v235, v171, s21, v239
    v_exp_f32 v234, v234
    v_add_f32 v243, v243, v233
    v_cvt_pk_bf16_f32 v208, v232, v233
    s_nop 0
    v_fma_f32 v232, v172, s21, v239
    v_exp_f32 v235, v235
    v_add_f32 v243, v243, v234
    s_nop 0
    v_fma_f32 v233, v173, s21, v239
    v_exp_f32 v232, v232
    v_add_f32 v243, v243, v235
    v_cvt_pk_bf16_f32 v209, v234, v235
    s_nop 0
    v_fma_f32 v234, v174, s21, v239
    v_exp_f32 v233, v233
    v_add_f32 v243, v243, v232
    s_nop 0
    v_fma_f32 v235, v175, s21, v239
    v_exp_f32 v234, v234
    v_add_f32 v243, v243, v233
    v_cvt_pk_bf16_f32 v210, v232, v233
    s_nop 0
    v_fma_f32 v232, v184, s21, v240
    v_exp_f32 v235, v235
    v_add_f32 v243, v243, v234
    s_nop 0
    v_fma_f32 v233, v185, s21, v240
    v_exp_f32 v232, v232
    v_add_f32 v243, v243, v235
    v_cvt_pk_bf16_f32 v211, v234, v235
    s_nop 0
    v_fma_f32 v234, v186, s21, v240
    v_exp_f32 v233, v233
    v_add_f32 v244, v244, v232
    s_nop 0
    v_fma_f32 v235, v187, s21, v240
    v_exp_f32 v234, v234
    v_add_f32 v244, v244, v233
    v_cvt_pk_bf16_f32 v212, v232, v233
    s_nop 0
    v_fma_f32 v232, v188, s21, v240
    v_exp_f32 v235, v235
    v_add_f32 v244, v244, v234
    s_nop 0
    v_fma_f32 v233, v189, s21, v240
    v_exp_f32 v232, v232
    v_add_f32 v244, v244, v235
    v_cvt_pk_bf16_f32 v213, v234, v235
    s_nop 0
    v_fma_f32 v234, v190, s21, v240
    v_exp_f32 v233, v233
    v_add_f32 v244, v244, v232
    s_nop 0
    v_fma_f32 v235, v191, s21, v240
    v_exp_f32 v234, v234
    v_add_f32 v244, v244, v233
    v_cvt_pk_bf16_f32 v214, v232, v233
    s_nop 0
    v_exp_f32 v235, v235
    v_add_f32 v244, v244, v234
    s_nop 0
    v_add_f32 v244, v244, v235
    v_cvt_pk_bf16_f32 v215, v234, v235
    s_nop 0
    s_nop 3
    s_branch L_backs15A
L_rares1A:
    s_nop 7
    v_max3_f32 v247, v160, v161, v162
    v_max3_f32 v247, v247, v163, v164
    v_max3_f32 v247, v247, v165, v166
    v_max3_f32 v247, v247, v167, v168
    v_max3_f32 v247, v247, v169, v170
    v_max3_f32 v247, v247, v171, v172
    v_max3_f32 v247, v247, v173, v174
    v_max_f32 v247, v247, v175
    v_mov_b32 v245, v247
    s_nop 1
    v_permlane32_swap_b32 v245, v247
    s_nop 0
    v_max_f32 v247, v247, v245
    v_mul_f32 v247, s30, v247
    v_min_f32 v247, v247, v239
    v_sub_f32 v248, v247, v239
    v_exp_f32 v248, v248
    v_mov_b32 v239, v247
    v_mul_f32 v241, v241, v248
    v_mul_f32 v0, v0, v248
    v_mul_f32 v1, v1, v248
    v_mul_f32 v2, v2, v248
    v_mul_f32 v3, v3, v248
    v_mul_f32 v4, v4, v248
    v_mul_f32 v5, v5, v248
    v_mul_f32 v6, v6, v248
    v_mul_f32 v7, v7, v248
    v_mul_f32 v8, v8, v248
    v_mul_f32 v9, v9, v248
    v_mul_f32 v10, v10, v248
    v_mul_f32 v11, v11, v248
    v_mul_f32 v12, v12, v248
    v_mul_f32 v13, v13, v248
    v_mul_f32 v14, v14, v248
    v_mul_f32 v15, v15, v248
    v_mul_f32 v16, v16, v248
    v_mul_f32 v17, v17, v248
    v_mul_f32 v18, v18, v248
    v_mul_f32 v19, v19, v248
    v_mul_f32 v20, v20, v248
    v_mul_f32 v21, v21, v248
    v_mul_f32 v22, v22, v248
    v_mul_f32 v23, v23, v248
    v_mul_f32 v24, v24, v248
    v_mul_f32 v25, v25, v248
    v_mul_f32 v26, v26, v248
    v_mul_f32 v27, v27, v248
    v_mul_f32 v28, v28, v248
    v_mul_f32 v29, v29, v248
    v_mul_f32 v30, v30, v248
    v_mul_f32 v31, v31, v248
    v_mul_f32 v32, v32, v248
    v_mul_f32 v33, v33, v248
    v_mul_f32 v34, v34, v248
    v_mul_f32 v35, v35, v248
    v_mul_f32 v36, v36, v248
    v_mul_f32 v37, v37, v248
    v_mul_f32 v38, v38, v248
    v_mul_f32 v39, v39, v248
    v_mul_f32 v40, v40, v248
    v_mul_f32 v41, v41, v248
    v_mul_f32 v42, v42, v248
    v_mul_f32 v43, v43, v248
    v_mul_f32 v44, v44, v248
    v_mul_f32 v45, v45, v248
    v_mul_f32 v46, v46, v248
    v_mul_f32 v47, v47, v248
    v_mul_f32 v48, v48, v248
    v_mul_f32 v49, v49, v248
    v_mul_f32 v50, v50, v248
    v_mul_f32 v51, v51, v248
    v_mul_f32 v52, v52, v248
    v_mul_f32 v53, v53, v248
    v_mul_f32 v54, v54, v248
    v_mul_f32 v55, v55, v248
    v_mul_f32 v56, v56, v248
    v_mul_f32 v57, v57, v248
    v_mul_f32 v58, v58, v248
    v_mul_f32 v59, v59, v248
    v_mul_f32 v60, v60, v248
    v_mul_f32 v61, v61, v248
    v_mul_f32 v62, v62, v248
    v_mul_f32 v63, v63, v248
    v_mul_f32 v64, v64, v248
    v_mul_f32 v65, v65, v248
    v_mul_f32 v66, v66, v248
    v_mul_f32 v67, v67, v248
    v_mul_f32 v68, v68, v248
    v_mul_f32 v69, v69, v248
    v_mul_f32 v70, v70, v248
    v_mul_f32 v71, v71, v248
    v_mul_f32 v72, v72, v248
    v_mul_f32 v73, v73, v248
    v_mul_f32 v74, v74, v248
    v_mul_f32 v75, v75, v248
    v_mul_f32 v76, v76, v248
    v_mul_f32 v77, v77, v248
    v_mul_f32 v78, v78, v248
    v_mul_f32 v79, v79, v248
    v_mul_f32 v80, v80, v248
    v_mul_f32 v81, v81, v248
    v_mul_f32 v82, v82, v248
    v_mul_f32 v83, v83, v248
    v_mul_f32 v84, v84, v248
    v_mul_f32 v85, v85, v248
    v_mul_f32 v86, v86, v248
    v_mul_f32 v87, v87, v248
    v_mul_f32 v88, v88, v248
    v_mul_f32 v89, v89, v248
    v_mul_f32 v90, v90, v248
    v_mul_f32 v91, v91, v248
    v_mul_f32 v92, v92, v248
    v_mul_f32 v93, v93, v248
    v_mul_f32 v94, v94, v248
    v_mul_f32 v95, v95, v248
    v_mul_f32 v96, v96, v248
    v_mul_f32 v97, v97, v248
    v_mul_f32 v98, v98, v248
    v_mul_f32 v99, v99, v248
    v_mul_f32 v100, v100, v248
    v_mul_f32 v101, v101, v248
    v_mul_f32 v102, v102, v248
    v_mul_f32 v103, v103, v248
    v_mul_f32 v104, v104, v248
    v_mul_f32 v105, v105, v248
    v_mul_f32 v106, v106, v248
    v_mul_f32 v107, v107, v248
    v_mul_f32 v108, v108, v248
    v_mul_f32 v109, v109, v248
    v_mul_f32 v110, v110, v248
    v_mul_f32 v111, v111, v248
    v_mul_f32 v112, v112, v248
    v_mul_f32 v113, v113, v248
    v_mul_f32 v114, v114, v248
    v_mul_f32 v115, v115, v248
    v_mul_f32 v116, v116, v248
    v_mul_f32 v117, v117, v248
    v_mul_f32 v118, v118, v248
    v_mul_f32 v119, v119, v248
    v_mul_f32 v120, v120, v248
    v_mul_f32 v121, v121, v248
    v_mul_f32 v122, v122, v248
    v_mul_f32 v123, v123, v248
    v_mul_f32 v124, v124, v248
    v_mul_f32 v125, v125, v248
    v_mul_f32 v126, v126, v248
    v_mul_f32 v127, v127, v248
    v_max3_f32 v247, v176, v177, v178
    v_max3_f32 v247, v247, v179, v180
    v_max3_f32 v247, v247, v181, v182
    v_max3_f32 v247, v247, v183, v184
    v_max3_f32 v247, v247, v185, v186
    v_max3_f32 v247, v247, v187, v188
    v_max3_f32 v247, v247, v189, v190
    v_max_f32 v247, v247, v191
    v_mov_b32 v245, v247
    s_nop 1
    v_permlane32_swap_b32 v245, v247
    s_nop 0
    v_max_f32 v247, v247, v245
    v_mul_f32 v247, s30, v247
    v_min_f32 v247, v247, v240
    v_sub_f32 v248, v247, v240
    v_exp_f32 v248, v248
    v_mov_b32 v240, v247
    v_mul_f32 v242, v242, v248
    v_accvgpr_read_b32 v245, a0
    v_mul_f32 v245, v245, v248
    v_accvgpr_write_b32 a0, v245
    v_accvgpr_read_b32 v245, a1
    v_mul_f32 v245, v245, v248
    v_accvgpr_write_b32 a1, v245
    v_accvgpr_read_b32 v245, a2
    v_mul_f32 v245, v245, v248
    v_accvgpr_write_b32 a2, v245
    v_accvgpr_read_b32 v245, a3
    v_mul_f32 v245, v245, v248
    v_accvgpr_write_b32 a3, v245
    v_accvgpr_read_b32 v245, a4
    v_mul_f32 v245, v245, v248
    v_accvgpr_write_b32 a4, v245
    v_accvgpr_read_b32 v245, a5
    v_mul_f32 v245, v245, v248
    v_accvgpr_write_b32 a5, v245
    v_accvgpr_read_b32 v245, a6
    v_mul_f32 v245, v245, v248
    v_accvgpr_write_b32 a6, v245
    v_accvgpr_read_b32 v245, a7
    v_mul_f32 v245, v245, v248
    v_accvgpr_write_b32 a7, v245
    v_accvgpr_read_b32 v245, a8
    v_mul_f32 v245, v245, v248
    v_accvgpr_write_b32 a8, v245
    v_accvgpr_read_b32 v245, a9
    v_mul_f32 v245, v245, v248
    v_accvgpr_write_b32 a9, v245
    v_accvgpr_read_b32 v245, a10
    v_mul_f32 v245, v245, v248
    v_accvgpr_write_b32 a10, v245
    v_accvgpr_read_b32 v245, a11
    v_mul_f32 v245, v245, v248
    v_accvgpr_write_b32 a11, v245
    v_accvgpr_read_b32 v245, a12
    v_mul_f32 v245, v245, v248
    v_accvgpr_write_b32 a12, v245
    v_accvgpr_read_b32 v245, a13
    v_mul_f32 v245, v245, v248
    v_accvgpr_write_b32 a13, v245
    v_accvgpr_read_b32 v245, a14
    v_mul_f32 v245, v245, v248
    v_accvgpr_write_b32 a14, v245
    v_accvgpr_read_b32 v245, a15
    v_mul_f32 v245, v245, v248
    v_accvgpr_write_b32 a15, v245
    v_accvgpr_read_b32 v245, a16
    v_mul_f32 v245, v245, v248
    v_accvgpr_write_b32 a16, v245
    v_accvgpr_read_b32 v245, a17
    v_mul_f32 v245, v245, v248
    v_accvgpr_write_b32 a17, v245
    v_accvgpr_read_b32 v245, a18
    v_mul_f32 v245, v245, v248
    v_accvgpr_write_b32 a18, v245
    v_accvgpr_read_b32 v245, a19
    v_mul_f32 v245, v245, v248
    v_accvgpr_write_b32 a19, v245
    v_accvgpr_read_b32 v245, a20
    v_mul_f32 v245, v245, v248
    v_accvgpr_write_b32 a20, v245
    v_accvgpr_read_b32 v245, a21
    v_mul_f32 v245, v245, v248
    v_accvgpr_write_b32 a21, v245
    v_accvgpr_read_b32 v245, a22
    v_mul_f32 v245, v245, v248
    v_accvgpr_write_b32 a22, v245
    v_accvgpr_read_b32 v245, a23
    v_mul_f32 v245, v245, v248
    v_accvgpr_write_b32 a23, v245
    v_accvgpr_read_b32 v245, a24
    v_mul_f32 v245, v245, v248
    v_accvgpr_write_b32 a24, v245
    v_accvgpr_read_b32 v245, a25
    v_mul_f32 v245, v245, v248
    v_accvgpr_write_b32 a25, v245
    v_accvgpr_read_b32 v245, a26
    v_mul_f32 v245, v245, v248
    v_accvgpr_write_b32 a26, v245
    v_accvgpr_read_b32 v245, a27
    v_mul_f32 v245, v245, v248
    v_accvgpr_write_b32 a27, v245
    v_accvgpr_read_b32 v245, a28
    v_mul_f32 v245, v245, v248
    v_accvgpr_write_b32 a28, v245
    v_accvgpr_read_b32 v245, a29
    v_mul_f32 v245, v245, v248
    v_accvgpr_write_b32 a29, v245
    v_accvgpr_read_b32 v245, a30
    v_mul_f32 v245, v245, v248
    v_accvgpr_write_b32 a30, v245
    v_accvgpr_read_b32 v245, a31
    v_mul_f32 v245, v245, v248
    v_accvgpr_write_b32 a31, v245
    v_accvgpr_read_b32 v245, a32
    v_mul_f32 v245, v245, v248
    v_accvgpr_write_b32 a32, v245
    v_accvgpr_read_b32 v245, a33
    v_mul_f32 v245, v245, v248
    v_accvgpr_write_b32 a33, v245
    v_accvgpr_read_b32 v245, a34
    v_mul_f32 v245, v245, v248
    v_accvgpr_write_b32 a34, v245
    v_accvgpr_read_b32 v245, a35
    v_mul_f32 v245, v245, v248
    v_accvgpr_write_b32 a35, v245
    v_accvgpr_read_b32 v245, a36
    v_mul_f32 v245, v245, v248
    v_accvgpr_write_b32 a36, v245
    v_accvgpr_read_b32 v245, a37
    v_mul_f32 v245, v245, v248
    v_accvgpr_write_b32 a37, v245
    v_accvgpr_read_b32 v245, a38
    v_mul_f32 v245, v245, v248
    v_accvgpr_write_b32 a38, v245
    v_accvgpr_read_b32 v245, a39
    v_mul_f32 v245, v245, v248
    v_accvgpr_write_b32 a39, v245
    v_accvgpr_read_b32 v245, a40
    v_mul_f32 v245, v245, v248
    v_accvgpr_write_b32 a40, v245
    v_accvgpr_read_b32 v245, a41
    v_mul_f32 v245, v245, v248
    v_accvgpr_write_b32 a41, v245
    v_accvgpr_read_b32 v245, a42
    v_mul_f32 v245, v245, v248
    v_accvgpr_write_b32 a42, v245
    v_accvgpr_read_b32 v245, a43
    v_mul_f32 v245, v245, v248
    v_accvgpr_write_b32 a43, v245
    v_accvgpr_read_b32 v245, a44
    v_mul_f32 v245, v245, v248
    v_accvgpr_write_b32 a44, v245
    v_accvgpr_read_b32 v245, a45
    v_mul_f32 v245, v245, v248
    v_accvgpr_write_b32 a45, v245
    v_accvgpr_read_b32 v245, a46
    v_mul_f32 v245, v245, v248
    v_accvgpr_write_b32 a46, v245
    v_accvgpr_read_b32 v245, a47
    v_mul_f32 v245, v245, v248
    v_accvgpr_write_b32 a47, v245
    v_accvgpr_read_b32 v245, a48
    v_mul_f32 v245, v245, v248
    v_accvgpr_write_b32 a48, v245
    v_accvgpr_read_b32 v245, a49
    v_mul_f32 v245, v245, v248
    v_accvgpr_write_b32 a49, v245
    v_accvgpr_read_b32 v245, a50
    v_mul_f32 v245, v245, v248
    v_accvgpr_write_b32 a50, v245
    v_accvgpr_read_b32 v245, a51
    v_mul_f32 v245, v245, v248
    v_accvgpr_write_b32 a51, v245
    v_accvgpr_read_b32 v245, a52
    v_mul_f32 v245, v245, v248
    v_accvgpr_write_b32 a52, v245
    v_accvgpr_read_b32 v245, a53
    v_mul_f32 v245, v245, v248
    v_accvgpr_write_b32 a53, v245
    v_accvgpr_read_b32 v245, a54
    v_mul_f32 v245, v245, v248
    v_accvgpr_write_b32 a54, v245
    v_accvgpr_read_b32 v245, a55
    v_mul_f32 v245, v245, v248
    v_accvgpr_write_b32 a55, v245
    v_accvgpr_read_b32 v245, a56
    v_mul_f32 v245, v245, v248
    v_accvgpr_write_b32 a56, v245
    v_accvgpr_read_b32 v245, a57
    v_mul_f32 v245, v245, v248
    v_accvgpr_write_b32 a57, v245
    v_accvgpr_read_b32 v245, a58
    v_mul_f32 v245, v245, v248
    v_accvgpr_write_b32 a58, v245
    v_accvgpr_read_b32 v245, a59
    v_mul_f32 v245, v245, v248
    v_accvgpr_write_b32 a59, v245
    v_accvgpr_read_b32 v245, a60
    v_mul_f32 v245, v245, v248
    v_accvgpr_write_b32 a60, v245
    v_accvgpr_read_b32 v245, a61
    v_mul_f32 v245, v245, v248
    v_accvgpr_write_b32 a61, v245
    v_accvgpr_read_b32 v245, a62
    v_mul_f32 v245, v245, v248
    v_accvgpr_write_b32 a62, v245
    v_accvgpr_read_b32 v245, a63
    v_mul_f32 v245, v245, v248
    v_accvgpr_write_b32 a63, v245
    v_accvgpr_read_b32 v245, a64
    v_mul_f32 v245, v245, v248
    v_accvgpr_write_b32 a64, v245
    v_accvgpr_read_b32 v245, a65
    v_mul_f32 v245, v245, v248
    v_accvgpr_write_b32 a65, v245
    v_accvgpr_read_b32 v245, a66
    v_mul_f32 v245, v245, v248
    v_accvgpr_write_b32 a66, v245
    v_accvgpr_read_b32 v245, a67
    v_mul_f32 v245, v245, v248
    v_accvgpr_write_b32 a67, v245
    v_accvgpr_read_b32 v245, a68
    v_mul_f32 v245, v245, v248
    v_accvgpr_write_b32 a68, v245
    v_accvgpr_read_b32 v245, a69
    v_mul_f32 v245, v245, v248
    v_accvgpr_write_b32 a69, v245
    v_accvgpr_read_b32 v245, a70
    v_mul_f32 v245, v245, v248
    v_accvgpr_write_b32 a70, v245
    v_accvgpr_read_b32 v245, a71
    v_mul_f32 v245, v245, v248
    v_accvgpr_write_b32 a71, v245
    v_accvgpr_read_b32 v245, a72
    v_mul_f32 v245, v245, v248
    v_accvgpr_write_b32 a72, v245
    v_accvgpr_read_b32 v245, a73
    v_mul_f32 v245, v245, v248
    v_accvgpr_write_b32 a73, v245
    v_accvgpr_read_b32 v245, a74
    v_mul_f32 v245, v245, v248
    v_accvgpr_write_b32 a74, v245
    v_accvgpr_read_b32 v245, a75
    v_mul_f32 v245, v245, v248
    v_accvgpr_write_b32 a75, v245
    v_accvgpr_read_b32 v245, a76
    v_mul_f32 v245, v245, v248
    v_accvgpr_write_b32 a76, v245
    v_accvgpr_read_b32 v245, a77
    v_mul_f32 v245, v245, v248
    v_accvgpr_write_b32 a77, v245
    v_accvgpr_read_b32 v245, a78
    v_mul_f32 v245, v245, v248
    v_accvgpr_write_b32 a78, v245
    v_accvgpr_read_b32 v245, a79
    v_mul_f32 v245, v245, v248
    v_accvgpr_write_b32 a79, v245
    v_accvgpr_read_b32 v245, a80
    v_mul_f32 v245, v245, v248
    v_accvgpr_write_b32 a80, v245
    v_accvgpr_read_b32 v245, a81
    v_mul_f32 v245, v245, v248
    v_accvgpr_write_b32 a81, v245
    v_accvgpr_read_b32 v245, a82
    v_mul_f32 v245, v245, v248
    v_accvgpr_write_b32 a82, v245
    v_accvgpr_read_b32 v245, a83
    v_mul_f32 v245, v245, v248
    v_accvgpr_write_b32 a83, v245
    v_accvgpr_read_b32 v245, a84
    v_mul_f32 v245, v245, v248
    v_accvgpr_write_b32 a84, v245
    v_accvgpr_read_b32 v245, a85
    v_mul_f32 v245, v245, v248
    v_accvgpr_write_b32 a85, v245
    v_accvgpr_read_b32 v245, a86
    v_mul_f32 v245, v245, v248
    v_accvgpr_write_b32 a86, v245
    v_accvgpr_read_b32 v245, a87
    v_mul_f32 v245, v245, v248
    v_accvgpr_write_b32 a87, v245
    v_accvgpr_read_b32 v245, a88
    v_mul_f32 v245, v245, v248
    v_accvgpr_write_b32 a88, v245
    v_accvgpr_read_b32 v245, a89
    v_mul_f32 v245, v245, v248
    v_accvgpr_write_b32 a89, v245
    v_accvgpr_read_b32 v245, a90
    v_mul_f32 v245, v245, v248
    v_accvgpr_write_b32 a90, v245
    v_accvgpr_read_b32 v245, a91
    v_mul_f32 v245, v245, v248
    v_accvgpr_write_b32 a91, v245
    v_accvgpr_read_b32 v245, a92
    v_mul_f32 v245, v245, v248
    v_accvgpr_write_b32 a92, v245
    v_accvgpr_read_b32 v245, a93
    v_mul_f32 v245, v245, v248
    v_accvgpr_write_b32 a93, v245
    v_accvgpr_read_b32 v245, a94
    v_mul_f32 v245, v245, v248
    v_accvgpr_write_b32 a94, v245
    v_accvgpr_read_b32 v245, a95
    v_mul_f32 v245, v245, v248
    v_accvgpr_write_b32 a95, v245
    v_accvgpr_read_b32 v245, a96
    v_mul_f32 v245, v245, v248
    v_accvgpr_write_b32 a96, v245
    v_accvgpr_read_b32 v245, a97
    v_mul_f32 v245, v245, v248
    v_accvgpr_write_b32 a97, v245
    v_accvgpr_read_b32 v245, a98
    v_mul_f32 v245, v245, v248
    v_accvgpr_write_b32 a98, v245
    v_accvgpr_read_b32 v245, a99
    v_mul_f32 v245, v245, v248
    v_accvgpr_write_b32 a99, v245
    v_accvgpr_read_b32 v245, a100
    v_mul_f32 v245, v245, v248
    v_accvgpr_write_b32 a100, v245
    v_accvgpr_read_b32 v245, a101
    v_mul_f32 v245, v245, v248
    v_accvgpr_write_b32 a101, v245
    v_accvgpr_read_b32 v245, a102
    v_mul_f32 v245, v245, v248
    v_accvgpr_write_b32 a102, v245
    v_accvgpr_read_b32 v245, a103
    v_mul_f32 v245, v245, v248
    v_accvgpr_write_b32 a103, v245
    v_accvgpr_read_b32 v245, a104
    v_mul_f32 v245, v245, v248
    v_accvgpr_write_b32 a104, v245
    v_accvgpr_read_b32 v245, a105
    v_mul_f32 v245, v245, v248
    v_accvgpr_write_b32 a105, v245
    v_accvgpr_read_b32 v245, a106
    v_mul_f32 v245, v245, v248
    v_accvgpr_write_b32 a106, v245
    v_accvgpr_read_b32 v245, a107
    v_mul_f32 v245, v245, v248
    v_accvgpr_write_b32 a107, v245
    v_accvgpr_read_b32 v245, a108
    v_mul_f32 v245, v245, v248
    v_accvgpr_write_b32 a108, v245
    v_accvgpr_read_b32 v245, a109
    v_mul_f32 v245, v245, v248
    v_accvgpr_write_b32 a109, v245
    v_accvgpr_read_b32 v245, a110
    v_mul_f32 v245, v245, v248
    v_accvgpr_write_b32 a110, v245
    v_accvgpr_read_b32 v245, a111
    v_mul_f32 v245, v245, v248
    v_accvgpr_write_b32 a111, v245
    v_accvgpr_read_b32 v245, a112
    v_mul_f32 v245, v245, v248
    v_accvgpr_write_b32 a112, v245
    v_accvgpr_read_b32 v245, a113
    v_mul_f32 v245, v245, v248
    v_accvgpr_write_b32 a113, v245
    v_accvgpr_read_b32 v245, a114
    v_mul_f32 v245, v245, v248
    v_accvgpr_write_b32 a114, v245
    v_accvgpr_read_b32 v245, a115
    v_mul_f32 v245, v245, v248
    v_accvgpr_write_b32 a115, v245
    v_accvgpr_read_b32 v245, a116
    v_mul_f32 v245, v245, v248
    v_accvgpr_write_b32 a116, v245
    v_accvgpr_read_b32 v245, a117
    v_mul_f32 v245, v245, v248
    v_accvgpr_write_b32 a117, v245
    v_accvgpr_read_b32 v245, a118
    v_mul_f32 v245, v245, v248
    v_accvgpr_write_b32 a118, v245
    v_accvgpr_read_b32 v245, a119
    v_mul_f32 v245, v245, v248
    v_accvgpr_write_b32 a119, v245
    v_accvgpr_read_b32 v245, a120
    v_mul_f32 v245, v245, v248
    v_accvgpr_write_b32 a120, v245
    v_accvgpr_read_b32 v245, a121
    v_mul_f32 v245, v245, v248
    v_accvgpr_write_b32 a121, v245
    v_accvgpr_read_b32 v245, a122
    v_mul_f32 v245, v245, v248
    v_accvgpr_write_b32 a122, v245
    v_accvgpr_read_b32 v245, a123
    v_mul_f32 v245, v245, v248
    v_accvgpr_write_b32 a123, v245
    v_accvgpr_read_b32 v245, a124
    v_mul_f32 v245, v245, v248
    v_accvgpr_write_b32 a124, v245
    v_accvgpr_read_b32 v245, a125
    v_mul_f32 v245, v245, v248
    v_accvgpr_write_b32 a125, v245
    v_accvgpr_read_b32 v245, a126
    v_mul_f32 v245, v245, v248
    v_accvgpr_write_b32 a126, v245
    v_accvgpr_read_b32 v245, a127
    v_mul_f32 v245, v245, v248
    v_accvgpr_write_b32 a127, v245
    v_fma_f32 v232, v160, s21, v239
    s_nop 0
    v_fma_f32 v233, v161, s21, v239
    v_exp_f32 v232, v232
    s_nop 0
    v_fma_f32 v234, v162, s21, v239
    v_exp_f32 v233, v233
    s_nop 0
    v_fma_f32 v235, v163, s21, v239
    v_exp_f32 v234, v234
    v_add_f32 v243, v232, v233
    v_cvt_pk_bf16_f32 v200, v232, v233
    s_nop 0
    v_fma_f32 v232, v164, s21, v239
    v_exp_f32 v235, v235
    v_add_f32 v243, v243, v234
    s_nop 0
    v_fma_f32 v233, v165, s21, v239
    v_exp_f32 v232, v232
    v_add_f32 v243, v243, v235
    v_cvt_pk_bf16_f32 v201, v234, v235
    s_nop 0
    v_fma_f32 v234, v166, s21, v239
    v_exp_f32 v233, v233
    v_add_f32 v243, v243, v232
    s_nop 0
    v_fma_f32 v235, v167, s21, v239
    v_exp_f32 v234, v234
    v_add_f32 v243, v243, v233
    v_cvt_pk_bf16_f32 v202, v232, v233
    s_nop 0
    v_fma_f32 v232, v176, s21, v240
    v_exp_f32 v235, v235
    v_add_f32 v243, v243, v234
    s_nop 0
    v_fma_f32 v233, v177, s21, v240
    v_exp_f32 v232, v232
    v_add_f32 v243, v243, v235
    v_cvt_pk_bf16_f32 v203, v234, v235
    s_nop 0
    v_fma_f32 v234, v178, s21, v240
    v_exp_f32 v233, v233
    s_nop 0
    v_fma_f32 v235, v179, s21, v240
    v_exp_f32 v234, v234
    v_add_f32 v244, v232, v233
    v_cvt_pk_bf16_f32 v204, v232, v233
    s_nop 0
    v_fma_f32 v232, v180, s21, v240
    v_exp_f32 v235, v235
    v_add_f32 v244, v244, v234
    s_nop 0
    v_fma_f32 v233, v181, s21, v240
    v_exp_f32 v232, v232
    v_add_f32 v244, v244, v235
    v_cvt_pk_bf16_f32 v205, v234, v235
    s_nop 0
    v_fma_f32 v234, v182, s21, v240
    v_exp_f32 v233, v233
    v_add_f32 v244, v244, v232
    s_nop 0
    v_fma_f32 v235, v183, s21, v240
    v_exp_f32 v234, v234
    v_add_f32 v244, v244, v233
    v_cvt_pk_bf16_f32 v206, v232, v233
    s_nop 0
    v_fma_f32 v232, v168, s21, v239
    v_exp_f32 v235, v235
    v_add_f32 v244, v244, v234
    s_nop 0
    v_fma_f32 v233, v169, s21, v239
    v_exp_f32 v232, v232
    v_add_f32 v244, v244, v235
    v_cvt_pk_bf16_f32 v207, v234, v235
    s_nop 0
    v_fma_f32 v234, v170, s21, v239
    v_exp_f32 v233, v233
    v_add_f32 v243, v243, v232
    s_nop 0
    v_fma_f32 v235, v171, s21, v239
    v_exp_f32 v234, v234
    v_add_f32 v243, v243, v233
    v_cvt_pk_bf16_f32 v208, v232, v233
    s_nop 0
    v_fma_f32 v232, v172, s21, v239
    v_exp_f32 v235, v235
    v_add_f32 v243, v243, v234
    s_nop 0
    v_fma_f32 v233, v173, s21, v239
    v_exp_f32 v232, v232
    v_add_f32 v243, v243, v235
    v_cvt_pk_bf16_f32 v209, v234, v235
    s_nop 0
    v_fma_f32 v234, v174, s21, v239
    v_exp_f32 v233, v233
    v_add_f32 v243, v243, v232
    s_nop 0
    v_fma_f32 v235, v175, s21, v239
    v_exp_f32 v234, v234
    v_add_f32 v243, v243, v233
    v_cvt_pk_bf16_f32 v210, v232, v233
    s_nop 0
    v_fma_f32 v232, v184, s21, v240
    v_exp_f32 v235, v235
    v_add_f32 v243, v243, v234
    s_nop 0
    v_fma_f32 v233, v185, s21, v240
    v_exp_f32 v232, v232
    v_add_f32 v243, v243, v235
    v_cvt_pk_bf16_f32 v211, v234, v235
    s_nop 0
    v_fma_f32 v234, v186, s21, v240
    v_exp_f32 v233, v233
    v_add_f32 v244, v244, v232
    s_nop 0
    v_fma_f32 v235, v187, s21, v240
    v_exp_f32 v234, v234
    v_add_f32 v244, v244, v233
    v_cvt_pk_bf16_f32 v212, v232, v233
    s_nop 0
    v_fma_f32 v232, v188, s21, v240
    v_exp_f32 v235, v235
    v_add_f32 v244, v244, v234
    s_nop 0
    v_fma_f32 v233, v189, s21, v240
    v_exp_f32 v232, v232
    v_add_f32 v244, v244, v235
    v_cvt_pk_bf16_f32 v213, v234, v235
    s_nop 0
    v_fma_f32 v234, v190, s21, v240
    v_exp_f32 v233, v233
    v_add_f32 v244, v244, v232
    s_nop 0
    v_fma_f32 v235, v191, s21, v240
    v_exp_f32 v234, v234
    v_add_f32 v244, v244, v233
    v_cvt_pk_bf16_f32 v214, v232, v233
    s_nop 0
    v_exp_f32 v235, v235
    v_add_f32 v244, v244, v234
    s_nop 0
    v_add_f32 v244, v244, v235
    v_cvt_pk_bf16_f32 v215, v234, v235
    s_nop 0
    s_nop 3
    s_branch L_backs1A
L_raref15A:
    s_nop 7
    v_max3_f32 v247, v160, v161, v162
    v_max3_f32 v247, v247, v163, v164
    v_max3_f32 v247, v247, v165, v166
    v_max3_f32 v247, v247, v167, v168
    v_max3_f32 v247, v247, v169, v170
    v_max3_f32 v247, v247, v171, v172
    v_max3_f32 v247, v247, v173, v174
    v_max_f32 v247, v247, v175
    v_mov_b32 v245, v247
    s_nop 1
    v_permlane32_swap_b32 v245, v247
    s_nop 0
    v_max_f32 v247, v247, v245
    v_mul_f32 v247, s30, v247
    v_min_f32 v247, v247, v239
    v_sub_f32 v248, v247, v239
    v_exp_f32 v248, v248
    v_mov_b32 v239, v247
    v_mul_f32 v241, v241, v248
    v_mul_f32 v0, v0, v248
    v_mul_f32 v1, v1, v248
    v_mul_f32 v2, v2, v248
    v_mul_f32 v3, v3, v248
    v_mul_f32 v4, v4, v248
    v_mul_f32 v5, v5, v248
    v_mul_f32 v6, v6, v248
    v_mul_f32 v7, v7, v248
    v_mul_f32 v8, v8, v248
    v_mul_f32 v9, v9, v248
    v_mul_f32 v10, v10, v248
    v_mul_f32 v11, v11, v248
    v_mul_f32 v12, v12, v248
    v_mul_f32 v13, v13, v248
    v_mul_f32 v14, v14, v248
    v_mul_f32 v15, v15, v248
    v_mul_f32 v16, v16, v248
    v_mul_f32 v17, v17, v248
    v_mul_f32 v18, v18, v248
    v_mul_f32 v19, v19, v248
    v_mul_f32 v20, v20, v248
    v_mul_f32 v21, v21, v248
    v_mul_f32 v22, v22, v248
    v_mul_f32 v23, v23, v248
    v_mul_f32 v24, v24, v248
    v_mul_f32 v25, v25, v248
    v_mul_f32 v26, v26, v248
    v_mul_f32 v27, v27, v248
    v_mul_f32 v28, v28, v248
    v_mul_f32 v29, v29, v248
    v_mul_f32 v30, v30, v248
    v_mul_f32 v31, v31, v248
    v_mul_f32 v32, v32, v248
    v_mul_f32 v33, v33, v248
    v_mul_f32 v34, v34, v248
    v_mul_f32 v35, v35, v248
    v_mul_f32 v36, v36, v248
    v_mul_f32 v37, v37, v248
    v_mul_f32 v38, v38, v248
    v_mul_f32 v39, v39, v248
    v_mul_f32 v40, v40, v248
    v_mul_f32 v41, v41, v248
    v_mul_f32 v42, v42, v248
    v_mul_f32 v43, v43, v248
    v_mul_f32 v44, v44, v248
    v_mul_f32 v45, v45, v248
    v_mul_f32 v46, v46, v248
    v_mul_f32 v47, v47, v248
    v_mul_f32 v48, v48, v248
    v_mul_f32 v49, v49, v248
    v_mul_f32 v50, v50, v248
    v_mul_f32 v51, v51, v248
    v_mul_f32 v52, v52, v248
    v_mul_f32 v53, v53, v248
    v_mul_f32 v54, v54, v248
    v_mul_f32 v55, v55, v248
    v_mul_f32 v56, v56, v248
    v_mul_f32 v57, v57, v248
    v_mul_f32 v58, v58, v248
    v_mul_f32 v59, v59, v248
    v_mul_f32 v60, v60, v248
    v_mul_f32 v61, v61, v248
    v_mul_f32 v62, v62, v248
    v_mul_f32 v63, v63, v248
    v_mul_f32 v64, v64, v248
    v_mul_f32 v65, v65, v248
    v_mul_f32 v66, v66, v248
    v_mul_f32 v67, v67, v248
    v_mul_f32 v68, v68, v248
    v_mul_f32 v69, v69, v248
    v_mul_f32 v70, v70, v248
    v_mul_f32 v71, v71, v248
    v_mul_f32 v72, v72, v248
    v_mul_f32 v73, v73, v248
    v_mul_f32 v74, v74, v248
    v_mul_f32 v75, v75, v248
    v_mul_f32 v76, v76, v248
    v_mul_f32 v77, v77, v248
    v_mul_f32 v78, v78, v248
    v_mul_f32 v79, v79, v248
    v_mul_f32 v80, v80, v248
    v_mul_f32 v81, v81, v248
    v_mul_f32 v82, v82, v248
    v_mul_f32 v83, v83, v248
    v_mul_f32 v84, v84, v248
    v_mul_f32 v85, v85, v248
    v_mul_f32 v86, v86, v248
    v_mul_f32 v87, v87, v248
    v_mul_f32 v88, v88, v248
    v_mul_f32 v89, v89, v248
    v_mul_f32 v90, v90, v248
    v_mul_f32 v91, v91, v248
    v_mul_f32 v92, v92, v248
    v_mul_f32 v93, v93, v248
    v_mul_f32 v94, v94, v248
    v_mul_f32 v95, v95, v248
    v_mul_f32 v96, v96, v248
    v_mul_f32 v97, v97, v248
    v_mul_f32 v98, v98, v248
    v_mul_f32 v99, v99, v248
    v_mul_f32 v100, v100, v248
    v_mul_f32 v101, v101, v248
    v_mul_f32 v102, v102, v248
    v_mul_f32 v103, v103, v248
    v_mul_f32 v104, v104, v248
    v_mul_f32 v105, v105, v248
    v_mul_f32 v106, v106, v248
    v_mul_f32 v107, v107, v248
    v_mul_f32 v108, v108, v248
    v_mul_f32 v109, v109, v248
    v_mul_f32 v110, v110, v248
    v_mul_f32 v111, v111, v248
    v_mul_f32 v112, v112, v248
    v_mul_f32 v113, v113, v248
    v_mul_f32 v114, v114, v248
    v_mul_f32 v115, v115, v248
    v_mul_f32 v116, v116, v248
    v_mul_f32 v117, v117, v248
    v_mul_f32 v118, v118, v248
    v_mul_f32 v119, v119, v248
    v_mul_f32 v120, v120, v248
    v_mul_f32 v121, v121, v248
    v_mul_f32 v122, v122, v248
    v_mul_f32 v123, v123, v248
    v_mul_f32 v124, v124, v248
    v_mul_f32 v125, v125, v248
    v_mul_f32 v126, v126, v248
    v_mul_f32 v127, v127, v248
    v_max3_f32 v247, v176, v177, v178
    v_max3_f32 v247, v247, v179, v180
    v_max3_f32 v247, v247, v181, v182
    v_max3_f32 v247, v247, v183, v184
    v_max3_f32 v247, v247, v185, v186
    v_max3_f32 v247, v247, v187, v188
    v_max3_f32 v247, v247, v189, v190
    v_max_f32 v247, v247, v191
    v_mov_b32 v245, v247
    s_nop 1
    v_permlane32_swap_b32 v245, v247
    s_nop 0
    v_max_f32 v247, v247, v245
    v_mul_f32 v247, s30, v247
    v_min_f32 v247, v247, v240
    v_sub_f32 v248, v247, v240
    v_exp_f32 v248, v248
    v_mov_b32 v240, v247
    v_mul_f32 v242, v242, v248
    v_accvgpr_read_b32 v245, a0
    v_mul_f32 v245, v245, v248
    v_accvgpr_write_b32 a0, v245
    v_accvgpr_read_b32 v245, a1
    v_mul_f32 v245, v245, v248
    v_accvgpr_write_b32 a1, v245
    v_accvgpr_read_b32 v245, a2
    v_mul_f32 v245, v245, v248
    v_accvgpr_write_b32 a2, v245
    v_accvgpr_read_b32 v245, a3
    v_mul_f32 v245, v245, v248
    v_accvgpr_write_b32 a3, v245
    v_accvgpr_read_b32 v245, a4
    v_mul_f32 v245, v245, v248
    v_accvgpr_write_b32 a4, v245
    v_accvgpr_read_b32 v245, a5
    v_mul_f32 v245, v245, v248
    v_accvgpr_write_b32 a5, v245
    v_accvgpr_read_b32 v245, a6
    v_mul_f32 v245, v245, v248
    v_accvgpr_write_b32 a6, v245
    v_accvgpr_read_b32 v245, a7
    v_mul_f32 v245, v245, v248
    v_accvgpr_write_b32 a7, v245
    v_accvgpr_read_b32 v245, a8
    v_mul_f32 v245, v245, v248
    v_accvgpr_write_b32 a8, v245
    v_accvgpr_read_b32 v245, a9
    v_mul_f32 v245, v245, v248
    v_accvgpr_write_b32 a9, v245
    v_accvgpr_read_b32 v245, a10
    v_mul_f32 v245, v245, v248
    v_accvgpr_write_b32 a10, v245
    v_accvgpr_read_b32 v245, a11
    v_mul_f32 v245, v245, v248
    v_accvgpr_write_b32 a11, v245
    v_accvgpr_read_b32 v245, a12
    v_mul_f32 v245, v245, v248
    v_accvgpr_write_b32 a12, v245
    v_accvgpr_read_b32 v245, a13
    v_mul_f32 v245, v245, v248
    v_accvgpr_write_b32 a13, v245
    v_accvgpr_read_b32 v245, a14
    v_mul_f32 v245, v245, v248
    v_accvgpr_write_b32 a14, v245
    v_accvgpr_read_b32 v245, a15
    v_mul_f32 v245, v245, v248
    v_accvgpr_write_b32 a15, v245
    v_accvgpr_read_b32 v245, a16
    v_mul_f32 v245, v245, v248
    v_accvgpr_write_b32 a16, v245
    v_accvgpr_read_b32 v245, a17
    v_mul_f32 v245, v245, v248
    v_accvgpr_write_b32 a17, v245
    v_accvgpr_read_b32 v245, a18
    v_mul_f32 v245, v245, v248
    v_accvgpr_write_b32 a18, v245
    v_accvgpr_read_b32 v245, a19
    v_mul_f32 v245, v245, v248
    v_accvgpr_write_b32 a19, v245
    v_accvgpr_read_b32 v245, a20
    v_mul_f32 v245, v245, v248
    v_accvgpr_write_b32 a20, v245
    v_accvgpr_read_b32 v245, a21
    v_mul_f32 v245, v245, v248
    v_accvgpr_write_b32 a21, v245
    v_accvgpr_read_b32 v245, a22
    v_mul_f32 v245, v245, v248
    v_accvgpr_write_b32 a22, v245
    v_accvgpr_read_b32 v245, a23
    v_mul_f32 v245, v245, v248
    v_accvgpr_write_b32 a23, v245
    v_accvgpr_read_b32 v245, a24
    v_mul_f32 v245, v245, v248
    v_accvgpr_write_b32 a24, v245
    v_accvgpr_read_b32 v245, a25
    v_mul_f32 v245, v245, v248
    v_accvgpr_write_b32 a25, v245
    v_accvgpr_read_b32 v245, a26
    v_mul_f32 v245, v245, v248
    v_accvgpr_write_b32 a26, v245
    v_accvgpr_read_b32 v245, a27
    v_mul_f32 v245, v245, v248
    v_accvgpr_write_b32 a27, v245
    v_accvgpr_read_b32 v245, a28
    v_mul_f32 v245, v245, v248
    v_accvgpr_write_b32 a28, v245
    v_accvgpr_read_b32 v245, a29
    v_mul_f32 v245, v245, v248
    v_accvgpr_write_b32 a29, v245
    v_accvgpr_read_b32 v245, a30
    v_mul_f32 v245, v245, v248
    v_accvgpr_write_b32 a30, v245
    v_accvgpr_read_b32 v245, a31
    v_mul_f32 v245, v245, v248
    v_accvgpr_write_b32 a31, v245
    v_accvgpr_read_b32 v245, a32
    v_mul_f32 v245, v245, v248
    v_accvgpr_write_b32 a32, v245
    v_accvgpr_read_b32 v245, a33
    v_mul_f32 v245, v245, v248
    v_accvgpr_write_b32 a33, v245
    v_accvgpr_read_b32 v245, a34
    v_mul_f32 v245, v245, v248
    v_accvgpr_write_b32 a34, v245
    v_accvgpr_read_b32 v245, a35
    v_mul_f32 v245, v245, v248
    v_accvgpr_write_b32 a35, v245
    v_accvgpr_read_b32 v245, a36
    v_mul_f32 v245, v245, v248
    v_accvgpr_write_b32 a36, v245
    v_accvgpr_read_b32 v245, a37
    v_mul_f32 v245, v245, v248
    v_accvgpr_write_b32 a37, v245
    v_accvgpr_read_b32 v245, a38
    v_mul_f32 v245, v245, v248
    v_accvgpr_write_b32 a38, v245
    v_accvgpr_read_b32 v245, a39
    v_mul_f32 v245, v245, v248
    v_accvgpr_write_b32 a39, v245
    v_accvgpr_read_b32 v245, a40
    v_mul_f32 v245, v245, v248
    v_accvgpr_write_b32 a40, v245
    v_accvgpr_read_b32 v245, a41
    v_mul_f32 v245, v245, v248
    v_accvgpr_write_b32 a41, v245
    v_accvgpr_read_b32 v245, a42
    v_mul_f32 v245, v245, v248
    v_accvgpr_write_b32 a42, v245
    v_accvgpr_read_b32 v245, a43
    v_mul_f32 v245, v245, v248
    v_accvgpr_write_b32 a43, v245
    v_accvgpr_read_b32 v245, a44
    v_mul_f32 v245, v245, v248
    v_accvgpr_write_b32 a44, v245
    v_accvgpr_read_b32 v245, a45
    v_mul_f32 v245, v245, v248
    v_accvgpr_write_b32 a45, v245
    v_accvgpr_read_b32 v245, a46
    v_mul_f32 v245, v245, v248
    v_accvgpr_write_b32 a46, v245
    v_accvgpr_read_b32 v245, a47
    v_mul_f32 v245, v245, v248
    v_accvgpr_write_b32 a47, v245
    v_accvgpr_read_b32 v245, a48
    v_mul_f32 v245, v245, v248
    v_accvgpr_write_b32 a48, v245
    v_accvgpr_read_b32 v245, a49
    v_mul_f32 v245, v245, v248
    v_accvgpr_write_b32 a49, v245
    v_accvgpr_read_b32 v245, a50
    v_mul_f32 v245, v245, v248
    v_accvgpr_write_b32 a50, v245
    v_accvgpr_read_b32 v245, a51
    v_mul_f32 v245, v245, v248
    v_accvgpr_write_b32 a51, v245
    v_accvgpr_read_b32 v245, a52
    v_mul_f32 v245, v245, v248
    v_accvgpr_write_b32 a52, v245
    v_accvgpr_read_b32 v245, a53
    v_mul_f32 v245, v245, v248
    v_accvgpr_write_b32 a53, v245
    v_accvgpr_read_b32 v245, a54
    v_mul_f32 v245, v245, v248
    v_accvgpr_write_b32 a54, v245
    v_accvgpr_read_b32 v245, a55
    v_mul_f32 v245, v245, v248
    v_accvgpr_write_b32 a55, v245
    v_accvgpr_read_b32 v245, a56
    v_mul_f32 v245, v245, v248
    v_accvgpr_write_b32 a56, v245
    v_accvgpr_read_b32 v245, a57
    v_mul_f32 v245, v245, v248
    v_accvgpr_write_b32 a57, v245
    v_accvgpr_read_b32 v245, a58
    v_mul_f32 v245, v245, v248
    v_accvgpr_write_b32 a58, v245
    v_accvgpr_read_b32 v245, a59
    v_mul_f32 v245, v245, v248
    v_accvgpr_write_b32 a59, v245
    v_accvgpr_read_b32 v245, a60
    v_mul_f32 v245, v245, v248
    v_accvgpr_write_b32 a60, v245
    v_accvgpr_read_b32 v245, a61
    v_mul_f32 v245, v245, v248
    v_accvgpr_write_b32 a61, v245
    v_accvgpr_read_b32 v245, a62
    v_mul_f32 v245, v245, v248
    v_accvgpr_write_b32 a62, v245
    v_accvgpr_read_b32 v245, a63
    v_mul_f32 v245, v245, v248
    v_accvgpr_write_b32 a63, v245
    v_accvgpr_read_b32 v245, a64
    v_mul_f32 v245, v245, v248
    v_accvgpr_write_b32 a64, v245
    v_accvgpr_read_b32 v245, a65
    v_mul_f32 v245, v245, v248
    v_accvgpr_write_b32 a65, v245
    v_accvgpr_read_b32 v245, a66
    v_mul_f32 v245, v245, v248
    v_accvgpr_write_b32 a66, v245
    v_accvgpr_read_b32 v245, a67
    v_mul_f32 v245, v245, v248
    v_accvgpr_write_b32 a67, v245
    v_accvgpr_read_b32 v245, a68
    v_mul_f32 v245, v245, v248
    v_accvgpr_write_b32 a68, v245
    v_accvgpr_read_b32 v245, a69
    v_mul_f32 v245, v245, v248
    v_accvgpr_write_b32 a69, v245
    v_accvgpr_read_b32 v245, a70
    v_mul_f32 v245, v245, v248
    v_accvgpr_write_b32 a70, v245
    v_accvgpr_read_b32 v245, a71
    v_mul_f32 v245, v245, v248
    v_accvgpr_write_b32 a71, v245
    v_accvgpr_read_b32 v245, a72
    v_mul_f32 v245, v245, v248
    v_accvgpr_write_b32 a72, v245
    v_accvgpr_read_b32 v245, a73
    v_mul_f32 v245, v245, v248
    v_accvgpr_write_b32 a73, v245
    v_accvgpr_read_b32 v245, a74
    v_mul_f32 v245, v245, v248
    v_accvgpr_write_b32 a74, v245
    v_accvgpr_read_b32 v245, a75
    v_mul_f32 v245, v245, v248
    v_accvgpr_write_b32 a75, v245
    v_accvgpr_read_b32 v245, a76
    v_mul_f32 v245, v245, v248
    v_accvgpr_write_b32 a76, v245
    v_accvgpr_read_b32 v245, a77
    v_mul_f32 v245, v245, v248
    v_accvgpr_write_b32 a77, v245
    v_accvgpr_read_b32 v245, a78
    v_mul_f32 v245, v245, v248
    v_accvgpr_write_b32 a78, v245
    v_accvgpr_read_b32 v245, a79
    v_mul_f32 v245, v245, v248
    v_accvgpr_write_b32 a79, v245
    v_accvgpr_read_b32 v245, a80
    v_mul_f32 v245, v245, v248
    v_accvgpr_write_b32 a80, v245
    v_accvgpr_read_b32 v245, a81
    v_mul_f32 v245, v245, v248
    v_accvgpr_write_b32 a81, v245
    v_accvgpr_read_b32 v245, a82
    v_mul_f32 v245, v245, v248
    v_accvgpr_write_b32 a82, v245
    v_accvgpr_read_b32 v245, a83
    v_mul_f32 v245, v245, v248
    v_accvgpr_write_b32 a83, v245
    v_accvgpr_read_b32 v245, a84
    v_mul_f32 v245, v245, v248
    v_accvgpr_write_b32 a84, v245
    v_accvgpr_read_b32 v245, a85
    v_mul_f32 v245, v245, v248
    v_accvgpr_write_b32 a85, v245
    v_accvgpr_read_b32 v245, a86
    v_mul_f32 v245, v245, v248
    v_accvgpr_write_b32 a86, v245
    v_accvgpr_read_b32 v245, a87
    v_mul_f32 v245, v245, v248
    v_accvgpr_write_b32 a87, v245
    v_accvgpr_read_b32 v245, a88
    v_mul_f32 v245, v245, v248
    v_accvgpr_write_b32 a88, v245
    v_accvgpr_read_b32 v245, a89
    v_mul_f32 v245, v245, v248
    v_accvgpr_write_b32 a89, v245
    v_accvgpr_read_b32 v245, a90
    v_mul_f32 v245, v245, v248
    v_accvgpr_write_b32 a90, v245
    v_accvgpr_read_b32 v245, a91
    v_mul_f32 v245, v245, v248
    v_accvgpr_write_b32 a91, v245
    v_accvgpr_read_b32 v245, a92
    v_mul_f32 v245, v245, v248
    v_accvgpr_write_b32 a92, v245
    v_accvgpr_read_b32 v245, a93
    v_mul_f32 v245, v245, v248
    v_accvgpr_write_b32 a93, v245
    v_accvgpr_read_b32 v245, a94
    v_mul_f32 v245, v245, v248
    v_accvgpr_write_b32 a94, v245
    v_accvgpr_read_b32 v245, a95
    v_mul_f32 v245, v245, v248
    v_accvgpr_write_b32 a95, v245
    v_accvgpr_read_b32 v245, a96
    v_mul_f32 v245, v245, v248
    v_accvgpr_write_b32 a96, v245
    v_accvgpr_read_b32 v245, a97
    v_mul_f32 v245, v245, v248
    v_accvgpr_write_b32 a97, v245
    v_accvgpr_read_b32 v245, a98
    v_mul_f32 v245, v245, v248
    v_accvgpr_write_b32 a98, v245
    v_accvgpr_read_b32 v245, a99
    v_mul_f32 v245, v245, v248
    v_accvgpr_write_b32 a99, v245
    v_accvgpr_read_b32 v245, a100
    v_mul_f32 v245, v245, v248
    v_accvgpr_write_b32 a100, v245
    v_accvgpr_read_b32 v245, a101
    v_mul_f32 v245, v245, v248
    v_accvgpr_write_b32 a101, v245
    v_accvgpr_read_b32 v245, a102
    v_mul_f32 v245, v245, v248
    v_accvgpr_write_b32 a102, v245
    v_accvgpr_read_b32 v245, a103
    v_mul_f32 v245, v245, v248
    v_accvgpr_write_b32 a103, v245
    v_accvgpr_read_b32 v245, a104
    v_mul_f32 v245, v245, v248
    v_accvgpr_write_b32 a104, v245
    v_accvgpr_read_b32 v245, a105
    v_mul_f32 v245, v245, v248
    v_accvgpr_write_b32 a105, v245
    v_accvgpr_read_b32 v245, a106
    v_mul_f32 v245, v245, v248
    v_accvgpr_write_b32 a106, v245
    v_accvgpr_read_b32 v245, a107
    v_mul_f32 v245, v245, v248
    v_accvgpr_write_b32 a107, v245
    v_accvgpr_read_b32 v245, a108
    v_mul_f32 v245, v245, v248
    v_accvgpr_write_b32 a108, v245
    v_accvgpr_read_b32 v245, a109
    v_mul_f32 v245, v245, v248
    v_accvgpr_write_b32 a109, v245
    v_accvgpr_read_b32 v245, a110
    v_mul_f32 v245, v245, v248
    v_accvgpr_write_b32 a110, v245
    v_accvgpr_read_b32 v245, a111
    v_mul_f32 v245, v245, v248
    v_accvgpr_write_b32 a111, v245
    v_accvgpr_read_b32 v245, a112
    v_mul_f32 v245, v245, v248
    v_accvgpr_write_b32 a112, v245
    v_accvgpr_read_b32 v245, a113
    v_mul_f32 v245, v245, v248
    v_accvgpr_write_b32 a113, v245
    v_accvgpr_read_b32 v245, a114
    v_mul_f32 v245, v245, v248
    v_accvgpr_write_b32 a114, v245
    v_accvgpr_read_b32 v245, a115
    v_mul_f32 v245, v245, v248
    v_accvgpr_write_b32 a115, v245
    v_accvgpr_read_b32 v245, a116
    v_mul_f32 v245, v245, v248
    v_accvgpr_write_b32 a116, v245
    v_accvgpr_read_b32 v245, a117
    v_mul_f32 v245, v245, v248
    v_accvgpr_write_b32 a117, v245
    v_accvgpr_read_b32 v245, a118
    v_mul_f32 v245, v245, v248
    v_accvgpr_write_b32 a118, v245
    v_accvgpr_read_b32 v245, a119
    v_mul_f32 v245, v245, v248
    v_accvgpr_write_b32 a119, v245
    v_accvgpr_read_b32 v245, a120
    v_mul_f32 v245, v245, v248
    v_accvgpr_write_b32 a120, v245
    v_accvgpr_read_b32 v245, a121
    v_mul_f32 v245, v245, v248
    v_accvgpr_write_b32 a121, v245
    v_accvgpr_read_b32 v245, a122
    v_mul_f32 v245, v245, v248
    v_accvgpr_write_b32 a122, v245
    v_accvgpr_read_b32 v245, a123
    v_mul_f32 v245, v245, v248
    v_accvgpr_write_b32 a123, v245
    v_accvgpr_read_b32 v245, a124
    v_mul_f32 v245, v245, v248
    v_accvgpr_write_b32 a124, v245
    v_accvgpr_read_b32 v245, a125
    v_mul_f32 v245, v245, v248
    v_accvgpr_write_b32 a125, v245
    v_accvgpr_read_b32 v245, a126
    v_mul_f32 v245, v245, v248
    v_accvgpr_write_b32 a126, v245
    v_accvgpr_read_b32 v245, a127
    v_mul_f32 v245, v245, v248
    v_accvgpr_write_b32 a127, v245
    v_fma_f32 v232, v160, s21, v239
    s_nop 0
    v_fma_f32 v233, v161, s21, v239
    v_exp_f32 v232, v232
    s_nop 0
    v_fma_f32 v234, v162, s21, v239
    v_exp_f32 v233, v233
    s_nop 0
    v_fma_f32 v235, v163, s21, v239
    v_exp_f32 v234, v234
    v_add_f32 v243, v232, v233
    v_cvt_pk_bf16_f32 v200, v232, v233
    s_nop 0
    v_fma_f32 v232, v164, s21, v239
    v_exp_f32 v235, v235
    v_add_f32 v243, v243, v234
    s_nop 0
    v_fma_f32 v233, v165, s21, v239
    v_exp_f32 v232, v232
    v_add_f32 v243, v243, v235
    v_cvt_pk_bf16_f32 v201, v234, v235
    s_nop 0
    v_fma_f32 v234, v166, s21, v239
    v_exp_f32 v233, v233
    v_add_f32 v243, v243, v232
    s_nop 0
    v_fma_f32 v235, v167, s21, v239
    v_exp_f32 v234, v234
    v_add_f32 v243, v243, v233
    v_cvt_pk_bf16_f32 v202, v232, v233
    s_nop 0
    v_fma_f32 v232, v176, s21, v240
    v_exp_f32 v235, v235
    v_add_f32 v243, v243, v234
    s_nop 0
    v_fma_f32 v233, v177, s21, v240
    v_exp_f32 v232, v232
    v_add_f32 v243, v243, v235
    v_cvt_pk_bf16_f32 v203, v234, v235
    s_nop 0
    v_fma_f32 v234, v178, s21, v240
    v_exp_f32 v233, v233
    s_nop 0
    v_fma_f32 v235, v179, s21, v240
    v_exp_f32 v234, v234
    v_add_f32 v244, v232, v233
    v_cvt_pk_bf16_f32 v204, v232, v233
    s_nop 0
    v_fma_f32 v232, v180, s21, v240
    v_exp_f32 v235, v235
    v_add_f32 v244, v244, v234
    s_nop 0
    v_fma_f32 v233, v181, s21, v240
    v_exp_f32 v232, v232
    v_add_f32 v244, v244, v235
    v_cvt_pk_bf16_f32 v205, v234, v235
    s_nop 0
    v_fma_f32 v234, v182, s21, v240
    v_exp_f32 v233, v233
    v_add_f32 v244, v244, v232
    s_nop 0
    v_fma_f32 v235, v183, s21, v240
    v_exp_f32 v234, v234
    v_add_f32 v244, v244, v233
    v_cvt_pk_bf16_f32 v206, v232, v233
    s_nop 0
    v_fma_f32 v232, v168, s21, v239
    v_exp_f32 v235, v235
    v_add_f32 v244, v244, v234
    s_nop 0
    v_fma_f32 v233, v169, s21, v239
    v_exp_f32 v232, v232
    v_add_f32 v244, v244, v235
    v_cvt_pk_bf16_f32 v207, v234, v235
    s_nop 0
    v_fma_f32 v234, v170, s21, v239
    v_exp_f32 v233, v233
    v_add_f32 v243, v243, v232
    s_nop 0
    v_fma_f32 v235, v171, s21, v239
    v_exp_f32 v234, v234
    v_add_f32 v243, v243, v233
    v_cvt_pk_bf16_f32 v208, v232, v233
    s_nop 0
    v_fma_f32 v232, v172, s21, v239
    v_exp_f32 v235, v235
    v_add_f32 v243, v243, v234
    s_nop 0
    v_fma_f32 v233, v173, s21, v239
    v_exp_f32 v232, v232
    v_add_f32 v243, v243, v235
    v_cvt_pk_bf16_f32 v209, v234, v235
    s_nop 0
    v_fma_f32 v234, v174, s21, v239
    v_exp_f32 v233, v233
    v_add_f32 v243, v243, v232
    s_nop 0
    v_fma_f32 v235, v175, s21, v239
    v_exp_f32 v234, v234
    v_add_f32 v243, v243, v233
    v_cvt_pk_bf16_f32 v210, v232, v233
    s_nop 0
    v_fma_f32 v232, v184, s21, v240
    v_exp_f32 v235, v235
    v_add_f32 v243, v243, v234
    s_nop 0
    v_fma_f32 v233, v185, s21, v240
    v_exp_f32 v232, v232
    v_add_f32 v243, v243, v235
    v_cvt_pk_bf16_f32 v211, v234, v235
    s_nop 0
    v_fma_f32 v234, v186, s21, v240
    v_exp_f32 v233, v233
    v_add_f32 v244, v244, v232
    s_nop 0
    v_fma_f32 v235, v187, s21, v240
    v_exp_f32 v234, v234
    v_add_f32 v244, v244, v233
    v_cvt_pk_bf16_f32 v212, v232, v233
    s_nop 0
    v_fma_f32 v232, v188, s21, v240
    v_exp_f32 v235, v235
    v_add_f32 v244, v244, v234
    s_nop 0
    v_fma_f32 v233, v189, s21, v240
    v_exp_f32 v232, v232
    v_add_f32 v244, v244, v235
    v_cvt_pk_bf16_f32 v213, v234, v235
    s_nop 0
    v_fma_f32 v234, v190, s21, v240
    v_exp_f32 v233, v233
    v_add_f32 v244, v244, v232
    s_nop 0
    v_fma_f32 v235, v191, s21, v240
    v_exp_f32 v234, v234
    v_add_f32 v244, v244, v233
    v_cvt_pk_bf16_f32 v214, v232, v233
    s_nop 0
    v_exp_f32 v235, v235
    v_add_f32 v244, v244, v234
    s_nop 0
    v_add_f32 v244, v244, v235
    v_cvt_pk_bf16_f32 v215, v234, v235
    s_nop 0
    s_nop 3
    s_branch L_backf15A
L_rarel0B:
    s_nop 7
    v_max3_f32 v247, v128, v129, v130
    v_max3_f32 v247, v247, v131, v132
    v_max3_f32 v247, v247, v133, v134
    v_max3_f32 v247, v247, v135, v136
    v_max3_f32 v247, v247, v137, v138
    v_max3_f32 v247, v247, v139, v140
    v_max3_f32 v247, v247, v141, v142
    v_max_f32 v247, v247, v143
    v_mov_b32 v245, v247
    s_nop 1
    v_permlane32_swap_b32 v245, v247
    s_nop 0
    v_max_f32 v247, v247, v245
    v_mul_f32 v247, s30, v247
    v_min_f32 v247, v247, v239
    v_sub_f32 v248, v247, v239
    v_exp_f32 v248, v248
    v_mov_b32 v239, v247
    v_mul_f32 v241, v241, v248
    v_mul_f32 v0, v0, v248
    v_mul_f32 v1, v1, v248
    v_mul_f32 v2, v2, v248
    v_mul_f32 v3, v3, v248
    v_mul_f32 v4, v4, v248
    v_mul_f32 v5, v5, v248
    v_mul_f32 v6, v6, v248
    v_mul_f32 v7, v7, v248
    v_mul_f32 v8, v8, v248
    v_mul_f32 v9, v9, v248
    v_mul_f32 v10, v10, v248
    v_mul_f32 v11, v11, v248
    v_mul_f32 v12, v12, v248
    v_mul_f32 v13, v13, v248
    v_mul_f32 v14, v14, v248
    v_mul_f32 v15, v15, v248
    v_mul_f32 v16, v16, v248
    v_mul_f32 v17, v17, v248
    v_mul_f32 v18, v18, v248
    v_mul_f32 v19, v19, v248
    v_mul_f32 v20, v20, v248
    v_mul_f32 v21, v21, v248
    v_mul_f32 v22, v22, v248
    v_mul_f32 v23, v23, v248
    v_mul_f32 v24, v24, v248
    v_mul_f32 v25, v25, v248
    v_mul_f32 v26, v26, v248
    v_mul_f32 v27, v27, v248
    v_mul_f32 v28, v28, v248
    v_mul_f32 v29, v29, v248
    v_mul_f32 v30, v30, v248
    v_mul_f32 v31, v31, v248
    v_mul_f32 v32, v32, v248
    v_mul_f32 v33, v33, v248
    v_mul_f32 v34, v34, v248
    v_mul_f32 v35, v35, v248
    v_mul_f32 v36, v36, v248
    v_mul_f32 v37, v37, v248
    v_mul_f32 v38, v38, v248
    v_mul_f32 v39, v39, v248
    v_mul_f32 v40, v40, v248
    v_mul_f32 v41, v41, v248
    v_mul_f32 v42, v42, v248
    v_mul_f32 v43, v43, v248
    v_mul_f32 v44, v44, v248
    v_mul_f32 v45, v45, v248
    v_mul_f32 v46, v46, v248
    v_mul_f32 v47, v47, v248
    v_mul_f32 v48, v48, v248
    v_mul_f32 v49, v49, v248
    v_mul_f32 v50, v50, v248
    v_mul_f32 v51, v51, v248
    v_mul_f32 v52, v52, v248
    v_mul_f32 v53, v53, v248
    v_mul_f32 v54, v54, v248
    v_mul_f32 v55, v55, v248
    v_mul_f32 v56, v56, v248
    v_mul_f32 v57, v57, v248
    v_mul_f32 v58, v58, v248
    v_mul_f32 v59, v59, v248
    v_mul_f32 v60, v60, v248
    v_mul_f32 v61, v61, v248
    v_mul_f32 v62, v62, v248
    v_mul_f32 v63, v63, v248
    v_mul_f32 v64, v64, v248
    v_mul_f32 v65, v65, v248
    v_mul_f32 v66, v66, v248
    v_mul_f32 v67, v67, v248
    v_mul_f32 v68, v68, v248
    v_mul_f32 v69, v69, v248
    v_mul_f32 v70, v70, v248
    v_mul_f32 v71, v71, v248
    v_mul_f32 v72, v72, v248
    v_mul_f32 v73, v73, v248
    v_mul_f32 v74, v74, v248
    v_mul_f32 v75, v75, v248
    v_mul_f32 v76, v76, v248
    v_mul_f32 v77, v77, v248
    v_mul_f32 v78, v78, v248
    v_mul_f32 v79, v79, v248
    v_mul_f32 v80, v80, v248
    v_mul_f32 v81, v81, v248
    v_mul_f32 v82, v82, v248
    v_mul_f32 v83, v83, v248
    v_mul_f32 v84, v84, v248
    v_mul_f32 v85, v85, v248
    v_mul_f32 v86, v86, v248
    v_mul_f32 v87, v87, v248
    v_mul_f32 v88, v88, v248
    v_mul_f32 v89, v89, v248
    v_mul_f32 v90, v90, v248
    v_mul_f32 v91, v91, v248
    v_mul_f32 v92, v92, v248
    v_mul_f32 v93, v93, v248
    v_mul_f32 v94, v94, v248
    v_mul_f32 v95, v95, v248
    v_mul_f32 v96, v96, v248
    v_mul_f32 v97, v97, v248
    v_mul_f32 v98, v98, v248
    v_mul_f32 v99, v99, v248
    v_mul_f32 v100, v100, v248
    v_mul_f32 v101, v101, v248
    v_mul_f32 v102, v102, v248
    v_mul_f32 v103, v103, v248
    v_mul_f32 v104, v104, v248
    v_mul_f32 v105, v105, v248
    v_mul_f32 v106, v106, v248
    v_mul_f32 v107, v107, v248
    v_mul_f32 v108, v108, v248
    v_mul_f32 v109, v109, v248
    v_mul_f32 v110, v110, v248
    v_mul_f32 v111, v111, v248
    v_mul_f32 v112, v112, v248
    v_mul_f32 v113, v113, v248
    v_mul_f32 v114, v114, v248
    v_mul_f32 v115, v115, v248
    v_mul_f32 v116, v116, v248
    v_mul_f32 v117, v117, v248
    v_mul_f32 v118, v118, v248
    v_mul_f32 v119, v119, v248
    v_mul_f32 v120, v120, v248
    v_mul_f32 v121, v121, v248
    v_mul_f32 v122, v122, v248
    v_mul_f32 v123, v123, v248
    v_mul_f32 v124, v124, v248
    v_mul_f32 v125, v125, v248
    v_mul_f32 v126, v126, v248
    v_mul_f32 v127, v127, v248
    v_max3_f32 v247, v144, v145, v146
    v_max3_f32 v247, v247, v147, v148
    v_max3_f32 v247, v247, v149, v150
    v_max3_f32 v247, v247, v151, v152
    v_max3_f32 v247, v247, v153, v154
    v_max3_f32 v247, v247, v155, v156
    v_max3_f32 v247, v247, v157, v158
    v_max_f32 v247, v247, v159
    v_mov_b32 v245, v247
    s_nop 1
    v_permlane32_swap_b32 v245, v247
    s_nop 0
    v_max_f32 v247, v247, v245
    v_mul_f32 v247, s30, v247
    v_min_f32 v247, v247, v240
    v_sub_f32 v248, v247, v240
    v_exp_f32 v248, v248
    v_mov_b32 v240, v247
    v_mul_f32 v242, v242, v248
    v_accvgpr_read_b32 v245, a0
    v_mul_f32 v245, v245, v248
    v_accvgpr_write_b32 a0, v245
    v_accvgpr_read_b32 v245, a1
    v_mul_f32 v245, v245, v248
    v_accvgpr_write_b32 a1, v245
    v_accvgpr_read_b32 v245, a2
    v_mul_f32 v245, v245, v248
    v_accvgpr_write_b32 a2, v245
    v_accvgpr_read_b32 v245, a3
    v_mul_f32 v245, v245, v248
    v_accvgpr_write_b32 a3, v245
    v_accvgpr_read_b32 v245, a4
    v_mul_f32 v245, v245, v248
    v_accvgpr_write_b32 a4, v245
    v_accvgpr_read_b32 v245, a5
    v_mul_f32 v245, v245, v248
    v_accvgpr_write_b32 a5, v245
    v_accvgpr_read_b32 v245, a6
    v_mul_f32 v245, v245, v248
    v_accvgpr_write_b32 a6, v245
    v_accvgpr_read_b32 v245, a7
    v_mul_f32 v245, v245, v248
    v_accvgpr_write_b32 a7, v245
    v_accvgpr_read_b32 v245, a8
    v_mul_f32 v245, v245, v248
    v_accvgpr_write_b32 a8, v245
    v_accvgpr_read_b32 v245, a9
    v_mul_f32 v245, v245, v248
    v_accvgpr_write_b32 a9, v245
    v_accvgpr_read_b32 v245, a10
    v_mul_f32 v245, v245, v248
    v_accvgpr_write_b32 a10, v245
    v_accvgpr_read_b32 v245, a11
    v_mul_f32 v245, v245, v248
    v_accvgpr_write_b32 a11, v245
    v_accvgpr_read_b32 v245, a12
    v_mul_f32 v245, v245, v248
    v_accvgpr_write_b32 a12, v245
    v_accvgpr_read_b32 v245, a13
    v_mul_f32 v245, v245, v248
    v_accvgpr_write_b32 a13, v245
    v_accvgpr_read_b32 v245, a14
    v_mul_f32 v245, v245, v248
    v_accvgpr_write_b32 a14, v245
    v_accvgpr_read_b32 v245, a15
    v_mul_f32 v245, v245, v248
    v_accvgpr_write_b32 a15, v245
    v_accvgpr_read_b32 v245, a16
    v_mul_f32 v245, v245, v248
    v_accvgpr_write_b32 a16, v245
    v_accvgpr_read_b32 v245, a17
    v_mul_f32 v245, v245, v248
    v_accvgpr_write_b32 a17, v245
    v_accvgpr_read_b32 v245, a18
    v_mul_f32 v245, v245, v248
    v_accvgpr_write_b32 a18, v245
    v_accvgpr_read_b32 v245, a19
    v_mul_f32 v245, v245, v248
    v_accvgpr_write_b32 a19, v245
    v_accvgpr_read_b32 v245, a20
    v_mul_f32 v245, v245, v248
    v_accvgpr_write_b32 a20, v245
    v_accvgpr_read_b32 v245, a21
    v_mul_f32 v245, v245, v248
    v_accvgpr_write_b32 a21, v245
    v_accvgpr_read_b32 v245, a22
    v_mul_f32 v245, v245, v248
    v_accvgpr_write_b32 a22, v245
    v_accvgpr_read_b32 v245, a23
    v_mul_f32 v245, v245, v248
    v_accvgpr_write_b32 a23, v245
    v_accvgpr_read_b32 v245, a24
    v_mul_f32 v245, v245, v248
    v_accvgpr_write_b32 a24, v245
    v_accvgpr_read_b32 v245, a25
    v_mul_f32 v245, v245, v248
    v_accvgpr_write_b32 a25, v245
    v_accvgpr_read_b32 v245, a26
    v_mul_f32 v245, v245, v248
    v_accvgpr_write_b32 a26, v245
    v_accvgpr_read_b32 v245, a27
    v_mul_f32 v245, v245, v248
    v_accvgpr_write_b32 a27, v245
    v_accvgpr_read_b32 v245, a28
    v_mul_f32 v245, v245, v248
    v_accvgpr_write_b32 a28, v245
    v_accvgpr_read_b32 v245, a29
    v_mul_f32 v245, v245, v248
    v_accvgpr_write_b32 a29, v245
    v_accvgpr_read_b32 v245, a30
    v_mul_f32 v245, v245, v248
    v_accvgpr_write_b32 a30, v245
    v_accvgpr_read_b32 v245, a31
    v_mul_f32 v245, v245, v248
    v_accvgpr_write_b32 a31, v245
    v_accvgpr_read_b32 v245, a32
    v_mul_f32 v245, v245, v248
    v_accvgpr_write_b32 a32, v245
    v_accvgpr_read_b32 v245, a33
    v_mul_f32 v245, v245, v248
    v_accvgpr_write_b32 a33, v245
    v_accvgpr_read_b32 v245, a34
    v_mul_f32 v245, v245, v248
    v_accvgpr_write_b32 a34, v245
    v_accvgpr_read_b32 v245, a35
    v_mul_f32 v245, v245, v248
    v_accvgpr_write_b32 a35, v245
    v_accvgpr_read_b32 v245, a36
    v_mul_f32 v245, v245, v248
    v_accvgpr_write_b32 a36, v245
    v_accvgpr_read_b32 v245, a37
    v_mul_f32 v245, v245, v248
    v_accvgpr_write_b32 a37, v245
    v_accvgpr_read_b32 v245, a38
    v_mul_f32 v245, v245, v248
    v_accvgpr_write_b32 a38, v245
    v_accvgpr_read_b32 v245, a39
    v_mul_f32 v245, v245, v248
    v_accvgpr_write_b32 a39, v245
    v_accvgpr_read_b32 v245, a40
    v_mul_f32 v245, v245, v248
    v_accvgpr_write_b32 a40, v245
    v_accvgpr_read_b32 v245, a41
    v_mul_f32 v245, v245, v248
    v_accvgpr_write_b32 a41, v245
    v_accvgpr_read_b32 v245, a42
    v_mul_f32 v245, v245, v248
    v_accvgpr_write_b32 a42, v245
    v_accvgpr_read_b32 v245, a43
    v_mul_f32 v245, v245, v248
    v_accvgpr_write_b32 a43, v245
    v_accvgpr_read_b32 v245, a44
    v_mul_f32 v245, v245, v248
    v_accvgpr_write_b32 a44, v245
    v_accvgpr_read_b32 v245, a45
    v_mul_f32 v245, v245, v248
    v_accvgpr_write_b32 a45, v245
    v_accvgpr_read_b32 v245, a46
    v_mul_f32 v245, v245, v248
    v_accvgpr_write_b32 a46, v245
    v_accvgpr_read_b32 v245, a47
    v_mul_f32 v245, v245, v248
    v_accvgpr_write_b32 a47, v245
    v_accvgpr_read_b32 v245, a48
    v_mul_f32 v245, v245, v248
    v_accvgpr_write_b32 a48, v245
    v_accvgpr_read_b32 v245, a49
    v_mul_f32 v245, v245, v248
    v_accvgpr_write_b32 a49, v245
    v_accvgpr_read_b32 v245, a50
    v_mul_f32 v245, v245, v248
    v_accvgpr_write_b32 a50, v245
    v_accvgpr_read_b32 v245, a51
    v_mul_f32 v245, v245, v248
    v_accvgpr_write_b32 a51, v245
    v_accvgpr_read_b32 v245, a52
    v_mul_f32 v245, v245, v248
    v_accvgpr_write_b32 a52, v245
    v_accvgpr_read_b32 v245, a53
    v_mul_f32 v245, v245, v248
    v_accvgpr_write_b32 a53, v245
    v_accvgpr_read_b32 v245, a54
    v_mul_f32 v245, v245, v248
    v_accvgpr_write_b32 a54, v245
    v_accvgpr_read_b32 v245, a55
    v_mul_f32 v245, v245, v248
    v_accvgpr_write_b32 a55, v245
    v_accvgpr_read_b32 v245, a56
    v_mul_f32 v245, v245, v248
    v_accvgpr_write_b32 a56, v245
    v_accvgpr_read_b32 v245, a57
    v_mul_f32 v245, v245, v248
    v_accvgpr_write_b32 a57, v245
    v_accvgpr_read_b32 v245, a58
    v_mul_f32 v245, v245, v248
    v_accvgpr_write_b32 a58, v245
    v_accvgpr_read_b32 v245, a59
    v_mul_f32 v245, v245, v248
    v_accvgpr_write_b32 a59, v245
    v_accvgpr_read_b32 v245, a60
    v_mul_f32 v245, v245, v248
    v_accvgpr_write_b32 a60, v245
    v_accvgpr_read_b32 v245, a61
    v_mul_f32 v245, v245, v248
    v_accvgpr_write_b32 a61, v245
    v_accvgpr_read_b32 v245, a62
    v_mul_f32 v245, v245, v248
    v_accvgpr_write_b32 a62, v245
    v_accvgpr_read_b32 v245, a63
    v_mul_f32 v245, v245, v248
    v_accvgpr_write_b32 a63, v245
    v_accvgpr_read_b32 v245, a64
    v_mul_f32 v245, v245, v248
    v_accvgpr_write_b32 a64, v245
    v_accvgpr_read_b32 v245, a65
    v_mul_f32 v245, v245, v248
    v_accvgpr_write_b32 a65, v245
    v_accvgpr_read_b32 v245, a66
    v_mul_f32 v245, v245, v248
    v_accvgpr_write_b32 a66, v245
    v_accvgpr_read_b32 v245, a67
    v_mul_f32 v245, v245, v248
    v_accvgpr_write_b32 a67, v245
    v_accvgpr_read_b32 v245, a68
    v_mul_f32 v245, v245, v248
    v_accvgpr_write_b32 a68, v245
    v_accvgpr_read_b32 v245, a69
    v_mul_f32 v245, v245, v248
    v_accvgpr_write_b32 a69, v245
    v_accvgpr_read_b32 v245, a70
    v_mul_f32 v245, v245, v248
    v_accvgpr_write_b32 a70, v245
    v_accvgpr_read_b32 v245, a71
    v_mul_f32 v245, v245, v248
    v_accvgpr_write_b32 a71, v245
    v_accvgpr_read_b32 v245, a72
    v_mul_f32 v245, v245, v248
    v_accvgpr_write_b32 a72, v245
    v_accvgpr_read_b32 v245, a73
    v_mul_f32 v245, v245, v248
    v_accvgpr_write_b32 a73, v245
    v_accvgpr_read_b32 v245, a74
    v_mul_f32 v245, v245, v248
    v_accvgpr_write_b32 a74, v245
    v_accvgpr_read_b32 v245, a75
    v_mul_f32 v245, v245, v248
    v_accvgpr_write_b32 a75, v245
    v_accvgpr_read_b32 v245, a76
    v_mul_f32 v245, v245, v248
    v_accvgpr_write_b32 a76, v245
    v_accvgpr_read_b32 v245, a77
    v_mul_f32 v245, v245, v248
    v_accvgpr_write_b32 a77, v245
    v_accvgpr_read_b32 v245, a78
    v_mul_f32 v245, v245, v248
    v_accvgpr_write_b32 a78, v245
    v_accvgpr_read_b32 v245, a79
    v_mul_f32 v245, v245, v248
    v_accvgpr_write_b32 a79, v245
    v_accvgpr_read_b32 v245, a80
    v_mul_f32 v245, v245, v248
    v_accvgpr_write_b32 a80, v245
    v_accvgpr_read_b32 v245, a81
    v_mul_f32 v245, v245, v248
    v_accvgpr_write_b32 a81, v245
    v_accvgpr_read_b32 v245, a82
    v_mul_f32 v245, v245, v248
    v_accvgpr_write_b32 a82, v245
    v_accvgpr_read_b32 v245, a83
    v_mul_f32 v245, v245, v248
    v_accvgpr_write_b32 a83, v245
    v_accvgpr_read_b32 v245, a84
    v_mul_f32 v245, v245, v248
    v_accvgpr_write_b32 a84, v245
    v_accvgpr_read_b32 v245, a85
    v_mul_f32 v245, v245, v248
    v_accvgpr_write_b32 a85, v245
    v_accvgpr_read_b32 v245, a86
    v_mul_f32 v245, v245, v248
    v_accvgpr_write_b32 a86, v245
    v_accvgpr_read_b32 v245, a87
    v_mul_f32 v245, v245, v248
    v_accvgpr_write_b32 a87, v245
    v_accvgpr_read_b32 v245, a88
    v_mul_f32 v245, v245, v248
    v_accvgpr_write_b32 a88, v245
    v_accvgpr_read_b32 v245, a89
    v_mul_f32 v245, v245, v248
    v_accvgpr_write_b32 a89, v245
    v_accvgpr_read_b32 v245, a90
    v_mul_f32 v245, v245, v248
    v_accvgpr_write_b32 a90, v245
    v_accvgpr_read_b32 v245, a91
    v_mul_f32 v245, v245, v248
    v_accvgpr_write_b32 a91, v245
    v_accvgpr_read_b32 v245, a92
    v_mul_f32 v245, v245, v248
    v_accvgpr_write_b32 a92, v245
    v_accvgpr_read_b32 v245, a93
    v_mul_f32 v245, v245, v248
    v_accvgpr_write_b32 a93, v245
    v_accvgpr_read_b32 v245, a94
    v_mul_f32 v245, v245, v248
    v_accvgpr_write_b32 a94, v245
    v_accvgpr_read_b32 v245, a95
    v_mul_f32 v245, v245, v248
    v_accvgpr_write_b32 a95, v245
    v_accvgpr_read_b32 v245, a96
    v_mul_f32 v245, v245, v248
    v_accvgpr_write_b32 a96, v245
    v_accvgpr_read_b32 v245, a97
    v_mul_f32 v245, v245, v248
    v_accvgpr_write_b32 a97, v245
    v_accvgpr_read_b32 v245, a98
    v_mul_f32 v245, v245, v248
    v_accvgpr_write_b32 a98, v245
    v_accvgpr_read_b32 v245, a99
    v_mul_f32 v245, v245, v248
    v_accvgpr_write_b32 a99, v245
    v_accvgpr_read_b32 v245, a100
    v_mul_f32 v245, v245, v248
    v_accvgpr_write_b32 a100, v245
    v_accvgpr_read_b32 v245, a101
    v_mul_f32 v245, v245, v248
    v_accvgpr_write_b32 a101, v245
    v_accvgpr_read_b32 v245, a102
    v_mul_f32 v245, v245, v248
    v_accvgpr_write_b32 a102, v245
    v_accvgpr_read_b32 v245, a103
    v_mul_f32 v245, v245, v248
    v_accvgpr_write_b32 a103, v245
    v_accvgpr_read_b32 v245, a104
    v_mul_f32 v245, v245, v248
    v_accvgpr_write_b32 a104, v245
    v_accvgpr_read_b32 v245, a105
    v_mul_f32 v245, v245, v248
    v_accvgpr_write_b32 a105, v245
    v_accvgpr_read_b32 v245, a106
    v_mul_f32 v245, v245, v248
    v_accvgpr_write_b32 a106, v245
    v_accvgpr_read_b32 v245, a107
    v_mul_f32 v245, v245, v248
    v_accvgpr_write_b32 a107, v245
    v_accvgpr_read_b32 v245, a108
    v_mul_f32 v245, v245, v248
    v_accvgpr_write_b32 a108, v245
    v_accvgpr_read_b32 v245, a109
    v_mul_f32 v245, v245, v248
    v_accvgpr_write_b32 a109, v245
    v_accvgpr_read_b32 v245, a110
    v_mul_f32 v245, v245, v248
    v_accvgpr_write_b32 a110, v245
    v_accvgpr_read_b32 v245, a111
    v_mul_f32 v245, v245, v248
    v_accvgpr_write_b32 a111, v245
    v_accvgpr_read_b32 v245, a112
    v_mul_f32 v245, v245, v248
    v_accvgpr_write_b32 a112, v245
    v_accvgpr_read_b32 v245, a113
    v_mul_f32 v245, v245, v248
    v_accvgpr_write_b32 a113, v245
    v_accvgpr_read_b32 v245, a114
    v_mul_f32 v245, v245, v248
    v_accvgpr_write_b32 a114, v245
    v_accvgpr_read_b32 v245, a115
    v_mul_f32 v245, v245, v248
    v_accvgpr_write_b32 a115, v245
    v_accvgpr_read_b32 v245, a116
    v_mul_f32 v245, v245, v248
    v_accvgpr_write_b32 a116, v245
    v_accvgpr_read_b32 v245, a117
    v_mul_f32 v245, v245, v248
    v_accvgpr_write_b32 a117, v245
    v_accvgpr_read_b32 v245, a118
    v_mul_f32 v245, v245, v248
    v_accvgpr_write_b32 a118, v245
    v_accvgpr_read_b32 v245, a119
    v_mul_f32 v245, v245, v248
    v_accvgpr_write_b32 a119, v245
    v_accvgpr_read_b32 v245, a120
    v_mul_f32 v245, v245, v248
    v_accvgpr_write_b32 a120, v245
    v_accvgpr_read_b32 v245, a121
    v_mul_f32 v245, v245, v248
    v_accvgpr_write_b32 a121, v245
    v_accvgpr_read_b32 v245, a122
    v_mul_f32 v245, v245, v248
    v_accvgpr_write_b32 a122, v245
    v_accvgpr_read_b32 v245, a123
    v_mul_f32 v245, v245, v248
    v_accvgpr_write_b32 a123, v245
    v_accvgpr_read_b32 v245, a124
    v_mul_f32 v245, v245, v248
    v_accvgpr_write_b32 a124, v245
    v_accvgpr_read_b32 v245, a125
    v_mul_f32 v245, v245, v248
    v_accvgpr_write_b32 a125, v245
    v_accvgpr_read_b32 v245, a126
    v_mul_f32 v245, v245, v248
    v_accvgpr_write_b32 a126, v245
    v_accvgpr_read_b32 v245, a127
    v_mul_f32 v245, v245, v248
    v_accvgpr_write_b32 a127, v245
    v_fma_f32 v232, v128, s21, v239
    s_nop 0
    v_fma_f32 v233, v129, s21, v239
    v_exp_f32 v232, v232
    s_nop 0
    v_fma_f32 v234, v130, s21, v239
    v_exp_f32 v233, v233
    s_nop 0
    v_fma_f32 v235, v131, s21, v239
    v_exp_f32 v234, v234
    v_add_f32 v243, v232, v233
    v_cvt_pk_bf16_f32 v192, v232, v233
    s_nop 0
    v_fma_f32 v232, v132, s21, v239
    v_exp_f32 v235, v235
    v_add_f32 v243, v243, v234
    s_nop 0
    v_fma_f32 v233, v133, s21, v239
    v_exp_f32 v232, v232
    v_add_f32 v243, v243, v235
    v_cvt_pk_bf16_f32 v193, v234, v235
    s_nop 0
    v_fma_f32 v234, v134, s21, v239
    v_exp_f32 v233, v233
    v_add_f32 v243, v243, v232
    s_nop 0
    v_fma_f32 v235, v135, s21, v239
    v_exp_f32 v234, v234
    v_add_f32 v243, v243, v233
    v_cvt_pk_bf16_f32 v194, v232, v233
    s_nop 0
    v_fma_f32 v232, v144, s21, v240
    v_exp_f32 v235, v235
    v_add_f32 v243, v243, v234
    s_nop 0
    v_fma_f32 v233, v145, s21, v240
    v_exp_f32 v232, v232
    v_add_f32 v243, v243, v235
    v_cvt_pk_bf16_f32 v195, v234, v235
    s_nop 0
    v_fma_f32 v234, v146, s21, v240
    v_exp_f32 v233, v233
    s_nop 0
    v_fma_f32 v235, v147, s21, v240
    v_exp_f32 v234, v234
    v_add_f32 v244, v232, v233
    v_cvt_pk_bf16_f32 v196, v232, v233
    s_nop 0
    v_fma_f32 v232, v148, s21, v240
    v_exp_f32 v235, v235
    v_add_f32 v244, v244, v234
    s_nop 0
    v_fma_f32 v233, v149, s21, v240
    v_exp_f32 v232, v232
    v_add_f32 v244, v244, v235
    v_cvt_pk_bf16_f32 v197, v234, v235
    s_nop 0
    v_fma_f32 v234, v150, s21, v240
    v_exp_f32 v233, v233
    v_add_f32 v244, v244, v232
    s_nop 0
    v_fma_f32 v235, v151, s21, v240
    v_exp_f32 v234, v234
    v_add_f32 v244, v244, v233
    v_cvt_pk_bf16_f32 v198, v232, v233
    s_nop 0
    v_fma_f32 v232, v136, s21, v239
    v_exp_f32 v235, v235
    v_add_f32 v244, v244, v234
    s_nop 0
    v_fma_f32 v233, v137, s21, v239
    v_exp_f32 v232, v232
    v_add_f32 v244, v244, v235
    v_cvt_pk_bf16_f32 v199, v234, v235
    s_nop 0
    v_fma_f32 v234, v138, s21, v239
    v_exp_f32 v233, v233
    v_add_f32 v243, v243, v232
    s_nop 0
    v_fma_f32 v235, v139, s21, v239
    v_exp_f32 v234, v234
    v_add_f32 v243, v243, v233
    v_cvt_pk_bf16_f32 v208, v232, v233
    s_nop 0
    v_fma_f32 v232, v140, s21, v239
    v_exp_f32 v235, v235
    v_add_f32 v243, v243, v234
    s_nop 0
    v_fma_f32 v233, v141, s21, v239
    v_exp_f32 v232, v232
    v_add_f32 v243, v243, v235
    v_cvt_pk_bf16_f32 v209, v234, v235
    s_nop 0
    v_fma_f32 v234, v142, s21, v239
    v_exp_f32 v233, v233
    v_add_f32 v243, v243, v232
    s_nop 0
    v_fma_f32 v235, v143, s21, v239
    v_exp_f32 v234, v234
    v_add_f32 v243, v243, v233
    v_cvt_pk_bf16_f32 v210, v232, v233
    s_nop 0
    v_fma_f32 v232, v152, s21, v240
    v_exp_f32 v235, v235
    v_add_f32 v243, v243, v234
    s_nop 0
    v_fma_f32 v233, v153, s21, v240
    v_exp_f32 v232, v232
    v_add_f32 v243, v243, v235
    v_cvt_pk_bf16_f32 v211, v234, v235
    s_nop 0
    v_fma_f32 v234, v154, s21, v240
    v_exp_f32 v233, v233
    v_add_f32 v244, v244, v232
    s_nop 0
    v_fma_f32 v235, v155, s21, v240
    v_exp_f32 v234, v234
    v_add_f32 v244, v244, v233
    v_cvt_pk_bf16_f32 v212, v232, v233
    s_nop 0
    v_fma_f32 v232, v156, s21, v240
    v_exp_f32 v235, v235
    v_add_f32 v244, v244, v234
    s_nop 0
    v_fma_f32 v233, v157, s21, v240
    v_exp_f32 v232, v232
    v_add_f32 v244, v244, v235
    v_cvt_pk_bf16_f32 v213, v234, v235
    s_nop 0
    v_fma_f32 v234, v158, s21, v240
    v_exp_f32 v233, v233
    v_add_f32 v244, v244, v232
    s_nop 0
    v_fma_f32 v235, v159, s21, v240
    v_exp_f32 v234, v234
    v_add_f32 v244, v244, v233
    v_cvt_pk_bf16_f32 v214, v232, v233
    s_nop 0
    v_exp_f32 v235, v235
    v_add_f32 v244, v244, v234
    s_nop 0
    v_add_f32 v244, v244, v235
    v_cvt_pk_bf16_f32 v215, v234, v235
    s_nop 0
    s_nop 3
    s_branch L_backl0B
L_rarel1B:
    s_nop 7
    v_max3_f32 v247, v160, v161, v162
    v_max3_f32 v247, v247, v163, v164
    v_max3_f32 v247, v247, v165, v166
    v_max3_f32 v247, v247, v167, v168
    v_max3_f32 v247, v247, v169, v170
    v_max3_f32 v247, v247, v171, v172
    v_max3_f32 v247, v247, v173, v174
    v_max_f32 v247, v247, v175
    v_mov_b32 v245, v247
    s_nop 1
    v_permlane32_swap_b32 v245, v247
    s_nop 0
    v_max_f32 v247, v247, v245
    v_mul_f32 v247, s30, v247
    v_min_f32 v247, v247, v239
    v_sub_f32 v248, v247, v239
    v_exp_f32 v248, v248
    v_mov_b32 v239, v247
    v_mul_f32 v241, v241, v248
    v_mul_f32 v0, v0, v248
    v_mul_f32 v1, v1, v248
    v_mul_f32 v2, v2, v248
    v_mul_f32 v3, v3, v248
    v_mul_f32 v4, v4, v248
    v_mul_f32 v5, v5, v248
    v_mul_f32 v6, v6, v248
    v_mul_f32 v7, v7, v248
    v_mul_f32 v8, v8, v248
    v_mul_f32 v9, v9, v248
    v_mul_f32 v10, v10, v248
    v_mul_f32 v11, v11, v248
    v_mul_f32 v12, v12, v248
    v_mul_f32 v13, v13, v248
    v_mul_f32 v14, v14, v248
    v_mul_f32 v15, v15, v248
    v_mul_f32 v16, v16, v248
    v_mul_f32 v17, v17, v248
    v_mul_f32 v18, v18, v248
    v_mul_f32 v19, v19, v248
    v_mul_f32 v20, v20, v248
    v_mul_f32 v21, v21, v248
    v_mul_f32 v22, v22, v248
    v_mul_f32 v23, v23, v248
    v_mul_f32 v24, v24, v248
    v_mul_f32 v25, v25, v248
    v_mul_f32 v26, v26, v248
    v_mul_f32 v27, v27, v248
    v_mul_f32 v28, v28, v248
    v_mul_f32 v29, v29, v248
    v_mul_f32 v30, v30, v248
    v_mul_f32 v31, v31, v248
    v_mul_f32 v32, v32, v248
    v_mul_f32 v33, v33, v248
    v_mul_f32 v34, v34, v248
    v_mul_f32 v35, v35, v248
    v_mul_f32 v36, v36, v248
    v_mul_f32 v37, v37, v248
    v_mul_f32 v38, v38, v248
    v_mul_f32 v39, v39, v248
    v_mul_f32 v40, v40, v248
    v_mul_f32 v41, v41, v248
    v_mul_f32 v42, v42, v248
    v_mul_f32 v43, v43, v248
    v_mul_f32 v44, v44, v248
    v_mul_f32 v45, v45, v248
    v_mul_f32 v46, v46, v248
    v_mul_f32 v47, v47, v248
    v_mul_f32 v48, v48, v248
    v_mul_f32 v49, v49, v248
    v_mul_f32 v50, v50, v248
    v_mul_f32 v51, v51, v248
    v_mul_f32 v52, v52, v248
    v_mul_f32 v53, v53, v248
    v_mul_f32 v54, v54, v248
    v_mul_f32 v55, v55, v248
    v_mul_f32 v56, v56, v248
    v_mul_f32 v57, v57, v248
    v_mul_f32 v58, v58, v248
    v_mul_f32 v59, v59, v248
    v_mul_f32 v60, v60, v248
    v_mul_f32 v61, v61, v248
    v_mul_f32 v62, v62, v248
    v_mul_f32 v63, v63, v248
    v_mul_f32 v64, v64, v248
    v_mul_f32 v65, v65, v248
    v_mul_f32 v66, v66, v248
    v_mul_f32 v67, v67, v248
    v_mul_f32 v68, v68, v248
    v_mul_f32 v69, v69, v248
    v_mul_f32 v70, v70, v248
    v_mul_f32 v71, v71, v248
    v_mul_f32 v72, v72, v248
    v_mul_f32 v73, v73, v248
    v_mul_f32 v74, v74, v248
    v_mul_f32 v75, v75, v248
    v_mul_f32 v76, v76, v248
    v_mul_f32 v77, v77, v248
    v_mul_f32 v78, v78, v248
    v_mul_f32 v79, v79, v248
    v_mul_f32 v80, v80, v248
    v_mul_f32 v81, v81, v248
    v_mul_f32 v82, v82, v248
    v_mul_f32 v83, v83, v248
    v_mul_f32 v84, v84, v248
    v_mul_f32 v85, v85, v248
    v_mul_f32 v86, v86, v248
    v_mul_f32 v87, v87, v248
    v_mul_f32 v88, v88, v248
    v_mul_f32 v89, v89, v248
    v_mul_f32 v90, v90, v248
    v_mul_f32 v91, v91, v248
    v_mul_f32 v92, v92, v248
    v_mul_f32 v93, v93, v248
    v_mul_f32 v94, v94, v248
    v_mul_f32 v95, v95, v248
    v_mul_f32 v96, v96, v248
    v_mul_f32 v97, v97, v248
    v_mul_f32 v98, v98, v248
    v_mul_f32 v99, v99, v248
    v_mul_f32 v100, v100, v248
    v_mul_f32 v101, v101, v248
    v_mul_f32 v102, v102, v248
    v_mul_f32 v103, v103, v248
    v_mul_f32 v104, v104, v248
    v_mul_f32 v105, v105, v248
    v_mul_f32 v106, v106, v248
    v_mul_f32 v107, v107, v248
    v_mul_f32 v108, v108, v248
    v_mul_f32 v109, v109, v248
    v_mul_f32 v110, v110, v248
    v_mul_f32 v111, v111, v248
    v_mul_f32 v112, v112, v248
    v_mul_f32 v113, v113, v248
    v_mul_f32 v114, v114, v248
    v_mul_f32 v115, v115, v248
    v_mul_f32 v116, v116, v248
    v_mul_f32 v117, v117, v248
    v_mul_f32 v118, v118, v248
    v_mul_f32 v119, v119, v248
    v_mul_f32 v120, v120, v248
    v_mul_f32 v121, v121, v248
    v_mul_f32 v122, v122, v248
    v_mul_f32 v123, v123, v248
    v_mul_f32 v124, v124, v248
    v_mul_f32 v125, v125, v248
    v_mul_f32 v126, v126, v248
    v_mul_f32 v127, v127, v248
    v_max3_f32 v247, v176, v177, v178
    v_max3_f32 v247, v247, v179, v180
    v_max3_f32 v247, v247, v181, v182
    v_max3_f32 v247, v247, v183, v184
    v_max3_f32 v247, v247, v185, v186
    v_max3_f32 v247, v247, v187, v188
    v_max3_f32 v247, v247, v189, v190
    v_max_f32 v247, v247, v191
    v_mov_b32 v245, v247
    s_nop 1
    v_permlane32_swap_b32 v245, v247
    s_nop 0
    v_max_f32 v247, v247, v245
    v_mul_f32 v247, s30, v247
    v_min_f32 v247, v247, v240
    v_sub_f32 v248, v247, v240
    v_exp_f32 v248, v248
    v_mov_b32 v240, v247
    v_mul_f32 v242, v242, v248
    v_accvgpr_read_b32 v245, a0
    v_mul_f32 v245, v245, v248
    v_accvgpr_write_b32 a0, v245
    v_accvgpr_read_b32 v245, a1
    v_mul_f32 v245, v245, v248
    v_accvgpr_write_b32 a1, v245
    v_accvgpr_read_b32 v245, a2
    v_mul_f32 v245, v245, v248
    v_accvgpr_write_b32 a2, v245
    v_accvgpr_read_b32 v245, a3
    v_mul_f32 v245, v245, v248
    v_accvgpr_write_b32 a3, v245
    v_accvgpr_read_b32 v245, a4
    v_mul_f32 v245, v245, v248
    v_accvgpr_write_b32 a4, v245
    v_accvgpr_read_b32 v245, a5
    v_mul_f32 v245, v245, v248
    v_accvgpr_write_b32 a5, v245
    v_accvgpr_read_b32 v245, a6
    v_mul_f32 v245, v245, v248
    v_accvgpr_write_b32 a6, v245
    v_accvgpr_read_b32 v245, a7
    v_mul_f32 v245, v245, v248
    v_accvgpr_write_b32 a7, v245
    v_accvgpr_read_b32 v245, a8
    v_mul_f32 v245, v245, v248
    v_accvgpr_write_b32 a8, v245
    v_accvgpr_read_b32 v245, a9
    v_mul_f32 v245, v245, v248
    v_accvgpr_write_b32 a9, v245
    v_accvgpr_read_b32 v245, a10
    v_mul_f32 v245, v245, v248
    v_accvgpr_write_b32 a10, v245
    v_accvgpr_read_b32 v245, a11
    v_mul_f32 v245, v245, v248
    v_accvgpr_write_b32 a11, v245
    v_accvgpr_read_b32 v245, a12
    v_mul_f32 v245, v245, v248
    v_accvgpr_write_b32 a12, v245
    v_accvgpr_read_b32 v245, a13
    v_mul_f32 v245, v245, v248
    v_accvgpr_write_b32 a13, v245
    v_accvgpr_read_b32 v245, a14
    v_mul_f32 v245, v245, v248
    v_accvgpr_write_b32 a14, v245
    v_accvgpr_read_b32 v245, a15
    v_mul_f32 v245, v245, v248
    v_accvgpr_write_b32 a15, v245
    v_accvgpr_read_b32 v245, a16
    v_mul_f32 v245, v245, v248
    v_accvgpr_write_b32 a16, v245
    v_accvgpr_read_b32 v245, a17
    v_mul_f32 v245, v245, v248
    v_accvgpr_write_b32 a17, v245
    v_accvgpr_read_b32 v245, a18
    v_mul_f32 v245, v245, v248
    v_accvgpr_write_b32 a18, v245
    v_accvgpr_read_b32 v245, a19
    v_mul_f32 v245, v245, v248
    v_accvgpr_write_b32 a19, v245
    v_accvgpr_read_b32 v245, a20
    v_mul_f32 v245, v245, v248
    v_accvgpr_write_b32 a20, v245
    v_accvgpr_read_b32 v245, a21
    v_mul_f32 v245, v245, v248
    v_accvgpr_write_b32 a21, v245
    v_accvgpr_read_b32 v245, a22
    v_mul_f32 v245, v245, v248
    v_accvgpr_write_b32 a22, v245
    v_accvgpr_read_b32 v245, a23
    v_mul_f32 v245, v245, v248
    v_accvgpr_write_b32 a23, v245
    v_accvgpr_read_b32 v245, a24
    v_mul_f32 v245, v245, v248
    v_accvgpr_write_b32 a24, v245
    v_accvgpr_read_b32 v245, a25
    v_mul_f32 v245, v245, v248
    v_accvgpr_write_b32 a25, v245
    v_accvgpr_read_b32 v245, a26
    v_mul_f32 v245, v245, v248
    v_accvgpr_write_b32 a26, v245
    v_accvgpr_read_b32 v245, a27
    v_mul_f32 v245, v245, v248
    v_accvgpr_write_b32 a27, v245
    v_accvgpr_read_b32 v245, a28
    v_mul_f32 v245, v245, v248
    v_accvgpr_write_b32 a28, v245
    v_accvgpr_read_b32 v245, a29
    v_mul_f32 v245, v245, v248
    v_accvgpr_write_b32 a29, v245
    v_accvgpr_read_b32 v245, a30
    v_mul_f32 v245, v245, v248
    v_accvgpr_write_b32 a30, v245
    v_accvgpr_read_b32 v245, a31
    v_mul_f32 v245, v245, v248
    v_accvgpr_write_b32 a31, v245
    v_accvgpr_read_b32 v245, a32
    v_mul_f32 v245, v245, v248
    v_accvgpr_write_b32 a32, v245
    v_accvgpr_read_b32 v245, a33
    v_mul_f32 v245, v245, v248
    v_accvgpr_write_b32 a33, v245
    v_accvgpr_read_b32 v245, a34
    v_mul_f32 v245, v245, v248
    v_accvgpr_write_b32 a34, v245
    v_accvgpr_read_b32 v245, a35
    v_mul_f32 v245, v245, v248
    v_accvgpr_write_b32 a35, v245
    v_accvgpr_read_b32 v245, a36
    v_mul_f32 v245, v245, v248
    v_accvgpr_write_b32 a36, v245
    v_accvgpr_read_b32 v245, a37
    v_mul_f32 v245, v245, v248
    v_accvgpr_write_b32 a37, v245
    v_accvgpr_read_b32 v245, a38
    v_mul_f32 v245, v245, v248
    v_accvgpr_write_b32 a38, v245
    v_accvgpr_read_b32 v245, a39
    v_mul_f32 v245, v245, v248
    v_accvgpr_write_b32 a39, v245
    v_accvgpr_read_b32 v245, a40
    v_mul_f32 v245, v245, v248
    v_accvgpr_write_b32 a40, v245
    v_accvgpr_read_b32 v245, a41
    v_mul_f32 v245, v245, v248
    v_accvgpr_write_b32 a41, v245
    v_accvgpr_read_b32 v245, a42
    v_mul_f32 v245, v245, v248
    v_accvgpr_write_b32 a42, v245
    v_accvgpr_read_b32 v245, a43
    v_mul_f32 v245, v245, v248
    v_accvgpr_write_b32 a43, v245
    v_accvgpr_read_b32 v245, a44
    v_mul_f32 v245, v245, v248
    v_accvgpr_write_b32 a44, v245
    v_accvgpr_read_b32 v245, a45
    v_mul_f32 v245, v245, v248
    v_accvgpr_write_b32 a45, v245
    v_accvgpr_read_b32 v245, a46
    v_mul_f32 v245, v245, v248
    v_accvgpr_write_b32 a46, v245
    v_accvgpr_read_b32 v245, a47
    v_mul_f32 v245, v245, v248
    v_accvgpr_write_b32 a47, v245
    v_accvgpr_read_b32 v245, a48
    v_mul_f32 v245, v245, v248
    v_accvgpr_write_b32 a48, v245
    v_accvgpr_read_b32 v245, a49
    v_mul_f32 v245, v245, v248
    v_accvgpr_write_b32 a49, v245
    v_accvgpr_read_b32 v245, a50
    v_mul_f32 v245, v245, v248
    v_accvgpr_write_b32 a50, v245
    v_accvgpr_read_b32 v245, a51
    v_mul_f32 v245, v245, v248
    v_accvgpr_write_b32 a51, v245
    v_accvgpr_read_b32 v245, a52
    v_mul_f32 v245, v245, v248
    v_accvgpr_write_b32 a52, v245
    v_accvgpr_read_b32 v245, a53
    v_mul_f32 v245, v245, v248
    v_accvgpr_write_b32 a53, v245
    v_accvgpr_read_b32 v245, a54
    v_mul_f32 v245, v245, v248
    v_accvgpr_write_b32 a54, v245
    v_accvgpr_read_b32 v245, a55
    v_mul_f32 v245, v245, v248
    v_accvgpr_write_b32 a55, v245
    v_accvgpr_read_b32 v245, a56
    v_mul_f32 v245, v245, v248
    v_accvgpr_write_b32 a56, v245
    v_accvgpr_read_b32 v245, a57
    v_mul_f32 v245, v245, v248
    v_accvgpr_write_b32 a57, v245
    v_accvgpr_read_b32 v245, a58
    v_mul_f32 v245, v245, v248
    v_accvgpr_write_b32 a58, v245
    v_accvgpr_read_b32 v245, a59
    v_mul_f32 v245, v245, v248
    v_accvgpr_write_b32 a59, v245
    v_accvgpr_read_b32 v245, a60
    v_mul_f32 v245, v245, v248
    v_accvgpr_write_b32 a60, v245
    v_accvgpr_read_b32 v245, a61
    v_mul_f32 v245, v245, v248
    v_accvgpr_write_b32 a61, v245
    v_accvgpr_read_b32 v245, a62
    v_mul_f32 v245, v245, v248
    v_accvgpr_write_b32 a62, v245
    v_accvgpr_read_b32 v245, a63
    v_mul_f32 v245, v245, v248
    v_accvgpr_write_b32 a63, v245
    v_accvgpr_read_b32 v245, a64
    v_mul_f32 v245, v245, v248
    v_accvgpr_write_b32 a64, v245
    v_accvgpr_read_b32 v245, a65
    v_mul_f32 v245, v245, v248
    v_accvgpr_write_b32 a65, v245
    v_accvgpr_read_b32 v245, a66
    v_mul_f32 v245, v245, v248
    v_accvgpr_write_b32 a66, v245
    v_accvgpr_read_b32 v245, a67
    v_mul_f32 v245, v245, v248
    v_accvgpr_write_b32 a67, v245
    v_accvgpr_read_b32 v245, a68
    v_mul_f32 v245, v245, v248
    v_accvgpr_write_b32 a68, v245
    v_accvgpr_read_b32 v245, a69
    v_mul_f32 v245, v245, v248
    v_accvgpr_write_b32 a69, v245
    v_accvgpr_read_b32 v245, a70
    v_mul_f32 v245, v245, v248
    v_accvgpr_write_b32 a70, v245
    v_accvgpr_read_b32 v245, a71
    v_mul_f32 v245, v245, v248
    v_accvgpr_write_b32 a71, v245
    v_accvgpr_read_b32 v245, a72
    v_mul_f32 v245, v245, v248
    v_accvgpr_write_b32 a72, v245
    v_accvgpr_read_b32 v245, a73
    v_mul_f32 v245, v245, v248
    v_accvgpr_write_b32 a73, v245
    v_accvgpr_read_b32 v245, a74
    v_mul_f32 v245, v245, v248
    v_accvgpr_write_b32 a74, v245
    v_accvgpr_read_b32 v245, a75
    v_mul_f32 v245, v245, v248
    v_accvgpr_write_b32 a75, v245
    v_accvgpr_read_b32 v245, a76
    v_mul_f32 v245, v245, v248
    v_accvgpr_write_b32 a76, v245
    v_accvgpr_read_b32 v245, a77
    v_mul_f32 v245, v245, v248
    v_accvgpr_write_b32 a77, v245
    v_accvgpr_read_b32 v245, a78
    v_mul_f32 v245, v245, v248
    v_accvgpr_write_b32 a78, v245
    v_accvgpr_read_b32 v245, a79
    v_mul_f32 v245, v245, v248
    v_accvgpr_write_b32 a79, v245
    v_accvgpr_read_b32 v245, a80
    v_mul_f32 v245, v245, v248
    v_accvgpr_write_b32 a80, v245
    v_accvgpr_read_b32 v245, a81
    v_mul_f32 v245, v245, v248
    v_accvgpr_write_b32 a81, v245
    v_accvgpr_read_b32 v245, a82
    v_mul_f32 v245, v245, v248
    v_accvgpr_write_b32 a82, v245
    v_accvgpr_read_b32 v245, a83
    v_mul_f32 v245, v245, v248
    v_accvgpr_write_b32 a83, v245
    v_accvgpr_read_b32 v245, a84
    v_mul_f32 v245, v245, v248
    v_accvgpr_write_b32 a84, v245
    v_accvgpr_read_b32 v245, a85
    v_mul_f32 v245, v245, v248
    v_accvgpr_write_b32 a85, v245
    v_accvgpr_read_b32 v245, a86
    v_mul_f32 v245, v245, v248
    v_accvgpr_write_b32 a86, v245
    v_accvgpr_read_b32 v245, a87
    v_mul_f32 v245, v245, v248
    v_accvgpr_write_b32 a87, v245
    v_accvgpr_read_b32 v245, a88
    v_mul_f32 v245, v245, v248
    v_accvgpr_write_b32 a88, v245
    v_accvgpr_read_b32 v245, a89
    v_mul_f32 v245, v245, v248
    v_accvgpr_write_b32 a89, v245
    v_accvgpr_read_b32 v245, a90
    v_mul_f32 v245, v245, v248
    v_accvgpr_write_b32 a90, v245
    v_accvgpr_read_b32 v245, a91
    v_mul_f32 v245, v245, v248
    v_accvgpr_write_b32 a91, v245
    v_accvgpr_read_b32 v245, a92
    v_mul_f32 v245, v245, v248
    v_accvgpr_write_b32 a92, v245
    v_accvgpr_read_b32 v245, a93
    v_mul_f32 v245, v245, v248
    v_accvgpr_write_b32 a93, v245
    v_accvgpr_read_b32 v245, a94
    v_mul_f32 v245, v245, v248
    v_accvgpr_write_b32 a94, v245
    v_accvgpr_read_b32 v245, a95
    v_mul_f32 v245, v245, v248
    v_accvgpr_write_b32 a95, v245
    v_accvgpr_read_b32 v245, a96
    v_mul_f32 v245, v245, v248
    v_accvgpr_write_b32 a96, v245
    v_accvgpr_read_b32 v245, a97
    v_mul_f32 v245, v245, v248
    v_accvgpr_write_b32 a97, v245
    v_accvgpr_read_b32 v245, a98
    v_mul_f32 v245, v245, v248
    v_accvgpr_write_b32 a98, v245
    v_accvgpr_read_b32 v245, a99
    v_mul_f32 v245, v245, v248
    v_accvgpr_write_b32 a99, v245
    v_accvgpr_read_b32 v245, a100
    v_mul_f32 v245, v245, v248
    v_accvgpr_write_b32 a100, v245
    v_accvgpr_read_b32 v245, a101
    v_mul_f32 v245, v245, v248
    v_accvgpr_write_b32 a101, v245
    v_accvgpr_read_b32 v245, a102
    v_mul_f32 v245, v245, v248
    v_accvgpr_write_b32 a102, v245
    v_accvgpr_read_b32 v245, a103
    v_mul_f32 v245, v245, v248
    v_accvgpr_write_b32 a103, v245
    v_accvgpr_read_b32 v245, a104
    v_mul_f32 v245, v245, v248
    v_accvgpr_write_b32 a104, v245
    v_accvgpr_read_b32 v245, a105
    v_mul_f32 v245, v245, v248
    v_accvgpr_write_b32 a105, v245
    v_accvgpr_read_b32 v245, a106
    v_mul_f32 v245, v245, v248
    v_accvgpr_write_b32 a106, v245
    v_accvgpr_read_b32 v245, a107
    v_mul_f32 v245, v245, v248
    v_accvgpr_write_b32 a107, v245
    v_accvgpr_read_b32 v245, a108
    v_mul_f32 v245, v245, v248
    v_accvgpr_write_b32 a108, v245
    v_accvgpr_read_b32 v245, a109
    v_mul_f32 v245, v245, v248
    v_accvgpr_write_b32 a109, v245
    v_accvgpr_read_b32 v245, a110
    v_mul_f32 v245, v245, v248
    v_accvgpr_write_b32 a110, v245
    v_accvgpr_read_b32 v245, a111
    v_mul_f32 v245, v245, v248
    v_accvgpr_write_b32 a111, v245
    v_accvgpr_read_b32 v245, a112
    v_mul_f32 v245, v245, v248
    v_accvgpr_write_b32 a112, v245
    v_accvgpr_read_b32 v245, a113
    v_mul_f32 v245, v245, v248
    v_accvgpr_write_b32 a113, v245
    v_accvgpr_read_b32 v245, a114
    v_mul_f32 v245, v245, v248
    v_accvgpr_write_b32 a114, v245
    v_accvgpr_read_b32 v245, a115
    v_mul_f32 v245, v245, v248
    v_accvgpr_write_b32 a115, v245
    v_accvgpr_read_b32 v245, a116
    v_mul_f32 v245, v245, v248
    v_accvgpr_write_b32 a116, v245
    v_accvgpr_read_b32 v245, a117
    v_mul_f32 v245, v245, v248
    v_accvgpr_write_b32 a117, v245
    v_accvgpr_read_b32 v245, a118
    v_mul_f32 v245, v245, v248
    v_accvgpr_write_b32 a118, v245
    v_accvgpr_read_b32 v245, a119
    v_mul_f32 v245, v245, v248
    v_accvgpr_write_b32 a119, v245
    v_accvgpr_read_b32 v245, a120
    v_mul_f32 v245, v245, v248
    v_accvgpr_write_b32 a120, v245
    v_accvgpr_read_b32 v245, a121
    v_mul_f32 v245, v245, v248
    v_accvgpr_write_b32 a121, v245
    v_accvgpr_read_b32 v245, a122
    v_mul_f32 v245, v245, v248
    v_accvgpr_write_b32 a122, v245
    v_accvgpr_read_b32 v245, a123
    v_mul_f32 v245, v245, v248
    v_accvgpr_write_b32 a123, v245
    v_accvgpr_read_b32 v245, a124
    v_mul_f32 v245, v245, v248
    v_accvgpr_write_b32 a124, v245
    v_accvgpr_read_b32 v245, a125
    v_mul_f32 v245, v245, v248
    v_accvgpr_write_b32 a125, v245
    v_accvgpr_read_b32 v245, a126
    v_mul_f32 v245, v245, v248
    v_accvgpr_write_b32 a126, v245
    v_accvgpr_read_b32 v245, a127
    v_mul_f32 v245, v245, v248
    v_accvgpr_write_b32 a127, v245
    v_fma_f32 v232, v160, s21, v239
    s_nop 0
    v_fma_f32 v233, v161, s21, v239
    v_exp_f32 v232, v232
    s_nop 0
    v_fma_f32 v234, v162, s21, v239
    v_exp_f32 v233, v233
    s_nop 0
    v_fma_f32 v235, v163, s21, v239
    v_exp_f32 v234, v234
    v_add_f32 v243, v232, v233
    v_cvt_pk_bf16_f32 v200, v232, v233
    s_nop 0
    v_fma_f32 v232, v164, s21, v239
    v_exp_f32 v235, v235
    v_add_f32 v243, v243, v234
    s_nop 0
    v_fma_f32 v233, v165, s21, v239
    v_exp_f32 v232, v232
    v_add_f32 v243, v243, v235
    v_cvt_pk_bf16_f32 v201, v234, v235
    s_nop 0
    v_fma_f32 v234, v166, s21, v239
    v_exp_f32 v233, v233
    v_add_f32 v243, v243, v232
    s_nop 0
    v_fma_f32 v235, v167, s21, v239
    v_exp_f32 v234, v234
    v_add_f32 v243, v243, v233
    v_cvt_pk_bf16_f32 v202, v232, v233
    s_nop 0
    v_fma_f32 v232, v176, s21, v240
    v_exp_f32 v235, v235
    v_add_f32 v243, v243, v234
    s_nop 0
    v_fma_f32 v233, v177, s21, v240
    v_exp_f32 v232, v232
    v_add_f32 v243, v243, v235
    v_cvt_pk_bf16_f32 v203, v234, v235
    s_nop 0
    v_fma_f32 v234, v178, s21, v240
    v_exp_f32 v233, v233
    s_nop 0
    v_fma_f32 v235, v179, s21, v240
    v_exp_f32 v234, v234
    v_add_f32 v244, v232, v233
    v_cvt_pk_bf16_f32 v204, v232, v233
    s_nop 0
    v_fma_f32 v232, v180, s21, v240
    v_exp_f32 v235, v235
    v_add_f32 v244, v244, v234
    s_nop 0
    v_fma_f32 v233, v181, s21, v240
    v_exp_f32 v232, v232
    v_add_f32 v244, v244, v235
    v_cvt_pk_bf16_f32 v205, v234, v235
    s_nop 0
    v_fma_f32 v234, v182, s21, v240
    v_exp_f32 v233, v233
    v_add_f32 v244, v244, v232
    s_nop 0
    v_fma_f32 v235, v183, s21, v240
    v_exp_f32 v234, v234
    v_add_f32 v244, v244, v233
    v_cvt_pk_bf16_f32 v206, v232, v233
    s_nop 0
    v_fma_f32 v232, v168, s21, v239
    v_exp_f32 v235, v235
    v_add_f32 v244, v244, v234
    s_nop 0
    v_fma_f32 v233, v169, s21, v239
    v_exp_f32 v232, v232
    v_add_f32 v244, v244, v235
    v_cvt_pk_bf16_f32 v207, v234, v235
    s_nop 0
    v_fma_f32 v234, v170, s21, v239
    v_exp_f32 v233, v233
    v_add_f32 v243, v243, v232
    s_nop 0
    v_fma_f32 v235, v171, s21, v239
    v_exp_f32 v234, v234
    v_add_f32 v243, v243, v233
    v_cvt_pk_bf16_f32 v208, v232, v233
    s_nop 0
    v_fma_f32 v232, v172, s21, v239
    v_exp_f32 v235, v235
    v_add_f32 v243, v243, v234
    s_nop 0
    v_fma_f32 v233, v173, s21, v239
    v_exp_f32 v232, v232
    v_add_f32 v243, v243, v235
    v_cvt_pk_bf16_f32 v209, v234, v235
    s_nop 0
    v_fma_f32 v234, v174, s21, v239
    v_exp_f32 v233, v233
    v_add_f32 v243, v243, v232
    s_nop 0
    v_fma_f32 v235, v175, s21, v239
    v_exp_f32 v234, v234
    v_add_f32 v243, v243, v233
    v_cvt_pk_bf16_f32 v210, v232, v233
    s_nop 0
    v_fma_f32 v232, v184, s21, v240
    v_exp_f32 v235, v235
    v_add_f32 v243, v243, v234
    s_nop 0
    v_fma_f32 v233, v185, s21, v240
    v_exp_f32 v232, v232
    v_add_f32 v243, v243, v235
    v_cvt_pk_bf16_f32 v211, v234, v235
    s_nop 0
    v_fma_f32 v234, v186, s21, v240
    v_exp_f32 v233, v233
    v_add_f32 v244, v244, v232
    s_nop 0
    v_fma_f32 v235, v187, s21, v240
    v_exp_f32 v234, v234
    v_add_f32 v244, v244, v233
    v_cvt_pk_bf16_f32 v212, v232, v233
    s_nop 0
    v_fma_f32 v232, v188, s21, v240
    v_exp_f32 v235, v235
    v_add_f32 v244, v244, v234
    s_nop 0
    v_fma_f32 v233, v189, s21, v240
    v_exp_f32 v232, v232
    v_add_f32 v244, v244, v235
    v_cvt_pk_bf16_f32 v213, v234, v235
    s_nop 0
    v_fma_f32 v234, v190, s21, v240
    v_exp_f32 v233, v233
    v_add_f32 v244, v244, v232
    s_nop 0
    v_fma_f32 v235, v191, s21, v240
    v_exp_f32 v234, v234
    v_add_f32 v244, v244, v233
    v_cvt_pk_bf16_f32 v214, v232, v233
    s_nop 0
    v_exp_f32 v235, v235
    v_add_f32 v244, v244, v234
    s_nop 0
    v_add_f32 v244, v244, v235
    v_cvt_pk_bf16_f32 v215, v234, v235
    s_nop 0
    s_nop 3
    s_branch L_backl1B
L_rares14B:
    s_nop 7
    v_max3_f32 v247, v128, v129, v130
    v_max3_f32 v247, v247, v131, v132
    v_max3_f32 v247, v247, v133, v134
    v_max3_f32 v247, v247, v135, v136
    v_max3_f32 v247, v247, v137, v138
    v_max3_f32 v247, v247, v139, v140
    v_max3_f32 v247, v247, v141, v142
    v_max_f32 v247, v247, v143
    v_mov_b32 v245, v247
    s_nop 1
    v_permlane32_swap_b32 v245, v247
    s_nop 0
    v_max_f32 v247, v247, v245
    v_mul_f32 v247, s30, v247
    v_min_f32 v247, v247, v239
    v_sub_f32 v248, v247, v239
    v_exp_f32 v248, v248
    v_mov_b32 v239, v247
    v_mul_f32 v241, v241, v248
    v_mul_f32 v0, v0, v248
    v_mul_f32 v1, v1, v248
    v_mul_f32 v2, v2, v248
    v_mul_f32 v3, v3, v248
    v_mul_f32 v4, v4, v248
    v_mul_f32 v5, v5, v248
    v_mul_f32 v6, v6, v248
    v_mul_f32 v7, v7, v248
    v_mul_f32 v8, v8, v248
    v_mul_f32 v9, v9, v248
    v_mul_f32 v10, v10, v248
    v_mul_f32 v11, v11, v248
    v_mul_f32 v12, v12, v248
    v_mul_f32 v13, v13, v248
    v_mul_f32 v14, v14, v248
    v_mul_f32 v15, v15, v248
    v_mul_f32 v16, v16, v248
    v_mul_f32 v17, v17, v248
    v_mul_f32 v18, v18, v248
    v_mul_f32 v19, v19, v248
    v_mul_f32 v20, v20, v248
    v_mul_f32 v21, v21, v248
    v_mul_f32 v22, v22, v248
    v_mul_f32 v23, v23, v248
    v_mul_f32 v24, v24, v248
    v_mul_f32 v25, v25, v248
    v_mul_f32 v26, v26, v248
    v_mul_f32 v27, v27, v248
    v_mul_f32 v28, v28, v248
    v_mul_f32 v29, v29, v248
    v_mul_f32 v30, v30, v248
    v_mul_f32 v31, v31, v248
    v_mul_f32 v32, v32, v248
    v_mul_f32 v33, v33, v248
    v_mul_f32 v34, v34, v248
    v_mul_f32 v35, v35, v248
    v_mul_f32 v36, v36, v248
    v_mul_f32 v37, v37, v248
    v_mul_f32 v38, v38, v248
    v_mul_f32 v39, v39, v248
    v_mul_f32 v40, v40, v248
    v_mul_f32 v41, v41, v248
    v_mul_f32 v42, v42, v248
    v_mul_f32 v43, v43, v248
    v_mul_f32 v44, v44, v248
    v_mul_f32 v45, v45, v248
    v_mul_f32 v46, v46, v248
    v_mul_f32 v47, v47, v248
    v_mul_f32 v48, v48, v248
    v_mul_f32 v49, v49, v248
    v_mul_f32 v50, v50, v248
    v_mul_f32 v51, v51, v248
    v_mul_f32 v52, v52, v248
    v_mul_f32 v53, v53, v248
    v_mul_f32 v54, v54, v248
    v_mul_f32 v55, v55, v248
    v_mul_f32 v56, v56, v248
    v_mul_f32 v57, v57, v248
    v_mul_f32 v58, v58, v248
    v_mul_f32 v59, v59, v248
    v_mul_f32 v60, v60, v248
    v_mul_f32 v61, v61, v248
    v_mul_f32 v62, v62, v248
    v_mul_f32 v63, v63, v248
    v_mul_f32 v64, v64, v248
    v_mul_f32 v65, v65, v248
    v_mul_f32 v66, v66, v248
    v_mul_f32 v67, v67, v248
    v_mul_f32 v68, v68, v248
    v_mul_f32 v69, v69, v248
    v_mul_f32 v70, v70, v248
    v_mul_f32 v71, v71, v248
    v_mul_f32 v72, v72, v248
    v_mul_f32 v73, v73, v248
    v_mul_f32 v74, v74, v248
    v_mul_f32 v75, v75, v248
    v_mul_f32 v76, v76, v248
    v_mul_f32 v77, v77, v248
    v_mul_f32 v78, v78, v248
    v_mul_f32 v79, v79, v248
    v_mul_f32 v80, v80, v248
    v_mul_f32 v81, v81, v248
    v_mul_f32 v82, v82, v248
    v_mul_f32 v83, v83, v248
    v_mul_f32 v84, v84, v248
    v_mul_f32 v85, v85, v248
    v_mul_f32 v86, v86, v248
    v_mul_f32 v87, v87, v248
    v_mul_f32 v88, v88, v248
    v_mul_f32 v89, v89, v248
    v_mul_f32 v90, v90, v248
    v_mul_f32 v91, v91, v248
    v_mul_f32 v92, v92, v248
    v_mul_f32 v93, v93, v248
    v_mul_f32 v94, v94, v248
    v_mul_f32 v95, v95, v248
    v_mul_f32 v96, v96, v248
    v_mul_f32 v97, v97, v248
    v_mul_f32 v98, v98, v248
    v_mul_f32 v99, v99, v248
    v_mul_f32 v100, v100, v248
    v_mul_f32 v101, v101, v248
    v_mul_f32 v102, v102, v248
    v_mul_f32 v103, v103, v248
    v_mul_f32 v104, v104, v248
    v_mul_f32 v105, v105, v248
    v_mul_f32 v106, v106, v248
    v_mul_f32 v107, v107, v248
    v_mul_f32 v108, v108, v248
    v_mul_f32 v109, v109, v248
    v_mul_f32 v110, v110, v248
    v_mul_f32 v111, v111, v248
    v_mul_f32 v112, v112, v248
    v_mul_f32 v113, v113, v248
    v_mul_f32 v114, v114, v248
    v_mul_f32 v115, v115, v248
    v_mul_f32 v116, v116, v248
    v_mul_f32 v117, v117, v248
    v_mul_f32 v118, v118, v248
    v_mul_f32 v119, v119, v248
    v_mul_f32 v120, v120, v248
    v_mul_f32 v121, v121, v248
    v_mul_f32 v122, v122, v248
    v_mul_f32 v123, v123, v248
    v_mul_f32 v124, v124, v248
    v_mul_f32 v125, v125, v248
    v_mul_f32 v126, v126, v248
    v_mul_f32 v127, v127, v248
    v_max3_f32 v247, v144, v145, v146
    v_max3_f32 v247, v247, v147, v148
    v_max3_f32 v247, v247, v149, v150
    v_max3_f32 v247, v247, v151, v152
    v_max3_f32 v247, v247, v153, v154
    v_max3_f32 v247, v247, v155, v156
    v_max3_f32 v247, v247, v157, v158
    v_max_f32 v247, v247, v159
    v_mov_b32 v245, v247
    s_nop 1
    v_permlane32_swap_b32 v245, v247
    s_nop 0
    v_max_f32 v247, v247, v245
    v_mul_f32 v247, s30, v247
    v_min_f32 v247, v247, v240
    v_sub_f32 v248, v247, v240
    v_exp_f32 v248, v248
    v_mov_b32 v240, v247
    v_mul_f32 v242, v242, v248
    v_accvgpr_read_b32 v245, a0
    v_mul_f32 v245, v245, v248
    v_accvgpr_write_b32 a0, v245
    v_accvgpr_read_b32 v245, a1
    v_mul_f32 v245, v245, v248
    v_accvgpr_write_b32 a1, v245
    v_accvgpr_read_b32 v245, a2
    v_mul_f32 v245, v245, v248
    v_accvgpr_write_b32 a2, v245
    v_accvgpr_read_b32 v245, a3
    v_mul_f32 v245, v245, v248
    v_accvgpr_write_b32 a3, v245
    v_accvgpr_read_b32 v245, a4
    v_mul_f32 v245, v245, v248
    v_accvgpr_write_b32 a4, v245
    v_accvgpr_read_b32 v245, a5
    v_mul_f32 v245, v245, v248
    v_accvgpr_write_b32 a5, v245
    v_accvgpr_read_b32 v245, a6
    v_mul_f32 v245, v245, v248
    v_accvgpr_write_b32 a6, v245
    v_accvgpr_read_b32 v245, a7
    v_mul_f32 v245, v245, v248
    v_accvgpr_write_b32 a7, v245
    v_accvgpr_read_b32 v245, a8
    v_mul_f32 v245, v245, v248
    v_accvgpr_write_b32 a8, v245
    v_accvgpr_read_b32 v245, a9
    v_mul_f32 v245, v245, v248
    v_accvgpr_write_b32 a9, v245
    v_accvgpr_read_b32 v245, a10
    v_mul_f32 v245, v245, v248
    v_accvgpr_write_b32 a10, v245
    v_accvgpr_read_b32 v245, a11
    v_mul_f32 v245, v245, v248
    v_accvgpr_write_b32 a11, v245
    v_accvgpr_read_b32 v245, a12
    v_mul_f32 v245, v245, v248
    v_accvgpr_write_b32 a12, v245
    v_accvgpr_read_b32 v245, a13
    v_mul_f32 v245, v245, v248
    v_accvgpr_write_b32 a13, v245
    v_accvgpr_read_b32 v245, a14
    v_mul_f32 v245, v245, v248
    v_accvgpr_write_b32 a14, v245
    v_accvgpr_read_b32 v245, a15
    v_mul_f32 v245, v245, v248
    v_accvgpr_write_b32 a15, v245
    v_accvgpr_read_b32 v245, a16
    v_mul_f32 v245, v245, v248
    v_accvgpr_write_b32 a16, v245
    v_accvgpr_read_b32 v245, a17
    v_mul_f32 v245, v245, v248
    v_accvgpr_write_b32 a17, v245
    v_accvgpr_read_b32 v245, a18
    v_mul_f32 v245, v245, v248
    v_accvgpr_write_b32 a18, v245
    v_accvgpr_read_b32 v245, a19
    v_mul_f32 v245, v245, v248
    v_accvgpr_write_b32 a19, v245
    v_accvgpr_read_b32 v245, a20
    v_mul_f32 v245, v245, v248
    v_accvgpr_write_b32 a20, v245
    v_accvgpr_read_b32 v245, a21
    v_mul_f32 v245, v245, v248
    v_accvgpr_write_b32 a21, v245
    v_accvgpr_read_b32 v245, a22
    v_mul_f32 v245, v245, v248
    v_accvgpr_write_b32 a22, v245
    v_accvgpr_read_b32 v245, a23
    v_mul_f32 v245, v245, v248
    v_accvgpr_write_b32 a23, v245
    v_accvgpr_read_b32 v245, a24
    v_mul_f32 v245, v245, v248
    v_accvgpr_write_b32 a24, v245
    v_accvgpr_read_b32 v245, a25
    v_mul_f32 v245, v245, v248
    v_accvgpr_write_b32 a25, v245
    v_accvgpr_read_b32 v245, a26
    v_mul_f32 v245, v245, v248
    v_accvgpr_write_b32 a26, v245
    v_accvgpr_read_b32 v245, a27
    v_mul_f32 v245, v245, v248
    v_accvgpr_write_b32 a27, v245
    v_accvgpr_read_b32 v245, a28
    v_mul_f32 v245, v245, v248
    v_accvgpr_write_b32 a28, v245
    v_accvgpr_read_b32 v245, a29
    v_mul_f32 v245, v245, v248
    v_accvgpr_write_b32 a29, v245
    v_accvgpr_read_b32 v245, a30
    v_mul_f32 v245, v245, v248
    v_accvgpr_write_b32 a30, v245
    v_accvgpr_read_b32 v245, a31
    v_mul_f32 v245, v245, v248
    v_accvgpr_write_b32 a31, v245
    v_accvgpr_read_b32 v245, a32
    v_mul_f32 v245, v245, v248
    v_accvgpr_write_b32 a32, v245
    v_accvgpr_read_b32 v245, a33
    v_mul_f32 v245, v245, v248
    v_accvgpr_write_b32 a33, v245
    v_accvgpr_read_b32 v245, a34
    v_mul_f32 v245, v245, v248
    v_accvgpr_write_b32 a34, v245
    v_accvgpr_read_b32 v245, a35
    v_mul_f32 v245, v245, v248
    v_accvgpr_write_b32 a35, v245
    v_accvgpr_read_b32 v245, a36
    v_mul_f32 v245, v245, v248
    v_accvgpr_write_b32 a36, v245
    v_accvgpr_read_b32 v245, a37
    v_mul_f32 v245, v245, v248
    v_accvgpr_write_b32 a37, v245
    v_accvgpr_read_b32 v245, a38
    v_mul_f32 v245, v245, v248
    v_accvgpr_write_b32 a38, v245
    v_accvgpr_read_b32 v245, a39
    v_mul_f32 v245, v245, v248
    v_accvgpr_write_b32 a39, v245
    v_accvgpr_read_b32 v245, a40
    v_mul_f32 v245, v245, v248
    v_accvgpr_write_b32 a40, v245
    v_accvgpr_read_b32 v245, a41
    v_mul_f32 v245, v245, v248
    v_accvgpr_write_b32 a41, v245
    v_accvgpr_read_b32 v245, a42
    v_mul_f32 v245, v245, v248
    v_accvgpr_write_b32 a42, v245
    v_accvgpr_read_b32 v245, a43
    v_mul_f32 v245, v245, v248
    v_accvgpr_write_b32 a43, v245
    v_accvgpr_read_b32 v245, a44
    v_mul_f32 v245, v245, v248
    v_accvgpr_write_b32 a44, v245
    v_accvgpr_read_b32 v245, a45
    v_mul_f32 v245, v245, v248
    v_accvgpr_write_b32 a45, v245
    v_accvgpr_read_b32 v245, a46
    v_mul_f32 v245, v245, v248
    v_accvgpr_write_b32 a46, v245
    v_accvgpr_read_b32 v245, a47
    v_mul_f32 v245, v245, v248
    v_accvgpr_write_b32 a47, v245
    v_accvgpr_read_b32 v245, a48
    v_mul_f32 v245, v245, v248
    v_accvgpr_write_b32 a48, v245
    v_accvgpr_read_b32 v245, a49
    v_mul_f32 v245, v245, v248
    v_accvgpr_write_b32 a49, v245
    v_accvgpr_read_b32 v245, a50
    v_mul_f32 v245, v245, v248
    v_accvgpr_write_b32 a50, v245
    v_accvgpr_read_b32 v245, a51
    v_mul_f32 v245, v245, v248
    v_accvgpr_write_b32 a51, v245
    v_accvgpr_read_b32 v245, a52
    v_mul_f32 v245, v245, v248
    v_accvgpr_write_b32 a52, v245
    v_accvgpr_read_b32 v245, a53
    v_mul_f32 v245, v245, v248
    v_accvgpr_write_b32 a53, v245
    v_accvgpr_read_b32 v245, a54
    v_mul_f32 v245, v245, v248
    v_accvgpr_write_b32 a54, v245
    v_accvgpr_read_b32 v245, a55
    v_mul_f32 v245, v245, v248
    v_accvgpr_write_b32 a55, v245
    v_accvgpr_read_b32 v245, a56
    v_mul_f32 v245, v245, v248
    v_accvgpr_write_b32 a56, v245
    v_accvgpr_read_b32 v245, a57
    v_mul_f32 v245, v245, v248
    v_accvgpr_write_b32 a57, v245
    v_accvgpr_read_b32 v245, a58
    v_mul_f32 v245, v245, v248
    v_accvgpr_write_b32 a58, v245
    v_accvgpr_read_b32 v245, a59
    v_mul_f32 v245, v245, v248
    v_accvgpr_write_b32 a59, v245
    v_accvgpr_read_b32 v245, a60
    v_mul_f32 v245, v245, v248
    v_accvgpr_write_b32 a60, v245
    v_accvgpr_read_b32 v245, a61
    v_mul_f32 v245, v245, v248
    v_accvgpr_write_b32 a61, v245
    v_accvgpr_read_b32 v245, a62
    v_mul_f32 v245, v245, v248
    v_accvgpr_write_b32 a62, v245
    v_accvgpr_read_b32 v245, a63
    v_mul_f32 v245, v245, v248
    v_accvgpr_write_b32 a63, v245
    v_accvgpr_read_b32 v245, a64
    v_mul_f32 v245, v245, v248
    v_accvgpr_write_b32 a64, v245
    v_accvgpr_read_b32 v245, a65
    v_mul_f32 v245, v245, v248
    v_accvgpr_write_b32 a65, v245
    v_accvgpr_read_b32 v245, a66
    v_mul_f32 v245, v245, v248
    v_accvgpr_write_b32 a66, v245
    v_accvgpr_read_b32 v245, a67
    v_mul_f32 v245, v245, v248
    v_accvgpr_write_b32 a67, v245
    v_accvgpr_read_b32 v245, a68
    v_mul_f32 v245, v245, v248
    v_accvgpr_write_b32 a68, v245
    v_accvgpr_read_b32 v245, a69
    v_mul_f32 v245, v245, v248
    v_accvgpr_write_b32 a69, v245
    v_accvgpr_read_b32 v245, a70
    v_mul_f32 v245, v245, v248
    v_accvgpr_write_b32 a70, v245
    v_accvgpr_read_b32 v245, a71
    v_mul_f32 v245, v245, v248
    v_accvgpr_write_b32 a71, v245
    v_accvgpr_read_b32 v245, a72
    v_mul_f32 v245, v245, v248
    v_accvgpr_write_b32 a72, v245
    v_accvgpr_read_b32 v245, a73
    v_mul_f32 v245, v245, v248
    v_accvgpr_write_b32 a73, v245
    v_accvgpr_read_b32 v245, a74
    v_mul_f32 v245, v245, v248
    v_accvgpr_write_b32 a74, v245
    v_accvgpr_read_b32 v245, a75
    v_mul_f32 v245, v245, v248
    v_accvgpr_write_b32 a75, v245
    v_accvgpr_read_b32 v245, a76
    v_mul_f32 v245, v245, v248
    v_accvgpr_write_b32 a76, v245
    v_accvgpr_read_b32 v245, a77
    v_mul_f32 v245, v245, v248
    v_accvgpr_write_b32 a77, v245
    v_accvgpr_read_b32 v245, a78
    v_mul_f32 v245, v245, v248
    v_accvgpr_write_b32 a78, v245
    v_accvgpr_read_b32 v245, a79
    v_mul_f32 v245, v245, v248
    v_accvgpr_write_b32 a79, v245
    v_accvgpr_read_b32 v245, a80
    v_mul_f32 v245, v245, v248
    v_accvgpr_write_b32 a80, v245
    v_accvgpr_read_b32 v245, a81
    v_mul_f32 v245, v245, v248
    v_accvgpr_write_b32 a81, v245
    v_accvgpr_read_b32 v245, a82
    v_mul_f32 v245, v245, v248
    v_accvgpr_write_b32 a82, v245
    v_accvgpr_read_b32 v245, a83
    v_mul_f32 v245, v245, v248
    v_accvgpr_write_b32 a83, v245
    v_accvgpr_read_b32 v245, a84
    v_mul_f32 v245, v245, v248
    v_accvgpr_write_b32 a84, v245
    v_accvgpr_read_b32 v245, a85
    v_mul_f32 v245, v245, v248
    v_accvgpr_write_b32 a85, v245
    v_accvgpr_read_b32 v245, a86
    v_mul_f32 v245, v245, v248
    v_accvgpr_write_b32 a86, v245
    v_accvgpr_read_b32 v245, a87
    v_mul_f32 v245, v245, v248
    v_accvgpr_write_b32 a87, v245
    v_accvgpr_read_b32 v245, a88
    v_mul_f32 v245, v245, v248
    v_accvgpr_write_b32 a88, v245
    v_accvgpr_read_b32 v245, a89
    v_mul_f32 v245, v245, v248
    v_accvgpr_write_b32 a89, v245
    v_accvgpr_read_b32 v245, a90
    v_mul_f32 v245, v245, v248
    v_accvgpr_write_b32 a90, v245
    v_accvgpr_read_b32 v245, a91
    v_mul_f32 v245, v245, v248
    v_accvgpr_write_b32 a91, v245
    v_accvgpr_read_b32 v245, a92
    v_mul_f32 v245, v245, v248
    v_accvgpr_write_b32 a92, v245
    v_accvgpr_read_b32 v245, a93
    v_mul_f32 v245, v245, v248
    v_accvgpr_write_b32 a93, v245
    v_accvgpr_read_b32 v245, a94
    v_mul_f32 v245, v245, v248
    v_accvgpr_write_b32 a94, v245
    v_accvgpr_read_b32 v245, a95
    v_mul_f32 v245, v245, v248
    v_accvgpr_write_b32 a95, v245
    v_accvgpr_read_b32 v245, a96
    v_mul_f32 v245, v245, v248
    v_accvgpr_write_b32 a96, v245
    v_accvgpr_read_b32 v245, a97
    v_mul_f32 v245, v245, v248
    v_accvgpr_write_b32 a97, v245
    v_accvgpr_read_b32 v245, a98
    v_mul_f32 v245, v245, v248
    v_accvgpr_write_b32 a98, v245
    v_accvgpr_read_b32 v245, a99
    v_mul_f32 v245, v245, v248
    v_accvgpr_write_b32 a99, v245
    v_accvgpr_read_b32 v245, a100
    v_mul_f32 v245, v245, v248
    v_accvgpr_write_b32 a100, v245
    v_accvgpr_read_b32 v245, a101
    v_mul_f32 v245, v245, v248
    v_accvgpr_write_b32 a101, v245
    v_accvgpr_read_b32 v245, a102
    v_mul_f32 v245, v245, v248
    v_accvgpr_write_b32 a102, v245
    v_accvgpr_read_b32 v245, a103
    v_mul_f32 v245, v245, v248
    v_accvgpr_write_b32 a103, v245
    v_accvgpr_read_b32 v245, a104
    v_mul_f32 v245, v245, v248
    v_accvgpr_write_b32 a104, v245
    v_accvgpr_read_b32 v245, a105
    v_mul_f32 v245, v245, v248
    v_accvgpr_write_b32 a105, v245
    v_accvgpr_read_b32 v245, a106
    v_mul_f32 v245, v245, v248
    v_accvgpr_write_b32 a106, v245
    v_accvgpr_read_b32 v245, a107
    v_mul_f32 v245, v245, v248
    v_accvgpr_write_b32 a107, v245
    v_accvgpr_read_b32 v245, a108
    v_mul_f32 v245, v245, v248
    v_accvgpr_write_b32 a108, v245
    v_accvgpr_read_b32 v245, a109
    v_mul_f32 v245, v245, v248
    v_accvgpr_write_b32 a109, v245
    v_accvgpr_read_b32 v245, a110
    v_mul_f32 v245, v245, v248
    v_accvgpr_write_b32 a110, v245
    v_accvgpr_read_b32 v245, a111
    v_mul_f32 v245, v245, v248
    v_accvgpr_write_b32 a111, v245
    v_accvgpr_read_b32 v245, a112
    v_mul_f32 v245, v245, v248
    v_accvgpr_write_b32 a112, v245
    v_accvgpr_read_b32 v245, a113
    v_mul_f32 v245, v245, v248
    v_accvgpr_write_b32 a113, v245
    v_accvgpr_read_b32 v245, a114
    v_mul_f32 v245, v245, v248
    v_accvgpr_write_b32 a114, v245
    v_accvgpr_read_b32 v245, a115
    v_mul_f32 v245, v245, v248
    v_accvgpr_write_b32 a115, v245
    v_accvgpr_read_b32 v245, a116
    v_mul_f32 v245, v245, v248
    v_accvgpr_write_b32 a116, v245
    v_accvgpr_read_b32 v245, a117
    v_mul_f32 v245, v245, v248
    v_accvgpr_write_b32 a117, v245
    v_accvgpr_read_b32 v245, a118
    v_mul_f32 v245, v245, v248
    v_accvgpr_write_b32 a118, v245
    v_accvgpr_read_b32 v245, a119
    v_mul_f32 v245, v245, v248
    v_accvgpr_write_b32 a119, v245
    v_accvgpr_read_b32 v245, a120
    v_mul_f32 v245, v245, v248
    v_accvgpr_write_b32 a120, v245
    v_accvgpr_read_b32 v245, a121
    v_mul_f32 v245, v245, v248
    v_accvgpr_write_b32 a121, v245
    v_accvgpr_read_b32 v245, a122
    v_mul_f32 v245, v245, v248
    v_accvgpr_write_b32 a122, v245
    v_accvgpr_read_b32 v245, a123
    v_mul_f32 v245, v245, v248
    v_accvgpr_write_b32 a123, v245
    v_accvgpr_read_b32 v245, a124
    v_mul_f32 v245, v245, v248
    v_accvgpr_write_b32 a124, v245
    v_accvgpr_read_b32 v245, a125
    v_mul_f32 v245, v245, v248
    v_accvgpr_write_b32 a125, v245
    v_accvgpr_read_b32 v245, a126
    v_mul_f32 v245, v245, v248
    v_accvgpr_write_b32 a126, v245
    v_accvgpr_read_b32 v245, a127
    v_mul_f32 v245, v245, v248
    v_accvgpr_write_b32 a127, v245
    v_fma_f32 v232, v128, s21, v239
    s_nop 0
    v_fma_f32 v233, v129, s21, v239
    v_exp_f32 v232, v232
    s_nop 0
    v_fma_f32 v234, v130, s21, v239
    v_exp_f32 v233, v233
    s_nop 0
    v_fma_f32 v235, v131, s21, v239
    v_exp_f32 v234, v234
    v_add_f32 v243, v232, v233
    v_cvt_pk_bf16_f32 v192, v232, v233
    s_nop 0
    v_fma_f32 v232, v132, s21, v239
    v_exp_f32 v235, v235
    v_add_f32 v243, v243, v234
    s_nop 0
    v_fma_f32 v233, v133, s21, v239
    v_exp_f32 v232, v232
    v_add_f32 v243, v243, v235
    v_cvt_pk_bf16_f32 v193, v234, v235
    s_nop 0
    v_fma_f32 v234, v134, s21, v239
    v_exp_f32 v233, v233
    v_add_f32 v243, v243, v232
    s_nop 0
    v_fma_f32 v235, v135, s21, v239
    v_exp_f32 v234, v234
    v_add_f32 v243, v243, v233
    v_cvt_pk_bf16_f32 v194, v232, v233
    s_nop 0
    v_fma_f32 v232, v144, s21, v240
    v_exp_f32 v235, v235
    v_add_f32 v243, v243, v234
    s_nop 0
    v_fma_f32 v233, v145, s21, v240
    v_exp_f32 v232, v232
    v_add_f32 v243, v243, v235
    v_cvt_pk_bf16_f32 v195, v234, v235
    s_nop 0
    v_fma_f32 v234, v146, s21, v240
    v_exp_f32 v233, v233
    s_nop 0
    v_fma_f32 v235, v147, s21, v240
    v_exp_f32 v234, v234
    v_add_f32 v244, v232, v233
    v_cvt_pk_bf16_f32 v196, v232, v233
    s_nop 0
    v_fma_f32 v232, v148, s21, v240
    v_exp_f32 v235, v235
    v_add_f32 v244, v244, v234
    s_nop 0
    v_fma_f32 v233, v149, s21, v240
    v_exp_f32 v232, v232
    v_add_f32 v244, v244, v235
    v_cvt_pk_bf16_f32 v197, v234, v235
    s_nop 0
    v_fma_f32 v234, v150, s21, v240
    v_exp_f32 v233, v233
    v_add_f32 v244, v244, v232
    s_nop 0
    v_fma_f32 v235, v151, s21, v240
    v_exp_f32 v234, v234
    v_add_f32 v244, v244, v233
    v_cvt_pk_bf16_f32 v198, v232, v233
    s_nop 0
    v_fma_f32 v232, v136, s21, v239
    v_exp_f32 v235, v235
    v_add_f32 v244, v244, v234
    s_nop 0
    v_fma_f32 v233, v137, s21, v239
    v_exp_f32 v232, v232
    v_add_f32 v244, v244, v235
    v_cvt_pk_bf16_f32 v199, v234, v235
    s_nop 0
    v_fma_f32 v234, v138, s21, v239
    v_exp_f32 v233, v233
    v_add_f32 v243, v243, v232
    s_nop 0
    v_fma_f32 v235, v139, s21, v239
    v_exp_f32 v234, v234
    v_add_f32 v243, v243, v233
    v_cvt_pk_bf16_f32 v208, v232, v233
    s_nop 0
    v_fma_f32 v232, v140, s21, v239
    v_exp_f32 v235, v235
    v_add_f32 v243, v243, v234
    s_nop 0
    v_fma_f32 v233, v141, s21, v239
    v_exp_f32 v232, v232
    v_add_f32 v243, v243, v235
    v_cvt_pk_bf16_f32 v209, v234, v235
    s_nop 0
    v_fma_f32 v234, v142, s21, v239
    v_exp_f32 v233, v233
    v_add_f32 v243, v243, v232
    s_nop 0
    v_fma_f32 v235, v143, s21, v239
    v_exp_f32 v234, v234
    v_add_f32 v243, v243, v233
    v_cvt_pk_bf16_f32 v210, v232, v233
    s_nop 0
    v_fma_f32 v232, v152, s21, v240
    v_exp_f32 v235, v235
    v_add_f32 v243, v243, v234
    s_nop 0
    v_fma_f32 v233, v153, s21, v240
    v_exp_f32 v232, v232
    v_add_f32 v243, v243, v235
    v_cvt_pk_bf16_f32 v211, v234, v235
    s_nop 0
    v_fma_f32 v234, v154, s21, v240
    v_exp_f32 v233, v233
    v_add_f32 v244, v244, v232
    s_nop 0
    v_fma_f32 v235, v155, s21, v240
    v_exp_f32 v234, v234
    v_add_f32 v244, v244, v233
    v_cvt_pk_bf16_f32 v212, v232, v233
    s_nop 0
    v_fma_f32 v232, v156, s21, v240
    v_exp_f32 v235, v235
    v_add_f32 v244, v244, v234
    s_nop 0
    v_fma_f32 v233, v157, s21, v240
    v_exp_f32 v232, v232
    v_add_f32 v244, v244, v235
    v_cvt_pk_bf16_f32 v213, v234, v235
    s_nop 0
    v_fma_f32 v234, v158, s21, v240
    v_exp_f32 v233, v233
    v_add_f32 v244, v244, v232
    s_nop 0
    v_fma_f32 v235, v159, s21, v240
    v_exp_f32 v234, v234
    v_add_f32 v244, v244, v233
    v_cvt_pk_bf16_f32 v214, v232, v233
    s_nop 0
    v_exp_f32 v235, v235
    v_add_f32 v244, v244, v234
    s_nop 0
    v_add_f32 v244, v244, v235
    v_cvt_pk_bf16_f32 v215, v234, v235
    s_nop 0
    s_nop 3
    s_branch L_backs14B
L_rares15B:
    s_nop 7
    v_max3_f32 v247, v160, v161, v162
    v_max3_f32 v247, v247, v163, v164
    v_max3_f32 v247, v247, v165, v166
    v_max3_f32 v247, v247, v167, v168
    v_max3_f32 v247, v247, v169, v170
    v_max3_f32 v247, v247, v171, v172
    v_max3_f32 v247, v247, v173, v174
    v_max_f32 v247, v247, v175
    v_mov_b32 v245, v247
    s_nop 1
    v_permlane32_swap_b32 v245, v247
    s_nop 0
    v_max_f32 v247, v247, v245
    v_mul_f32 v247, s30, v247
    v_min_f32 v247, v247, v239
    v_sub_f32 v248, v247, v239
    v_exp_f32 v248, v248
    v_mov_b32 v239, v247
    v_mul_f32 v241, v241, v248
    v_mul_f32 v0, v0, v248
    v_mul_f32 v1, v1, v248
    v_mul_f32 v2, v2, v248
    v_mul_f32 v3, v3, v248
    v_mul_f32 v4, v4, v248
    v_mul_f32 v5, v5, v248
    v_mul_f32 v6, v6, v248
    v_mul_f32 v7, v7, v248
    v_mul_f32 v8, v8, v248
    v_mul_f32 v9, v9, v248
    v_mul_f32 v10, v10, v248
    v_mul_f32 v11, v11, v248
    v_mul_f32 v12, v12, v248
    v_mul_f32 v13, v13, v248
    v_mul_f32 v14, v14, v248
    v_mul_f32 v15, v15, v248
    v_mul_f32 v16, v16, v248
    v_mul_f32 v17, v17, v248
    v_mul_f32 v18, v18, v248
    v_mul_f32 v19, v19, v248
    v_mul_f32 v20, v20, v248
    v_mul_f32 v21, v21, v248
    v_mul_f32 v22, v22, v248
    v_mul_f32 v23, v23, v248
    v_mul_f32 v24, v24, v248
    v_mul_f32 v25, v25, v248
    v_mul_f32 v26, v26, v248
    v_mul_f32 v27, v27, v248
    v_mul_f32 v28, v28, v248
    v_mul_f32 v29, v29, v248
    v_mul_f32 v30, v30, v248
    v_mul_f32 v31, v31, v248
    v_mul_f32 v32, v32, v248
    v_mul_f32 v33, v33, v248
    v_mul_f32 v34, v34, v248
    v_mul_f32 v35, v35, v248
    v_mul_f32 v36, v36, v248
    v_mul_f32 v37, v37, v248
    v_mul_f32 v38, v38, v248
    v_mul_f32 v39, v39, v248
    v_mul_f32 v40, v40, v248
    v_mul_f32 v41, v41, v248
    v_mul_f32 v42, v42, v248
    v_mul_f32 v43, v43, v248
    v_mul_f32 v44, v44, v248
    v_mul_f32 v45, v45, v248
    v_mul_f32 v46, v46, v248
    v_mul_f32 v47, v47, v248
    v_mul_f32 v48, v48, v248
    v_mul_f32 v49, v49, v248
    v_mul_f32 v50, v50, v248
    v_mul_f32 v51, v51, v248
    v_mul_f32 v52, v52, v248
    v_mul_f32 v53, v53, v248
    v_mul_f32 v54, v54, v248
    v_mul_f32 v55, v55, v248
    v_mul_f32 v56, v56, v248
    v_mul_f32 v57, v57, v248
    v_mul_f32 v58, v58, v248
    v_mul_f32 v59, v59, v248
    v_mul_f32 v60, v60, v248
    v_mul_f32 v61, v61, v248
    v_mul_f32 v62, v62, v248
    v_mul_f32 v63, v63, v248
    v_mul_f32 v64, v64, v248
    v_mul_f32 v65, v65, v248
    v_mul_f32 v66, v66, v248
    v_mul_f32 v67, v67, v248
    v_mul_f32 v68, v68, v248
    v_mul_f32 v69, v69, v248
    v_mul_f32 v70, v70, v248
    v_mul_f32 v71, v71, v248
    v_mul_f32 v72, v72, v248
    v_mul_f32 v73, v73, v248
    v_mul_f32 v74, v74, v248
    v_mul_f32 v75, v75, v248
    v_mul_f32 v76, v76, v248
    v_mul_f32 v77, v77, v248
    v_mul_f32 v78, v78, v248
    v_mul_f32 v79, v79, v248
    v_mul_f32 v80, v80, v248
    v_mul_f32 v81, v81, v248
    v_mul_f32 v82, v82, v248
    v_mul_f32 v83, v83, v248
    v_mul_f32 v84, v84, v248
    v_mul_f32 v85, v85, v248
    v_mul_f32 v86, v86, v248
    v_mul_f32 v87, v87, v248
    v_mul_f32 v88, v88, v248
    v_mul_f32 v89, v89, v248
    v_mul_f32 v90, v90, v248
    v_mul_f32 v91, v91, v248
    v_mul_f32 v92, v92, v248
    v_mul_f32 v93, v93, v248
    v_mul_f32 v94, v94, v248
    v_mul_f32 v95, v95, v248
    v_mul_f32 v96, v96, v248
    v_mul_f32 v97, v97, v248
    v_mul_f32 v98, v98, v248
    v_mul_f32 v99, v99, v248
    v_mul_f32 v100, v100, v248
    v_mul_f32 v101, v101, v248
    v_mul_f32 v102, v102, v248
    v_mul_f32 v103, v103, v248
    v_mul_f32 v104, v104, v248
    v_mul_f32 v105, v105, v248
    v_mul_f32 v106, v106, v248
    v_mul_f32 v107, v107, v248
    v_mul_f32 v108, v108, v248
    v_mul_f32 v109, v109, v248
    v_mul_f32 v110, v110, v248
    v_mul_f32 v111, v111, v248
    v_mul_f32 v112, v112, v248
    v_mul_f32 v113, v113, v248
    v_mul_f32 v114, v114, v248
    v_mul_f32 v115, v115, v248
    v_mul_f32 v116, v116, v248
    v_mul_f32 v117, v117, v248
    v_mul_f32 v118, v118, v248
    v_mul_f32 v119, v119, v248
    v_mul_f32 v120, v120, v248
    v_mul_f32 v121, v121, v248
    v_mul_f32 v122, v122, v248
    v_mul_f32 v123, v123, v248
    v_mul_f32 v124, v124, v248
    v_mul_f32 v125, v125, v248
    v_mul_f32 v126, v126, v248
    v_mul_f32 v127, v127, v248
    v_max3_f32 v247, v176, v177, v178
    v_max3_f32 v247, v247, v179, v180
    v_max3_f32 v247, v247, v181, v182
    v_max3_f32 v247, v247, v183, v184
    v_max3_f32 v247, v247, v185, v186
    v_max3_f32 v247, v247, v187, v188
    v_max3_f32 v247, v247, v189, v190
    v_max_f32 v247, v247, v191
    v_mov_b32 v245, v247
    s_nop 1
    v_permlane32_swap_b32 v245, v247
    s_nop 0
    v_max_f32 v247, v247, v245
    v_mul_f32 v247, s30, v247
    v_min_f32 v247, v247, v240
    v_sub_f32 v248, v247, v240
    v_exp_f32 v248, v248
    v_mov_b32 v240, v247
    v_mul_f32 v242, v242, v248
    v_accvgpr_read_b32 v245, a0
    v_mul_f32 v245, v245, v248
    v_accvgpr_write_b32 a0, v245
    v_accvgpr_read_b32 v245, a1
    v_mul_f32 v245, v245, v248
    v_accvgpr_write_b32 a1, v245
    v_accvgpr_read_b32 v245, a2
    v_mul_f32 v245, v245, v248
    v_accvgpr_write_b32 a2, v245
    v_accvgpr_read_b32 v245, a3
    v_mul_f32 v245, v245, v248
    v_accvgpr_write_b32 a3, v245
    v_accvgpr_read_b32 v245, a4
    v_mul_f32 v245, v245, v248
    v_accvgpr_write_b32 a4, v245
    v_accvgpr_read_b32 v245, a5
    v_mul_f32 v245, v245, v248
    v_accvgpr_write_b32 a5, v245
    v_accvgpr_read_b32 v245, a6
    v_mul_f32 v245, v245, v248
    v_accvgpr_write_b32 a6, v245
    v_accvgpr_read_b32 v245, a7
    v_mul_f32 v245, v245, v248
    v_accvgpr_write_b32 a7, v245
    v_accvgpr_read_b32 v245, a8
    v_mul_f32 v245, v245, v248
    v_accvgpr_write_b32 a8, v245
    v_accvgpr_read_b32 v245, a9
    v_mul_f32 v245, v245, v248
    v_accvgpr_write_b32 a9, v245
    v_accvgpr_read_b32 v245, a10
    v_mul_f32 v245, v245, v248
    v_accvgpr_write_b32 a10, v245
    v_accvgpr_read_b32 v245, a11
    v_mul_f32 v245, v245, v248
    v_accvgpr_write_b32 a11, v245
    v_accvgpr_read_b32 v245, a12
    v_mul_f32 v245, v245, v248
    v_accvgpr_write_b32 a12, v245
    v_accvgpr_read_b32 v245, a13
    v_mul_f32 v245, v245, v248
    v_accvgpr_write_b32 a13, v245
    v_accvgpr_read_b32 v245, a14
    v_mul_f32 v245, v245, v248
    v_accvgpr_write_b32 a14, v245
    v_accvgpr_read_b32 v245, a15
    v_mul_f32 v245, v245, v248
    v_accvgpr_write_b32 a15, v245
    v_accvgpr_read_b32 v245, a16
    v_mul_f32 v245, v245, v248
    v_accvgpr_write_b32 a16, v245
    v_accvgpr_read_b32 v245, a17
    v_mul_f32 v245, v245, v248
    v_accvgpr_write_b32 a17, v245
    v_accvgpr_read_b32 v245, a18
    v_mul_f32 v245, v245, v248
    v_accvgpr_write_b32 a18, v245
    v_accvgpr_read_b32 v245, a19
    v_mul_f32 v245, v245, v248
    v_accvgpr_write_b32 a19, v245
    v_accvgpr_read_b32 v245, a20
    v_mul_f32 v245, v245, v248
    v_accvgpr_write_b32 a20, v245
    v_accvgpr_read_b32 v245, a21
    v_mul_f32 v245, v245, v248
    v_accvgpr_write_b32 a21, v245
    v_accvgpr_read_b32 v245, a22
    v_mul_f32 v245, v245, v248
    v_accvgpr_write_b32 a22, v245
    v_accvgpr_read_b32 v245, a23
    v_mul_f32 v245, v245, v248
    v_accvgpr_write_b32 a23, v245
    v_accvgpr_read_b32 v245, a24
    v_mul_f32 v245, v245, v248
    v_accvgpr_write_b32 a24, v245
    v_accvgpr_read_b32 v245, a25
    v_mul_f32 v245, v245, v248
    v_accvgpr_write_b32 a25, v245
    v_accvgpr_read_b32 v245, a26
    v_mul_f32 v245, v245, v248
    v_accvgpr_write_b32 a26, v245
    v_accvgpr_read_b32 v245, a27
    v_mul_f32 v245, v245, v248
    v_accvgpr_write_b32 a27, v245
    v_accvgpr_read_b32 v245, a28
    v_mul_f32 v245, v245, v248
    v_accvgpr_write_b32 a28, v245
    v_accvgpr_read_b32 v245, a29
    v_mul_f32 v245, v245, v248
    v_accvgpr_write_b32 a29, v245
    v_accvgpr_read_b32 v245, a30
    v_mul_f32 v245, v245, v248
    v_accvgpr_write_b32 a30, v245
    v_accvgpr_read_b32 v245, a31
    v_mul_f32 v245, v245, v248
    v_accvgpr_write_b32 a31, v245
    v_accvgpr_read_b32 v245, a32
    v_mul_f32 v245, v245, v248
    v_accvgpr_write_b32 a32, v245
    v_accvgpr_read_b32 v245, a33
    v_mul_f32 v245, v245, v248
    v_accvgpr_write_b32 a33, v245
    v_accvgpr_read_b32 v245, a34
    v_mul_f32 v245, v245, v248
    v_accvgpr_write_b32 a34, v245
    v_accvgpr_read_b32 v245, a35
    v_mul_f32 v245, v245, v248
    v_accvgpr_write_b32 a35, v245
    v_accvgpr_read_b32 v245, a36
    v_mul_f32 v245, v245, v248
    v_accvgpr_write_b32 a36, v245
    v_accvgpr_read_b32 v245, a37
    v_mul_f32 v245, v245, v248
    v_accvgpr_write_b32 a37, v245
    v_accvgpr_read_b32 v245, a38
    v_mul_f32 v245, v245, v248
    v_accvgpr_write_b32 a38, v245
    v_accvgpr_read_b32 v245, a39
    v_mul_f32 v245, v245, v248
    v_accvgpr_write_b32 a39, v245
    v_accvgpr_read_b32 v245, a40
    v_mul_f32 v245, v245, v248
    v_accvgpr_write_b32 a40, v245
    v_accvgpr_read_b32 v245, a41
    v_mul_f32 v245, v245, v248
    v_accvgpr_write_b32 a41, v245
    v_accvgpr_read_b32 v245, a42
    v_mul_f32 v245, v245, v248
    v_accvgpr_write_b32 a42, v245
    v_accvgpr_read_b32 v245, a43
    v_mul_f32 v245, v245, v248
    v_accvgpr_write_b32 a43, v245
    v_accvgpr_read_b32 v245, a44
    v_mul_f32 v245, v245, v248
    v_accvgpr_write_b32 a44, v245
    v_accvgpr_read_b32 v245, a45
    v_mul_f32 v245, v245, v248
    v_accvgpr_write_b32 a45, v245
    v_accvgpr_read_b32 v245, a46
    v_mul_f32 v245, v245, v248
    v_accvgpr_write_b32 a46, v245
    v_accvgpr_read_b32 v245, a47
    v_mul_f32 v245, v245, v248
    v_accvgpr_write_b32 a47, v245
    v_accvgpr_read_b32 v245, a48
    v_mul_f32 v245, v245, v248
    v_accvgpr_write_b32 a48, v245
    v_accvgpr_read_b32 v245, a49
    v_mul_f32 v245, v245, v248
    v_accvgpr_write_b32 a49, v245
    v_accvgpr_read_b32 v245, a50
    v_mul_f32 v245, v245, v248
    v_accvgpr_write_b32 a50, v245
    v_accvgpr_read_b32 v245, a51
    v_mul_f32 v245, v245, v248
    v_accvgpr_write_b32 a51, v245
    v_accvgpr_read_b32 v245, a52
    v_mul_f32 v245, v245, v248
    v_accvgpr_write_b32 a52, v245
    v_accvgpr_read_b32 v245, a53
    v_mul_f32 v245, v245, v248
    v_accvgpr_write_b32 a53, v245
    v_accvgpr_read_b32 v245, a54
    v_mul_f32 v245, v245, v248
    v_accvgpr_write_b32 a54, v245
    v_accvgpr_read_b32 v245, a55
    v_mul_f32 v245, v245, v248
    v_accvgpr_write_b32 a55, v245
    v_accvgpr_read_b32 v245, a56
    v_mul_f32 v245, v245, v248
    v_accvgpr_write_b32 a56, v245
    v_accvgpr_read_b32 v245, a57
    v_mul_f32 v245, v245, v248
    v_accvgpr_write_b32 a57, v245
    v_accvgpr_read_b32 v245, a58
    v_mul_f32 v245, v245, v248
    v_accvgpr_write_b32 a58, v245
    v_accvgpr_read_b32 v245, a59
    v_mul_f32 v245, v245, v248
    v_accvgpr_write_b32 a59, v245
    v_accvgpr_read_b32 v245, a60
    v_mul_f32 v245, v245, v248
    v_accvgpr_write_b32 a60, v245
    v_accvgpr_read_b32 v245, a61
    v_mul_f32 v245, v245, v248
    v_accvgpr_write_b32 a61, v245
    v_accvgpr_read_b32 v245, a62
    v_mul_f32 v245, v245, v248
    v_accvgpr_write_b32 a62, v245
    v_accvgpr_read_b32 v245, a63
    v_mul_f32 v245, v245, v248
    v_accvgpr_write_b32 a63, v245
    v_accvgpr_read_b32 v245, a64
    v_mul_f32 v245, v245, v248
    v_accvgpr_write_b32 a64, v245
    v_accvgpr_read_b32 v245, a65
    v_mul_f32 v245, v245, v248
    v_accvgpr_write_b32 a65, v245
    v_accvgpr_read_b32 v245, a66
    v_mul_f32 v245, v245, v248
    v_accvgpr_write_b32 a66, v245
    v_accvgpr_read_b32 v245, a67
    v_mul_f32 v245, v245, v248
    v_accvgpr_write_b32 a67, v245
    v_accvgpr_read_b32 v245, a68
    v_mul_f32 v245, v245, v248
    v_accvgpr_write_b32 a68, v245
    v_accvgpr_read_b32 v245, a69
    v_mul_f32 v245, v245, v248
    v_accvgpr_write_b32 a69, v245
    v_accvgpr_read_b32 v245, a70
    v_mul_f32 v245, v245, v248
    v_accvgpr_write_b32 a70, v245
    v_accvgpr_read_b32 v245, a71
    v_mul_f32 v245, v245, v248
    v_accvgpr_write_b32 a71, v245
    v_accvgpr_read_b32 v245, a72
    v_mul_f32 v245, v245, v248
    v_accvgpr_write_b32 a72, v245
    v_accvgpr_read_b32 v245, a73
    v_mul_f32 v245, v245, v248
    v_accvgpr_write_b32 a73, v245
    v_accvgpr_read_b32 v245, a74
    v_mul_f32 v245, v245, v248
    v_accvgpr_write_b32 a74, v245
    v_accvgpr_read_b32 v245, a75
    v_mul_f32 v245, v245, v248
    v_accvgpr_write_b32 a75, v245
    v_accvgpr_read_b32 v245, a76
    v_mul_f32 v245, v245, v248
    v_accvgpr_write_b32 a76, v245
    v_accvgpr_read_b32 v245, a77
    v_mul_f32 v245, v245, v248
    v_accvgpr_write_b32 a77, v245
    v_accvgpr_read_b32 v245, a78
    v_mul_f32 v245, v245, v248
    v_accvgpr_write_b32 a78, v245
    v_accvgpr_read_b32 v245, a79
    v_mul_f32 v245, v245, v248
    v_accvgpr_write_b32 a79, v245
    v_accvgpr_read_b32 v245, a80
    v_mul_f32 v245, v245, v248
    v_accvgpr_write_b32 a80, v245
    v_accvgpr_read_b32 v245, a81
    v_mul_f32 v245, v245, v248
    v_accvgpr_write_b32 a81, v245
    v_accvgpr_read_b32 v245, a82
    v_mul_f32 v245, v245, v248
    v_accvgpr_write_b32 a82, v245
    v_accvgpr_read_b32 v245, a83
    v_mul_f32 v245, v245, v248
    v_accvgpr_write_b32 a83, v245
    v_accvgpr_read_b32 v245, a84
    v_mul_f32 v245, v245, v248
    v_accvgpr_write_b32 a84, v245
    v_accvgpr_read_b32 v245, a85
    v_mul_f32 v245, v245, v248
    v_accvgpr_write_b32 a85, v245
    v_accvgpr_read_b32 v245, a86
    v_mul_f32 v245, v245, v248
    v_accvgpr_write_b32 a86, v245
    v_accvgpr_read_b32 v245, a87
    v_mul_f32 v245, v245, v248
    v_accvgpr_write_b32 a87, v245
    v_accvgpr_read_b32 v245, a88
    v_mul_f32 v245, v245, v248
    v_accvgpr_write_b32 a88, v245
    v_accvgpr_read_b32 v245, a89
    v_mul_f32 v245, v245, v248
    v_accvgpr_write_b32 a89, v245
    v_accvgpr_read_b32 v245, a90
    v_mul_f32 v245, v245, v248
    v_accvgpr_write_b32 a90, v245
    v_accvgpr_read_b32 v245, a91
    v_mul_f32 v245, v245, v248
    v_accvgpr_write_b32 a91, v245
    v_accvgpr_read_b32 v245, a92
    v_mul_f32 v245, v245, v248
    v_accvgpr_write_b32 a92, v245
    v_accvgpr_read_b32 v245, a93
    v_mul_f32 v245, v245, v248
    v_accvgpr_write_b32 a93, v245
    v_accvgpr_read_b32 v245, a94
    v_mul_f32 v245, v245, v248
    v_accvgpr_write_b32 a94, v245
    v_accvgpr_read_b32 v245, a95
    v_mul_f32 v245, v245, v248
    v_accvgpr_write_b32 a95, v245
    v_accvgpr_read_b32 v245, a96
    v_mul_f32 v245, v245, v248
    v_accvgpr_write_b32 a96, v245
    v_accvgpr_read_b32 v245, a97
    v_mul_f32 v245, v245, v248
    v_accvgpr_write_b32 a97, v245
    v_accvgpr_read_b32 v245, a98
    v_mul_f32 v245, v245, v248
    v_accvgpr_write_b32 a98, v245
    v_accvgpr_read_b32 v245, a99
    v_mul_f32 v245, v245, v248
    v_accvgpr_write_b32 a99, v245
    v_accvgpr_read_b32 v245, a100
    v_mul_f32 v245, v245, v248
    v_accvgpr_write_b32 a100, v245
    v_accvgpr_read_b32 v245, a101
    v_mul_f32 v245, v245, v248
    v_accvgpr_write_b32 a101, v245
    v_accvgpr_read_b32 v245, a102
    v_mul_f32 v245, v245, v248
    v_accvgpr_write_b32 a102, v245
    v_accvgpr_read_b32 v245, a103
    v_mul_f32 v245, v245, v248
    v_accvgpr_write_b32 a103, v245
    v_accvgpr_read_b32 v245, a104
    v_mul_f32 v245, v245, v248
    v_accvgpr_write_b32 a104, v245
    v_accvgpr_read_b32 v245, a105
    v_mul_f32 v245, v245, v248
    v_accvgpr_write_b32 a105, v245
    v_accvgpr_read_b32 v245, a106
    v_mul_f32 v245, v245, v248
    v_accvgpr_write_b32 a106, v245
    v_accvgpr_read_b32 v245, a107
    v_mul_f32 v245, v245, v248
    v_accvgpr_write_b32 a107, v245
    v_accvgpr_read_b32 v245, a108
    v_mul_f32 v245, v245, v248
    v_accvgpr_write_b32 a108, v245
    v_accvgpr_read_b32 v245, a109
    v_mul_f32 v245, v245, v248
    v_accvgpr_write_b32 a109, v245
    v_accvgpr_read_b32 v245, a110
    v_mul_f32 v245, v245, v248
    v_accvgpr_write_b32 a110, v245
    v_accvgpr_read_b32 v245, a111
    v_mul_f32 v245, v245, v248
    v_accvgpr_write_b32 a111, v245
    v_accvgpr_read_b32 v245, a112
    v_mul_f32 v245, v245, v248
    v_accvgpr_write_b32 a112, v245
    v_accvgpr_read_b32 v245, a113
    v_mul_f32 v245, v245, v248
    v_accvgpr_write_b32 a113, v245
    v_accvgpr_read_b32 v245, a114
    v_mul_f32 v245, v245, v248
    v_accvgpr_write_b32 a114, v245
    v_accvgpr_read_b32 v245, a115
    v_mul_f32 v245, v245, v248
    v_accvgpr_write_b32 a115, v245
    v_accvgpr_read_b32 v245, a116
    v_mul_f32 v245, v245, v248
    v_accvgpr_write_b32 a116, v245
    v_accvgpr_read_b32 v245, a117
    v_mul_f32 v245, v245, v248
    v_accvgpr_write_b32 a117, v245
    v_accvgpr_read_b32 v245, a118
    v_mul_f32 v245, v245, v248
    v_accvgpr_write_b32 a118, v245
    v_accvgpr_read_b32 v245, a119
    v_mul_f32 v245, v245, v248
    v_accvgpr_write_b32 a119, v245
    v_accvgpr_read_b32 v245, a120
    v_mul_f32 v245, v245, v248
    v_accvgpr_write_b32 a120, v245
    v_accvgpr_read_b32 v245, a121
    v_mul_f32 v245, v245, v248
    v_accvgpr_write_b32 a121, v245
    v_accvgpr_read_b32 v245, a122
    v_mul_f32 v245, v245, v248
    v_accvgpr_write_b32 a122, v245
    v_accvgpr_read_b32 v245, a123
    v_mul_f32 v245, v245, v248
    v_accvgpr_write_b32 a123, v245
    v_accvgpr_read_b32 v245, a124
    v_mul_f32 v245, v245, v248
    v_accvgpr_write_b32 a124, v245
    v_accvgpr_read_b32 v245, a125
    v_mul_f32 v245, v245, v248
    v_accvgpr_write_b32 a125, v245
    v_accvgpr_read_b32 v245, a126
    v_mul_f32 v245, v245, v248
    v_accvgpr_write_b32 a126, v245
    v_accvgpr_read_b32 v245, a127
    v_mul_f32 v245, v245, v248
    v_accvgpr_write_b32 a127, v245
    v_fma_f32 v232, v160, s21, v239
    s_nop 0
    v_fma_f32 v233, v161, s21, v239
    v_exp_f32 v232, v232
    s_nop 0
    v_fma_f32 v234, v162, s21, v239
    v_exp_f32 v233, v233
    s_nop 0
    v_fma_f32 v235, v163, s21, v239
    v_exp_f32 v234, v234
    v_add_f32 v243, v232, v233
    v_cvt_pk_bf16_f32 v200, v232, v233
    s_nop 0
    v_fma_f32 v232, v164, s21, v239
    v_exp_f32 v235, v235
    v_add_f32 v243, v243, v234
    s_nop 0
    v_fma_f32 v233, v165, s21, v239
    v_exp_f32 v232, v232
    v_add_f32 v243, v243, v235
    v_cvt_pk_bf16_f32 v201, v234, v235
    s_nop 0
    v_fma_f32 v234, v166, s21, v239
    v_exp_f32 v233, v233
    v_add_f32 v243, v243, v232
    s_nop 0
    v_fma_f32 v235, v167, s21, v239
    v_exp_f32 v234, v234
    v_add_f32 v243, v243, v233
    v_cvt_pk_bf16_f32 v202, v232, v233
    s_nop 0
    v_fma_f32 v232, v176, s21, v240
    v_exp_f32 v235, v235
    v_add_f32 v243, v243, v234
    s_nop 0
    v_fma_f32 v233, v177, s21, v240
    v_exp_f32 v232, v232
    v_add_f32 v243, v243, v235
    v_cvt_pk_bf16_f32 v203, v234, v235
    s_nop 0
    v_fma_f32 v234, v178, s21, v240
    v_exp_f32 v233, v233
    s_nop 0
    v_fma_f32 v235, v179, s21, v240
    v_exp_f32 v234, v234
    v_add_f32 v244, v232, v233
    v_cvt_pk_bf16_f32 v204, v232, v233
    s_nop 0
    v_fma_f32 v232, v180, s21, v240
    v_exp_f32 v235, v235
    v_add_f32 v244, v244, v234
    s_nop 0
    v_fma_f32 v233, v181, s21, v240
    v_exp_f32 v232, v232
    v_add_f32 v244, v244, v235
    v_cvt_pk_bf16_f32 v205, v234, v235
    s_nop 0
    v_fma_f32 v234, v182, s21, v240
    v_exp_f32 v233, v233
    v_add_f32 v244, v244, v232
    s_nop 0
    v_fma_f32 v235, v183, s21, v240
    v_exp_f32 v234, v234
    v_add_f32 v244, v244, v233
    v_cvt_pk_bf16_f32 v206, v232, v233
    s_nop 0
    v_fma_f32 v232, v168, s21, v239
    v_exp_f32 v235, v235
    v_add_f32 v244, v244, v234
    s_nop 0
    v_fma_f32 v233, v169, s21, v239
    v_exp_f32 v232, v232
    v_add_f32 v244, v244, v235
    v_cvt_pk_bf16_f32 v207, v234, v235
    s_nop 0
    v_fma_f32 v234, v170, s21, v239
    v_exp_f32 v233, v233
    v_add_f32 v243, v243, v232
    s_nop 0
    v_fma_f32 v235, v171, s21, v239
    v_exp_f32 v234, v234
    v_add_f32 v243, v243, v233
    v_cvt_pk_bf16_f32 v208, v232, v233
    s_nop 0
    v_fma_f32 v232, v172, s21, v239
    v_exp_f32 v235, v235
    v_add_f32 v243, v243, v234
    s_nop 0
    v_fma_f32 v233, v173, s21, v239
    v_exp_f32 v232, v232
    v_add_f32 v243, v243, v235
    v_cvt_pk_bf16_f32 v209, v234, v235
    s_nop 0
    v_fma_f32 v234, v174, s21, v239
    v_exp_f32 v233, v233
    v_add_f32 v243, v243, v232
    s_nop 0
    v_fma_f32 v235, v175, s21, v239
    v_exp_f32 v234, v234
    v_add_f32 v243, v243, v233
    v_cvt_pk_bf16_f32 v210, v232, v233
    s_nop 0
    v_fma_f32 v232, v184, s21, v240
    v_exp_f32 v235, v235
    v_add_f32 v243, v243, v234
    s_nop 0
    v_fma_f32 v233, v185, s21, v240
    v_exp_f32 v232, v232
    v_add_f32 v243, v243, v235
    v_cvt_pk_bf16_f32 v211, v234, v235
    s_nop 0
    v_fma_f32 v234, v186, s21, v240
    v_exp_f32 v233, v233
    v_add_f32 v244, v244, v232
    s_nop 0
    v_fma_f32 v235, v187, s21, v240
    v_exp_f32 v234, v234
    v_add_f32 v244, v244, v233
    v_cvt_pk_bf16_f32 v212, v232, v233
    s_nop 0
    v_fma_f32 v232, v188, s21, v240
    v_exp_f32 v235, v235
    v_add_f32 v244, v244, v234
    s_nop 0
    v_fma_f32 v233, v189, s21, v240
    v_exp_f32 v232, v232
    v_add_f32 v244, v244, v235
    v_cvt_pk_bf16_f32 v213, v234, v235
    s_nop 0
    v_fma_f32 v234, v190, s21, v240
    v_exp_f32 v233, v233
    v_add_f32 v244, v244, v232
    s_nop 0
    v_fma_f32 v235, v191, s21, v240
    v_exp_f32 v234, v234
    v_add_f32 v244, v244, v233
    v_cvt_pk_bf16_f32 v214, v232, v233
    s_nop 0
    v_exp_f32 v235, v235
    v_add_f32 v244, v244, v234
    s_nop 0
    v_add_f32 v244, v244, v235
    v_cvt_pk_bf16_f32 v215, v234, v235
    s_nop 0
    s_nop 3
    s_branch L_backs15B
L_rares1B:
    s_nop 7
    v_max3_f32 v247, v160, v161, v162
    v_max3_f32 v247, v247, v163, v164
    v_max3_f32 v247, v247, v165, v166
    v_max3_f32 v247, v247, v167, v168
    v_max3_f32 v247, v247, v169, v170
    v_max3_f32 v247, v247, v171, v172
    v_max3_f32 v247, v247, v173, v174
    v_max_f32 v247, v247, v175
    v_mov_b32 v245, v247
    s_nop 1
    v_permlane32_swap_b32 v245, v247
    s_nop 0
    v_max_f32 v247, v247, v245
    v_mul_f32 v247, s30, v247
    v_min_f32 v247, v247, v239
    v_sub_f32 v248, v247, v239
    v_exp_f32 v248, v248
    v_mov_b32 v239, v247
    v_mul_f32 v241, v241, v248
    v_mul_f32 v0, v0, v248
    v_mul_f32 v1, v1, v248
    v_mul_f32 v2, v2, v248
    v_mul_f32 v3, v3, v248
    v_mul_f32 v4, v4, v248
    v_mul_f32 v5, v5, v248
    v_mul_f32 v6, v6, v248
    v_mul_f32 v7, v7, v248
    v_mul_f32 v8, v8, v248
    v_mul_f32 v9, v9, v248
    v_mul_f32 v10, v10, v248
    v_mul_f32 v11, v11, v248
    v_mul_f32 v12, v12, v248
    v_mul_f32 v13, v13, v248
    v_mul_f32 v14, v14, v248
    v_mul_f32 v15, v15, v248
    v_mul_f32 v16, v16, v248
    v_mul_f32 v17, v17, v248
    v_mul_f32 v18, v18, v248
    v_mul_f32 v19, v19, v248
    v_mul_f32 v20, v20, v248
    v_mul_f32 v21, v21, v248
    v_mul_f32 v22, v22, v248
    v_mul_f32 v23, v23, v248
    v_mul_f32 v24, v24, v248
    v_mul_f32 v25, v25, v248
    v_mul_f32 v26, v26, v248
    v_mul_f32 v27, v27, v248
    v_mul_f32 v28, v28, v248
    v_mul_f32 v29, v29, v248
    v_mul_f32 v30, v30, v248
    v_mul_f32 v31, v31, v248
    v_mul_f32 v32, v32, v248
    v_mul_f32 v33, v33, v248
    v_mul_f32 v34, v34, v248
    v_mul_f32 v35, v35, v248
    v_mul_f32 v36, v36, v248
    v_mul_f32 v37, v37, v248
    v_mul_f32 v38, v38, v248
    v_mul_f32 v39, v39, v248
    v_mul_f32 v40, v40, v248
    v_mul_f32 v41, v41, v248
    v_mul_f32 v42, v42, v248
    v_mul_f32 v43, v43, v248
    v_mul_f32 v44, v44, v248
    v_mul_f32 v45, v45, v248
    v_mul_f32 v46, v46, v248
    v_mul_f32 v47, v47, v248
    v_mul_f32 v48, v48, v248
    v_mul_f32 v49, v49, v248
    v_mul_f32 v50, v50, v248
    v_mul_f32 v51, v51, v248
    v_mul_f32 v52, v52, v248
    v_mul_f32 v53, v53, v248
    v_mul_f32 v54, v54, v248
    v_mul_f32 v55, v55, v248
    v_mul_f32 v56, v56, v248
    v_mul_f32 v57, v57, v248
    v_mul_f32 v58, v58, v248
    v_mul_f32 v59, v59, v248
    v_mul_f32 v60, v60, v248
    v_mul_f32 v61, v61, v248
    v_mul_f32 v62, v62, v248
    v_mul_f32 v63, v63, v248
    v_mul_f32 v64, v64, v248
    v_mul_f32 v65, v65, v248
    v_mul_f32 v66, v66, v248
    v_mul_f32 v67, v67, v248
    v_mul_f32 v68, v68, v248
    v_mul_f32 v69, v69, v248
    v_mul_f32 v70, v70, v248
    v_mul_f32 v71, v71, v248
    v_mul_f32 v72, v72, v248
    v_mul_f32 v73, v73, v248
    v_mul_f32 v74, v74, v248
    v_mul_f32 v75, v75, v248
    v_mul_f32 v76, v76, v248
    v_mul_f32 v77, v77, v248
    v_mul_f32 v78, v78, v248
    v_mul_f32 v79, v79, v248
    v_mul_f32 v80, v80, v248
    v_mul_f32 v81, v81, v248
    v_mul_f32 v82, v82, v248
    v_mul_f32 v83, v83, v248
    v_mul_f32 v84, v84, v248
    v_mul_f32 v85, v85, v248
    v_mul_f32 v86, v86, v248
    v_mul_f32 v87, v87, v248
    v_mul_f32 v88, v88, v248
    v_mul_f32 v89, v89, v248
    v_mul_f32 v90, v90, v248
    v_mul_f32 v91, v91, v248
    v_mul_f32 v92, v92, v248
    v_mul_f32 v93, v93, v248
    v_mul_f32 v94, v94, v248
    v_mul_f32 v95, v95, v248
    v_mul_f32 v96, v96, v248
    v_mul_f32 v97, v97, v248
    v_mul_f32 v98, v98, v248
    v_mul_f32 v99, v99, v248
    v_mul_f32 v100, v100, v248
    v_mul_f32 v101, v101, v248
    v_mul_f32 v102, v102, v248
    v_mul_f32 v103, v103, v248
    v_mul_f32 v104, v104, v248
    v_mul_f32 v105, v105, v248
    v_mul_f32 v106, v106, v248
    v_mul_f32 v107, v107, v248
    v_mul_f32 v108, v108, v248
    v_mul_f32 v109, v109, v248
    v_mul_f32 v110, v110, v248
    v_mul_f32 v111, v111, v248
    v_mul_f32 v112, v112, v248
    v_mul_f32 v113, v113, v248
    v_mul_f32 v114, v114, v248
    v_mul_f32 v115, v115, v248
    v_mul_f32 v116, v116, v248
    v_mul_f32 v117, v117, v248
    v_mul_f32 v118, v118, v248
    v_mul_f32 v119, v119, v248
    v_mul_f32 v120, v120, v248
    v_mul_f32 v121, v121, v248
    v_mul_f32 v122, v122, v248
    v_mul_f32 v123, v123, v248
    v_mul_f32 v124, v124, v248
    v_mul_f32 v125, v125, v248
    v_mul_f32 v126, v126, v248
    v_mul_f32 v127, v127, v248
    v_max3_f32 v247, v176, v177, v178
    v_max3_f32 v247, v247, v179, v180
    v_max3_f32 v247, v247, v181, v182
    v_max3_f32 v247, v247, v183, v184
    v_max3_f32 v247, v247, v185, v186
    v_max3_f32 v247, v247, v187, v188
    v_max3_f32 v247, v247, v189, v190
    v_max_f32 v247, v247, v191
    v_mov_b32 v245, v247
    s_nop 1
    v_permlane32_swap_b32 v245, v247
    s_nop 0
    v_max_f32 v247, v247, v245
    v_mul_f32 v247, s30, v247
    v_min_f32 v247, v247, v240
    v_sub_f32 v248, v247, v240
    v_exp_f32 v248, v248
    v_mov_b32 v240, v247
    v_mul_f32 v242, v242, v248
    v_accvgpr_read_b32 v245, a0
    v_mul_f32 v245, v245, v248
    v_accvgpr_write_b32 a0, v245
    v_accvgpr_read_b32 v245, a1
    v_mul_f32 v245, v245, v248
    v_accvgpr_write_b32 a1, v245
    v_accvgpr_read_b32 v245, a2
    v_mul_f32 v245, v245, v248
    v_accvgpr_write_b32 a2, v245
    v_accvgpr_read_b32 v245, a3
    v_mul_f32 v245, v245, v248
    v_accvgpr_write_b32 a3, v245
    v_accvgpr_read_b32 v245, a4
    v_mul_f32 v245, v245, v248
    v_accvgpr_write_b32 a4, v245
    v_accvgpr_read_b32 v245, a5
    v_mul_f32 v245, v245, v248
    v_accvgpr_write_b32 a5, v245
    v_accvgpr_read_b32 v245, a6
    v_mul_f32 v245, v245, v248
    v_accvgpr_write_b32 a6, v245
    v_accvgpr_read_b32 v245, a7
    v_mul_f32 v245, v245, v248
    v_accvgpr_write_b32 a7, v245
    v_accvgpr_read_b32 v245, a8
    v_mul_f32 v245, v245, v248
    v_accvgpr_write_b32 a8, v245
    v_accvgpr_read_b32 v245, a9
    v_mul_f32 v245, v245, v248
    v_accvgpr_write_b32 a9, v245
    v_accvgpr_read_b32 v245, a10
    v_mul_f32 v245, v245, v248
    v_accvgpr_write_b32 a10, v245
    v_accvgpr_read_b32 v245, a11
    v_mul_f32 v245, v245, v248
    v_accvgpr_write_b32 a11, v245
    v_accvgpr_read_b32 v245, a12
    v_mul_f32 v245, v245, v248
    v_accvgpr_write_b32 a12, v245
    v_accvgpr_read_b32 v245, a13
    v_mul_f32 v245, v245, v248
    v_accvgpr_write_b32 a13, v245
    v_accvgpr_read_b32 v245, a14
    v_mul_f32 v245, v245, v248
    v_accvgpr_write_b32 a14, v245
    v_accvgpr_read_b32 v245, a15
    v_mul_f32 v245, v245, v248
    v_accvgpr_write_b32 a15, v245
    v_accvgpr_read_b32 v245, a16
    v_mul_f32 v245, v245, v248
    v_accvgpr_write_b32 a16, v245
    v_accvgpr_read_b32 v245, a17
    v_mul_f32 v245, v245, v248
    v_accvgpr_write_b32 a17, v245
    v_accvgpr_read_b32 v245, a18
    v_mul_f32 v245, v245, v248
    v_accvgpr_write_b32 a18, v245
    v_accvgpr_read_b32 v245, a19
    v_mul_f32 v245, v245, v248
    v_accvgpr_write_b32 a19, v245
    v_accvgpr_read_b32 v245, a20
    v_mul_f32 v245, v245, v248
    v_accvgpr_write_b32 a20, v245
    v_accvgpr_read_b32 v245, a21
    v_mul_f32 v245, v245, v248
    v_accvgpr_write_b32 a21, v245
    v_accvgpr_read_b32 v245, a22
    v_mul_f32 v245, v245, v248
    v_accvgpr_write_b32 a22, v245
    v_accvgpr_read_b32 v245, a23
    v_mul_f32 v245, v245, v248
    v_accvgpr_write_b32 a23, v245
    v_accvgpr_read_b32 v245, a24
    v_mul_f32 v245, v245, v248
    v_accvgpr_write_b32 a24, v245
    v_accvgpr_read_b32 v245, a25
    v_mul_f32 v245, v245, v248
    v_accvgpr_write_b32 a25, v245
    v_accvgpr_read_b32 v245, a26
    v_mul_f32 v245, v245, v248
    v_accvgpr_write_b32 a26, v245
    v_accvgpr_read_b32 v245, a27
    v_mul_f32 v245, v245, v248
    v_accvgpr_write_b32 a27, v245
    v_accvgpr_read_b32 v245, a28
    v_mul_f32 v245, v245, v248
    v_accvgpr_write_b32 a28, v245
    v_accvgpr_read_b32 v245, a29
    v_mul_f32 v245, v245, v248
    v_accvgpr_write_b32 a29, v245
    v_accvgpr_read_b32 v245, a30
    v_mul_f32 v245, v245, v248
    v_accvgpr_write_b32 a30, v245
    v_accvgpr_read_b32 v245, a31
    v_mul_f32 v245, v245, v248
    v_accvgpr_write_b32 a31, v245
    v_accvgpr_read_b32 v245, a32
    v_mul_f32 v245, v245, v248
    v_accvgpr_write_b32 a32, v245
    v_accvgpr_read_b32 v245, a33
    v_mul_f32 v245, v245, v248
    v_accvgpr_write_b32 a33, v245
    v_accvgpr_read_b32 v245, a34
    v_mul_f32 v245, v245, v248
    v_accvgpr_write_b32 a34, v245
    v_accvgpr_read_b32 v245, a35
    v_mul_f32 v245, v245, v248
    v_accvgpr_write_b32 a35, v245
    v_accvgpr_read_b32 v245, a36
    v_mul_f32 v245, v245, v248
    v_accvgpr_write_b32 a36, v245
    v_accvgpr_read_b32 v245, a37
    v_mul_f32 v245, v245, v248
    v_accvgpr_write_b32 a37, v245
    v_accvgpr_read_b32 v245, a38
    v_mul_f32 v245, v245, v248
    v_accvgpr_write_b32 a38, v245
    v_accvgpr_read_b32 v245, a39
    v_mul_f32 v245, v245, v248
    v_accvgpr_write_b32 a39, v245
    v_accvgpr_read_b32 v245, a40
    v_mul_f32 v245, v245, v248
    v_accvgpr_write_b32 a40, v245
    v_accvgpr_read_b32 v245, a41
    v_mul_f32 v245, v245, v248
    v_accvgpr_write_b32 a41, v245
    v_accvgpr_read_b32 v245, a42
    v_mul_f32 v245, v245, v248
    v_accvgpr_write_b32 a42, v245
    v_accvgpr_read_b32 v245, a43
    v_mul_f32 v245, v245, v248
    v_accvgpr_write_b32 a43, v245
    v_accvgpr_read_b32 v245, a44
    v_mul_f32 v245, v245, v248
    v_accvgpr_write_b32 a44, v245
    v_accvgpr_read_b32 v245, a45
    v_mul_f32 v245, v245, v248
    v_accvgpr_write_b32 a45, v245
    v_accvgpr_read_b32 v245, a46
    v_mul_f32 v245, v245, v248
    v_accvgpr_write_b32 a46, v245
    v_accvgpr_read_b32 v245, a47
    v_mul_f32 v245, v245, v248
    v_accvgpr_write_b32 a47, v245
    v_accvgpr_read_b32 v245, a48
    v_mul_f32 v245, v245, v248
    v_accvgpr_write_b32 a48, v245
    v_accvgpr_read_b32 v245, a49
    v_mul_f32 v245, v245, v248
    v_accvgpr_write_b32 a49, v245
    v_accvgpr_read_b32 v245, a50
    v_mul_f32 v245, v245, v248
    v_accvgpr_write_b32 a50, v245
    v_accvgpr_read_b32 v245, a51
    v_mul_f32 v245, v245, v248
    v_accvgpr_write_b32 a51, v245
    v_accvgpr_read_b32 v245, a52
    v_mul_f32 v245, v245, v248
    v_accvgpr_write_b32 a52, v245
    v_accvgpr_read_b32 v245, a53
    v_mul_f32 v245, v245, v248
    v_accvgpr_write_b32 a53, v245
    v_accvgpr_read_b32 v245, a54
    v_mul_f32 v245, v245, v248
    v_accvgpr_write_b32 a54, v245
    v_accvgpr_read_b32 v245, a55
    v_mul_f32 v245, v245, v248
    v_accvgpr_write_b32 a55, v245
    v_accvgpr_read_b32 v245, a56
    v_mul_f32 v245, v245, v248
    v_accvgpr_write_b32 a56, v245
    v_accvgpr_read_b32 v245, a57
    v_mul_f32 v245, v245, v248
    v_accvgpr_write_b32 a57, v245
    v_accvgpr_read_b32 v245, a58
    v_mul_f32 v245, v245, v248
    v_accvgpr_write_b32 a58, v245
    v_accvgpr_read_b32 v245, a59
    v_mul_f32 v245, v245, v248
    v_accvgpr_write_b32 a59, v245
    v_accvgpr_read_b32 v245, a60
    v_mul_f32 v245, v245, v248
    v_accvgpr_write_b32 a60, v245
    v_accvgpr_read_b32 v245, a61
    v_mul_f32 v245, v245, v248
    v_accvgpr_write_b32 a61, v245
    v_accvgpr_read_b32 v245, a62
    v_mul_f32 v245, v245, v248
    v_accvgpr_write_b32 a62, v245
    v_accvgpr_read_b32 v245, a63
    v_mul_f32 v245, v245, v248
    v_accvgpr_write_b32 a63, v245
    v_accvgpr_read_b32 v245, a64
    v_mul_f32 v245, v245, v248
    v_accvgpr_write_b32 a64, v245
    v_accvgpr_read_b32 v245, a65
    v_mul_f32 v245, v245, v248
    v_accvgpr_write_b32 a65, v245
    v_accvgpr_read_b32 v245, a66
    v_mul_f32 v245, v245, v248
    v_accvgpr_write_b32 a66, v245
    v_accvgpr_read_b32 v245, a67
    v_mul_f32 v245, v245, v248
    v_accvgpr_write_b32 a67, v245
    v_accvgpr_read_b32 v245, a68
    v_mul_f32 v245, v245, v248
    v_accvgpr_write_b32 a68, v245
    v_accvgpr_read_b32 v245, a69
    v_mul_f32 v245, v245, v248
    v_accvgpr_write_b32 a69, v245
    v_accvgpr_read_b32 v245, a70
    v_mul_f32 v245, v245, v248
    v_accvgpr_write_b32 a70, v245
    v_accvgpr_read_b32 v245, a71
    v_mul_f32 v245, v245, v248
    v_accvgpr_write_b32 a71, v245
    v_accvgpr_read_b32 v245, a72
    v_mul_f32 v245, v245, v248
    v_accvgpr_write_b32 a72, v245
    v_accvgpr_read_b32 v245, a73
    v_mul_f32 v245, v245, v248
    v_accvgpr_write_b32 a73, v245
    v_accvgpr_read_b32 v245, a74
    v_mul_f32 v245, v245, v248
    v_accvgpr_write_b32 a74, v245
    v_accvgpr_read_b32 v245, a75
    v_mul_f32 v245, v245, v248
    v_accvgpr_write_b32 a75, v245
    v_accvgpr_read_b32 v245, a76
    v_mul_f32 v245, v245, v248
    v_accvgpr_write_b32 a76, v245
    v_accvgpr_read_b32 v245, a77
    v_mul_f32 v245, v245, v248
    v_accvgpr_write_b32 a77, v245
    v_accvgpr_read_b32 v245, a78
    v_mul_f32 v245, v245, v248
    v_accvgpr_write_b32 a78, v245
    v_accvgpr_read_b32 v245, a79
    v_mul_f32 v245, v245, v248
    v_accvgpr_write_b32 a79, v245
    v_accvgpr_read_b32 v245, a80
    v_mul_f32 v245, v245, v248
    v_accvgpr_write_b32 a80, v245
    v_accvgpr_read_b32 v245, a81
    v_mul_f32 v245, v245, v248
    v_accvgpr_write_b32 a81, v245
    v_accvgpr_read_b32 v245, a82
    v_mul_f32 v245, v245, v248
    v_accvgpr_write_b32 a82, v245
    v_accvgpr_read_b32 v245, a83
    v_mul_f32 v245, v245, v248
    v_accvgpr_write_b32 a83, v245
    v_accvgpr_read_b32 v245, a84
    v_mul_f32 v245, v245, v248
    v_accvgpr_write_b32 a84, v245
    v_accvgpr_read_b32 v245, a85
    v_mul_f32 v245, v245, v248
    v_accvgpr_write_b32 a85, v245
    v_accvgpr_read_b32 v245, a86
    v_mul_f32 v245, v245, v248
    v_accvgpr_write_b32 a86, v245
    v_accvgpr_read_b32 v245, a87
    v_mul_f32 v245, v245, v248
    v_accvgpr_write_b32 a87, v245
    v_accvgpr_read_b32 v245, a88
    v_mul_f32 v245, v245, v248
    v_accvgpr_write_b32 a88, v245
    v_accvgpr_read_b32 v245, a89
    v_mul_f32 v245, v245, v248
    v_accvgpr_write_b32 a89, v245
    v_accvgpr_read_b32 v245, a90
    v_mul_f32 v245, v245, v248
    v_accvgpr_write_b32 a90, v245
    v_accvgpr_read_b32 v245, a91
    v_mul_f32 v245, v245, v248
    v_accvgpr_write_b32 a91, v245
    v_accvgpr_read_b32 v245, a92
    v_mul_f32 v245, v245, v248
    v_accvgpr_write_b32 a92, v245
    v_accvgpr_read_b32 v245, a93
    v_mul_f32 v245, v245, v248
    v_accvgpr_write_b32 a93, v245
    v_accvgpr_read_b32 v245, a94
    v_mul_f32 v245, v245, v248
    v_accvgpr_write_b32 a94, v245
    v_accvgpr_read_b32 v245, a95
    v_mul_f32 v245, v245, v248
    v_accvgpr_write_b32 a95, v245
    v_accvgpr_read_b32 v245, a96
    v_mul_f32 v245, v245, v248
    v_accvgpr_write_b32 a96, v245
    v_accvgpr_read_b32 v245, a97
    v_mul_f32 v245, v245, v248
    v_accvgpr_write_b32 a97, v245
    v_accvgpr_read_b32 v245, a98
    v_mul_f32 v245, v245, v248
    v_accvgpr_write_b32 a98, v245
    v_accvgpr_read_b32 v245, a99
    v_mul_f32 v245, v245, v248
    v_accvgpr_write_b32 a99, v245
    v_accvgpr_read_b32 v245, a100
    v_mul_f32 v245, v245, v248
    v_accvgpr_write_b32 a100, v245
    v_accvgpr_read_b32 v245, a101
    v_mul_f32 v245, v245, v248
    v_accvgpr_write_b32 a101, v245
    v_accvgpr_read_b32 v245, a102
    v_mul_f32 v245, v245, v248
    v_accvgpr_write_b32 a102, v245
    v_accvgpr_read_b32 v245, a103
    v_mul_f32 v245, v245, v248
    v_accvgpr_write_b32 a103, v245
    v_accvgpr_read_b32 v245, a104
    v_mul_f32 v245, v245, v248
    v_accvgpr_write_b32 a104, v245
    v_accvgpr_read_b32 v245, a105
    v_mul_f32 v245, v245, v248
    v_accvgpr_write_b32 a105, v245
    v_accvgpr_read_b32 v245, a106
    v_mul_f32 v245, v245, v248
    v_accvgpr_write_b32 a106, v245
    v_accvgpr_read_b32 v245, a107
    v_mul_f32 v245, v245, v248
    v_accvgpr_write_b32 a107, v245
    v_accvgpr_read_b32 v245, a108
    v_mul_f32 v245, v245, v248
    v_accvgpr_write_b32 a108, v245
    v_accvgpr_read_b32 v245, a109
    v_mul_f32 v245, v245, v248
    v_accvgpr_write_b32 a109, v245
    v_accvgpr_read_b32 v245, a110
    v_mul_f32 v245, v245, v248
    v_accvgpr_write_b32 a110, v245
    v_accvgpr_read_b32 v245, a111
    v_mul_f32 v245, v245, v248
    v_accvgpr_write_b32 a111, v245
    v_accvgpr_read_b32 v245, a112
    v_mul_f32 v245, v245, v248
    v_accvgpr_write_b32 a112, v245
    v_accvgpr_read_b32 v245, a113
    v_mul_f32 v245, v245, v248
    v_accvgpr_write_b32 a113, v245
    v_accvgpr_read_b32 v245, a114
    v_mul_f32 v245, v245, v248
    v_accvgpr_write_b32 a114, v245
    v_accvgpr_read_b32 v245, a115
    v_mul_f32 v245, v245, v248
    v_accvgpr_write_b32 a115, v245
    v_accvgpr_read_b32 v245, a116
    v_mul_f32 v245, v245, v248
    v_accvgpr_write_b32 a116, v245
    v_accvgpr_read_b32 v245, a117
    v_mul_f32 v245, v245, v248
    v_accvgpr_write_b32 a117, v245
    v_accvgpr_read_b32 v245, a118
    v_mul_f32 v245, v245, v248
    v_accvgpr_write_b32 a118, v245
    v_accvgpr_read_b32 v245, a119
    v_mul_f32 v245, v245, v248
    v_accvgpr_write_b32 a119, v245
    v_accvgpr_read_b32 v245, a120
    v_mul_f32 v245, v245, v248
    v_accvgpr_write_b32 a120, v245
    v_accvgpr_read_b32 v245, a121
    v_mul_f32 v245, v245, v248
    v_accvgpr_write_b32 a121, v245
    v_accvgpr_read_b32 v245, a122
    v_mul_f32 v245, v245, v248
    v_accvgpr_write_b32 a122, v245
    v_accvgpr_read_b32 v245, a123
    v_mul_f32 v245, v245, v248
    v_accvgpr_write_b32 a123, v245
    v_accvgpr_read_b32 v245, a124
    v_mul_f32 v245, v245, v248
    v_accvgpr_write_b32 a124, v245
    v_accvgpr_read_b32 v245, a125
    v_mul_f32 v245, v245, v248
    v_accvgpr_write_b32 a125, v245
    v_accvgpr_read_b32 v245, a126
    v_mul_f32 v245, v245, v248
    v_accvgpr_write_b32 a126, v245
    v_accvgpr_read_b32 v245, a127
    v_mul_f32 v245, v245, v248
    v_accvgpr_write_b32 a127, v245
    v_fma_f32 v232, v160, s21, v239
    s_nop 0
    v_fma_f32 v233, v161, s21, v239
    v_exp_f32 v232, v232
    s_nop 0
    v_fma_f32 v234, v162, s21, v239
    v_exp_f32 v233, v233
    s_nop 0
    v_fma_f32 v235, v163, s21, v239
    v_exp_f32 v234, v234
    v_add_f32 v243, v232, v233
    v_cvt_pk_bf16_f32 v200, v232, v233
    s_nop 0
    v_fma_f32 v232, v164, s21, v239
    v_exp_f32 v235, v235
    v_add_f32 v243, v243, v234
    s_nop 0
    v_fma_f32 v233, v165, s21, v239
    v_exp_f32 v232, v232
    v_add_f32 v243, v243, v235
    v_cvt_pk_bf16_f32 v201, v234, v235
    s_nop 0
    v_fma_f32 v234, v166, s21, v239
    v_exp_f32 v233, v233
    v_add_f32 v243, v243, v232
    s_nop 0
    v_fma_f32 v235, v167, s21, v239
    v_exp_f32 v234, v234
    v_add_f32 v243, v243, v233
    v_cvt_pk_bf16_f32 v202, v232, v233
    s_nop 0
    v_fma_f32 v232, v176, s21, v240
    v_exp_f32 v235, v235
    v_add_f32 v243, v243, v234
    s_nop 0
    v_fma_f32 v233, v177, s21, v240
    v_exp_f32 v232, v232
    v_add_f32 v243, v243, v235
    v_cvt_pk_bf16_f32 v203, v234, v235
    s_nop 0
    v_fma_f32 v234, v178, s21, v240
    v_exp_f32 v233, v233
    s_nop 0
    v_fma_f32 v235, v179, s21, v240
    v_exp_f32 v234, v234
    v_add_f32 v244, v232, v233
    v_cvt_pk_bf16_f32 v204, v232, v233
    s_nop 0
    v_fma_f32 v232, v180, s21, v240
    v_exp_f32 v235, v235
    v_add_f32 v244, v244, v234
    s_nop 0
    v_fma_f32 v233, v181, s21, v240
    v_exp_f32 v232, v232
    v_add_f32 v244, v244, v235
    v_cvt_pk_bf16_f32 v205, v234, v235
    s_nop 0
    v_fma_f32 v234, v182, s21, v240
    v_exp_f32 v233, v233
    v_add_f32 v244, v244, v232
    s_nop 0
    v_fma_f32 v235, v183, s21, v240
    v_exp_f32 v234, v234
    v_add_f32 v244, v244, v233
    v_cvt_pk_bf16_f32 v206, v232, v233
    s_nop 0
    v_fma_f32 v232, v168, s21, v239
    v_exp_f32 v235, v235
    v_add_f32 v244, v244, v234
    s_nop 0
    v_fma_f32 v233, v169, s21, v239
    v_exp_f32 v232, v232
    v_add_f32 v244, v244, v235
    v_cvt_pk_bf16_f32 v207, v234, v235
    s_nop 0
    v_fma_f32 v234, v170, s21, v239
    v_exp_f32 v233, v233
    v_add_f32 v243, v243, v232
    s_nop 0
    v_fma_f32 v235, v171, s21, v239
    v_exp_f32 v234, v234
    v_add_f32 v243, v243, v233
    v_cvt_pk_bf16_f32 v208, v232, v233
    s_nop 0
    v_fma_f32 v232, v172, s21, v239
    v_exp_f32 v235, v235
    v_add_f32 v243, v243, v234
    s_nop 0
    v_fma_f32 v233, v173, s21, v239
    v_exp_f32 v232, v232
    v_add_f32 v243, v243, v235
    v_cvt_pk_bf16_f32 v209, v234, v235
    s_nop 0
    v_fma_f32 v234, v174, s21, v239
    v_exp_f32 v233, v233
    v_add_f32 v243, v243, v232
    s_nop 0
    v_fma_f32 v235, v175, s21, v239
    v_exp_f32 v234, v234
    v_add_f32 v243, v243, v233
    v_cvt_pk_bf16_f32 v210, v232, v233
    s_nop 0
    v_fma_f32 v232, v184, s21, v240
    v_exp_f32 v235, v235
    v_add_f32 v243, v243, v234
    s_nop 0
    v_fma_f32 v233, v185, s21, v240
    v_exp_f32 v232, v232
    v_add_f32 v243, v243, v235
    v_cvt_pk_bf16_f32 v211, v234, v235
    s_nop 0
    v_fma_f32 v234, v186, s21, v240
    v_exp_f32 v233, v233
    v_add_f32 v244, v244, v232
    s_nop 0
    v_fma_f32 v235, v187, s21, v240
    v_exp_f32 v234, v234
    v_add_f32 v244, v244, v233
    v_cvt_pk_bf16_f32 v212, v232, v233
    s_nop 0
    v_fma_f32 v232, v188, s21, v240
    v_exp_f32 v235, v235
    v_add_f32 v244, v244, v234
    s_nop 0
    v_fma_f32 v233, v189, s21, v240
    v_exp_f32 v232, v232
    v_add_f32 v244, v244, v235
    v_cvt_pk_bf16_f32 v213, v234, v235
    s_nop 0
    v_fma_f32 v234, v190, s21, v240
    v_exp_f32 v233, v233
    v_add_f32 v244, v244, v232
    s_nop 0
    v_fma_f32 v235, v191, s21, v240
    v_exp_f32 v234, v234
    v_add_f32 v244, v244, v233
    v_cvt_pk_bf16_f32 v214, v232, v233
    s_nop 0
    v_exp_f32 v235, v235
    v_add_f32 v244, v244, v234
    s_nop 0
    v_add_f32 v244, v244, v235
    v_cvt_pk_bf16_f32 v215, v234, v235
    s_nop 0
    s_nop 3
    s_branch L_backs1B
L_raref15B:
    s_nop 7
    v_max3_f32 v247, v160, v161, v162
    v_max3_f32 v247, v247, v163, v164
    v_max3_f32 v247, v247, v165, v166
    v_max3_f32 v247, v247, v167, v168
    v_max3_f32 v247, v247, v169, v170
    v_max3_f32 v247, v247, v171, v172
    v_max3_f32 v247, v247, v173, v174
    v_max_f32 v247, v247, v175
    v_mov_b32 v245, v247
    s_nop 1
    v_permlane32_swap_b32 v245, v247
    s_nop 0
    v_max_f32 v247, v247, v245
    v_mul_f32 v247, s30, v247
    v_min_f32 v247, v247, v239
    v_sub_f32 v248, v247, v239
    v_exp_f32 v248, v248
    v_mov_b32 v239, v247
    v_mul_f32 v241, v241, v248
    v_mul_f32 v0, v0, v248
    v_mul_f32 v1, v1, v248
    v_mul_f32 v2, v2, v248
    v_mul_f32 v3, v3, v248
    v_mul_f32 v4, v4, v248
    v_mul_f32 v5, v5, v248
    v_mul_f32 v6, v6, v248
    v_mul_f32 v7, v7, v248
    v_mul_f32 v8, v8, v248
    v_mul_f32 v9, v9, v248
    v_mul_f32 v10, v10, v248
    v_mul_f32 v11, v11, v248
    v_mul_f32 v12, v12, v248
    v_mul_f32 v13, v13, v248
    v_mul_f32 v14, v14, v248
    v_mul_f32 v15, v15, v248
    v_mul_f32 v16, v16, v248
    v_mul_f32 v17, v17, v248
    v_mul_f32 v18, v18, v248
    v_mul_f32 v19, v19, v248
    v_mul_f32 v20, v20, v248
    v_mul_f32 v21, v21, v248
    v_mul_f32 v22, v22, v248
    v_mul_f32 v23, v23, v248
    v_mul_f32 v24, v24, v248
    v_mul_f32 v25, v25, v248
    v_mul_f32 v26, v26, v248
    v_mul_f32 v27, v27, v248
    v_mul_f32 v28, v28, v248
    v_mul_f32 v29, v29, v248
    v_mul_f32 v30, v30, v248
    v_mul_f32 v31, v31, v248
    v_mul_f32 v32, v32, v248
    v_mul_f32 v33, v33, v248
    v_mul_f32 v34, v34, v248
    v_mul_f32 v35, v35, v248
    v_mul_f32 v36, v36, v248
    v_mul_f32 v37, v37, v248
    v_mul_f32 v38, v38, v248
    v_mul_f32 v39, v39, v248
    v_mul_f32 v40, v40, v248
    v_mul_f32 v41, v41, v248
    v_mul_f32 v42, v42, v248
    v_mul_f32 v43, v43, v248
    v_mul_f32 v44, v44, v248
    v_mul_f32 v45, v45, v248
    v_mul_f32 v46, v46, v248
    v_mul_f32 v47, v47, v248
    v_mul_f32 v48, v48, v248
    v_mul_f32 v49, v49, v248
    v_mul_f32 v50, v50, v248
    v_mul_f32 v51, v51, v248
    v_mul_f32 v52, v52, v248
    v_mul_f32 v53, v53, v248
    v_mul_f32 v54, v54, v248
    v_mul_f32 v55, v55, v248
    v_mul_f32 v56, v56, v248
    v_mul_f32 v57, v57, v248
    v_mul_f32 v58, v58, v248
    v_mul_f32 v59, v59, v248
    v_mul_f32 v60, v60, v248
    v_mul_f32 v61, v61, v248
    v_mul_f32 v62, v62, v248
    v_mul_f32 v63, v63, v248
    v_mul_f32 v64, v64, v248
    v_mul_f32 v65, v65, v248
    v_mul_f32 v66, v66, v248
    v_mul_f32 v67, v67, v248
    v_mul_f32 v68, v68, v248
    v_mul_f32 v69, v69, v248
    v_mul_f32 v70, v70, v248
    v_mul_f32 v71, v71, v248
    v_mul_f32 v72, v72, v248
    v_mul_f32 v73, v73, v248
    v_mul_f32 v74, v74, v248
    v_mul_f32 v75, v75, v248
    v_mul_f32 v76, v76, v248
    v_mul_f32 v77, v77, v248
    v_mul_f32 v78, v78, v248
    v_mul_f32 v79, v79, v248
    v_mul_f32 v80, v80, v248
    v_mul_f32 v81, v81, v248
    v_mul_f32 v82, v82, v248
    v_mul_f32 v83, v83, v248
    v_mul_f32 v84, v84, v248
    v_mul_f32 v85, v85, v248
    v_mul_f32 v86, v86, v248
    v_mul_f32 v87, v87, v248
    v_mul_f32 v88, v88, v248
    v_mul_f32 v89, v89, v248
    v_mul_f32 v90, v90, v248
    v_mul_f32 v91, v91, v248
    v_mul_f32 v92, v92, v248
    v_mul_f32 v93, v93, v248
    v_mul_f32 v94, v94, v248
    v_mul_f32 v95, v95, v248
    v_mul_f32 v96, v96, v248
    v_mul_f32 v97, v97, v248
    v_mul_f32 v98, v98, v248
    v_mul_f32 v99, v99, v248
    v_mul_f32 v100, v100, v248
    v_mul_f32 v101, v101, v248
    v_mul_f32 v102, v102, v248
    v_mul_f32 v103, v103, v248
    v_mul_f32 v104, v104, v248
    v_mul_f32 v105, v105, v248
    v_mul_f32 v106, v106, v248
    v_mul_f32 v107, v107, v248
    v_mul_f32 v108, v108, v248
    v_mul_f32 v109, v109, v248
    v_mul_f32 v110, v110, v248
    v_mul_f32 v111, v111, v248
    v_mul_f32 v112, v112, v248
    v_mul_f32 v113, v113, v248
    v_mul_f32 v114, v114, v248
    v_mul_f32 v115, v115, v248
    v_mul_f32 v116, v116, v248
    v_mul_f32 v117, v117, v248
    v_mul_f32 v118, v118, v248
    v_mul_f32 v119, v119, v248
    v_mul_f32 v120, v120, v248
    v_mul_f32 v121, v121, v248
    v_mul_f32 v122, v122, v248
    v_mul_f32 v123, v123, v248
    v_mul_f32 v124, v124, v248
    v_mul_f32 v125, v125, v248
    v_mul_f32 v126, v126, v248
    v_mul_f32 v127, v127, v248
    v_max3_f32 v247, v176, v177, v178
    v_max3_f32 v247, v247, v179, v180
    v_max3_f32 v247, v247, v181, v182
    v_max3_f32 v247, v247, v183, v184
    v_max3_f32 v247, v247, v185, v186
    v_max3_f32 v247, v247, v187, v188
    v_max3_f32 v247, v247, v189, v190
    v_max_f32 v247, v247, v191
    v_mov_b32 v245, v247
    s_nop 1
    v_permlane32_swap_b32 v245, v247
    s_nop 0
    v_max_f32 v247, v247, v245
    v_mul_f32 v247, s30, v247
    v_min_f32 v247, v247, v240
    v_sub_f32 v248, v247, v240
    v_exp_f32 v248, v248
    v_mov_b32 v240, v247
    v_mul_f32 v242, v242, v248
    v_accvgpr_read_b32 v245, a0
    v_mul_f32 v245, v245, v248
    v_accvgpr_write_b32 a0, v245
    v_accvgpr_read_b32 v245, a1
    v_mul_f32 v245, v245, v248
    v_accvgpr_write_b32 a1, v245
    v_accvgpr_read_b32 v245, a2
    v_mul_f32 v245, v245, v248
    v_accvgpr_write_b32 a2, v245
    v_accvgpr_read_b32 v245, a3
    v_mul_f32 v245, v245, v248
    v_accvgpr_write_b32 a3, v245
    v_accvgpr_read_b32 v245, a4
    v_mul_f32 v245, v245, v248
    v_accvgpr_write_b32 a4, v245
    v_accvgpr_read_b32 v245, a5
    v_mul_f32 v245, v245, v248
    v_accvgpr_write_b32 a5, v245
    v_accvgpr_read_b32 v245, a6
    v_mul_f32 v245, v245, v248
    v_accvgpr_write_b32 a6, v245
    v_accvgpr_read_b32 v245, a7
    v_mul_f32 v245, v245, v248
    v_accvgpr_write_b32 a7, v245
    v_accvgpr_read_b32 v245, a8
    v_mul_f32 v245, v245, v248
    v_accvgpr_write_b32 a8, v245
    v_accvgpr_read_b32 v245, a9
    v_mul_f32 v245, v245, v248
    v_accvgpr_write_b32 a9, v245
    v_accvgpr_read_b32 v245, a10
    v_mul_f32 v245, v245, v248
    v_accvgpr_write_b32 a10, v245
    v_accvgpr_read_b32 v245, a11
    v_mul_f32 v245, v245, v248
    v_accvgpr_write_b32 a11, v245
    v_accvgpr_read_b32 v245, a12
    v_mul_f32 v245, v245, v248
    v_accvgpr_write_b32 a12, v245
    v_accvgpr_read_b32 v245, a13
    v_mul_f32 v245, v245, v248
    v_accvgpr_write_b32 a13, v245
    v_accvgpr_read_b32 v245, a14
    v_mul_f32 v245, v245, v248
    v_accvgpr_write_b32 a14, v245
    v_accvgpr_read_b32 v245, a15
    v_mul_f32 v245, v245, v248
    v_accvgpr_write_b32 a15, v245
    v_accvgpr_read_b32 v245, a16
    v_mul_f32 v245, v245, v248
    v_accvgpr_write_b32 a16, v245
    v_accvgpr_read_b32 v245, a17
    v_mul_f32 v245, v245, v248
    v_accvgpr_write_b32 a17, v245
    v_accvgpr_read_b32 v245, a18
    v_mul_f32 v245, v245, v248
    v_accvgpr_write_b32 a18, v245
    v_accvgpr_read_b32 v245, a19
    v_mul_f32 v245, v245, v248
    v_accvgpr_write_b32 a19, v245
    v_accvgpr_read_b32 v245, a20
    v_mul_f32 v245, v245, v248
    v_accvgpr_write_b32 a20, v245
    v_accvgpr_read_b32 v245, a21
    v_mul_f32 v245, v245, v248
    v_accvgpr_write_b32 a21, v245
    v_accvgpr_read_b32 v245, a22
    v_mul_f32 v245, v245, v248
    v_accvgpr_write_b32 a22, v245
    v_accvgpr_read_b32 v245, a23
    v_mul_f32 v245, v245, v248
    v_accvgpr_write_b32 a23, v245
    v_accvgpr_read_b32 v245, a24
    v_mul_f32 v245, v245, v248
    v_accvgpr_write_b32 a24, v245
    v_accvgpr_read_b32 v245, a25
    v_mul_f32 v245, v245, v248
    v_accvgpr_write_b32 a25, v245
    v_accvgpr_read_b32 v245, a26
    v_mul_f32 v245, v245, v248
    v_accvgpr_write_b32 a26, v245
    v_accvgpr_read_b32 v245, a27
    v_mul_f32 v245, v245, v248
    v_accvgpr_write_b32 a27, v245
    v_accvgpr_read_b32 v245, a28
    v_mul_f32 v245, v245, v248
    v_accvgpr_write_b32 a28, v245
    v_accvgpr_read_b32 v245, a29
    v_mul_f32 v245, v245, v248
    v_accvgpr_write_b32 a29, v245
    v_accvgpr_read_b32 v245, a30
    v_mul_f32 v245, v245, v248
    v_accvgpr_write_b32 a30, v245
    v_accvgpr_read_b32 v245, a31
    v_mul_f32 v245, v245, v248
    v_accvgpr_write_b32 a31, v245
    v_accvgpr_read_b32 v245, a32
    v_mul_f32 v245, v245, v248
    v_accvgpr_write_b32 a32, v245
    v_accvgpr_read_b32 v245, a33
    v_mul_f32 v245, v245, v248
    v_accvgpr_write_b32 a33, v245
    v_accvgpr_read_b32 v245, a34
    v_mul_f32 v245, v245, v248
    v_accvgpr_write_b32 a34, v245
    v_accvgpr_read_b32 v245, a35
    v_mul_f32 v245, v245, v248
    v_accvgpr_write_b32 a35, v245
    v_accvgpr_read_b32 v245, a36
    v_mul_f32 v245, v245, v248
    v_accvgpr_write_b32 a36, v245
    v_accvgpr_read_b32 v245, a37
    v_mul_f32 v245, v245, v248
    v_accvgpr_write_b32 a37, v245
    v_accvgpr_read_b32 v245, a38
    v_mul_f32 v245, v245, v248
    v_accvgpr_write_b32 a38, v245
    v_accvgpr_read_b32 v245, a39
    v_mul_f32 v245, v245, v248
    v_accvgpr_write_b32 a39, v245
    v_accvgpr_read_b32 v245, a40
    v_mul_f32 v245, v245, v248
    v_accvgpr_write_b32 a40, v245
    v_accvgpr_read_b32 v245, a41
    v_mul_f32 v245, v245, v248
    v_accvgpr_write_b32 a41, v245
    v_accvgpr_read_b32 v245, a42
    v_mul_f32 v245, v245, v248
    v_accvgpr_write_b32 a42, v245
    v_accvgpr_read_b32 v245, a43
    v_mul_f32 v245, v245, v248
    v_accvgpr_write_b32 a43, v245
    v_accvgpr_read_b32 v245, a44
    v_mul_f32 v245, v245, v248
    v_accvgpr_write_b32 a44, v245
    v_accvgpr_read_b32 v245, a45
    v_mul_f32 v245, v245, v248
    v_accvgpr_write_b32 a45, v245
    v_accvgpr_read_b32 v245, a46
    v_mul_f32 v245, v245, v248
    v_accvgpr_write_b32 a46, v245
    v_accvgpr_read_b32 v245, a47
    v_mul_f32 v245, v245, v248
    v_accvgpr_write_b32 a47, v245
    v_accvgpr_read_b32 v245, a48
    v_mul_f32 v245, v245, v248
    v_accvgpr_write_b32 a48, v245
    v_accvgpr_read_b32 v245, a49
    v_mul_f32 v245, v245, v248
    v_accvgpr_write_b32 a49, v245
    v_accvgpr_read_b32 v245, a50
    v_mul_f32 v245, v245, v248
    v_accvgpr_write_b32 a50, v245
    v_accvgpr_read_b32 v245, a51
    v_mul_f32 v245, v245, v248
    v_accvgpr_write_b32 a51, v245
    v_accvgpr_read_b32 v245, a52
    v_mul_f32 v245, v245, v248
    v_accvgpr_write_b32 a52, v245
    v_accvgpr_read_b32 v245, a53
    v_mul_f32 v245, v245, v248
    v_accvgpr_write_b32 a53, v245
    v_accvgpr_read_b32 v245, a54
    v_mul_f32 v245, v245, v248
    v_accvgpr_write_b32 a54, v245
    v_accvgpr_read_b32 v245, a55
    v_mul_f32 v245, v245, v248
    v_accvgpr_write_b32 a55, v245
    v_accvgpr_read_b32 v245, a56
    v_mul_f32 v245, v245, v248
    v_accvgpr_write_b32 a56, v245
    v_accvgpr_read_b32 v245, a57
    v_mul_f32 v245, v245, v248
    v_accvgpr_write_b32 a57, v245
    v_accvgpr_read_b32 v245, a58
    v_mul_f32 v245, v245, v248
    v_accvgpr_write_b32 a58, v245
    v_accvgpr_read_b32 v245, a59
    v_mul_f32 v245, v245, v248
    v_accvgpr_write_b32 a59, v245
    v_accvgpr_read_b32 v245, a60
    v_mul_f32 v245, v245, v248
    v_accvgpr_write_b32 a60, v245
    v_accvgpr_read_b32 v245, a61
    v_mul_f32 v245, v245, v248
    v_accvgpr_write_b32 a61, v245
    v_accvgpr_read_b32 v245, a62
    v_mul_f32 v245, v245, v248
    v_accvgpr_write_b32 a62, v245
    v_accvgpr_read_b32 v245, a63
    v_mul_f32 v245, v245, v248
    v_accvgpr_write_b32 a63, v245
    v_accvgpr_read_b32 v245, a64
    v_mul_f32 v245, v245, v248
    v_accvgpr_write_b32 a64, v245
    v_accvgpr_read_b32 v245, a65
    v_mul_f32 v245, v245, v248
    v_accvgpr_write_b32 a65, v245
    v_accvgpr_read_b32 v245, a66
    v_mul_f32 v245, v245, v248
    v_accvgpr_write_b32 a66, v245
    v_accvgpr_read_b32 v245, a67
    v_mul_f32 v245, v245, v248
    v_accvgpr_write_b32 a67, v245
    v_accvgpr_read_b32 v245, a68
    v_mul_f32 v245, v245, v248
    v_accvgpr_write_b32 a68, v245
    v_accvgpr_read_b32 v245, a69
    v_mul_f32 v245, v245, v248
    v_accvgpr_write_b32 a69, v245
    v_accvgpr_read_b32 v245, a70
    v_mul_f32 v245, v245, v248
    v_accvgpr_write_b32 a70, v245
    v_accvgpr_read_b32 v245, a71
    v_mul_f32 v245, v245, v248
    v_accvgpr_write_b32 a71, v245
    v_accvgpr_read_b32 v245, a72
    v_mul_f32 v245, v245, v248
    v_accvgpr_write_b32 a72, v245
    v_accvgpr_read_b32 v245, a73
    v_mul_f32 v245, v245, v248
    v_accvgpr_write_b32 a73, v245
    v_accvgpr_read_b32 v245, a74
    v_mul_f32 v245, v245, v248
    v_accvgpr_write_b32 a74, v245
    v_accvgpr_read_b32 v245, a75
    v_mul_f32 v245, v245, v248
    v_accvgpr_write_b32 a75, v245
    v_accvgpr_read_b32 v245, a76
    v_mul_f32 v245, v245, v248
    v_accvgpr_write_b32 a76, v245
    v_accvgpr_read_b32 v245, a77
    v_mul_f32 v245, v245, v248
    v_accvgpr_write_b32 a77, v245
    v_accvgpr_read_b32 v245, a78
    v_mul_f32 v245, v245, v248
    v_accvgpr_write_b32 a78, v245
    v_accvgpr_read_b32 v245, a79
    v_mul_f32 v245, v245, v248
    v_accvgpr_write_b32 a79, v245
    v_accvgpr_read_b32 v245, a80
    v_mul_f32 v245, v245, v248
    v_accvgpr_write_b32 a80, v245
    v_accvgpr_read_b32 v245, a81
    v_mul_f32 v245, v245, v248
    v_accvgpr_write_b32 a81, v245
    v_accvgpr_read_b32 v245, a82
    v_mul_f32 v245, v245, v248
    v_accvgpr_write_b32 a82, v245
    v_accvgpr_read_b32 v245, a83
    v_mul_f32 v245, v245, v248
    v_accvgpr_write_b32 a83, v245
    v_accvgpr_read_b32 v245, a84
    v_mul_f32 v245, v245, v248
    v_accvgpr_write_b32 a84, v245
    v_accvgpr_read_b32 v245, a85
    v_mul_f32 v245, v245, v248
    v_accvgpr_write_b32 a85, v245
    v_accvgpr_read_b32 v245, a86
    v_mul_f32 v245, v245, v248
    v_accvgpr_write_b32 a86, v245
    v_accvgpr_read_b32 v245, a87
    v_mul_f32 v245, v245, v248
    v_accvgpr_write_b32 a87, v245
    v_accvgpr_read_b32 v245, a88
    v_mul_f32 v245, v245, v248
    v_accvgpr_write_b32 a88, v245
    v_accvgpr_read_b32 v245, a89
    v_mul_f32 v245, v245, v248
    v_accvgpr_write_b32 a89, v245
    v_accvgpr_read_b32 v245, a90
    v_mul_f32 v245, v245, v248
    v_accvgpr_write_b32 a90, v245
    v_accvgpr_read_b32 v245, a91
    v_mul_f32 v245, v245, v248
    v_accvgpr_write_b32 a91, v245
    v_accvgpr_read_b32 v245, a92
    v_mul_f32 v245, v245, v248
    v_accvgpr_write_b32 a92, v245
    v_accvgpr_read_b32 v245, a93
    v_mul_f32 v245, v245, v248
    v_accvgpr_write_b32 a93, v245
    v_accvgpr_read_b32 v245, a94
    v_mul_f32 v245, v245, v248
    v_accvgpr_write_b32 a94, v245
    v_accvgpr_read_b32 v245, a95
    v_mul_f32 v245, v245, v248
    v_accvgpr_write_b32 a95, v245
    v_accvgpr_read_b32 v245, a96
    v_mul_f32 v245, v245, v248
    v_accvgpr_write_b32 a96, v245
    v_accvgpr_read_b32 v245, a97
    v_mul_f32 v245, v245, v248
    v_accvgpr_write_b32 a97, v245
    v_accvgpr_read_b32 v245, a98
    v_mul_f32 v245, v245, v248
    v_accvgpr_write_b32 a98, v245
    v_accvgpr_read_b32 v245, a99
    v_mul_f32 v245, v245, v248
    v_accvgpr_write_b32 a99, v245
    v_accvgpr_read_b32 v245, a100
    v_mul_f32 v245, v245, v248
    v_accvgpr_write_b32 a100, v245
    v_accvgpr_read_b32 v245, a101
    v_mul_f32 v245, v245, v248
    v_accvgpr_write_b32 a101, v245
    v_accvgpr_read_b32 v245, a102
    v_mul_f32 v245, v245, v248
    v_accvgpr_write_b32 a102, v245
    v_accvgpr_read_b32 v245, a103
    v_mul_f32 v245, v245, v248
    v_accvgpr_write_b32 a103, v245
    v_accvgpr_read_b32 v245, a104
    v_mul_f32 v245, v245, v248
    v_accvgpr_write_b32 a104, v245
    v_accvgpr_read_b32 v245, a105
    v_mul_f32 v245, v245, v248
    v_accvgpr_write_b32 a105, v245
    v_accvgpr_read_b32 v245, a106
    v_mul_f32 v245, v245, v248
    v_accvgpr_write_b32 a106, v245
    v_accvgpr_read_b32 v245, a107
    v_mul_f32 v245, v245, v248
    v_accvgpr_write_b32 a107, v245
    v_accvgpr_read_b32 v245, a108
    v_mul_f32 v245, v245, v248
    v_accvgpr_write_b32 a108, v245
    v_accvgpr_read_b32 v245, a109
    v_mul_f32 v245, v245, v248
    v_accvgpr_write_b32 a109, v245
    v_accvgpr_read_b32 v245, a110
    v_mul_f32 v245, v245, v248
    v_accvgpr_write_b32 a110, v245
    v_accvgpr_read_b32 v245, a111
    v_mul_f32 v245, v245, v248
    v_accvgpr_write_b32 a111, v245
    v_accvgpr_read_b32 v245, a112
    v_mul_f32 v245, v245, v248
    v_accvgpr_write_b32 a112, v245
    v_accvgpr_read_b32 v245, a113
    v_mul_f32 v245, v245, v248
    v_accvgpr_write_b32 a113, v245
    v_accvgpr_read_b32 v245, a114
    v_mul_f32 v245, v245, v248
    v_accvgpr_write_b32 a114, v245
    v_accvgpr_read_b32 v245, a115
    v_mul_f32 v245, v245, v248
    v_accvgpr_write_b32 a115, v245
    v_accvgpr_read_b32 v245, a116
    v_mul_f32 v245, v245, v248
    v_accvgpr_write_b32 a116, v245
    v_accvgpr_read_b32 v245, a117
    v_mul_f32 v245, v245, v248
    v_accvgpr_write_b32 a117, v245
    v_accvgpr_read_b32 v245, a118
    v_mul_f32 v245, v245, v248
    v_accvgpr_write_b32 a118, v245
    v_accvgpr_read_b32 v245, a119
    v_mul_f32 v245, v245, v248
    v_accvgpr_write_b32 a119, v245
    v_accvgpr_read_b32 v245, a120
    v_mul_f32 v245, v245, v248
    v_accvgpr_write_b32 a120, v245
    v_accvgpr_read_b32 v245, a121
    v_mul_f32 v245, v245, v248
    v_accvgpr_write_b32 a121, v245
    v_accvgpr_read_b32 v245, a122
    v_mul_f32 v245, v245, v248
    v_accvgpr_write_b32 a122, v245
    v_accvgpr_read_b32 v245, a123
    v_mul_f32 v245, v245, v248
    v_accvgpr_write_b32 a123, v245
    v_accvgpr_read_b32 v245, a124
    v_mul_f32 v245, v245, v248
    v_accvgpr_write_b32 a124, v245
    v_accvgpr_read_b32 v245, a125
    v_mul_f32 v245, v245, v248
    v_accvgpr_write_b32 a125, v245
    v_accvgpr_read_b32 v245, a126
    v_mul_f32 v245, v245, v248
    v_accvgpr_write_b32 a126, v245
    v_accvgpr_read_b32 v245, a127
    v_mul_f32 v245, v245, v248
    v_accvgpr_write_b32 a127, v245
    v_fma_f32 v232, v160, s21, v239
    s_nop 0
    v_fma_f32 v233, v161, s21, v239
    v_exp_f32 v232, v232
    s_nop 0
    v_fma_f32 v234, v162, s21, v239
    v_exp_f32 v233, v233
    s_nop 0
    v_fma_f32 v235, v163, s21, v239
    v_exp_f32 v234, v234
    v_add_f32 v243, v232, v233
    v_cvt_pk_bf16_f32 v200, v232, v233
    s_nop 0
    v_fma_f32 v232, v164, s21, v239
    v_exp_f32 v235, v235
    v_add_f32 v243, v243, v234
    s_nop 0
    v_fma_f32 v233, v165, s21, v239
    v_exp_f32 v232, v232
    v_add_f32 v243, v243, v235
    v_cvt_pk_bf16_f32 v201, v234, v235
    s_nop 0
    v_fma_f32 v234, v166, s21, v239
    v_exp_f32 v233, v233
    v_add_f32 v243, v243, v232
    s_nop 0
    v_fma_f32 v235, v167, s21, v239
    v_exp_f32 v234, v234
    v_add_f32 v243, v243, v233
    v_cvt_pk_bf16_f32 v202, v232, v233
    s_nop 0
    v_fma_f32 v232, v176, s21, v240
    v_exp_f32 v235, v235
    v_add_f32 v243, v243, v234
    s_nop 0
    v_fma_f32 v233, v177, s21, v240
    v_exp_f32 v232, v232
    v_add_f32 v243, v243, v235
    v_cvt_pk_bf16_f32 v203, v234, v235
    s_nop 0
    v_fma_f32 v234, v178, s21, v240
    v_exp_f32 v233, v233
    s_nop 0
    v_fma_f32 v235, v179, s21, v240
    v_exp_f32 v234, v234
    v_add_f32 v244, v232, v233
    v_cvt_pk_bf16_f32 v204, v232, v233
    s_nop 0
    v_fma_f32 v232, v180, s21, v240
    v_exp_f32 v235, v235
    v_add_f32 v244, v244, v234
    s_nop 0
    v_fma_f32 v233, v181, s21, v240
    v_exp_f32 v232, v232
    v_add_f32 v244, v244, v235
    v_cvt_pk_bf16_f32 v205, v234, v235
    s_nop 0
    v_fma_f32 v234, v182, s21, v240
    v_exp_f32 v233, v233
    v_add_f32 v244, v244, v232
    s_nop 0
    v_fma_f32 v235, v183, s21, v240
    v_exp_f32 v234, v234
    v_add_f32 v244, v244, v233
    v_cvt_pk_bf16_f32 v206, v232, v233
    s_nop 0
    v_fma_f32 v232, v168, s21, v239
    v_exp_f32 v235, v235
    v_add_f32 v244, v244, v234
    s_nop 0
    v_fma_f32 v233, v169, s21, v239
    v_exp_f32 v232, v232
    v_add_f32 v244, v244, v235
    v_cvt_pk_bf16_f32 v207, v234, v235
    s_nop 0
    v_fma_f32 v234, v170, s21, v239
    v_exp_f32 v233, v233
    v_add_f32 v243, v243, v232
    s_nop 0
    v_fma_f32 v235, v171, s21, v239
    v_exp_f32 v234, v234
    v_add_f32 v243, v243, v233
    v_cvt_pk_bf16_f32 v208, v232, v233
    s_nop 0
    v_fma_f32 v232, v172, s21, v239
    v_exp_f32 v235, v235
    v_add_f32 v243, v243, v234
    s_nop 0
    v_fma_f32 v233, v173, s21, v239
    v_exp_f32 v232, v232
    v_add_f32 v243, v243, v235
    v_cvt_pk_bf16_f32 v209, v234, v235
    s_nop 0
    v_fma_f32 v234, v174, s21, v239
    v_exp_f32 v233, v233
    v_add_f32 v243, v243, v232
    s_nop 0
    v_fma_f32 v235, v175, s21, v239
    v_exp_f32 v234, v234
    v_add_f32 v243, v243, v233
    v_cvt_pk_bf16_f32 v210, v232, v233
    s_nop 0
    v_fma_f32 v232, v184, s21, v240
    v_exp_f32 v235, v235
    v_add_f32 v243, v243, v234
    s_nop 0
    v_fma_f32 v233, v185, s21, v240
    v_exp_f32 v232, v232
    v_add_f32 v243, v243, v235
    v_cvt_pk_bf16_f32 v211, v234, v235
    s_nop 0
    v_fma_f32 v234, v186, s21, v240
    v_exp_f32 v233, v233
    v_add_f32 v244, v244, v232
    s_nop 0
    v_fma_f32 v235, v187, s21, v240
    v_exp_f32 v234, v234
    v_add_f32 v244, v244, v233
    v_cvt_pk_bf16_f32 v212, v232, v233
    s_nop 0
    v_fma_f32 v232, v188, s21, v240
    v_exp_f32 v235, v235
    v_add_f32 v244, v244, v234
    s_nop 0
    v_fma_f32 v233, v189, s21, v240
    v_exp_f32 v232, v232
    v_add_f32 v244, v244, v235
    v_cvt_pk_bf16_f32 v213, v234, v235
    s_nop 0
    v_fma_f32 v234, v190, s21, v240
    v_exp_f32 v233, v233
    v_add_f32 v244, v244, v232
    s_nop 0
    v_fma_f32 v235, v191, s21, v240
    v_exp_f32 v234, v234
    v_add_f32 v244, v244, v233
    v_cvt_pk_bf16_f32 v214, v232, v233
    s_nop 0
    v_exp_f32 v235, v235
    v_add_f32 v244, v244, v234
    s_nop 0
    v_add_f32 v244, v244, v235
    v_cvt_pk_bf16_f32 v215, v234, v235
    s_nop 0
    s_nop 3
    s_branch L_backf15B
    s_endpgm
.section .rodata,"a"
.p2align 6
.amdhsa_kernel standalone__mha_softmax__near_ridge_kernel
  .amdhsa_next_free_vgpr 512
  .amdhsa_next_free_sgpr 96
  .amdhsa_accum_offset 256
  .amdhsa_group_segment_fixed_size 0
  .amdhsa_kernarg_size 48
  .amdhsa_user_sgpr_count 2
  .amdhsa_user_sgpr_kernarg_segment_ptr 1
  .amdhsa_system_sgpr_workgroup_id_x 1
.end_amdhsa_kernel
```
